```python
import torch

def _softmax(x, axis=-1):
    return torch.softmax(x, dim=axis)
def _gelu(x):
    return torch.nn.functional.gelu(x, approximate="tanh")
def _silu(x):
    return torch.nn.functional.silu(x)
def _sigmoid(x):
    return torch.sigmoid(x)
def _layernorm(x, axis=-1, eps=1e-5):
    m = x.mean(dim=axis, keepdim=True)
    v = x.var(dim=axis, keepdim=True, unbiased=False)
    return (x - m) / torch.sqrt(v + eps)
def _scatter_add(tgt, idx, src, axis=0):
    return tgt.clone().index_add_(axis, idx, src)
def _segment_sum(src, seg, n):
    out = torch.zeros((n,) + src.shape[1:], dtype=src.dtype)
    return out.index_add_(0, seg, src)
def _pad(x, pw):
    flat = tuple(v for pair in reversed(pw) for v in pair)
    return torch.nn.functional.pad(x, flat)

kernel_name = 'standalone__seq2seq_rnn_t_joint__speech'

def setup_inputs():

    _w = (lambda a: (lambda t: t.to(torch.bfloat16) if t.is_floating_point() else t)(torch.as_tensor(a)))
    B, T, D, K = 2, 16000, 256, 15
    U = 8
    sc = (1.0 / (K * D)) ** 0.5
    sd = (1.0 / D) ** 0.5
    return {
        "x": _w((lambda *s: torch.randn(*s, dtype=torch.bfloat16) * 0.2)(B, T, D) * 0.5),
        "w1": _w((lambda *s: torch.randn(*s, dtype=torch.bfloat16) * 3.2)(K, D, D) * sc),
        "w2": _w((lambda *s: torch.randn(*s, dtype=torch.bfloat16) * 3.2)(K, D, D) * sc),
        "g": _w((lambda *s: torch.randn(*s, dtype=torch.bfloat16) * 3.2)(B, U, D) * 0.5),
        "w_f": _w((lambda *s: torch.randn(*s, dtype=torch.bfloat16) * 3.2)(D, D) * sd),
        "w_g": _w((lambda *s: torch.randn(*s, dtype=torch.bfloat16) * 3.2)(D, D) * sd),
        "w_o": _w((lambda *s: torch.randn(*s, dtype=torch.bfloat16) * 3.2)(D, D) * sd),
    }

def reference(x, w1, w2, g, w_f, w_g, w_o):
    B, T, D = x.shape
    K = w1.shape[0]
    pad = K // 2
    xp = _pad(x, ((0,0),(pad,pad),(0,0)))
    h = torch.zeros_like(x)
    for i in range(K):
        h = h + torch.einsum("btc,cd->btd", xp[:, i:i+T, :], w1[i])
    h = _gelu(h)[:, ::2, :]
    T1 = h.shape[1]
    hp = _pad(h, ((0,0),(pad,pad),(0,0)))
    f = torch.zeros_like(h)
    for i in range(K):
        f = f + torch.einsum("btc,cd->btd", hp[:, i:i+T1, :], w2[i])
    f = _gelu(f)[:, ::2, :]
    fe = torch.einsum("btd,de->bte", f, w_f)
    ge = torch.einsum("bud,de->bue", g, w_g)
    j = torch.tanh(fe[:, :, None, :] + ge[:, None, :, :])
    return torch.einsum("btud,dv->btuv", j, w_o)
```

```asm
; @launch grid=(256,1,1) block=(256,1,1) lds=163840
.amdgcn_target "amdgcn-amd-amdhsa--gfx950"
.text
.text
.globl standalone__seq2seq_rnn_t_joint__speech_kernel
.p2align 8
.type standalone__seq2seq_rnn_t_joint__speech_kernel,@function
standalone__seq2seq_rnn_t_joint__speech_kernel:
    s_cmp_ge_u32 s2, 256
    s_cbranch_scc1 L_end
    s_load_dwordx16 s[4:19], s[0:1], 0
    s_load_dwordx4 s[20:23], s[0:1], 64
    s_memrealtime s[62:63]
    s_getpc_b64 s[78:79]
L_pc:
    v_lshrrev_b32 v158, 6, v0
    s_lshr_b32 s56, s2, 3
    v_and_b32 v0, 63, v0
    v_readfirstlane_b32 s48, v158
    v_and_b32 v152, 3, v0
    s_and_b32 s55, s2, 7
    s_lshl2_add_u32 s58, s56, s48
    s_lshl_b32 s58, s58, 9
    v_lshl_add_u32 v153, v152, 7, s58
    global_load_dword v159, v153, s[78:79]
    s_lshr_b32 s58, s58, 2
    s_add_u32 s78, s78, s58
    s_addc_u32 s79, s79, 0
    s_and_b32 s49, s56, 3
    s_lshr_b32 s56, s56, 2
    s_lshl_b32 s55, s55, 3
    s_add_u32 s50, s55, s56
    s_lshr_b32 s51, s50, 5
    s_and_b32 s52, s50, 31
    s_mul_i32 s57, s52, 500
    s_sub_u32 s57, s57, 7
    s_lshl_b32 s57, s57, 9
    s_mov_b32 s26, 8192000
    s_mov_b32 s27, 0x20000
    s_mov_b32 s30, 1966080
    s_mov_b32 s31, 0x20000
    v_lshrrev_b32 v154, 4, v0
    s_lshl_b32 s53, s48, 10
    s_lshl_b32 s61, s49, 7
    s_lshl_b32 s68, s48, 1
    s_lshl_b32 s69, s48, 14
    s_add_u32 s69, s69, s57
    v_and_b32 v152, 7, v0
    v_xor_b32 v143, s68, v152
    v_lshlrev_b32 v142, 11, v154
    v_lshl_add_u32 v143, v143, 4, v142
    v_add_u32 v143, s69, v143
    v_bfe_u32 v156, v0, 3, 1
    v_lshl_add_u32 v2, v156, 10, v143
    v_xor_b32 v158, 1, v156
    v_lshl_add_u32 v158, v158, 10, v143
    v_add_u32 v3, 65536, v158
    v_add_u32 v4, 131072, v2
    v_add_u32 v5, 196608, v158
    v_add_u32 v6, 8192, v2
    v_add_u32 v7, 73728, v158
    v_add_u32 v8, 139264, v2
    v_add_u32 v9, 204800, v158
    v_lshl_add_u32 v157, v152, 4, v142
    v_lshl_add_u32 v157, v156, 10, v157
    s_add_u32 s60, s57, 262144
    v_add_u32 v10, s60, v157
    v_add_u32 v11, 512, v2
    v_lshrrev_b32 v157, 3, v0
    s_lshl_b32 s60, s48, 12
    s_add_u32 s60, s60, s61
    v_lshlrev_b32 v151, 9, v157
    v_add_u32 v151, s60, v151
    s_and_b32 s60, s48, 1
    s_lshl_b32 s60, s60, 1
    v_and_b32 v150, 1, v154
    v_or_b32 v150, s60, v150
    v_bfe_u32 v149, v0, 1, 2
    v_xor_b32 v150, v150, v149
    v_lshl_add_u32 v151, v150, 5, v151
    v_and_b32 v150, 1, v0
    v_lshl_add_u32 v32, v150, 4, v151
    s_lshl_b32 s54, s48, 11
    s_mul_i32 s60, s51, 8192000
    s_waitcnt lgkmcnt(0)
    s_add_u32 s24, s4, s60
    s_addc_u32 s25, s5, 0
    s_mov_b32 s28, s6
    s_mov_b32 s29, s7
    s_add_u32 m0, s54, 0
    s_nop 0
    buffer_load_dwordx4 v2, s[24:27], 0 offen  lds
    v_mov_b32 v37, 2147483648
    s_lshl2_add_u32 s60, s49, s48
    s_mul_i32 s60, s60, 17408
    s_add_u32 s60, s60, s57
    v_cmp_gt_u32 vcc, 17, v0
    v_lshl_add_u32 v149, v0, 10, s60
    s_lshl2_add_u32 s60, s56, s48
    s_lshr_b32 s59, s60, 2
    v_cndmask_b32 v34, v37, v149, vcc
    s_lshl_b32 s59, s59, 18
    s_lshl_b32 s60, s48, 13
    s_add_u32 s59, s59, s60
    s_add_u32 s59, s59, s61
    v_cmp_gt_u32 vcc, 16, v0
    v_lshl_add_u32 v149, v0, 9, s59
    s_nop 0
    s_add_u32 m0, s54, 8192
    s_nop 0
    buffer_load_dwordx4 v3, s[24:27], 0 offen  lds
    v_cndmask_b32 v147, v37, v149, vcc
    s_mov_b32 s43, 0x20000
    v_lshrrev_b32 v149, 3, v0
    v_and_b32 v150, 7, v0
    v_lshlrev_b32 v149, 9, v149
    v_lshl_add_u32 v149, v150, 4, v149
    s_lshl_b32 s60, s48, 12
    v_add_u32 v104, s60, v149
    s_mov_b32 s66, 1.0
    s_cmp_lt_u32 s2, 192
    s_cbranch_scc0 L_t1b
    s_mul_i32 s56, s2, 1366
    s_lshr_b32 s56, s56, 16
    s_mul_i32 s58, s56, 48
    s_sub_u32 s58, s2, s58
    s_lshl_b32 s65, s56, 7
    s_lshl2_add_u32 s56, s56, s48
    s_lshr_b32 s59, s58, 3
    s_bfe_u32 s60, s58, 0x10002
    s_and_b32 s55, s58, 3
    s_lshl2_add_u32 s64, s55, s60
    s_lshl_b32 s64, s64, 3
    s_add_u32 s64, s64, s59
    s_add_u32 s64, s64, 2
    s_lshl_b32 s64, s64, 14
    s_add_u32 s64, s64, s65
    s_add_u32 s65, s64, 262144
    s_mov_b32 s40, s6
    s_mov_b32 s41, s7
    s_mov_b32 s42, 1966080
    s_branch L_t1c
L_t1b:
    s_and_b32 s58, s2, 7
    s_bfe_u32 s59, s2, 0x20003
    s_lshl2_add_u32 s56, s59, s48
    s_lshl_b32 s64, s58, 14
    s_lshl_b32 s60, s59, 7
    s_add_u32 s64, s64, s60
    s_mov_b32 s65, 2147483648
    s_mov_b32 s42, 131072
    s_cmp_lt_u32 s2, 224
    s_cselect_b32 s40, s14, s16
    s_cselect_b32 s41, s15, s17
    s_cselect_b32 s66, 1.0, -2.0
L_t1c:
    s_add_u32 m0, s54, 16384
    s_nop 0
    buffer_load_dwordx4 v4, s[24:27], 0 offen  lds
    s_add_u32 m0, s54, 24576
    s_nop 0
    buffer_load_dwordx4 v5, s[24:27], 0 offen  lds
    s_add_u32 m0, s53, 34816
    s_nop 0
    buffer_load_dwordx4 v104, s[40:43], s64 offen  lds
    s_add_u32 m0, s53, 38912
    s_nop 0
    buffer_load_dwordx4 v104, s[40:43], s65 offen  lds
    s_mov_b32 s36, s22
    s_mov_b32 s37, s23
    s_add_u32 m0, s53, 69632
    s_mov_b32 s55, 0
    buffer_load_dwordx4 v32, s[28:31], s55 offen  lds
    s_mov_b32 s38, 26476544
    s_mov_b32 s39, 0x20000
    s_mov_b32 s44, s20
    s_mov_b32 s45, s21
    s_mov_b32 s46, 256
    s_mov_b32 s47, 0x20000
    v_cmp_eq_u32 vcc, 0, v0
    v_mov_b32 v149, 0
    s_lshl_b32 s62, s62, 2
    s_or_b32 s62, s62, 2
    v_cndmask_b32 v39, v37, v149, vcc
    v_mov_b32 v148, s62
    s_lshl_b32 s63, s48, 3
    s_add_u32 s63, s63, s2
    s_cmp_lt_u32 s63, 8
    s_cselect_b32 s63, 0, 2147483648
    s_add_u32 m0, s53, 73728
    s_mov_b32 s55, 262144
    buffer_load_dwordx4 v32, s[28:31], s55 offen  lds
    s_mov_b32 s3, s63
    v_mov_b32 v140, v148
    v_mov_b32 v141, 0
    v_lshlrev_b32 v36, 4, v0
    s_cmp_lt_u32 s2, 192
    s_cbranch_scc0 L_t2b
    s_lshl_b32 s67, s56, 10
    s_lshl_b32 s63, s58, 4
    s_add_u32 s67, s67, s63
    s_add_u32 s67, s67, 15056896
    s_and_b32 s63, s59, 1
    s_and_b32 s59, s59, 6
    s_bfe_u32 s60, s58, 0x10002
    s_add_u32 s59, s59, s60
    s_lshl_b32 s59, s59, 1
    s_add_u32 s59, s59, s63
    s_mul_i32 s59, s59, 12288
    s_mul_i32 s63, s56, 147456
    s_add_u32 s63, s63, s59
    s_and_b32 s55, s58, 3
    s_lshl_b32 s55, s55, 10
    s_add_u32 s63, s63, s55
    s_add_u32 s63, s63, 15138816
    s_add_u32 s62, s63, 4096
    s_branch L_t2c
L_t2b:
    s_lshl_b32 s56, s56, 3
    s_add_u32 s56, s56, s58
    s_lshl_b32 s62, s56, 10
    s_lshl_b32 s67, s56, 4
    s_mov_b32 s63, 2147483648
    s_cmp_lt_u32 s2, 224
    s_cselect_b32 s56, 10354688, s63
    s_cselect_b32 s58, 15091712, s63
    s_cbranch_scc1 L_t2d
    s_mov_b32 s56, 14811136
    s_mov_b32 s58, 15089664
L_t2d:
    s_add_u32 s62, s62, s56
    s_add_u32 s67, s67, s58
L_t2c:
    s_add_u32 m0, s53, 77824
    s_mov_b32 s55, 524288
    buffer_load_dwordx4 v32, s[28:31], s55 offen  lds
    s_add_u32 m0, s53, 81920
    s_mov_b32 s55, 786432
    buffer_load_dwordx4 v32, s[28:31], s55 offen  lds
    s_add_u32 s69, s63, 8192
    v_lshlrev_b32 v150, 10, v154
    v_and_b32 v149, 3, v0
    v_lshl_add_u32 v151, v149, 1, v150
    v_bfe_u32 v149, v0, 2, 1
    v_lshl_add_u32 v144, v149, 4, v151
    v_bfe_u32 v149, v0, 3, 1
    s_add_u32 m0, s53, 86016
    s_mov_b32 s55, 1048576
    buffer_load_dwordx4 v32, s[28:31], s55 offen  lds
    v_lshl_add_u32 v144, v149, 3, v144
    s_lshl_b32 s56, s48, 5
    v_add_u32 v144, s56, v144
    v_and_b32 v149, 15, v0
    v_lshl_add_u32 v150, v149, 3, v150
    s_lshl_b32 s56, s48, 1
    v_add_u32 v150, s56, v150
    s_cmp_lt_u32 s2, 224
    s_cselect_b64 vcc, -1, 0
    v_bfe_u32 v149, v0, 2, 2
    v_cndmask_b32 v145, v150, v144, vcc
    v_lshl_add_u32 v155, v149, 4, v151
    s_lshr_b32 s56, s48, 1
    s_lshl_b32 s56, s56, 6
    s_and_b32 s58, s48, 1
    s_lshl_b32 s58, s58, 3
    s_add_u32 m0, s53, 90112
    s_mov_b32 s55, 1310720
    buffer_load_dwordx4 v32, s[28:31], s55 offen  lds
    s_add_u32 s56, s56, s58
    s_add_u32 s56, s56, 139264
    v_add_u32 v155, s56, v155
    s_mov_b32 s70, 128
    s_mov_b32 s71, 256
    s_mov_b32 s72, 384
    s_mov_b32 s73, 512
    s_mov_b32 s74, 640
    s_mov_b32 s75, 768
    s_mov_b32 s76, 896
    v_and_b32 v152, 15, v0
    v_lshlrev_b32 v142, 11, v152
    v_lshlrev_b32 v143, 10, v152
    v_add_u32 v143, 104448, v143
    v_add_u32 v156, 0, v152
    v_and_b32 v156, 7, v156
    s_add_u32 m0, s53, 94208
    s_mov_b32 s55, 1572864
    buffer_load_dwordx4 v32, s[28:31], s55 offen  lds
    v_lshlrev_b32 v156, 1, v156
    v_xor_b32 v156, v156, v154
    v_xor_b32 v157, 0, v156
    v_lshl_add_u32 v12, v157, 4, v142
    v_lshl_add_u32 v20, v157, 4, v143
    v_xor_b32 v157, 4, v156
    v_lshl_add_u32 v16, v157, 4, v142
    v_lshl_add_u32 v24, v157, 4, v143
    v_xor_b32 v157, 8, v156
    v_lshl_add_u32 v14, v157, 4, v142
    v_lshl_add_u32 v22, v157, 4, v143
    v_xor_b32 v157, 12, v156
    v_lshl_add_u32 v18, v157, 4, v142
    v_lshl_add_u32 v26, v157, 4, v143
    v_add_u32 v156, 1, v152
    v_and_b32 v156, 7, v156
    s_add_u32 m0, s53, 98304
    s_mov_b32 s55, 1835008
    buffer_load_dwordx4 v32, s[28:31], s55 offen  lds
    v_lshlrev_b32 v156, 1, v156
    v_xor_b32 v156, v156, v154
    v_xor_b32 v157, 0, v156
    v_lshl_add_u32 v13, v157, 4, v142
    v_lshl_add_u32 v21, v157, 4, v143
    v_xor_b32 v157, 4, v156
    v_lshl_add_u32 v17, v157, 4, v142
    v_lshl_add_u32 v25, v157, 4, v143
    v_xor_b32 v157, 8, v156
    v_lshl_add_u32 v15, v157, 4, v142
    v_lshl_add_u32 v23, v157, 4, v143
    v_xor_b32 v157, 12, v156
    v_lshl_add_u32 v19, v157, 4, v142
    v_lshl_add_u32 v27, v157, 4, v143
    v_bfe_u32 v156, v0, 2, 2
    v_lshl_add_u32 v157, v154, 3, v156
    s_mov_b32 m0, 32768
    s_nop 0
    buffer_load_dwordx4 v10, s[24:27], 0 offen  lds
    v_lshlrev_b32 v157, 7, v157
    v_lshrrev_b32 v156, 1, v156
    v_and_b32 v158, 1, v154
    v_lshl_or_b32 v156, v158, 1, v156
    v_xor_b32 v156, s48, v156
    v_lshl_add_u32 v157, v156, 5, v157
    v_and_b32 v156, 1, v0
    v_lshl_add_u32 v157, v156, 4, v157
    v_bfe_u32 v156, v0, 1, 1
    v_lshl_add_u32 v157, v156, 3, v157
    v_add_u32 v33, 69632, v157
    v_add_u32 v35, 135168, v157
    v_and_b32 v156, 7, v0
    v_lshlrev_b32 v156, 4, v156
    v_bfe_u32 v158, v0, 3, 1
    v_lshrrev_b32 v157, 3, v0
    s_add_u32 m0, s54, 1024
    s_nop 0
    buffer_load_dwordx4 v6, s[24:27], 0 offen  lds
    v_lshl_add_u32 v157, v157, 8, v156
    v_add_u32 v157, s54, v157
    v_lshl_add_u32 v28, v158, 7, v157
    v_xor_b32 v29, 128, v28
    v_lshl_add_u32 v157, v154, 8, v156
    v_add_u32 v157, s53, v157
    v_add_u32 v157, 104448, v157
    v_lshl_add_u32 v30, v158, 7, v157
    v_xor_b32 v31, 128, v30
    s_mov_b32 s35, 0x20000
    s_cmp_lt_u32 s2, 240
    s_cbranch_scc0 L_t3b
    s_mov_b32 s32, s8
    s_mov_b32 s33, s9
    s_mov_b32 s34, 1966080
    v_add_u32 v155, 139264, v144
    s_mul_i32 s56, s2, 1093
    s_lshr_b32 s56, s56, 16
    s_mul_i32 s57, s56, 60
    s_sub_u32 s57, s2, s57
    s_lshl_b32 s55, s56, 7
    s_lshl2_add_u32 s56, s56, s48
    s_mul_i32 s6, s56, 60
    s_add_u32 s6, s6, s57
    s_lshl_b32 s6, s6, 11
    s_add_u32 s6, s6, 8388608
    s_lshl_b32 s7, s56, 6
    s_add_u32 s7, s7, s57
    s_lshl_b32 s7, s7, 4
    s_add_u32 s7, s7, 15073280
    s_lshl_b32 s58, s57, 1
    s_add_u32 s58, s58, 0
    s_mul_i32 s59, s58, 4370
    s_lshr_b32 s59, s59, 16
    s_mul_i32 s60, s59, 15
    s_sub_u32 s58, s58, s60
    s_lshl_b32 s60, s58, 1
    s_sub_u32 s68, s60, 15
    s_cmp_lt_u32 s58, 8
    s_cselect_b32 s60, s60, s68
    s_lshl_b32 s60, s60, 3
    s_add_u32 s60, s60, s59
    s_lshl_b32 s60, s60, 14
    s_add_u32 s4, s60, s55
    s_lshl_b32 s58, s57, 1
    s_add_u32 s58, s58, 1
    s_mul_i32 s59, s58, 4370
    s_lshr_b32 s59, s59, 16
    s_mul_i32 s60, s59, 15
    s_sub_u32 s58, s58, s60
    s_lshl_b32 s60, s58, 1
    s_sub_u32 s68, s60, 15
    s_cmp_lt_u32 s58, 8
    s_cselect_b32 s60, s60, s68
    s_lshl_b32 s60, s60, 3
    s_add_u32 s60, s60, s59
    s_lshl_b32 s60, s60, 14
    s_add_u32 s5, s60, s55
    s_branch L_t3c
L_t3b:
    s_mov_b32 s32, s12
    s_mov_b32 s33, s13
    s_mov_b32 s34, 131072
    s_bfe_u32 s56, s2, 0x20002
    s_and_b32 s57, s2, 3
    s_lshl_b32 s4, s57, 15
    s_lshl_b32 s58, s56, 7
    s_add_u32 s4, s4, s58
    s_add_u32 s5, s4, 16384
    s_lshl2_add_u32 s56, s56, s48
    s_lshl2_add_u32 s56, s56, s57
    s_lshl_b32 s6, s56, 11
    s_add_u32 s6, s6, 14680064
    s_lshl_b32 s7, s56, 4
    s_add_u32 s7, s7, 15093760
L_t3c:
    s_add_u32 m0, s54, 9216
    s_nop 0
    buffer_load_dwordx4 v7, s[24:27], 0 offen  lds
    s_add_u32 m0, s54, 17408
    s_nop 0
    buffer_load_dwordx4 v8, s[24:27], 0 offen  lds
    s_add_u32 m0, s54, 25600
    s_nop 0
    buffer_load_dwordx4 v9, s[24:27], 0 offen  lds
    s_cmp_eq_u32 s48, 0
    s_cselect_b32 s77, s2, 999
    s_lshl_b32 s56, s49, 2
    s_add_u32 s8, s56, s48
    s_mul_i32 s9, s8, 147456
    s_add_u32 s9, s9, 15138816
    s_mul_i32 s68, s50, 16
    s_add_u32 s68, s68, s49
    s_lshl_b32 s68, s68, 7
    s_add_u32 s68, s68, 4194304
    s_mov_b32 s60, 0x07060302
    buffer_atomic_cmpswap v[140:141], v39, s[44:47], s3 offen sc1
    s_mov_b32 s55, 131072
    buffer_load_dword v146, v147, s[28:31], 0 offen
    buffer_load_dword v146, v34, s[24:27], s73 offen
    buffer_load_dword v146, v147, s[28:31], s55 offen
    s_waitcnt vmcnt(8)
    s_barrier
    ds_read_b64_tr_b16 a[128:129], v33 offset:0
    ds_read_b64_tr_b16 a[130:131], v33 offset:512
    ds_read_b64_tr_b16 a[132:133], v33 offset:4096
    ds_read_b64_tr_b16 a[134:135], v33 offset:4608
    ds_read_b64_tr_b16 a[136:137], v33 offset:8192
    ds_read_b64_tr_b16 a[138:139], v33 offset:8704
    ds_read_b64_tr_b16 a[140:141], v33 offset:12288
    ds_read_b64_tr_b16 a[142:143], v33 offset:12800
    ds_read_b64_tr_b16 a[144:145], v33 offset:16384
    ds_read_b64_tr_b16 a[146:147], v33 offset:16896
    ds_read_b64_tr_b16 a[148:149], v33 offset:20480
    ds_read_b64_tr_b16 a[150:151], v33 offset:20992
    ds_read_b64_tr_b16 a[152:153], v33 offset:24576
    ds_read_b64_tr_b16 a[154:155], v33 offset:25088
    ds_read_b64_tr_b16 a[156:157], v33 offset:28672
    ds_read_b64_tr_b16 a[158:159], v33 offset:29184
    ds_read_b128 v[40:43], v12 offset:0
    ds_read_b128 v[44:47], v14 offset:0
    ds_read_b128 v[48:51], v12 offset:256
    ds_read_b128 v[52:55], v14 offset:256
    ds_read_b128 v[56:59], v12 offset:512
    ds_read_b128 v[60:63], v14 offset:512
    ds_read_b128 v[64:67], v12 offset:768
    ds_read_b128 v[68:71], v14 offset:768
    s_waitcnt lgkmcnt(7)
    v_mfma_f32_16x16x32_bf16 v[160:163], a[128:131], v[40:43], 0
    s_waitcnt lgkmcnt(6)
    s_add_u32 m0, s53, 102400
    s_mov_b32 s55, 16384
    v_mfma_f32_16x16x32_bf16 v[160:163], a[132:135], v[44:47], v[160:163]
    s_waitcnt lgkmcnt(5)
    buffer_load_dwordx4 v32, s[28:31], s55 offen  lds
    v_mfma_f32_16x16x32_bf16 v[160:163], a[136:139], v[48:51], v[160:163]
    s_waitcnt lgkmcnt(4)
    ds_read_u16 v120, v145 offset:34816
    v_mfma_f32_16x16x32_bf16 v[160:163], a[140:143], v[52:55], v[160:163]
    s_waitcnt lgkmcnt(4)
    ds_read_u16 v121, v145 offset:34944
    v_mfma_f32_16x16x32_bf16 v[160:163], a[144:147], v[56:59], v[160:163]
    s_waitcnt lgkmcnt(4)
    ds_read_u16 v122, v145 offset:35072
    v_mfma_f32_16x16x32_bf16 v[160:163], a[148:151], v[60:63], v[160:163]
    s_waitcnt lgkmcnt(4)
    s_add_u32 m0, s53, 106496
    s_mov_b32 s55, 278528
    v_mfma_f32_16x16x32_bf16 v[160:163], a[152:155], v[64:67], v[160:163]
    s_waitcnt lgkmcnt(3)
    buffer_load_dwordx4 v32, s[28:31], s55 offen  lds
    v_mfma_f32_16x16x32_bf16 v[160:163], a[156:159], v[68:71], v[160:163]
    ds_read_u16 v123, v145 offset:35200
    v_mfma_f32_16x16x32_bf16 v[192:195], a[128:131], v[44:47], 0
    ds_read_u16 v124, v145 offset:35328
    v_mfma_f32_16x16x32_bf16 v[192:195], a[132:135], v[48:51], v[192:195]
    ds_read_u16 v125, v145 offset:35456
    v_mfma_f32_16x16x32_bf16 v[192:195], a[136:139], v[52:55], v[192:195]
    s_add_u32 m0, s53, 110592
    s_mov_b32 s55, 540672
    ds_read_u16 v126, v145 offset:35584
    v_mfma_f32_16x16x32_bf16 v[192:195], a[140:143], v[56:59], v[192:195]
    buffer_load_dwordx4 v32, s[28:31], s55 offen  lds
    v_mfma_f32_16x16x32_bf16 v[192:195], a[144:147], v[60:63], v[192:195]
    ds_read_u16 v127, v145 offset:35712
    v_mfma_f32_16x16x32_bf16 v[192:195], a[148:151], v[64:67], v[192:195]
    ds_read_u16 v128, v145 offset:38912
    v_mfma_f32_16x16x32_bf16 v[192:195], a[152:155], v[68:71], v[192:195]
    ds_read_u16 v129, v145 offset:39040
    v_mfma_f32_16x16x32_bf16 v[164:167], a[128:131], v[48:51], 0
    s_add_u32 m0, s53, 114688
    s_mov_b32 s55, 802816
    ds_read_b128 v[72:75], v13 offset:2048
    v_mfma_f32_16x16x32_bf16 v[164:167], a[132:135], v[52:55], v[164:167]
    buffer_load_dwordx4 v32, s[28:31], s55 offen  lds
    v_mfma_f32_16x16x32_bf16 v[164:167], a[136:139], v[56:59], v[164:167]
    ds_read_u16 v130, v145 offset:39168
    v_mfma_f32_16x16x32_bf16 v[164:167], a[140:143], v[60:63], v[164:167]
    ds_read_u16 v131, v145 offset:39296
    v_mfma_f32_16x16x32_bf16 v[164:167], a[144:147], v[64:67], v[164:167]
    ds_read_b128 v[76:79], v15 offset:2048
    v_mfma_f32_16x16x32_bf16 v[164:167], a[148:151], v[68:71], v[164:167]
    s_add_u32 m0, s53, 118784
    s_mov_b32 s55, 1064960
    ds_read_u16 v132, v145 offset:39424
    v_mfma_f32_16x16x32_bf16 v[196:199], a[128:131], v[52:55], 0
    buffer_load_dwordx4 v32, s[28:31], s55 offen  lds
    v_mfma_f32_16x16x32_bf16 v[196:199], a[132:135], v[56:59], v[196:199]
    ds_read_u16 v133, v145 offset:39552
    v_mfma_f32_16x16x32_bf16 v[196:199], a[136:139], v[60:63], v[196:199]
    ds_read_b128 v[80:83], v13 offset:2304
    v_mfma_f32_16x16x32_bf16 v[196:199], a[140:143], v[64:67], v[196:199]
    ds_read_u16 v134, v145 offset:39680
    ds_read_u16 v135, v145 offset:39808
    v_mfma_f32_16x16x32_bf16 v[196:199], a[144:147], v[68:71], v[196:199]
    s_add_u32 m0, s53, 122880
    s_mov_b32 s55, 1327104
    v_mfma_f32_16x16x32_bf16 v[168:171], a[128:131], v[56:59], 0
    buffer_load_dwordx4 v32, s[28:31], s55 offen  lds
    v_mfma_f32_16x16x32_bf16 v[168:171], a[132:135], v[60:63], v[168:171]
    ds_read_b128 v[84:87], v15 offset:2304
    v_mfma_f32_16x16x32_bf16 v[168:171], a[136:139], v[64:67], v[168:171]
    v_mfma_f32_16x16x32_bf16 v[168:171], a[140:143], v[68:71], v[168:171]
    v_mfma_f32_16x16x32_bf16 v[200:203], a[128:131], v[60:63], 0
    s_add_u32 m0, s53, 126976
    s_mov_b32 s55, 1589248
    v_mfma_f32_16x16x32_bf16 v[200:203], a[132:135], v[64:67], v[200:203]
    s_waitcnt lgkmcnt(5)
    ds_read_b128 v[88:91], v13 offset:2560
    v_lshlrev_b32 v120, 16, v120
    v_mfma_f32_16x16x32_bf16 v[200:203], a[136:139], v[68:71], v[200:203]
    buffer_load_dwordx4 v32, s[28:31], s55 offen  lds
    v_lshlrev_b32 v121, 16, v121
    v_mfma_f32_16x16x32_bf16 v[172:175], a[128:131], v[64:67], 0
    v_lshlrev_b32 v122, 16, v122
    v_lshlrev_b32 v123, 16, v123
    v_mfma_f32_16x16x32_bf16 v[172:175], a[132:135], v[68:71], v[172:175]
    v_lshlrev_b32 v124, 16, v124
    v_lshlrev_b32 v125, 16, v125
    v_mfma_f32_16x16x32_bf16 v[204:207], a[128:131], v[68:71], 0
    ds_read_b128 v[92:95], v15 offset:2560
    v_mfma_f32_16x16x32_bf16 v[208:211], a[156:159], v[72:75], 0
    s_add_u32 m0, s53, 131072
    s_mov_b32 s55, 1851392
    buffer_load_dwordx4 v32, s[28:31], s55 offen  lds
    v_mfma_f32_16x16x32_bf16 v[180:183], a[152:155], v[72:75], 0
    v_lshlrev_b32 v126, 16, v126
    v_lshlrev_b32 v127, 16, v127
    v_mfma_f32_16x16x32_bf16 v[180:183], a[156:159], v[76:79], v[180:183]
    s_waitcnt lgkmcnt(2)
    v_lshl_or_b32 v136, v129, 16, v128
    v_mfma_f32_16x16x32_bf16 v[212:215], a[148:151], v[72:75], 0
    ds_read_b128 v[96:99], v13 offset:2816
    v_lshl_or_b32 v137, v131, 16, v130
    v_mfma_f32_16x16x32_bf16 v[212:215], a[152:155], v[76:79], v[212:215]
    s_waitcnt vmcnt(12)
    s_barrier
    v_lshl_or_b32 v138, v133, 16, v132
    v_mfma_f32_16x16x32_bf16 v[212:215], a[156:159], v[80:83], v[212:215]
    s_add_u32 m0, s53, 135168
    s_mov_b32 s55, 131072
    buffer_load_dwordx4 v32, s[28:31], s55 offen  lds
    v_mfma_f32_16x16x32_bf16 v[184:187], a[144:147], v[72:75], 0
    v_lshl_or_b32 v139, v135, 16, v134
    v_mfma_f32_16x16x32_bf16 v[184:187], a[148:151], v[76:79], v[184:187]
    ds_read_b128 v[100:103], v12 offset:1024
    v_mfma_f32_16x16x32_bf16 v[184:187], a[152:155], v[80:83], v[184:187]
    buffer_store_dwordx4 v[136:139], v36, s[36:39], s63 offen sc1
    v_mfma_f32_16x16x32_bf16 v[184:187], a[156:159], v[84:87], v[184:187]
    s_add_u32 m0, s53, 139264
    s_mov_b32 s55, 393216
    v_lshlrev_b32 v128, 16, v128
    v_mfma_f32_16x16x32_bf16 v[216:219], a[140:143], v[72:75], 0
    buffer_load_dwordx4 v32, s[28:31], s55 offen  lds
    v_lshlrev_b32 v129, 16, v129
    v_mfma_f32_16x16x32_bf16 v[216:219], a[144:147], v[76:79], v[216:219]
    ds_read_b128 v[40:43], v14 offset:1024
    v_lshlrev_b32 v130, 16, v130
    v_mfma_f32_16x16x32_bf16 v[216:219], a[148:151], v[80:83], v[216:219]
    v_lshlrev_b32 v131, 16, v131
    v_mfma_f32_16x16x32_bf16 v[216:219], a[152:155], v[84:87], v[216:219]
    s_waitcnt lgkmcnt(2)
    v_lshlrev_b32 v132, 16, v132
    v_lshlrev_b32 v133, 16, v133
    v_mfma_f32_16x16x32_bf16 v[216:219], a[156:159], v[88:91], v[216:219]
    s_add_u32 m0, s53, 143360
    s_mov_b32 s55, 655360
    v_mfma_f32_16x16x32_bf16 v[188:191], a[136:139], v[72:75], 0
    ds_read_b128 v[44:47], v12 offset:1280
    v_lshlrev_b32 v134, 16, v134
    v_mfma_f32_16x16x32_bf16 v[188:191], a[140:143], v[76:79], v[188:191]
    buffer_load_dwordx4 v32, s[28:31], s55 offen  lds
    v_lshlrev_b32 v135, 16, v135
    v_mfma_f32_16x16x32_bf16 v[188:191], a[144:147], v[80:83], v[188:191]
    v_add_f32 v128, v120, v128
    v_mfma_f32_16x16x32_bf16 v[188:191], a[148:151], v[84:87], v[188:191]
    v_add_f32 v129, v121, v129
    v_add_f32 v130, v122, v130
    v_mfma_f32_16x16x32_bf16 v[188:191], a[152:155], v[88:91], v[188:191]
    ds_read_b128 v[48:51], v14 offset:1280
    v_mfma_f32_16x16x32_bf16 v[188:191], a[156:159], v[92:95], v[188:191]
    s_add_u32 m0, s53, 147456
    s_mov_b32 s55, 917504
    buffer_load_dwordx4 v32, s[28:31], s55 offen  lds
    v_mfma_f32_16x16x32_bf16 v[220:223], a[132:135], v[72:75], 0
    v_add_f32 v131, v123, v131
    v_add_f32 v132, v124, v132
    v_mfma_f32_16x16x32_bf16 v[220:223], a[136:139], v[76:79], v[220:223]
    v_add_f32 v133, v125, v133
    v_mfma_f32_16x16x32_bf16 v[220:223], a[140:143], v[80:83], v[220:223]
    v_add_f32 v134, v126, v134
    v_add_f32 v135, v127, v135
    v_mfma_f32_16x16x32_bf16 v[220:223], a[144:147], v[84:87], v[220:223]
    s_add_u32 m0, s53, 151552
    s_mov_b32 s55, 1179648
    ds_read_b128 v[52:55], v12 offset:1536
    v_mfma_f32_16x16x32_bf16 v[220:223], a[148:151], v[88:91], v[220:223]
    buffer_load_dwordx4 v32, s[28:31], s55 offen  lds
    v_cvt_pk_bf16_f32 v140, v128, v129
    v_mfma_f32_16x16x32_bf16 v[220:223], a[152:155], v[92:95], v[220:223]
    v_cvt_pk_bf16_f32 v141, v130, v131
    v_mfma_f32_16x16x32_bf16 v[220:223], a[156:159], v[96:99], v[220:223]
    s_waitcnt lgkmcnt(2)
    v_cvt_pk_bf16_f32 v142, v132, v133
    v_mfma_f32_16x16x32_bf16 v[192:195], a[156:159], v[100:103], v[192:195]
    v_cvt_pk_bf16_f32 v143, v134, v135
    v_mfma_f32_16x16x32_bf16 v[164:167], a[152:155], v[100:103], v[164:167]
    s_add_u32 m0, s53, 155648
    s_mov_b32 s55, 1441792
    v_mfma_f32_16x16x32_bf16 v[164:167], a[156:159], v[40:43], v[164:167]
    ds_read_b128 v[56:59], v14 offset:1536
    v_mfma_f32_16x16x32_bf16 v[196:199], a[148:151], v[100:103], v[196:199]
    buffer_load_dwordx4 v32, s[28:31], s55 offen  lds
    buffer_store_dwordx4 v[140:143], v36, s[36:39], s69 offen sc1
    v_mfma_f32_16x16x32_bf16 v[196:199], a[152:155], v[40:43], v[196:199]
    v_mul_f32 v120, s66, v120
    v_mul_f32 v121, s66, v121
    v_mfma_f32_16x16x32_bf16 v[196:199], a[156:159], v[44:47], v[196:199]
    v_mul_f32 v122, s66, v122
    v_mfma_f32_16x16x32_bf16 v[168:171], a[144:147], v[100:103], v[168:171]
    s_add_u32 m0, s53, 159744
    s_mov_b32 s55, 1703936
    v_mul_f32 v123, s66, v123
    v_mfma_f32_16x16x32_bf16 v[168:171], a[148:151], v[40:43], v[168:171]
    buffer_load_dwordx4 v32, s[28:31], s55 offen  lds
    v_mul_f32 v124, s66, v124
    v_mfma_f32_16x16x32_bf16 v[168:171], a[152:155], v[44:47], v[168:171]
    s_waitcnt lgkmcnt(1)
    v_mul_f32 v125, s66, v125
    v_mfma_f32_16x16x32_bf16 v[168:171], a[156:159], v[48:51], v[168:171]
    ds_read_b128 v[60:63], v12 offset:1792
    v_mul_f32 v126, s66, v126
    v_mfma_f32_16x16x32_bf16 v[200:203], a[140:143], v[100:103], v[200:203]
    v_mul_f32 v127, s66, v127
    v_mfma_f32_16x16x32_bf16 v[200:203], a[144:147], v[40:43], v[200:203]
    v_perm_b32 v128, v121, v120, s60
    v_perm_b32 v129, v123, v122, s60
    v_mfma_f32_16x16x32_bf16 v[200:203], a[148:151], v[44:47], v[200:203]
    v_perm_b32 v130, v125, v124, s60
    v_mfma_f32_16x16x32_bf16 v[200:203], a[152:155], v[48:51], v[200:203]
    v_perm_b32 v131, v127, v126, s60
    v_mfma_f32_16x16x32_bf16 v[200:203], a[156:159], v[52:55], v[200:203]
    buffer_store_dwordx4 v[128:131], v36, s[36:39], s62 offen sc1
    v_mfma_f32_16x16x32_bf16 v[172:175], a[136:139], v[100:103], v[172:175]
    buffer_load_dword v38, off, s[44:47], 0 sc1
    v_mfma_f32_16x16x32_bf16 v[172:175], a[140:143], v[40:43], v[172:175]
    v_mfma_f32_16x16x32_bf16 v[172:175], a[144:147], v[44:47], v[172:175]
    ds_read_b128 v[64:67], v14 offset:1792
    v_mfma_f32_16x16x32_bf16 v[172:175], a[148:151], v[48:51], v[172:175]
    v_mfma_f32_16x16x32_bf16 v[172:175], a[152:155], v[52:55], v[172:175]
    s_waitcnt lgkmcnt(1)
    v_mfma_f32_16x16x32_bf16 v[172:175], a[156:159], v[56:59], v[172:175]
    v_mfma_f32_16x16x32_bf16 v[204:207], a[132:135], v[100:103], v[204:207]
    v_mfma_f32_16x16x32_bf16 v[204:207], a[136:139], v[40:43], v[204:207]
    v_mfma_f32_16x16x32_bf16 v[204:207], a[140:143], v[44:47], v[204:207]
    v_mfma_f32_16x16x32_bf16 v[204:207], a[144:147], v[48:51], v[204:207]
    v_mfma_f32_16x16x32_bf16 v[204:207], a[148:151], v[52:55], v[204:207]
    ds_read_b128 v[68:71], v16 offset:0
    v_mfma_f32_16x16x32_bf16 v[204:207], a[152:155], v[56:59], v[204:207]
    s_waitcnt vmcnt(11)
    s_barrier
    v_mfma_f32_16x16x32_bf16 v[204:207], a[156:159], v[60:63], v[204:207]
    s_add_u32 m0, s54, 34816
    ds_read_b64_tr_b16 a[160:161], v33 offset:32768
    v_mfma_f32_16x16x32_bf16 v[176:179], a[128:131], v[100:103], 0
    ds_read_b64_tr_b16 a[162:163], v33 offset:33280
    v_mfma_f32_16x16x32_bf16 v[176:179], a[132:135], v[40:43], v[176:179]
    buffer_load_dwordx4 v11, s[24:27], 0 offen  lds
    v_mfma_f32_16x16x32_bf16 v[176:179], a[136:139], v[44:47], v[176:179]
    ds_read_b128 v[72:75], v18 offset:0
    v_mfma_f32_16x16x32_bf16 v[176:179], a[140:143], v[48:51], v[176:179]
    ds_read_b64_tr_b16 a[164:165], v33 offset:36864
    v_mfma_f32_16x16x32_bf16 v[176:179], a[144:147], v[52:55], v[176:179]
    ds_read_b64_tr_b16 a[166:167], v33 offset:37376
    v_mfma_f32_16x16x32_bf16 v[176:179], a[148:151], v[56:59], v[176:179]
    s_add_u32 m0, s54, 43008
    ds_read_b128 v[76:79], v16 offset:256
    v_mfma_f32_16x16x32_bf16 v[176:179], a[152:155], v[60:63], v[176:179]
    s_waitcnt lgkmcnt(7)
    ds_read_b64_tr_b16 a[168:169], v33 offset:40960
    v_mfma_f32_16x16x32_bf16 v[176:179], a[156:159], v[64:67], v[176:179]
    buffer_load_dwordx4 v3, s[24:27], s73 offen  lds
    v_mfma_f32_16x16x32_bf16 v[208:211], a[128:131], v[40:43], v[208:211]
    ds_read_b64_tr_b16 a[170:171], v33 offset:41472
    v_mfma_f32_16x16x32_bf16 v[208:211], a[132:135], v[44:47], v[208:211]
    ds_read_b128 v[80:83], v18 offset:256
    v_mfma_f32_16x16x32_bf16 v[208:211], a[136:139], v[48:51], v[208:211]
    ds_read_b64_tr_b16 a[172:173], v33 offset:45056
    v_mfma_f32_16x16x32_bf16 v[208:211], a[140:143], v[52:55], v[208:211]
    s_add_u32 m0, s54, 51200
    ds_read_b64_tr_b16 a[174:175], v33 offset:45568
    v_mfma_f32_16x16x32_bf16 v[208:211], a[144:147], v[56:59], v[208:211]
    ds_read_b64_tr_b16 a[176:177], v33 offset:49152
    v_mfma_f32_16x16x32_bf16 v[208:211], a[148:151], v[60:63], v[208:211]
    buffer_load_dwordx4 v4, s[24:27], s73 offen  lds
    v_mfma_f32_16x16x32_bf16 v[208:211], a[152:155], v[64:67], v[208:211]
    ds_read_b128 v[84:87], v16 offset:512
    v_mfma_f32_16x16x32_bf16 v[180:183], a[128:131], v[44:47], v[180:183]
    ds_read_b64_tr_b16 a[178:179], v33 offset:49664
    v_mfma_f32_16x16x32_bf16 v[180:183], a[132:135], v[48:51], v[180:183]
    ds_read_b64_tr_b16 a[180:181], v33 offset:53248
    v_mfma_f32_16x16x32_bf16 v[180:183], a[136:139], v[52:55], v[180:183]
    s_add_u32 m0, s54, 59392
    ds_read_b128 v[88:91], v18 offset:512
    v_mfma_f32_16x16x32_bf16 v[180:183], a[140:143], v[56:59], v[180:183]
    ds_read_b64_tr_b16 a[182:183], v33 offset:53760
    v_mfma_f32_16x16x32_bf16 v[180:183], a[144:147], v[60:63], v[180:183]
    buffer_load_dwordx4 v5, s[24:27], s73 offen  lds
    v_mfma_f32_16x16x32_bf16 v[180:183], a[148:151], v[64:67], v[180:183]
    ds_read_b64_tr_b16 a[184:185], v33 offset:57344
    v_mfma_f32_16x16x32_bf16 v[212:215], a[128:131], v[48:51], v[212:215]
    ds_read_b64_tr_b16 a[186:187], v33 offset:57856
    v_mfma_f32_16x16x32_bf16 v[212:215], a[132:135], v[52:55], v[212:215]
    ds_read_b128 v[92:95], v16 offset:768
    v_mfma_f32_16x16x32_bf16 v[212:215], a[136:139], v[56:59], v[212:215]
    s_add_u32 m0, s54, 35840
    ds_read_b64_tr_b16 a[188:189], v33 offset:61440
    v_mfma_f32_16x16x32_bf16 v[212:215], a[140:143], v[60:63], v[212:215]
    ds_read_b64_tr_b16 a[190:191], v33 offset:61952
    v_mfma_f32_16x16x32_bf16 v[212:215], a[144:147], v[64:67], v[212:215]
    buffer_load_dwordx4 v6, s[24:27], s73 offen  lds
    v_mfma_f32_16x16x32_bf16 v[184:187], a[128:131], v[52:55], v[184:187]
    ds_read_b128 v[96:99], v18 offset:768
    v_mfma_f32_16x16x32_bf16 v[184:187], a[132:135], v[56:59], v[184:187]
    v_mfma_f32_16x16x32_bf16 v[184:187], a[136:139], v[60:63], v[184:187]
    v_mfma_f32_16x16x32_bf16 v[184:187], a[140:143], v[64:67], v[184:187]
    s_add_u32 m0, s54, 44032
    v_mfma_f32_16x16x32_bf16 v[216:219], a[128:131], v[56:59], v[216:219]
    buffer_load_dwordx4 v7, s[24:27], s73 offen  lds
    v_mfma_f32_16x16x32_bf16 v[216:219], a[132:135], v[60:63], v[216:219]
    v_mfma_f32_16x16x32_bf16 v[216:219], a[136:139], v[64:67], v[216:219]
    v_mfma_f32_16x16x32_bf16 v[188:191], a[128:131], v[60:63], v[188:191]
    ds_read_b128 v[100:103], v16 offset:1024
    v_mfma_f32_16x16x32_bf16 v[188:191], a[132:135], v[64:67], v[188:191]
    v_mfma_f32_16x16x32_bf16 v[220:223], a[128:131], v[64:67], v[220:223]
    s_waitcnt lgkmcnt(2)
    s_add_u32 m0, s54, 52224
    v_mfma_f32_16x16x32_bf16 v[160:163], a[160:163], v[68:71], v[160:163]
    buffer_load_dwordx4 v8, s[24:27], s73 offen  lds
    v_mfma_f32_16x16x32_bf16 v[160:163], a[164:167], v[72:75], v[160:163]
    v_mfma_f32_16x16x32_bf16 v[160:163], a[168:171], v[76:79], v[160:163]
    v_mfma_f32_16x16x32_bf16 v[160:163], a[172:175], v[80:83], v[160:163]
    v_mfma_f32_16x16x32_bf16 v[160:163], a[176:179], v[84:87], v[160:163]
    v_mfma_f32_16x16x32_bf16 v[160:163], a[180:183], v[88:91], v[160:163]
    s_add_u32 m0, s54, 60416
    ds_read_b128 v[40:43], v18 offset:1024
    v_mfma_f32_16x16x32_bf16 v[160:163], a[184:187], v[92:95], v[160:163]
    s_waitcnt lgkmcnt(2)
    buffer_load_dwordx4 v9, s[24:27], s73 offen  lds
    v_mfma_f32_16x16x32_bf16 v[160:163], a[188:191], v[96:99], v[160:163]
    v_mfma_f32_16x16x32_bf16 v[192:195], a[160:163], v[72:75], v[192:195]
    v_mfma_f32_16x16x32_bf16 v[192:195], a[164:167], v[76:79], v[192:195]
    v_mfma_f32_16x16x32_bf16 v[192:195], a[168:171], v[80:83], v[192:195]
    v_mfma_f32_16x16x32_bf16 v[192:195], a[172:175], v[84:87], v[192:195]
    s_mov_b32 m0, 67584
    v_mfma_f32_16x16x32_bf16 v[192:195], a[176:179], v[88:91], v[192:195]
    buffer_load_dwordx4 v10, s[24:27], s73 offen  lds
    v_mfma_f32_16x16x32_bf16 v[192:195], a[180:183], v[92:95], v[192:195]
    ds_read_b128 v[44:47], v16 offset:1280
    v_mfma_f32_16x16x32_bf16 v[192:195], a[184:187], v[96:99], v[192:195]
    s_waitcnt lgkmcnt(2)
    v_mfma_f32_16x16x32_bf16 v[192:195], a[188:191], v[100:103], v[192:195]
    v_mfma_f32_16x16x32_bf16 v[164:167], a[160:163], v[76:79], v[164:167]
    v_mfma_f32_16x16x32_bf16 v[164:167], a[164:167], v[80:83], v[164:167]
    s_waitcnt vmcnt(9)
    v_readfirstlane_b32 s3, v38
    s_nop 0
    s_cmp_eq_u32 s3, 0
    s_cbranch_scc1 L_non
L_non_b:
    buffer_store_dword v38, v39, s[36:39], s67 offen sc1
    v_mfma_f32_16x16x32_bf16 v[164:167], a[168:171], v[84:87], v[164:167]
    s_add_u32 m0, s53, 69632
    s_mov_b32 s55, 147456
    buffer_load_dwordx4 v32, s[28:31], s55 offen  lds
    v_mfma_f32_16x16x32_bf16 v[164:167], a[172:175], v[88:91], v[164:167]
    v_mfma_f32_16x16x32_bf16 v[164:167], a[176:179], v[92:95], v[164:167]
    v_mfma_f32_16x16x32_bf16 v[164:167], a[180:183], v[96:99], v[164:167]
    ds_read_b128 v[48:51], v18 offset:1280
    v_mfma_f32_16x16x32_bf16 v[164:167], a[184:187], v[100:103], v[164:167]
    s_waitcnt lgkmcnt(2)
    v_mfma_f32_16x16x32_bf16 v[164:167], a[188:191], v[40:43], v[164:167]
    s_add_u32 m0, s53, 73728
    s_mov_b32 s55, 409600
    v_mfma_f32_16x16x32_bf16 v[196:199], a[160:163], v[80:83], v[196:199]
    buffer_load_dwordx4 v32, s[28:31], s55 offen  lds
    v_mfma_f32_16x16x32_bf16 v[196:199], a[164:167], v[84:87], v[196:199]
    v_mfma_f32_16x16x32_bf16 v[196:199], a[168:171], v[88:91], v[196:199]
    v_mfma_f32_16x16x32_bf16 v[196:199], a[172:175], v[92:95], v[196:199]
    v_mfma_f32_16x16x32_bf16 v[196:199], a[176:179], v[96:99], v[196:199]
    v_mfma_f32_16x16x32_bf16 v[196:199], a[180:183], v[100:103], v[196:199]
    s_add_u32 m0, s53, 77824
    s_mov_b32 s55, 671744
    ds_read_b128 v[52:55], v16 offset:1536
    v_mfma_f32_16x16x32_bf16 v[196:199], a[184:187], v[40:43], v[196:199]
    s_waitcnt lgkmcnt(2)
    buffer_load_dwordx4 v32, s[28:31], s55 offen  lds
    v_mfma_f32_16x16x32_bf16 v[196:199], a[188:191], v[44:47], v[196:199]
    v_mfma_f32_16x16x32_bf16 v[168:171], a[160:163], v[84:87], v[168:171]
    v_mfma_f32_16x16x32_bf16 v[168:171], a[164:167], v[88:91], v[168:171]
    v_mfma_f32_16x16x32_bf16 v[168:171], a[168:171], v[92:95], v[168:171]
    v_mfma_f32_16x16x32_bf16 v[168:171], a[172:175], v[96:99], v[168:171]
    s_add_u32 m0, s53, 81920
    s_mov_b32 s55, 933888
    v_mfma_f32_16x16x32_bf16 v[168:171], a[176:179], v[100:103], v[168:171]
    buffer_load_dwordx4 v32, s[28:31], s55 offen  lds
    v_mfma_f32_16x16x32_bf16 v[168:171], a[180:183], v[40:43], v[168:171]
    ds_read_b128 v[56:59], v18 offset:1536
    v_mfma_f32_16x16x32_bf16 v[168:171], a[184:187], v[44:47], v[168:171]
    s_waitcnt lgkmcnt(2)
    v_mfma_f32_16x16x32_bf16 v[168:171], a[188:191], v[48:51], v[168:171]
    v_mfma_f32_16x16x32_bf16 v[200:203], a[160:163], v[88:91], v[200:203]
    v_mfma_f32_16x16x32_bf16 v[200:203], a[164:167], v[92:95], v[200:203]
    s_add_u32 m0, s53, 86016
    s_mov_b32 s55, 1196032
    v_mfma_f32_16x16x32_bf16 v[200:203], a[168:171], v[96:99], v[200:203]
    buffer_load_dwordx4 v32, s[28:31], s55 offen  lds
    v_mfma_f32_16x16x32_bf16 v[200:203], a[172:175], v[100:103], v[200:203]
    v_mfma_f32_16x16x32_bf16 v[200:203], a[176:179], v[40:43], v[200:203]
    v_mfma_f32_16x16x32_bf16 v[200:203], a[180:183], v[44:47], v[200:203]
    ds_read_b128 v[60:63], v16 offset:1792
    v_mfma_f32_16x16x32_bf16 v[200:203], a[184:187], v[48:51], v[200:203]
    s_waitcnt lgkmcnt(2)
    v_mfma_f32_16x16x32_bf16 v[200:203], a[188:191], v[52:55], v[200:203]
    s_add_u32 m0, s53, 90112
    s_mov_b32 s55, 1458176
    v_mfma_f32_16x16x32_bf16 v[172:175], a[160:163], v[92:95], v[172:175]
    buffer_load_dwordx4 v32, s[28:31], s55 offen  lds
    v_mfma_f32_16x16x32_bf16 v[172:175], a[164:167], v[96:99], v[172:175]
    v_mfma_f32_16x16x32_bf16 v[172:175], a[168:171], v[100:103], v[172:175]
    v_mfma_f32_16x16x32_bf16 v[172:175], a[172:175], v[40:43], v[172:175]
    v_mfma_f32_16x16x32_bf16 v[172:175], a[176:179], v[44:47], v[172:175]
    v_mfma_f32_16x16x32_bf16 v[172:175], a[180:183], v[48:51], v[172:175]
    s_add_u32 m0, s53, 94208
    s_mov_b32 s55, 1720320
    ds_read_b128 v[64:67], v18 offset:1792
    v_mfma_f32_16x16x32_bf16 v[172:175], a[184:187], v[52:55], v[172:175]
    s_waitcnt lgkmcnt(2)
    buffer_load_dwordx4 v32, s[28:31], s55 offen  lds
    v_mfma_f32_16x16x32_bf16 v[172:175], a[188:191], v[56:59], v[172:175]
    v_mfma_f32_16x16x32_bf16 v[204:207], a[160:163], v[96:99], v[204:207]
    s_barrier
    v_mfma_f32_16x16x32_bf16 v[204:207], a[164:167], v[100:103], v[204:207]
    v_mfma_f32_16x16x32_bf16 v[204:207], a[168:171], v[40:43], v[204:207]
    v_mfma_f32_16x16x32_bf16 v[204:207], a[172:175], v[44:47], v[204:207]
    ds_read_b64_tr_b16 a[128:129], v35 offset:0
    v_mfma_f32_16x16x32_bf16 v[204:207], a[176:179], v[48:51], v[204:207]
    v_mfma_f32_16x16x32_bf16 v[204:207], a[180:183], v[52:55], v[204:207]
    ds_read_b128 v[68:71], v17 offset:2048
    v_mfma_f32_16x16x32_bf16 v[204:207], a[184:187], v[56:59], v[204:207]
    s_waitcnt lgkmcnt(3)
    ds_read_b64_tr_b16 a[130:131], v35 offset:512
    v_mfma_f32_16x16x32_bf16 v[204:207], a[188:191], v[60:63], v[204:207]
    v_mfma_f32_16x16x32_bf16 v[176:179], a[160:163], v[100:103], v[176:179]
    v_mfma_f32_16x16x32_bf16 v[176:179], a[164:167], v[40:43], v[176:179]
    ds_read_b64_tr_b16 a[132:133], v35 offset:4096
    v_mfma_f32_16x16x32_bf16 v[176:179], a[168:171], v[44:47], v[176:179]
    v_mfma_f32_16x16x32_bf16 v[176:179], a[172:175], v[48:51], v[176:179]
    v_mfma_f32_16x16x32_bf16 v[176:179], a[176:179], v[52:55], v[176:179]
    ds_read_b128 v[72:75], v19 offset:2048
    v_mfma_f32_16x16x32_bf16 v[176:179], a[180:183], v[56:59], v[176:179]
    ds_read_b64_tr_b16 a[134:135], v35 offset:4608
    v_mfma_f32_16x16x32_bf16 v[176:179], a[184:187], v[60:63], v[176:179]
    s_waitcnt lgkmcnt(5)
    buffer_load_dword v1, v34, s[24:27], s70 offen
    v_and_b32 v144, 15, v0
    v_mfma_f32_16x16x32_bf16 v[176:179], a[188:191], v[64:67], v[176:179]
    ds_read_b64_tr_b16 a[136:137], v35 offset:8192
    v_mfma_f32_16x16x32_bf16 v[208:211], a[160:163], v[40:43], v[208:211]
    ds_read_b128 v[76:79], v17 offset:2304
    v_mfma_f32_16x16x32_bf16 v[208:211], a[164:167], v[44:47], v[208:211]
    v_mfma_f32_16x16x32_bf16 v[208:211], a[168:171], v[48:51], v[208:211]
    ds_read_b64_tr_b16 a[138:139], v35 offset:8704
    v_mfma_f32_16x16x32_bf16 v[208:211], a[172:175], v[52:55], v[208:211]
    v_mfma_f32_16x16x32_bf16 v[208:211], a[176:179], v[56:59], v[208:211]
    ds_read_b128 v[80:83], v19 offset:2304
    v_mfma_f32_16x16x32_bf16 v[208:211], a[180:183], v[60:63], v[208:211]
    ds_read_b64_tr_b16 a[140:141], v35 offset:12288
    v_lshlrev_b32 v145, 9, v144
    v_mfma_f32_16x16x32_bf16 v[208:211], a[184:187], v[64:67], v[208:211]
    s_waitcnt lgkmcnt(6)
    v_mfma_f32_16x16x32_bf16 v[208:211], a[188:191], v[68:71], v[208:211]
    v_mfma_f32_16x16x32_bf16 v[180:183], a[160:163], v[44:47], v[180:183]
    ds_read_b128 v[84:87], v17 offset:2560
    v_mfma_f32_16x16x32_bf16 v[180:183], a[164:167], v[48:51], v[180:183]
    ds_read_b64_tr_b16 a[142:143], v35 offset:12800
    v_mfma_f32_16x16x32_bf16 v[180:183], a[168:171], v[52:55], v[180:183]
    v_mfma_f32_16x16x32_bf16 v[180:183], a[172:175], v[56:59], v[180:183]
    ds_read_b64_tr_b16 a[144:145], v35 offset:16384
    v_mfma_f32_16x16x32_bf16 v[180:183], a[176:179], v[60:63], v[180:183]
    ds_read_b128 v[88:91], v19 offset:2560
    v_lshrrev_b32 v132, 4, v0
    v_mfma_f32_16x16x32_bf16 v[180:183], a[180:183], v[64:67], v[180:183]
    v_mfma_f32_16x16x32_bf16 v[180:183], a[184:187], v[68:71], v[180:183]
    ds_read_b64_tr_b16 a[146:147], v35 offset:16896
    v_mfma_f32_16x16x32_bf16 v[180:183], a[188:191], v[72:75], v[180:183]
    v_mfma_f32_16x16x32_bf16 v[212:215], a[160:163], v[48:51], v[212:215]
    s_waitcnt vmcnt(9)
    ds_read_b128 v[92:95], v17 offset:2816
    s_barrier
    v_mfma_f32_16x16x32_bf16 v[212:215], a[164:167], v[52:55], v[212:215]
    buffer_load_dword v1, v34, s[24:27], s74 offen
    v_mfma_f32_16x16x32_bf16 v[212:215], a[168:171], v[56:59], v[212:215]
    ds_read_b64_tr_b16 a[148:149], v35 offset:20480
    v_mfma_f32_16x16x32_bf16 v[212:215], a[172:175], v[60:63], v[212:215]
    v_mfma_f32_16x16x32_bf16 v[212:215], a[176:179], v[64:67], v[212:215]
    ds_read_b128 v[96:99], v12 offset:34816
    v_lshl_add_u32 v145, v132, 4, v145
    v_mfma_f32_16x16x32_bf16 v[212:215], a[180:183], v[68:71], v[212:215]
    ds_read_b64_tr_b16 a[150:151], v35 offset:20992
    v_mfma_f32_16x16x32_bf16 v[212:215], a[184:187], v[72:75], v[212:215]
    s_waitcnt lgkmcnt(5)
    v_mfma_f32_16x16x32_bf16 v[212:215], a[188:191], v[76:79], v[212:215]
    ds_read_b64_tr_b16 a[152:153], v35 offset:24576
    v_mfma_f32_16x16x32_bf16 v[184:187], a[160:163], v[52:55], v[184:187]
    ds_read_b128 v[100:103], v14 offset:34816
    v_mfma_f32_16x16x32_bf16 v[184:187], a[164:167], v[56:59], v[184:187]
    v_mfma_f32_16x16x32_bf16 v[184:187], a[168:171], v[60:63], v[184:187]
    ds_read_b64_tr_b16 a[154:155], v35 offset:25088
    v_mfma_f32_16x16x32_bf16 v[184:187], a[172:175], v[64:67], v[184:187]
    v_lshlrev_b32 v144, 10, v144
    v_mfma_f32_16x16x32_bf16 v[184:187], a[176:179], v[68:71], v[184:187]
    ds_read_b128 v[40:43], v12 offset:35072
    v_mfma_f32_16x16x32_bf16 v[184:187], a[180:183], v[72:75], v[184:187]
    v_mfma_f32_16x16x32_bf16 v[184:187], a[184:187], v[76:79], v[184:187]
    v_mfma_f32_16x16x32_bf16 v[184:187], a[188:191], v[80:83], v[184:187]
    v_mfma_f32_16x16x32_bf16 v[216:219], a[160:163], v[56:59], v[216:219]
    ds_read_b128 v[44:47], v14 offset:35072
    v_mfma_f32_16x16x32_bf16 v[216:219], a[164:167], v[60:63], v[216:219]
    v_bfe_u32 v132, v0, 4, 1
    v_mfma_f32_16x16x32_bf16 v[216:219], a[168:171], v[64:67], v[216:219]
    v_mfma_f32_16x16x32_bf16 v[216:219], a[172:175], v[68:71], v[216:219]
    v_mfma_f32_16x16x32_bf16 v[216:219], a[176:179], v[72:75], v[216:219]
    ds_read_b128 v[48:51], v12 offset:35328
    v_mfma_f32_16x16x32_bf16 v[216:219], a[180:183], v[76:79], v[216:219]
    v_mfma_f32_16x16x32_bf16 v[216:219], a[184:187], v[80:83], v[216:219]
    v_lshl_add_u32 v144, v132, 5, v144
    v_mfma_f32_16x16x32_bf16 v[216:219], a[188:191], v[84:87], v[216:219]
    v_mfma_f32_16x16x32_bf16 v[188:191], a[160:163], v[60:63], v[188:191]
    ds_read_b128 v[52:55], v14 offset:35328
    v_mfma_f32_16x16x32_bf16 v[188:191], a[164:167], v[64:67], v[188:191]
    v_mfma_f32_16x16x32_bf16 v[188:191], a[168:171], v[68:71], v[188:191]
    v_mfma_f32_16x16x32_bf16 v[188:191], a[172:175], v[72:75], v[188:191]
    v_mfma_f32_16x16x32_bf16 v[188:191], a[176:179], v[76:79], v[188:191]
    ds_read_b128 v[56:59], v12 offset:35584
    v_lshrrev_b32 v132, 5, v0
    v_mfma_f32_16x16x32_bf16 v[188:191], a[180:183], v[80:83], v[188:191]
    v_mfma_f32_16x16x32_bf16 v[188:191], a[184:187], v[84:87], v[188:191]
    v_mfma_f32_16x16x32_bf16 v[188:191], a[188:191], v[88:91], v[188:191]
    v_mfma_f32_16x16x32_bf16 v[220:223], a[160:163], v[64:67], v[220:223]
    v_mfma_f32_16x16x32_bf16 v[220:223], a[164:167], v[68:71], v[220:223]
    v_lshl_add_u32 v144, v132, 4, v144
    v_mfma_f32_16x16x32_bf16 v[220:223], a[168:171], v[72:75], v[220:223]
    v_mfma_f32_16x16x32_bf16 v[220:223], a[172:175], v[76:79], v[220:223]
    ds_read_b128 v[60:63], v14 offset:35584
    v_mfma_f32_16x16x32_bf16 v[220:223], a[176:179], v[80:83], v[220:223]
    v_mfma_f32_16x16x32_bf16 v[220:223], a[180:183], v[84:87], v[220:223]
    v_mfma_f32_16x16x32_bf16 v[220:223], a[184:187], v[88:91], v[220:223]
    s_waitcnt lgkmcnt(1)
    v_add_u32 v156, 4096, v36
    v_mfma_f32_16x16x32_bf16 v[220:223], a[188:191], v[92:95], v[220:223]
    v_mfma_f32_16x16x32_bf16 v[160:163], a[128:131], v[96:99], v[160:163]
    v_mfma_f32_16x16x32_bf16 v[160:163], a[132:135], v[100:103], v[160:163]
    v_mfma_f32_16x16x32_bf16 v[160:163], a[136:139], v[40:43], v[160:163]
    s_mov_b32 s60, 0xffff0000
    ds_read_b128 v[64:67], v12 offset:35840
    v_mfma_f32_16x16x32_bf16 v[160:163], a[140:143], v[44:47], v[160:163]
    v_mfma_f32_16x16x32_bf16 v[160:163], a[144:147], v[48:51], v[160:163]
    s_lshl_b32 s64, s2, 13
    v_mfma_f32_16x16x32_bf16 v[160:163], a[148:151], v[52:55], v[160:163]
    v_mfma_f32_16x16x32_bf16 v[160:163], a[152:155], v[56:59], v[160:163]
    s_add_u32 s64, s64, 10354688
    v_mfma_f32_16x16x32_bf16 v[192:195], a[128:131], v[100:103], v[192:195]
    v_mfma_f32_16x16x32_bf16 v[192:195], a[132:135], v[40:43], v[192:195]
    s_barrier
    s_lshl_b32 s65, s2, 6
    v_mfma_f32_16x16x32_bf16 v[192:195], a[136:139], v[44:47], v[192:195]
    s_add_u32 m0, s54, 0
    ds_read_b128 v[68:71], v14 offset:35840
    v_mfma_f32_16x16x32_bf16 v[192:195], a[140:143], v[48:51], v[192:195]
    buffer_load_dwordx4 v2, s[24:27], s70 offen  lds
    v_mfma_f32_16x16x32_bf16 v[192:195], a[144:147], v[52:55], v[192:195]
    s_add_u32 s65, s65, 14942208
    v_mfma_f32_16x16x32_bf16 v[192:195], a[148:151], v[56:59], v[192:195]
    s_waitcnt lgkmcnt(1)
    v_mfma_f32_16x16x32_bf16 v[192:195], a[152:155], v[60:63], v[192:195]
    s_add_u32 s66, s65, 16384
    v_mfma_f32_16x16x32_bf16 v[164:167], a[128:131], v[40:43], v[164:167]
    v_mfma_f32_16x16x32_bf16 v[164:167], a[132:135], v[44:47], v[164:167]
    s_add_u32 m0, s54, 8192
    s_lshl_b32 s62, s2, 4
    v_mfma_f32_16x16x32_bf16 v[164:167], a[136:139], v[48:51], v[164:167]
    ds_read_b128 v[72:75], v12 offset:36096
    v_mfma_f32_16x16x32_bf16 v[164:167], a[140:143], v[52:55], v[164:167]
    buffer_load_dwordx4 v3, s[24:27], s70 offen  lds
    v_mfma_f32_16x16x32_bf16 v[164:167], a[144:147], v[56:59], v[164:167]
    s_add_u32 s62, s62, 15094784
    v_mfma_f32_16x16x32_bf16 v[164:167], a[148:151], v[60:63], v[164:167]
    v_mfma_f32_16x16x32_bf16 v[164:167], a[152:155], v[64:67], v[164:167]
    s_mov_b32 s63, 1077455419
    v_mfma_f32_16x16x32_bf16 v[196:199], a[128:131], v[44:47], v[196:199]
    s_add_u32 m0, s54, 16384
    v_mfma_f32_16x16x32_bf16 v[196:199], a[132:135], v[48:51], v[196:199]
    s_lshl_b32 s67, s48, 15
    buffer_load_dwordx4 v4, s[24:27], s70 offen  lds
    v_min_u32 v149, 47, v0
    v_mfma_f32_16x16x32_bf16 v[196:199], a[136:139], v[52:55], v[196:199]
    s_lshl_b32 s56, s8, 10
    ds_read_b128 v[76:79], v14 offset:36096
    v_mfma_f32_16x16x32_bf16 v[196:199], a[140:143], v[56:59], v[196:199]
    s_add_u32 s56, s56, 15056896
    v_mfma_f32_16x16x32_bf16 v[196:199], a[144:147], v[60:63], v[196:199]
    s_add_u32 s67, s67, 14680064
    v_lshl_add_u32 v149, v149, 4, s56
    v_mfma_f32_16x16x32_bf16 v[196:199], a[148:151], v[64:67], v[196:199]
    s_waitcnt lgkmcnt(1)
    v_mfma_f32_16x16x32_bf16 v[196:199], a[152:155], v[68:71], v[196:199]
    s_add_u32 m0, s54, 24576
    v_mfma_f32_16x16x32_bf16 v[168:171], a[128:131], v[48:51], v[168:171]
    buffer_load_dwordx4 v5, s[24:27], s70 offen  lds
    v_mfma_f32_16x16x32_bf16 v[168:171], a[132:135], v[52:55], v[168:171]
    v_mfma_f32_16x16x32_bf16 v[168:171], a[136:139], v[56:59], v[168:171]
    ds_read_b128 v[80:83], v12 offset:36352
    v_mfma_f32_16x16x32_bf16 v[168:171], a[140:143], v[60:63], v[168:171]
    v_mfma_f32_16x16x32_bf16 v[168:171], a[144:147], v[64:67], v[168:171]
    v_mfma_f32_16x16x32_bf16 v[168:171], a[148:151], v[68:71], v[168:171]
    s_add_u32 m0, s54, 1024
    v_mfma_f32_16x16x32_bf16 v[168:171], a[152:155], v[72:75], v[168:171]
    buffer_load_dwordx4 v6, s[24:27], s70 offen  lds
    v_mfma_f32_16x16x32_bf16 v[200:203], a[128:131], v[52:55], v[200:203]
    v_mfma_f32_16x16x32_bf16 v[200:203], a[132:135], v[56:59], v[200:203]
    v_mfma_f32_16x16x32_bf16 v[200:203], a[136:139], v[60:63], v[200:203]
    ds_read_b128 v[84:87], v14 offset:36352
    v_mfma_f32_16x16x32_bf16 v[200:203], a[140:143], v[64:67], v[200:203]
    v_mfma_f32_16x16x32_bf16 v[200:203], a[144:147], v[68:71], v[200:203]
    s_add_u32 m0, s54, 9216
    v_mfma_f32_16x16x32_bf16 v[200:203], a[148:151], v[72:75], v[200:203]
    s_waitcnt lgkmcnt(1)
    buffer_load_dwordx4 v7, s[24:27], s70 offen  lds
    v_mfma_f32_16x16x32_bf16 v[200:203], a[152:155], v[76:79], v[200:203]
    s_waitcnt vmcnt(8)
    s_barrier
    v_mfma_f32_16x16x32_bf16 v[172:175], a[128:131], v[56:59], v[172:175]
    v_mfma_f32_16x16x32_bf16 v[172:175], a[132:135], v[60:63], v[172:175]
    ds_read_b64_tr_b16 a[160:161], v33 offset:0
    v_mfma_f32_16x16x32_bf16 v[172:175], a[136:139], v[64:67], v[172:175]
    ds_read_b128 v[88:91], v12 offset:36608
    v_mfma_f32_16x16x32_bf16 v[172:175], a[140:143], v[68:71], v[172:175]
    s_add_u32 m0, s54, 17408
    v_mfma_f32_16x16x32_bf16 v[172:175], a[144:147], v[72:75], v[172:175]
    ds_read_b64_tr_b16 a[162:163], v33 offset:512
    v_mfma_f32_16x16x32_bf16 v[172:175], a[148:151], v[76:79], v[172:175]
    buffer_load_dwordx4 v8, s[24:27], s70 offen  lds
    v_mfma_f32_16x16x32_bf16 v[172:175], a[152:155], v[80:83], v[172:175]
    buffer_load_dword v150, v149, s[36:39], 0 offen sc1
    v_mfma_f32_16x16x32_bf16 v[204:207], a[128:131], v[60:63], v[204:207]
    ds_read_b128 v[92:95], v14 offset:36608
    v_mfma_f32_16x16x32_bf16 v[204:207], a[132:135], v[64:67], v[204:207]
    ds_read_b64_tr_b16 a[164:165], v33 offset:4096
    v_mfma_f32_16x16x32_bf16 v[204:207], a[136:139], v[68:71], v[204:207]
    s_add_u32 m0, s54, 25600
    v_mfma_f32_16x16x32_bf16 v[204:207], a[140:143], v[72:75], v[204:207]
    ds_read_b128 v[96:99], v13 offset:36864
    v_mfma_f32_16x16x32_bf16 v[204:207], a[144:147], v[76:79], v[204:207]
    ds_read_b64_tr_b16 a[166:167], v33 offset:4608
    v_mfma_f32_16x16x32_bf16 v[204:207], a[148:151], v[80:83], v[204:207]
    s_waitcnt lgkmcnt(5)
    buffer_load_dwordx4 v9, s[24:27], s70 offen  lds
    v_mfma_f32_16x16x32_bf16 v[204:207], a[152:155], v[84:87], v[204:207]
    ds_read_b64_tr_b16 a[168:169], v33 offset:8192
    v_mfma_f32_16x16x32_bf16 v[176:179], a[128:131], v[64:67], v[176:179]
    ds_read_b128 v[100:103], v15 offset:36864
    v_mfma_f32_16x16x32_bf16 v[176:179], a[132:135], v[68:71], v[176:179]
    s_mov_b32 m0, 32768
    v_mfma_f32_16x16x32_bf16 v[176:179], a[136:139], v[72:75], v[176:179]
    ds_read_b64_tr_b16 a[170:171], v33 offset:8704
    v_mfma_f32_16x16x32_bf16 v[176:179], a[140:143], v[76:79], v[176:179]
    buffer_load_dwordx4 v10, s[24:27], s70 offen  lds
    v_mfma_f32_16x16x32_bf16 v[176:179], a[144:147], v[80:83], v[176:179]
    ds_read_b128 v[40:43], v13 offset:37120
    v_mfma_f32_16x16x32_bf16 v[176:179], a[148:151], v[84:87], v[176:179]
    ds_read_b64_tr_b16 a[172:173], v33 offset:12288
    v_mfma_f32_16x16x32_bf16 v[176:179], a[152:155], v[88:91], v[176:179]
    v_mfma_f32_16x16x32_bf16 v[208:211], a[128:131], v[68:71], v[208:211]
    v_mfma_f32_16x16x32_bf16 v[208:211], a[132:135], v[72:75], v[208:211]
    ds_read_b128 v[44:47], v15 offset:37120
    v_mfma_f32_16x16x32_bf16 v[208:211], a[136:139], v[76:79], v[208:211]
    s_add_u32 m0, s53, 139264
    ds_read_b64_tr_b16 a[174:175], v33 offset:12800
    v_mfma_f32_16x16x32_bf16 v[208:211], a[140:143], v[80:83], v[208:211]
    buffer_load_dwordx4 v104, s[32:35], s4 offen  lds
    v_mfma_f32_16x16x32_bf16 v[208:211], a[144:147], v[84:87], v[208:211]
    ds_read_b64_tr_b16 a[176:177], v33 offset:16384
    v_mfma_f32_16x16x32_bf16 v[208:211], a[148:151], v[88:91], v[208:211]
    s_waitcnt lgkmcnt(5)
    ds_read_b128 v[48:51], v13 offset:37376
    v_mfma_f32_16x16x32_bf16 v[208:211], a[152:155], v[92:95], v[208:211]
    v_mfma_f32_16x16x32_bf16 v[180:183], a[128:131], v[72:75], v[180:183]
    s_add_u32 m0, s53, 143360
    ds_read_b64_tr_b16 a[178:179], v33 offset:16896
    v_mfma_f32_16x16x32_bf16 v[180:183], a[132:135], v[76:79], v[180:183]
    buffer_load_dwordx4 v104, s[32:35], s5 offen  lds
    v_mfma_f32_16x16x32_bf16 v[180:183], a[136:139], v[80:83], v[180:183]
    ds_read_b128 v[52:55], v15 offset:37376
    v_mfma_f32_16x16x32_bf16 v[180:183], a[140:143], v[84:87], v[180:183]
    ds_read_b64_tr_b16 a[180:181], v33 offset:20480
    v_mfma_f32_16x16x32_bf16 v[180:183], a[144:147], v[88:91], v[180:183]
    v_mfma_f32_16x16x32_bf16 v[180:183], a[148:151], v[92:95], v[180:183]
    v_mfma_f32_16x16x32_bf16 v[180:183], a[152:155], v[96:99], v[180:183]
    ds_read_b128 v[56:59], v16 offset:34816
    v_mfma_f32_16x16x32_bf16 v[212:215], a[128:131], v[76:79], v[212:215]
    ds_read_b64_tr_b16 a[182:183], v33 offset:20992
    v_mfma_f32_16x16x32_bf16 v[212:215], a[132:135], v[80:83], v[212:215]
    v_mfma_f32_16x16x32_bf16 v[212:215], a[136:139], v[84:87], v[212:215]
    ds_read_b64_tr_b16 a[184:185], v33 offset:24576
    v_mfma_f32_16x16x32_bf16 v[212:215], a[140:143], v[88:91], v[212:215]
    ds_read_b128 v[60:63], v18 offset:34816
    v_mfma_f32_16x16x32_bf16 v[212:215], a[144:147], v[92:95], v[212:215]
    v_mfma_f32_16x16x32_bf16 v[212:215], a[148:151], v[96:99], v[212:215]
    s_mov_b32 s32, s10
    ds_read_b64_tr_b16 a[186:187], v33 offset:25088
    v_mfma_f32_16x16x32_bf16 v[212:215], a[152:155], v[100:103], v[212:215]
    s_mov_b32 s33, s11
    v_mfma_f32_16x16x32_bf16 v[184:187], a[128:131], v[80:83], v[184:187]
    ds_read_b128 v[64:67], v16 offset:35072
    v_mfma_f32_16x16x32_bf16 v[184:187], a[132:135], v[84:87], v[184:187]
    s_mov_b32 s34, 8192
    v_mfma_f32_16x16x32_bf16 v[184:187], a[136:139], v[88:91], v[184:187]
    v_and_b32 v151, 31, v0
    v_mfma_f32_16x16x32_bf16 v[184:187], a[140:143], v[92:95], v[184:187]
    v_mfma_f32_16x16x32_bf16 v[184:187], a[144:147], v[96:99], v[184:187]
    ds_read_b128 v[68:71], v18 offset:35072
    v_mfma_f32_16x16x32_bf16 v[184:187], a[148:151], v[100:103], v[184:187]
    s_waitcnt lgkmcnt(4)
    s_lshl_b32 s57, s48, 9
    v_mfma_f32_16x16x32_bf16 v[184:187], a[152:155], v[40:43], v[184:187]
    s_add_u32 s57, s57, 15089664
    v_mfma_f32_16x16x32_bf16 v[216:219], a[128:131], v[84:87], v[216:219]
    v_lshl_add_u32 v151, v151, 4, s57
    v_mfma_f32_16x16x32_bf16 v[216:219], a[132:135], v[88:91], v[216:219]
    ds_read_b128 v[72:75], v16 offset:35328
    v_mfma_f32_16x16x32_bf16 v[216:219], a[136:139], v[92:95], v[216:219]
    s_waitcnt vmcnt(4)
    v_cmp_ne_u32 vcc, s3, v150
    s_nop 0
    s_cbranch_vccnz L_cw1
L_cw1_b:
    v_mfma_f32_16x16x32_bf16 v[216:219], a[140:143], v[96:99], v[216:219]
    v_mfma_f32_16x16x32_bf16 v[216:219], a[144:147], v[100:103], v[216:219]
    v_mfma_f32_16x16x32_bf16 v[216:219], a[148:151], v[40:43], v[216:219]
    ds_read_b128 v[76:79], v18 offset:35328
    v_and_b32 v152, 7, v0
    v_mfma_f32_16x16x32_bf16 v[216:219], a[152:155], v[44:47], v[216:219]
    s_add_u32 s55, s9, 0
    buffer_load_dwordx4 a[192:195], v36, s[36:39], s55 offen offset:0 sc1
    v_mfma_f32_16x16x32_bf16 v[188:191], a[128:131], v[88:91], v[188:191]
    v_mfma_f32_16x16x32_bf16 v[188:191], a[132:135], v[92:95], v[188:191]
    s_and_b32 s57, s2, 15
    v_mfma_f32_16x16x32_bf16 v[188:191], a[136:139], v[96:99], v[188:191]
    ds_read_b128 v[80:83], v16 offset:35584
    v_mfma_f32_16x16x32_bf16 v[188:191], a[140:143], v[100:103], v[188:191]
    s_lshl_b32 s57, s57, 7
    buffer_load_dwordx4 a[196:199], v36, s[36:39], s55 offen offset:1024 sc1
    v_mfma_f32_16x16x32_bf16 v[188:191], a[144:147], v[40:43], v[188:191]
    v_mfma_f32_16x16x32_bf16 v[188:191], a[148:151], v[44:47], v[188:191]
    s_add_u32 s57, s57, 15091712
    v_mfma_f32_16x16x32_bf16 v[188:191], a[152:155], v[48:51], v[188:191]
    v_cmp_gt_u32 vcc, 32, v0
    v_mfma_f32_16x16x32_bf16 v[220:223], a[128:131], v[92:95], v[220:223]
    v_mfma_f32_16x16x32_bf16 v[220:223], a[132:135], v[96:99], v[220:223]
    buffer_load_dwordx4 a[200:203], v36, s[36:39], s55 offen offset:2048 sc1
    v_mfma_f32_16x16x32_bf16 v[220:223], a[136:139], v[100:103], v[220:223]
    ds_read_b128 v[84:87], v18 offset:35584
    v_lshl_add_u32 v152, v152, 4, s57
    v_mfma_f32_16x16x32_bf16 v[220:223], a[140:143], v[40:43], v[220:223]
    v_mfma_f32_16x16x32_bf16 v[220:223], a[144:147], v[44:47], v[220:223]
    v_mfma_f32_16x16x32_bf16 v[220:223], a[148:151], v[48:51], v[220:223]
    s_nop 0
    v_mfma_f32_16x16x32_bf16 v[220:223], a[152:155], v[52:55], v[220:223]
    buffer_load_dwordx4 a[204:207], v36, s[36:39], s55 offen offset:3072 sc1
    v_mfma_f32_16x16x32_bf16 v[160:163], a[160:163], v[56:59], v[160:163]
    s_waitcnt lgkmcnt(1)
    v_cndmask_b32 v151, v152, v151, vcc
    v_mfma_f32_16x16x32_bf16 v[160:163], a[164:167], v[60:63], v[160:163]
    v_mfma_f32_16x16x32_bf16 v[160:163], a[168:171], v[64:67], v[160:163]
    ds_read_b128 v[88:91], v16 offset:35840
    v_mfma_f32_16x16x32_bf16 v[160:163], a[172:175], v[68:71], v[160:163]
    v_mfma_f32_16x16x32_bf16 v[160:163], a[176:179], v[72:75], v[160:163]
    s_add_u32 s55, s9, 4096
    buffer_load_dwordx4 a[208:211], v36, s[36:39], s55 offen offset:0 sc1
    v_mfma_f32_16x16x32_bf16 v[160:163], a[180:183], v[76:79], v[160:163]
    v_mfma_f32_16x16x32_bf16 v[160:163], a[184:187], v[80:83], v[160:163]
    v_mfma_f32_16x16x32_bf16 v[192:195], a[160:163], v[60:63], v[192:195]
    v_mfma_f32_16x16x32_bf16 v[192:195], a[164:167], v[64:67], v[192:195]
    s_waitcnt vmcnt(7)
    s_barrier
    v_mfma_f32_16x16x32_bf16 v[192:195], a[168:171], v[68:71], v[192:195]
    s_add_u32 m0, s54, 69632
    ds_read_b128 v[92:95], v18 offset:35840
    v_mfma_f32_16x16x32_bf16 v[192:195], a[172:175], v[72:75], v[192:195]
    buffer_load_dwordx4 v11, s[24:27], s70 offen  lds
    v_mfma_f32_16x16x32_bf16 v[192:195], a[176:179], v[76:79], v[192:195]
    ds_read_b128 v[104:107], v28 offset:0
    v_mfma_f32_16x16x32_bf16 v[192:195], a[180:183], v[80:83], v[192:195]
    s_waitcnt lgkmcnt(2)
    ds_read_b128 v[108:111], v29 offset:0
    v_mfma_f32_16x16x32_bf16 v[192:195], a[184:187], v[84:87], v[192:195]
    v_mfma_f32_16x16x32_bf16 v[164:167], a[160:163], v[64:67], v[164:167]
    buffer_load_dwordx4 a[212:215], v36, s[36:39], s55 offen offset:1024 sc1
    v_mfma_f32_16x16x32_bf16 v[164:167], a[164:167], v[68:71], v[164:167]
    v_mfma_f32_16x16x32_bf16 v[164:167], a[168:171], v[72:75], v[164:167]
    ds_read_b128 v[96:99], v16 offset:36096
    v_mfma_f32_16x16x32_bf16 v[164:167], a[172:175], v[76:79], v[164:167]
    v_mfma_f32_16x16x32_bf16 v[164:167], a[176:179], v[80:83], v[164:167]
    s_waitcnt lgkmcnt(1)
    v_lshlrev_b32 v112, 16, v104
    v_mfma_f32_16x16x32_bf16 v[164:167], a[180:183], v[84:87], v[164:167]
    s_add_u32 m0, s54, 77824
    v_lshlrev_b32 v113, 16, v108
    v_mfma_f32_16x16x32_bf16 v[164:167], a[184:187], v[88:91], v[164:167]
    buffer_load_dwordx4 v3, s[24:27], s74 offen  lds
    v_and_b32 v114, s60, v104
    v_mfma_f32_16x16x32_bf16 v[196:199], a[160:163], v[68:71], v[196:199]
    v_and_b32 v115, s60, v108
    v_mfma_f32_16x16x32_bf16 v[196:199], a[164:167], v[72:75], v[196:199]
    ds_read_b128 v[136:139], v28 offset:8192
    v_mfma_f32_16x16x32_bf16 v[196:199], a[168:171], v[76:79], v[196:199]
    ds_read_b128 v[100:103], v18 offset:36096
    v_mfma_f32_16x16x32_bf16 v[196:199], a[172:175], v[80:83], v[196:199]
    s_add_u32 m0, s54, 86016
    ds_read_b128 v[140:143], v29 offset:8192
    v_mfma_f32_16x16x32_bf16 v[196:199], a[176:179], v[84:87], v[196:199]
    buffer_load_dwordx4 v4, s[24:27], s74 offen  lds
    v_lshlrev_b32 v116, 16, v105
    v_mfma_f32_16x16x32_bf16 v[196:199], a[180:183], v[88:91], v[196:199]
    v_lshlrev_b32 v117, 16, v109
    v_and_b32 v118, s60, v105
    v_mfma_f32_16x16x32_bf16 v[196:199], a[184:187], v[92:95], v[196:199]
    v_and_b32 v119, s60, v109
    v_add_f32 v112, v112, v113
    v_mfma_f32_16x16x32_bf16 v[168:171], a[160:163], v[72:75], v[168:171]
    v_add_f32 v114, v114, v115
    v_add_f32 v116, v116, v117
    v_mfma_f32_16x16x32_bf16 v[168:171], a[164:167], v[76:79], v[168:171]
    s_add_u32 m0, s54, 94208
    v_add_f32 v118, v118, v119
    v_cvt_pk_bf16_f32 v104, v112, v114
    v_mfma_f32_16x16x32_bf16 v[168:171], a[168:171], v[80:83], v[168:171]
    ds_read_b128 v[40:43], v16 offset:36352
    v_cvt_pk_bf16_f32 v105, v116, v118
    v_mfma_f32_16x16x32_bf16 v[168:171], a[172:175], v[84:87], v[168:171]
    buffer_load_dwordx4 v5, s[24:27], s74 offen  lds
    v_lshlrev_b32 v112, 16, v106
    v_mfma_f32_16x16x32_bf16 v[168:171], a[176:179], v[88:91], v[168:171]
    v_lshlrev_b32 v113, 16, v110
    v_and_b32 v114, s60, v106
    v_mfma_f32_16x16x32_bf16 v[168:171], a[180:183], v[92:95], v[168:171]
    s_waitcnt lgkmcnt(2)
    v_and_b32 v115, s60, v110
    v_lshlrev_b32 v116, 16, v107
    v_mfma_f32_16x16x32_bf16 v[168:171], a[184:187], v[96:99], v[168:171]
    s_add_u32 m0, s54, 70656
    v_lshlrev_b32 v117, 16, v111
    v_and_b32 v118, s60, v107
    v_mfma_f32_16x16x32_bf16 v[200:203], a[160:163], v[76:79], v[200:203]
    buffer_load_dwordx4 v6, s[24:27], s74 offen  lds
    v_and_b32 v119, s60, v111
    v_mfma_f32_16x16x32_bf16 v[200:203], a[164:167], v[80:83], v[200:203]
    v_add_f32 v112, v112, v113
    v_add_f32 v114, v114, v115
    v_mfma_f32_16x16x32_bf16 v[200:203], a[168:171], v[84:87], v[200:203]
    ds_read_b128 v[44:47], v18 offset:36352
    v_add_f32 v116, v116, v117
    v_mfma_f32_16x16x32_bf16 v[200:203], a[172:175], v[88:91], v[200:203]
    v_add_f32 v118, v118, v119
    v_cvt_pk_bf16_f32 v106, v112, v114
    v_mfma_f32_16x16x32_bf16 v[200:203], a[176:179], v[92:95], v[200:203]
    s_add_u32 m0, s54, 78848
    v_cvt_pk_bf16_f32 v107, v116, v118
    v_mfma_f32_16x16x32_bf16 v[200:203], a[180:183], v[96:99], v[200:203]
    buffer_load_dwordx4 v7, s[24:27], s74 offen  lds
    v_mfma_f32_16x16x32_bf16 v[200:203], a[184:187], v[100:103], v[200:203]
    ds_write_b128 v30, v[104:107] offset:0
    v_mfma_f32_16x16x32_bf16 v[172:175], a[160:163], v[80:83], v[172:175]
    s_waitcnt lgkmcnt(2)
    v_lshlrev_b32 v112, 16, v136
    v_lshlrev_b32 v113, 16, v140
    v_mfma_f32_16x16x32_bf16 v[172:175], a[164:167], v[84:87], v[172:175]
    v_and_b32 v114, s60, v136
    v_and_b32 v115, s60, v140
    v_mfma_f32_16x16x32_bf16 v[172:175], a[168:171], v[88:91], v[172:175]
    ds_read_b128 v[48:51], v16 offset:36608
    v_mfma_f32_16x16x32_bf16 v[172:175], a[172:175], v[92:95], v[172:175]
    buffer_load_dwordx4 a[216:219], v36, s[36:39], s55 offen offset:2048 sc1
    v_mfma_f32_16x16x32_bf16 v[172:175], a[176:179], v[96:99], v[172:175]
    ds_read_b128 v[104:107], v28 offset:16384
    v_mfma_f32_16x16x32_bf16 v[172:175], a[180:183], v[100:103], v[172:175]
    ds_read_b128 v[108:111], v29 offset:16384
    v_lshlrev_b32 v116, 16, v137
    v_mfma_f32_16x16x32_bf16 v[172:175], a[184:187], v[40:43], v[172:175]
    v_lshlrev_b32 v117, 16, v141
    v_and_b32 v118, s60, v137
    v_mfma_f32_16x16x32_bf16 v[204:207], a[160:163], v[84:87], v[204:207]
    s_add_u32 m0, s54, 87040
    v_and_b32 v119, s60, v141
    v_add_f32 v112, v112, v113
    v_mfma_f32_16x16x32_bf16 v[204:207], a[164:167], v[88:91], v[204:207]
    buffer_load_dwordx4 v8, s[24:27], s74 offen  lds
    v_add_f32 v114, v114, v115
    v_mfma_f32_16x16x32_bf16 v[204:207], a[168:171], v[92:95], v[204:207]
    ds_read_b128 v[52:55], v18 offset:36608
    v_add_f32 v116, v116, v117
    v_mfma_f32_16x16x32_bf16 v[204:207], a[172:175], v[96:99], v[204:207]
    v_add_f32 v118, v118, v119
    v_cvt_pk_bf16_f32 v136, v112, v114
    v_mfma_f32_16x16x32_bf16 v[204:207], a[176:179], v[100:103], v[204:207]
    v_cvt_pk_bf16_f32 v137, v116, v118
    v_lshlrev_b32 v112, 16, v138
    v_mfma_f32_16x16x32_bf16 v[204:207], a[180:183], v[40:43], v[204:207]
    s_waitcnt lgkmcnt(3)
    s_add_u32 m0, s54, 95232
    v_lshlrev_b32 v113, 16, v142
    v_mfma_f32_16x16x32_bf16 v[204:207], a[184:187], v[44:47], v[204:207]
    buffer_load_dwordx4 v9, s[24:27], s74 offen  lds
    v_and_b32 v114, s60, v138
    v_mfma_f32_16x16x32_bf16 v[176:179], a[160:163], v[88:91], v[176:179]
    v_and_b32 v115, s60, v142
    v_lshlrev_b32 v116, 16, v139
    v_mfma_f32_16x16x32_bf16 v[176:179], a[164:167], v[92:95], v[176:179]
    v_lshlrev_b32 v117, 16, v143
    v_and_b32 v118, s60, v139
    v_mfma_f32_16x16x32_bf16 v[176:179], a[168:171], v[96:99], v[176:179]
    ds_read_b128 v[56:59], v17 offset:36864
    v_and_b32 v119, s60, v143
    v_mfma_f32_16x16x32_bf16 v[176:179], a[172:175], v[100:103], v[176:179]
    buffer_load_dwordx4 a[220:223], v36, s[36:39], s55 offen offset:3072 sc1
    v_add_f32 v112, v112, v113
    v_mfma_f32_16x16x32_bf16 v[176:179], a[176:179], v[40:43], v[176:179]
    v_add_f32 v114, v114, v115
    v_add_f32 v116, v116, v117
    v_mfma_f32_16x16x32_bf16 v[176:179], a[180:183], v[44:47], v[176:179]
    v_add_f32 v118, v118, v119
    v_cvt_pk_bf16_f32 v138, v112, v114
    v_mfma_f32_16x16x32_bf16 v[176:179], a[184:187], v[48:51], v[176:179]
    v_cvt_pk_bf16_f32 v139, v116, v118
    v_mfma_f32_16x16x32_bf16 v[208:211], a[160:163], v[92:95], v[208:211]
    ds_write_b128 v31, v[136:139] offset:4096
    v_mfma_f32_16x16x32_bf16 v[208:211], a[164:167], v[96:99], v[208:211]
    s_waitcnt lgkmcnt(2)
    s_mov_b32 m0, 102400
    v_lshlrev_b32 v112, 16, v104
    v_mfma_f32_16x16x32_bf16 v[208:211], a[168:171], v[100:103], v[208:211]
    ds_read_b128 v[60:63], v19 offset:36864
    v_lshlrev_b32 v113, 16, v108
    v_mfma_f32_16x16x32_bf16 v[208:211], a[172:175], v[40:43], v[208:211]
    buffer_load_dwordx4 v10, s[24:27], s74 offen  lds
    v_and_b32 v114, s60, v104
    v_mfma_f32_16x16x32_bf16 v[208:211], a[176:179], v[44:47], v[208:211]
    buffer_load_dword v1, v34, s[24:27], s71 offen
    v_and_b32 v115, s60, v108
    v_mfma_f32_16x16x32_bf16 v[208:211], a[180:183], v[48:51], v[208:211]
    ds_read_b128 v[136:139], v28 offset:24576
    v_mfma_f32_16x16x32_bf16 v[208:211], a[184:187], v[52:55], v[208:211]
    s_add_u32 s55, s9, 8192
    buffer_load_dwordx4 a[224:227], v36, s[36:39], s55 offen offset:0 sc1
    v_mfma_f32_16x16x32_bf16 v[180:183], a[160:163], v[96:99], v[180:183]
    ds_read_b128 v[140:143], v29 offset:24576
    v_lshlrev_b32 v116, 16, v105
    v_mfma_f32_16x16x32_bf16 v[180:183], a[164:167], v[100:103], v[180:183]
    v_lshlrev_b32 v117, 16, v109
    v_and_b32 v118, s60, v105
    v_mfma_f32_16x16x32_bf16 v[180:183], a[168:171], v[40:43], v[180:183]
    ds_read_b128 v[64:67], v17 offset:37120
    v_and_b32 v119, s60, v109
    v_mfma_f32_16x16x32_bf16 v[180:183], a[172:175], v[44:47], v[180:183]
    v_add_f32 v112, v112, v113
    v_add_f32 v114, v114, v115
    v_mfma_f32_16x16x32_bf16 v[180:183], a[176:179], v[48:51], v[180:183]
    buffer_load_dwordx4 a[228:231], v36, s[36:39], s55 offen offset:1024 sc1
    v_add_f32 v116, v116, v117
    v_mfma_f32_16x16x32_bf16 v[180:183], a[180:183], v[52:55], v[180:183]
    s_waitcnt lgkmcnt(3)
    v_add_f32 v118, v118, v119
    v_cvt_pk_bf16_f32 v104, v112, v114
    v_mfma_f32_16x16x32_bf16 v[180:183], a[184:187], v[56:59], v[180:183]
    v_cvt_pk_bf16_f32 v105, v116, v118
    v_lshlrev_b32 v112, 16, v106
    v_mfma_f32_16x16x32_bf16 v[212:215], a[160:163], v[100:103], v[212:215]
    v_lshlrev_b32 v113, 16, v110
    v_and_b32 v114, s60, v106
    v_mfma_f32_16x16x32_bf16 v[212:215], a[164:167], v[40:43], v[212:215]
    v_and_b32 v115, s60, v110
    v_lshlrev_b32 v116, 16, v107
    v_mfma_f32_16x16x32_bf16 v[212:215], a[168:171], v[44:47], v[212:215]
    ds_read_b128 v[68:71], v19 offset:37120
    v_lshlrev_b32 v117, 16, v111
    v_mfma_f32_16x16x32_bf16 v[212:215], a[172:175], v[48:51], v[212:215]
    buffer_load_dwordx4 a[232:235], v36, s[36:39], s55 offen offset:2048 sc1
    v_and_b32 v118, s60, v107
    v_mfma_f32_16x16x32_bf16 v[212:215], a[176:179], v[52:55], v[212:215]
    v_and_b32 v119, s60, v111
    v_add_f32 v112, v112, v113
    v_mfma_f32_16x16x32_bf16 v[212:215], a[180:183], v[56:59], v[212:215]
    v_add_f32 v114, v114, v115
    v_add_f32 v116, v116, v117
    v_mfma_f32_16x16x32_bf16 v[212:215], a[184:187], v[60:63], v[212:215]
    v_add_f32 v118, v118, v119
    v_cvt_pk_bf16_f32 v106, v112, v114
    v_mfma_f32_16x16x32_bf16 v[184:187], a[160:163], v[40:43], v[184:187]
    buffer_load_dwordx4 a[236:239], v36, s[36:39], s55 offen offset:3072 sc1
    v_cvt_pk_bf16_f32 v107, v116, v118
    v_mfma_f32_16x16x32_bf16 v[184:187], a[164:167], v[44:47], v[184:187]
    ds_write_b128 v30, v[104:107] offset:8192
    v_mfma_f32_16x16x32_bf16 v[184:187], a[168:171], v[48:51], v[184:187]
    s_waitcnt lgkmcnt(2)
    ds_read_b128 v[72:75], v17 offset:37376
    v_lshlrev_b32 v112, 16, v136
    v_mfma_f32_16x16x32_bf16 v[184:187], a[172:175], v[52:55], v[184:187]
    ds_read_b128 v[76:79], v12 offset:0
    v_lshlrev_b32 v113, 16, v140
    v_mfma_f32_16x16x32_bf16 v[184:187], a[176:179], v[56:59], v[184:187]
    v_and_b32 v114, s60, v136
    v_and_b32 v115, s60, v140
    v_mfma_f32_16x16x32_bf16 v[184:187], a[180:183], v[60:63], v[184:187]
    s_add_u32 s55, s9, 12288
    buffer_load_dwordx4 a[240:243], v36, s[36:39], s55 offen offset:0 sc1
    v_subrev_u32 v146, s54, v28
    v_mfma_f32_16x16x32_bf16 v[184:187], a[184:187], v[64:67], v[184:187]
    ds_read_b128 v[80:83], v12 offset:256
    v_xor_b32 v147, 128, v146
    v_mfma_f32_16x16x32_bf16 v[216:219], a[160:163], v[44:47], v[216:219]
    v_subrev_u32 v148, s53, v30
    v_mfma_f32_16x16x32_bf16 v[216:219], a[164:167], v[48:51], v[216:219]
    ds_read_b128 v[84:87], v12 offset:512
    v_mfma_f32_16x16x32_bf16 v[216:219], a[168:171], v[52:55], v[216:219]
    ds_read_b128 v[88:91], v19 offset:37376
    v_mfma_f32_16x16x32_bf16 v[216:219], a[172:175], v[56:59], v[216:219]
    buffer_load_dwordx4 a[244:247], v36, s[36:39], s55 offen offset:1024 sc1
    v_mfma_f32_16x16x32_bf16 v[216:219], a[176:179], v[60:63], v[216:219]
    ds_read_b128 v[92:95], v12 offset:768
    ds_read_b128 v[104:107], v146 offset:32768
    v_mfma_f32_16x16x32_bf16 v[216:219], a[180:183], v[64:67], v[216:219]
    s_waitcnt lgkmcnt(6)
    ds_read_b128 v[108:111], v147 offset:32768
    v_lshlrev_b32 v116, 16, v137
    v_mfma_f32_16x16x32_bf16 v[216:219], a[184:187], v[68:71], v[216:219]
    v_lshlrev_b32 v117, 16, v141
    v_and_b32 v118, s60, v137
    v_mfma_f32_16x16x32_bf16 v[188:191], a[160:163], v[48:51], v[188:191]
    v_and_b32 v119, s60, v141
    v_add_f32 v112, v112, v113
    v_mfma_f32_16x16x32_bf16 v[188:191], a[164:167], v[52:55], v[188:191]
    ds_read_b128 v[96:99], v12 offset:1024
    v_add_f32 v114, v114, v115
    v_mfma_f32_16x16x32_bf16 v[188:191], a[168:171], v[56:59], v[188:191]
    buffer_load_dwordx4 a[248:251], v36, s[36:39], s55 offen offset:2048 sc1
    v_add_f32 v116, v116, v117
    v_mfma_f32_16x16x32_bf16 v[188:191], a[172:175], v[60:63], v[188:191]
    v_add_f32 v118, v118, v119
    v_cvt_pk_bf16_f32 v136, v112, v114
    v_mfma_f32_16x16x32_bf16 v[188:191], a[176:179], v[64:67], v[188:191]
    v_cvt_pk_bf16_f32 v137, v116, v118
    v_lshlrev_b32 v112, 16, v138
    v_mfma_f32_16x16x32_bf16 v[188:191], a[180:183], v[68:71], v[188:191]
    ds_read_b128 v[100:103], v12 offset:1280
    v_lshlrev_b32 v113, 16, v142
    v_mfma_f32_16x16x32_bf16 v[188:191], a[184:187], v[72:75], v[188:191]
    buffer_load_dwordx4 a[252:255], v36, s[36:39], s55 offen offset:3072 sc1
    v_and_b32 v114, s60, v138
    v_mfma_f32_16x16x32_bf16 v[220:223], a[160:163], v[52:55], v[220:223]
    v_and_b32 v115, s60, v142
    v_lshlrev_b32 v116, 16, v139
    v_mfma_f32_16x16x32_bf16 v[220:223], a[164:167], v[56:59], v[220:223]
    v_lshlrev_b32 v117, 16, v143
    v_and_b32 v118, s60, v139
    v_mfma_f32_16x16x32_bf16 v[220:223], a[168:171], v[60:63], v[220:223]
    ds_read_b128 v[40:43], v12 offset:1536
    v_and_b32 v119, s60, v143
    v_mfma_f32_16x16x32_bf16 v[220:223], a[172:175], v[64:67], v[220:223]
    v_add_f32 v112, v112, v113
    v_add_f32 v114, v114, v115
    v_mfma_f32_16x16x32_bf16 v[220:223], a[176:179], v[68:71], v[220:223]
    ds_read_b128 v[44:47], v12 offset:1792
    v_add_f32 v116, v116, v117
    v_mfma_f32_16x16x32_bf16 v[220:223], a[180:183], v[72:75], v[220:223]
    s_waitcnt lgkmcnt(3)
    s_add_u32 s55, s9, 16384
    buffer_load_dwordx4 a[156:159], v36, s[36:39], s55 offen offset:0 sc1
    v_mfma_f32_16x16x32_bf16 v[220:223], a[184:187], v[88:91], v[220:223]
    s_waitcnt vmcnt(23)
    v_add_f32 v118, v118, v119
    v_cvt_pk_bf16_f32 v138, v112, v114
    v_mfma_f32_16x16x32_bf16 v[224:227], a[192:195], v[76:79], 0
    ds_read_b128 v[48:51], v13 offset:2048
    v_cvt_pk_bf16_f32 v139, v116, v118
    v_mfma_f32_16x16x32_bf16 v[224:227], a[196:199], v[80:83], v[224:227]
    ds_write_b128 v31, v[136:139] offset:12288
    v_mfma_f32_16x16x32_bf16 v[224:227], a[200:203], v[84:87], v[224:227]
    ds_read_b128 v[52:55], v13 offset:2304
    v_lshlrev_b32 v112, 16, v104
    v_mfma_f32_16x16x32_bf16 v[224:227], a[204:207], v[92:95], v[224:227]
    buffer_load_dwordx4 a[188:191], v36, s[36:39], s55 offen offset:1024 sc1
    v_lshlrev_b32 v113, 16, v108
    v_add_f32 v160, v160, v192
    v_mfma_f32_16x16x32_bf16 v[228:231], a[192:195], v[80:83], 0
    v_and_b32 v114, s60, v104
    v_and_b32 v115, s60, v108
    v_add_f32 v161, v161, v193
    v_mfma_f32_16x16x32_bf16 v[228:231], a[196:199], v[84:87], v[228:231]
    ds_read_b128 v[56:59], v13 offset:2560
    v_lshlrev_b32 v116, 16, v105
    v_add_f32 v162, v162, v194
    v_mfma_f32_16x16x32_bf16 v[228:231], a[200:203], v[92:95], v[228:231]
    v_lshlrev_b32 v117, 16, v109
    v_and_b32 v118, s60, v105
    v_add_f32 v163, v163, v195
    v_mfma_f32_16x16x32_bf16 v[228:231], a[204:207], v[96:99], v[228:231]
    ds_read_b128 v[60:63], v14 offset:0
    v_and_b32 v119, s60, v109
    v_add_f32 v164, v164, v196
    v_mfma_f32_16x16x32_bf16 v[232:235], a[192:195], v[84:87], 0
    buffer_load_dwordx4 a[128:131], v36, s[36:39], s55 offen offset:2048 sc1
    v_add_f32 v112, v112, v113
    v_add_f32 v165, v165, v197
    v_mfma_f32_16x16x32_bf16 v[232:235], a[196:199], v[92:95], v[232:235]
    v_add_f32 v114, v114, v115
    v_add_f32 v116, v116, v117
    v_add_f32 v166, v166, v198
    v_mfma_f32_16x16x32_bf16 v[232:235], a[200:203], v[96:99], v[232:235]
    s_waitcnt lgkmcnt(4)
    ds_read_b128 v[64:67], v14 offset:256
    v_add_f32 v118, v118, v119
    v_mfma_f32_16x16x32_bf16 v[232:235], a[204:207], v[100:103], v[232:235]
    v_cvt_pk_bf16_f32 v104, v112, v114
    v_cvt_pk_bf16_f32 v105, v116, v118
    v_add_f32 v167, v167, v199
    v_mfma_f32_16x16x32_bf16 v[236:239], a[192:195], v[92:95], 0
    ds_read_b128 v[68:71], v14 offset:512
    v_lshlrev_b32 v112, 16, v106
    v_add_f32 v168, v168, v200
    v_mfma_f32_16x16x32_bf16 v[236:239], a[196:199], v[96:99], v[236:239]
    buffer_load_dwordx4 a[132:135], v36, s[36:39], s55 offen offset:3072 sc1
    v_lshlrev_b32 v113, 16, v110
    v_add_f32 v169, v169, v201
    v_mfma_f32_16x16x32_bf16 v[236:239], a[200:203], v[100:103], v[236:239]
    v_and_b32 v114, s60, v106
    v_and_b32 v115, s60, v110
    v_add_f32 v170, v170, v202
    v_mfma_f32_16x16x32_bf16 v[236:239], a[204:207], v[40:43], v[236:239]
    ds_read_b128 v[72:75], v14 offset:768
    v_lshlrev_b32 v116, 16, v107
    v_add_f32 v171, v171, v203
    v_mfma_f32_16x16x32_bf16 v[240:243], a[192:195], v[96:99], 0
    v_lshlrev_b32 v117, 16, v111
    v_and_b32 v118, s60, v107
    v_add_f32 v172, v172, v204
    v_mfma_f32_16x16x32_bf16 v[240:243], a[196:199], v[100:103], v[240:243]
    s_add_u32 s55, s9, 20480
    buffer_load_dwordx4 a[136:139], v36, s[36:39], s55 offen offset:0 sc1
    v_and_b32 v119, s60, v111
    v_add_f32 v173, v173, v205
    v_mfma_f32_16x16x32_bf16 v[240:243], a[200:203], v[40:43], v[240:243]
    v_add_f32 v112, v112, v113
    v_add_f32 v114, v114, v115
    v_mfma_f32_16x16x32_bf16 v[240:243], a[204:207], v[44:47], v[240:243]
    ds_read_b128 v[88:91], v14 offset:1024
    v_add_f32 v116, v116, v117
    v_add_f32 v174, v174, v206
    v_mfma_f32_16x16x32_bf16 v[244:247], a[192:195], v[100:103], 0
    v_add_f32 v118, v118, v119
    v_cvt_pk_bf16_f32 v106, v112, v114
    v_add_f32 v175, v175, v207
    v_mfma_f32_16x16x32_bf16 v[244:247], a[196:199], v[40:43], v[244:247]
    v_cvt_pk_bf16_f32 v107, v116, v118
    v_add_f32 v176, v176, v208
    v_add_f32 v177, v177, v209
    v_mfma_f32_16x16x32_bf16 v[244:247], a[200:203], v[44:47], v[244:247]
    buffer_load_dwordx4 a[140:143], v36, s[36:39], s55 offen offset:1024 sc1
    v_add_f32 v178, v178, v210
    v_add_f32 v179, v179, v211
    v_mfma_f32_16x16x32_bf16 v[244:247], a[204:207], v[48:51], v[244:247]
    ds_read_b128 v[76:79], v14 offset:1280
    v_add_f32 v180, v180, v212
    v_add_f32 v181, v181, v213
    v_mfma_f32_16x16x32_bf16 v[248:251], a[192:195], v[40:43], 0
    ds_write_b128 v148, v[104:107] offset:16384
    v_mfma_f32_16x16x32_bf16 v[248:251], a[196:199], v[44:47], v[248:251]
    v_add_f32 v182, v182, v214
    v_add_f32 v183, v183, v215
    v_add_f32 v184, v184, v216
    v_mfma_f32_16x16x32_bf16 v[248:251], a[200:203], v[48:51], v[248:251]
    s_waitcnt lgkmcnt(3)
    v_add_f32 v185, v185, v217
    v_add_f32 v186, v186, v218
    v_add_f32 v187, v187, v219
    v_mfma_f32_16x16x32_bf16 v[248:251], a[204:207], v[52:55], v[248:251]
    ds_read_b128 v[80:83], v14 offset:1536
    v_add_f32 v188, v188, v220
    v_add_f32 v189, v189, v221
    v_mfma_f32_16x16x32_bf16 v[252:255], a[192:195], v[44:47], 0
    buffer_load_dwordx4 a[144:147], v36, s[36:39], s55 offen offset:2048 sc1
    v_add_f32 v190, v190, v222
    v_add_f32 v191, v191, v223
    v_mfma_f32_16x16x32_bf16 v[252:255], a[196:199], v[48:51], v[252:255]
    ds_read_b128 v[84:87], v14 offset:1792
    v_mfma_f32_16x16x32_bf16 v[252:255], a[200:203], v[52:55], v[252:255]
    v_mfma_f32_16x16x32_bf16 v[252:255], a[204:207], v[56:59], v[252:255]
    s_waitcnt vmcnt(17)
    v_mfma_f32_16x16x32_bf16 v[192:195], a[208:211], v[60:63], v[192:195]
    ds_read_b128 v[92:95], v15 offset:2048
    v_mfma_f32_16x16x32_bf16 v[192:195], a[212:215], v[64:67], v[192:195]
    buffer_load_dwordx4 a[148:151], v36, s[36:39], s55 offen offset:3072 sc1
    v_mfma_f32_16x16x32_bf16 v[192:195], a[216:219], v[68:71], v[192:195]
    ds_read_b128 v[96:99], v15 offset:2304
    v_mfma_f32_16x16x32_bf16 v[192:195], a[220:223], v[72:75], v[192:195]
    buffer_load_dword v152, v151, s[36:39], 0 offen sc1
    v_mfma_f32_16x16x32_bf16 v[196:199], a[208:211], v[64:67], v[196:199]
    s_waitcnt lgkmcnt(4) vmcnt(18)
    s_barrier
    v_mfma_f32_16x16x32_bf16 v[196:199], a[212:215], v[68:71], v[196:199]
    s_add_u32 m0, s54, 34816
    ds_read_b128 v[100:103], v15 offset:2560
    v_mfma_f32_16x16x32_bf16 v[196:199], a[216:219], v[72:75], v[196:199]
    buffer_load_dwordx4 v2, s[24:27], s71 offen  lds
    v_add_u32 v28, 69632, v28
    v_mfma_f32_16x16x32_bf16 v[196:199], a[220:223], v[88:91], v[196:199]
    ds_read_b128 v[40:43], v20 offset:0
    v_add_u32 v29, 69632, v29
    v_mfma_f32_16x16x32_bf16 v[200:203], a[208:211], v[68:71], v[200:203]
    ds_read_b128 v[104:107], v28 offset:0
    v_mfma_f32_16x16x32_bf16 v[200:203], a[212:215], v[72:75], v[200:203]
    ds_read_b128 v[108:111], v29 offset:0
    v_mfma_f32_16x16x32_bf16 v[200:203], a[216:219], v[88:91], v[200:203]
    ds_read_b128 v[44:47], v22 offset:0
    v_mfma_f32_16x16x32_bf16 v[200:203], a[220:223], v[76:79], v[200:203]
    s_add_u32 s55, s9, 24576
    buffer_load_dwordx4 a[152:155], v36, s[36:39], s55 offen offset:0 sc1
    v_mfma_f32_16x16x32_bf16 v[204:207], a[208:211], v[72:75], v[204:207]
    ds_read_b128 v[48:51], v20 offset:256
    v_mfma_f32_16x16x32_bf16 v[204:207], a[212:215], v[88:91], v[204:207]
    v_mfma_f32_16x16x32_bf16 v[204:207], a[216:219], v[76:79], v[204:207]
    s_waitcnt lgkmcnt(6)
    v_mfma_f32_16x16x32_bf16 v[204:207], a[220:223], v[80:83], v[204:207]
    s_add_u32 m0, s54, 43008
    ds_read_b128 v[52:55], v22 offset:256
    v_mfma_f32_16x16x32_bf16 v[208:211], a[208:211], v[88:91], v[208:211]
    s_waitcnt lgkmcnt(3)
    buffer_load_dwordx4 v3, s[24:27], s71 offen  lds
    v_lshlrev_b32 v112, 16, v104
    v_mfma_f32_16x16x32_bf16 v[208:211], a[212:215], v[76:79], v[208:211]
    v_lshlrev_b32 v113, 16, v108
    v_and_b32 v114, s60, v104
    v_mfma_f32_16x16x32_bf16 v[208:211], a[216:219], v[80:83], v[208:211]
    v_and_b32 v115, s60, v108
    v_mfma_f32_16x16x32_bf16 v[208:211], a[220:223], v[84:87], v[208:211]
    ds_read_b128 v[56:59], v20 offset:512
    v_mfma_f32_16x16x32_bf16 v[212:215], a[208:211], v[76:79], v[212:215]
    buffer_load_dwordx4 a[160:163], v36, s[36:39], s55 offen offset:1024 sc1
    v_mfma_f32_16x16x32_bf16 v[212:215], a[212:215], v[80:83], v[212:215]
    ds_read_b128 v[136:139], v28 offset:8192
    v_mfma_f32_16x16x32_bf16 v[212:215], a[216:219], v[84:87], v[212:215]
    ds_read_b128 v[140:143], v29 offset:8192
    v_lshlrev_b32 v116, 16, v105
    v_mfma_f32_16x16x32_bf16 v[212:215], a[220:223], v[92:95], v[212:215]
    ds_read_b128 v[60:63], v22 offset:512
    v_lshlrev_b32 v117, 16, v109
    v_mfma_f32_16x16x32_bf16 v[216:219], a[208:211], v[80:83], v[216:219]
    v_and_b32 v118, s60, v105
    v_and_b32 v119, s60, v109
    v_mfma_f32_16x16x32_bf16 v[216:219], a[212:215], v[84:87], v[216:219]
    s_add_u32 m0, s54, 51200
    v_add_f32 v112, v112, v113
    v_add_f32 v114, v114, v115
    v_mfma_f32_16x16x32_bf16 v[216:219], a[216:219], v[92:95], v[216:219]
    buffer_load_dwordx4 v4, s[24:27], s71 offen  lds
    v_add_f32 v116, v116, v117
    v_mfma_f32_16x16x32_bf16 v[216:219], a[220:223], v[96:99], v[216:219]
    ds_read_b128 v[64:67], v20 offset:768
    v_add_f32 v118, v118, v119
    v_mfma_f32_16x16x32_bf16 v[220:223], a[208:211], v[84:87], v[220:223]
    v_cvt_pk_bf16_f32 v104, v112, v114
    v_cvt_pk_bf16_f32 v105, v116, v118
    v_mfma_f32_16x16x32_bf16 v[220:223], a[212:215], v[92:95], v[220:223]
    ds_read_b128 v[68:71], v22 offset:768
    v_lshlrev_b32 v112, 16, v106
    v_mfma_f32_16x16x32_bf16 v[220:223], a[216:219], v[96:99], v[220:223]
    buffer_load_dwordx4 a[164:167], v36, s[36:39], s55 offen offset:2048 sc1
    v_lshlrev_b32 v113, 16, v110
    v_mfma_f32_16x16x32_bf16 v[220:223], a[220:223], v[100:103], v[220:223]
    s_waitcnt vmcnt(19)
    v_and_b32 v114, s60, v106
    v_mfma_f32_16x16x32_bf16 v[160:163], a[224:227], v[40:43], v[160:163]
    s_waitcnt lgkmcnt(3)
    ds_read_b128 v[72:75], v21 offset:1024
    v_and_b32 v115, s60, v110
    v_mfma_f32_16x16x32_bf16 v[160:163], a[228:231], v[44:47], v[160:163]
    v_lshlrev_b32 v116, 16, v107
    v_lshlrev_b32 v117, 16, v111
    v_mfma_f32_16x16x32_bf16 v[160:163], a[232:235], v[48:51], v[160:163]
    ds_read_b128 v[88:91], v23 offset:1024
    v_mfma_f32_16x16x32_bf16 v[160:163], a[236:239], v[52:55], v[160:163]
    s_add_u32 m0, s54, 59392
    v_and_b32 v118, s60, v107
    v_and_b32 v119, s60, v111
    v_mfma_f32_16x16x32_bf16 v[164:167], a[224:227], v[44:47], v[164:167]
    buffer_load_dwordx4 v5, s[24:27], s71 offen  lds
    v_add_f32 v112, v112, v113
    v_mfma_f32_16x16x32_bf16 v[164:167], a[228:231], v[48:51], v[164:167]
    ds_read_b128 v[76:79], v21 offset:1280
    v_add_f32 v114, v114, v115
    v_mfma_f32_16x16x32_bf16 v[164:167], a[232:235], v[52:55], v[164:167]
    v_add_f32 v116, v116, v117
    v_mfma_f32_16x16x32_bf16 v[164:167], a[236:239], v[56:59], v[164:167]
    ds_read_b128 v[80:83], v16 offset:0
    v_add_f32 v118, v118, v119
    v_mfma_f32_16x16x32_bf16 v[168:171], a[224:227], v[48:51], v[168:171]
    s_add_u32 m0, s54, 35840
    v_cvt_pk_bf16_f32 v106, v112, v114
    v_cvt_pk_bf16_f32 v107, v116, v118
    v_mfma_f32_16x16x32_bf16 v[168:171], a[228:231], v[52:55], v[168:171]
    buffer_load_dwordx4 v6, s[24:27], s71 offen  lds
    v_mfma_f32_16x16x32_bf16 v[168:171], a[232:235], v[56:59], v[168:171]
    s_waitcnt lgkmcnt(3)
    ds_read_b128 v[84:87], v16 offset:256
    v_mfma_f32_16x16x32_bf16 v[168:171], a[236:239], v[60:63], v[168:171]
    ds_write_b128 v30, v[104:107] offset:17408
    v_mfma_f32_16x16x32_bf16 v[172:175], a[224:227], v[52:55], v[172:175]
    ds_read_b128 v[92:95], v16 offset:512
    v_mfma_f32_16x16x32_bf16 v[172:175], a[228:231], v[56:59], v[172:175]
    s_add_u32 s55, s9, 28672
    buffer_load_dwordx4 a[168:171], v36, s[36:39], s55 offen offset:0 sc1
    v_mfma_f32_16x16x32_bf16 v[172:175], a[232:235], v[60:63], v[172:175]
    v_lshlrev_b32 v112, 16, v136
    v_lshlrev_b32 v113, 16, v140
    v_mfma_f32_16x16x32_bf16 v[172:175], a[236:239], v[64:67], v[172:175]
    ds_read_b128 v[96:99], v16 offset:768
    v_and_b32 v114, s60, v136
    v_mfma_f32_16x16x32_bf16 v[176:179], a[224:227], v[56:59], v[176:179]
    v_and_b32 v115, s60, v140
    v_mfma_f32_16x16x32_bf16 v[176:179], a[228:231], v[60:63], v[176:179]
    ds_read_b128 v[104:107], v28 offset:16384
    v_mfma_f32_16x16x32_bf16 v[176:179], a[232:235], v[64:67], v[176:179]
    s_add_u32 m0, s54, 44032
    ds_read_b128 v[108:111], v29 offset:16384
    v_mfma_f32_16x16x32_bf16 v[176:179], a[236:239], v[68:71], v[176:179]
    ds_read_b128 v[100:103], v16 offset:1024
    v_lshlrev_b32 v116, 16, v137
    v_mfma_f32_16x16x32_bf16 v[180:183], a[224:227], v[60:63], v[180:183]
    buffer_load_dwordx4 v7, s[24:27], s71 offen  lds
    v_lshlrev_b32 v117, 16, v141
    v_mfma_f32_16x16x32_bf16 v[180:183], a[228:231], v[64:67], v[180:183]
    v_and_b32 v118, s60, v137
    v_and_b32 v119, s60, v141
    v_mfma_f32_16x16x32_bf16 v[180:183], a[232:235], v[68:71], v[180:183]
    v_add_f32 v112, v112, v113
    v_add_f32 v114, v114, v115
    v_mfma_f32_16x16x32_bf16 v[180:183], a[236:239], v[72:75], v[180:183]
    ds_read_b128 v[40:43], v16 offset:1280
    v_add_f32 v116, v116, v117
    v_mfma_f32_16x16x32_bf16 v[184:187], a[224:227], v[64:67], v[184:187]
    buffer_load_dwordx4 a[172:175], v36, s[36:39], s55 offen offset:1024 sc1
    v_add_f32 v118, v118, v119
    v_mfma_f32_16x16x32_bf16 v[184:187], a[228:231], v[68:71], v[184:187]
    v_cvt_pk_bf16_f32 v136, v112, v114
    v_mfma_f32_16x16x32_bf16 v[184:187], a[232:235], v[72:75], v[184:187]
    s_waitcnt lgkmcnt(4)
    v_cvt_pk_bf16_f32 v137, v116, v118
    v_lshlrev_b32 v112, 16, v138
    v_mfma_f32_16x16x32_bf16 v[184:187], a[236:239], v[88:91], v[184:187]
    ds_read_b128 v[44:47], v16 offset:1536
    v_mfma_f32_16x16x32_bf16 v[188:191], a[224:227], v[68:71], v[188:191]
    s_add_u32 m0, s54, 52224
    v_lshlrev_b32 v113, 16, v142
    v_and_b32 v114, s60, v138
    v_mfma_f32_16x16x32_bf16 v[188:191], a[228:231], v[72:75], v[188:191]
    ds_read_b128 v[48:51], v16 offset:1792
    v_and_b32 v115, s60, v142
    v_mfma_f32_16x16x32_bf16 v[188:191], a[232:235], v[88:91], v[188:191]
    buffer_load_dwordx4 v8, s[24:27], s71 offen  lds
    v_lshlrev_b32 v116, 16, v139
    v_mfma_f32_16x16x32_bf16 v[188:191], a[236:239], v[76:79], v[188:191]
    s_waitcnt vmcnt(21)
    v_lshlrev_b32 v117, 16, v143
    v_mfma_f32_16x16x32_bf16 v[224:227], a[240:243], v[80:83], v[224:227]
    ds_read_b128 v[52:55], v17 offset:2048
    v_and_b32 v118, s60, v139
    v_mfma_f32_16x16x32_bf16 v[224:227], a[244:247], v[84:87], v[224:227]
    buffer_load_dwordx4 a[176:179], v36, s[36:39], s55 offen offset:2048 sc1
    v_and_b32 v119, s60, v143
    v_mfma_f32_16x16x32_bf16 v[224:227], a[248:251], v[92:95], v[224:227]
    ds_read_b128 v[56:59], v17 offset:2304
    v_add_f32 v112, v112, v113
    v_mfma_f32_16x16x32_bf16 v[224:227], a[252:255], v[96:99], v[224:227]
    v_add_f32 v114, v114, v115
    v_mfma_f32_16x16x32_bf16 v[228:231], a[240:243], v[84:87], v[228:231]
    v_add_f32 v116, v116, v117
    v_add_f32 v118, v118, v119
    v_mfma_f32_16x16x32_bf16 v[228:231], a[244:247], v[92:95], v[228:231]
    ds_read_b128 v[60:63], v17 offset:2560
    v_mfma_f32_16x16x32_bf16 v[228:231], a[248:251], v[96:99], v[228:231]
    s_waitcnt lgkmcnt(4)
    s_add_u32 m0, s54, 60416
    v_cvt_pk_bf16_f32 v138, v112, v114
    v_mfma_f32_16x16x32_bf16 v[228:231], a[252:255], v[100:103], v[228:231]
    ds_read_b128 v[64:67], v18 offset:0
    v_cvt_pk_bf16_f32 v139, v116, v118
    v_mfma_f32_16x16x32_bf16 v[232:235], a[240:243], v[92:95], v[232:235]
    buffer_load_dwordx4 v9, s[24:27], s71 offen  lds
    v_mfma_f32_16x16x32_bf16 v[232:235], a[244:247], v[96:99], v[232:235]
    ds_write_b128 v31, v[136:139] offset:21504
    v_mfma_f32_16x16x32_bf16 v[232:235], a[248:251], v[100:103], v[232:235]
    ds_read_b128 v[68:71], v18 offset:256
    v_mfma_f32_16x16x32_bf16 v[232:235], a[252:255], v[40:43], v[232:235]
    s_waitcnt vmcnt(14)
    v_cmp_ne_u32 vcc, s3, v152
    s_nop 0
    s_cbranch_vccnz L_cwo
L_cwo_b:
    v_mfma_f32_16x16x32_bf16 v[236:239], a[240:243], v[96:99], v[236:239]
    buffer_load_dwordx4 a[180:183], v36, s[36:39], s55 offen offset:3072 sc1
    v_mfma_f32_16x16x32_bf16 v[236:239], a[244:247], v[100:103], v[236:239]
    ds_read_b128 v[72:75], v18 offset:512
    v_lshlrev_b32 v112, 16, v104
    v_mfma_f32_16x16x32_bf16 v[236:239], a[248:251], v[40:43], v[236:239]
    v_lshlrev_b32 v113, 16, v108
    v_mfma_f32_16x16x32_bf16 v[236:239], a[252:255], v[44:47], v[236:239]
    ds_read_b128 v[88:91], v18 offset:768
    v_and_b32 v114, s60, v104
    v_mfma_f32_16x16x32_bf16 v[240:243], a[240:243], v[100:103], v[240:243]
    s_mov_b32 m0, 67584
    s_cmp_lt_u32 s77, 16
    s_cbranch_scc0 L_ge1
    buffer_load_dwordx4 a[0:3], v36, s[36:39], s64 offen offset:0 sc1
    buffer_load_dwordx4 a[32:35], v145, s[32:35], 0 offen offset:0
    buffer_load_dwordx4 a[4:7], v36, s[36:39], s64 offen offset:1024 sc1
    buffer_load_dwordx4 a[36:39], v145, s[32:35], 0 offen offset:64
    buffer_load_dwordx4 a[8:11], v36, s[36:39], s64 offen offset:2048 sc1
    buffer_load_dwordx4 a[40:43], v145, s[32:35], 0 offen offset:128
    buffer_load_dwordx4 a[12:15], v36, s[36:39], s64 offen offset:3072 sc1
    buffer_load_dwordx4 a[44:47], v145, s[32:35], 0 offen offset:192
    buffer_load_dwordx4 a[16:19], v156, s[36:39], s64 offen offset:0 sc1
    buffer_load_dwordx4 a[48:51], v145, s[32:35], 0 offen offset:256
    buffer_load_dwordx4 a[20:23], v156, s[36:39], s64 offen offset:1024 sc1
    buffer_load_dwordx4 a[52:55], v145, s[32:35], 0 offen offset:320
    buffer_load_dwordx4 a[24:27], v156, s[36:39], s64 offen offset:2048 sc1
    buffer_load_dwordx4 a[56:59], v145, s[32:35], 0 offen offset:384
    buffer_load_dwordx4 a[28:31], v156, s[36:39], s64 offen offset:3072 sc1
    buffer_load_dwordx4 a[60:63], v145, s[32:35], 0 offen offset:448
L_ge1:
    v_mfma_f32_16x16x32_bf16 v[240:243], a[244:247], v[40:43], v[240:243]
    buffer_load_dwordx4 v10, s[24:27], s71 offen  lds
    v_and_b32 v115, s60, v108
    v_mfma_f32_16x16x32_bf16 v[240:243], a[248:251], v[44:47], v[240:243]
    s_waitcnt lgkmcnt(4)
    ds_read_b128 v[136:139], v28 offset:24576
    v_mfma_f32_16x16x32_bf16 v[240:243], a[252:255], v[48:51], v[240:243]
    ds_read_b128 v[76:79], v18 offset:1024
    v_mfma_f32_16x16x32_bf16 v[244:247], a[240:243], v[40:43], v[244:247]
    buffer_load_dword v1, v34, s[24:27], s75 offen
    v_mfma_f32_16x16x32_bf16 v[244:247], a[244:247], v[44:47], v[244:247]
    s_add_u32 s55, s9, 32768
    buffer_load_dwordx4 a[184:187], v36, s[36:39], s55 offen offset:0 sc1
    v_mfma_f32_16x16x32_bf16 v[244:247], a[248:251], v[48:51], v[244:247]
L_rw0:
    ds_read_b128 v[140:143], v29 offset:24576
    v_lshlrev_b32 v116, 16, v105
    v_mfma_f32_16x16x32_bf16 v[244:247], a[252:255], v[52:55], v[244:247]
    ds_read_b128 v[80:83], v18 offset:1280
    v_mov_b32 v153, L_rw0-L_pc+2048
    v_mfma_f32_16x16x32_bf16 v[248:251], a[240:243], v[44:47], v[248:251]
    global_load_dword v1, v153, s[78:79]
    v_lshlrev_b32 v117, 16, v109
    v_mfma_f32_16x16x32_bf16 v[248:251], a[244:247], v[48:51], v[248:251]
    v_and_b32 v118, s60, v105
    v_and_b32 v119, s60, v109
    v_mfma_f32_16x16x32_bf16 v[248:251], a[248:251], v[52:55], v[248:251]
    buffer_load_dwordx4 a[192:195], v36, s[36:39], s55 offen offset:1024 sc1
    v_add_f32 v112, v112, v113
    v_mfma_f32_16x16x32_bf16 v[248:251], a[252:255], v[56:59], v[248:251]
    ds_read_b128 v[84:87], v18 offset:1536
    v_add_f32 v114, v114, v115
    v_mfma_f32_16x16x32_bf16 v[252:255], a[240:243], v[48:51], v[252:255]
    v_add_f32 v116, v116, v117
    v_add_f32 v118, v118, v119
    v_mfma_f32_16x16x32_bf16 v[252:255], a[244:247], v[52:55], v[252:255]
    ds_read_b128 v[92:95], v18 offset:1792
    v_cvt_pk_bf16_f32 v104, v112, v114
    v_mfma_f32_16x16x32_bf16 v[252:255], a[248:251], v[56:59], v[252:255]
    v_cvt_pk_bf16_f32 v105, v116, v118
    v_lshlrev_b32 v112, 16, v106
    v_mfma_f32_16x16x32_bf16 v[252:255], a[252:255], v[60:63], v[252:255]
    buffer_load_dwordx4 a[196:199], v36, s[36:39], s55 offen offset:2048 sc1
    v_lshlrev_b32 v113, 16, v110
    v_mfma_f32_16x16x32_bf16 v[192:195], a[156:159], v[64:67], v[192:195]
    s_waitcnt lgkmcnt(3)
    ds_read_b128 v[96:99], v19 offset:2048
    ds_read_u16 v120, v155 offset:0
    v_and_b32 v114, s60, v106
    v_mfma_f32_16x16x32_bf16 v[192:195], a[188:191], v[68:71], v[192:195]
    v_and_b32 v115, s60, v110
    v_lshlrev_b32 v116, 16, v107
    v_mfma_f32_16x16x32_bf16 v[192:195], a[128:131], v[72:75], v[192:195]
    ds_read_b128 v[100:103], v19 offset:2304
    v_mfma_f32_16x16x32_bf16 v[192:195], a[132:135], v[88:91], v[192:195]
    v_lshlrev_b32 v117, 16, v111
    v_and_b32 v118, s60, v107
    v_mfma_f32_16x16x32_bf16 v[196:199], a[156:159], v[68:71], v[196:199]
    s_add_u32 s55, s9, 36864
    buffer_load_dwordx4 a[200:203], v36, s[36:39], s55 offen offset:0 sc1
    v_and_b32 v119, s60, v111
    v_mfma_f32_16x16x32_bf16 v[196:199], a[188:191], v[72:75], v[196:199]
    ds_read_b128 v[40:43], v19 offset:2560
    v_add_f32 v112, v112, v113
    v_mfma_f32_16x16x32_bf16 v[196:199], a[128:131], v[88:91], v[196:199]
    ds_read_u16 v121, v155 offset:128
    v_add_f32 v114, v114, v115
    v_mfma_f32_16x16x32_bf16 v[196:199], a[132:135], v[76:79], v[196:199]
    ds_read_b128 v[44:47], v24 offset:0
    v_add_f32 v116, v116, v117
    v_mfma_f32_16x16x32_bf16 v[200:203], a[156:159], v[72:75], v[200:203]
    ds_read_u16 v122, v155 offset:256
    v_add_f32 v118, v118, v119
    v_mfma_f32_16x16x32_bf16 v[200:203], a[188:191], v[88:91], v[200:203]
    buffer_load_dwordx4 a[204:207], v36, s[36:39], s55 offen offset:1024 sc1
    v_cvt_pk_bf16_f32 v106, v112, v114
    v_mfma_f32_16x16x32_bf16 v[200:203], a[128:131], v[76:79], v[200:203]
    s_waitcnt lgkmcnt(5)
    ds_read_b128 v[48:51], v26 offset:0
    v_cvt_pk_bf16_f32 v107, v116, v118
    v_mfma_f32_16x16x32_bf16 v[200:203], a[132:135], v[80:83], v[200:203]
    ds_write_b128 v30, v[104:107] offset:25600
    v_mfma_f32_16x16x32_bf16 v[204:207], a[156:159], v[88:91], v[204:207]
    ds_read_b128 v[52:55], v24 offset:256
    v_mfma_f32_16x16x32_bf16 v[204:207], a[188:191], v[76:79], v[204:207]
    ds_read_u16 v123, v155 offset:384
    v_mfma_f32_16x16x32_bf16 v[204:207], a[128:131], v[80:83], v[204:207]
    buffer_load_dwordx4 a[208:211], v36, s[36:39], s55 offen offset:2048 sc1
    v_lshlrev_b32 v112, 16, v136
    v_mfma_f32_16x16x32_bf16 v[204:207], a[132:135], v[84:87], v[204:207]
    ds_read_b128 v[56:59], v26 offset:256
    v_lshlrev_b32 v113, 16, v140
    v_mfma_f32_16x16x32_bf16 v[208:211], a[156:159], v[76:79], v[208:211]
    ds_read_u16 v124, v155 offset:512
    v_and_b32 v114, s60, v136
    v_mfma_f32_16x16x32_bf16 v[208:211], a[188:191], v[80:83], v[208:211]
    v_and_b32 v115, s60, v140
    v_subrev_u32 v146, s54, v28
    v_mfma_f32_16x16x32_bf16 v[208:211], a[128:131], v[84:87], v[208:211]
    ds_read_u16 v125, v155 offset:640
    v_xor_b32 v147, 128, v146
    v_mfma_f32_16x16x32_bf16 v[208:211], a[132:135], v[92:95], v[208:211]
    ds_read_b128 v[60:63], v24 offset:512
    v_subrev_u32 v148, s53, v30
    v_mfma_f32_16x16x32_bf16 v[212:215], a[156:159], v[80:83], v[212:215]
    s_add_u32 s55, s9, 40960
    buffer_load_dwordx4 a[212:215], v36, s[36:39], s55 offen offset:0 sc1
    v_mfma_f32_16x16x32_bf16 v[212:215], a[188:191], v[84:87], v[212:215]
    ds_read_b128 v[104:107], v146 offset:32768
    v_mfma_f32_16x16x32_bf16 v[212:215], a[128:131], v[92:95], v[212:215]
    ds_read_b128 v[108:111], v147 offset:32768
    v_lshlrev_b32 v116, 16, v137
    v_mfma_f32_16x16x32_bf16 v[212:215], a[132:135], v[96:99], v[212:215]
    ds_read_b128 v[64:67], v26 offset:512
    v_lshlrev_b32 v117, 16, v141
    v_mfma_f32_16x16x32_bf16 v[216:219], a[156:159], v[84:87], v[216:219]
    buffer_load_dwordx4 a[216:219], v36, s[36:39], s55 offen offset:1024 sc1
    v_and_b32 v118, s60, v137
    v_mfma_f32_16x16x32_bf16 v[216:219], a[188:191], v[92:95], v[216:219]
    ds_read_u16 v126, v155 offset:768
    v_and_b32 v119, s60, v141
    v_add_f32 v112, v112, v113
    v_mfma_f32_16x16x32_bf16 v[216:219], a[128:131], v[96:99], v[216:219]
    s_waitcnt lgkmcnt(6)
    ds_read_b128 v[68:71], v24 offset:768
    v_add_f32 v114, v114, v115
    v_mfma_f32_16x16x32_bf16 v[216:219], a[132:135], v[100:103], v[216:219]
    ds_read_u16 v127, v155 offset:896
    v_add_f32 v116, v116, v117
    v_mfma_f32_16x16x32_bf16 v[220:223], a[156:159], v[92:95], v[220:223]
    ds_read_b128 v[72:75], v26 offset:768
    v_add_f32 v118, v118, v119
    v_mfma_f32_16x16x32_bf16 v[220:223], a[188:191], v[96:99], v[220:223]
    buffer_load_dwordx4 a[220:223], v36, s[36:39], s55 offen offset:2048 sc1
    v_cvt_pk_bf16_f32 v136, v112, v114
    v_mfma_f32_16x16x32_bf16 v[220:223], a[128:131], v[100:103], v[220:223]
    v_add_u32 v12, 34816, v12
    v_cvt_pk_bf16_f32 v137, v116, v118
    v_mfma_f32_16x16x32_bf16 v[220:223], a[132:135], v[40:43], v[220:223]
    ds_read_b128 v[88:91], v25 offset:1024
    v_add_u32 v13, 34816, v13
    v_mfma_f32_16x16x32_bf16 v[160:163], a[136:139], v[44:47], v[160:163]
    v_add_u32 v14, 34816, v14
    v_lshlrev_b32 v112, 16, v138
    v_mfma_f32_16x16x32_bf16 v[160:163], a[140:143], v[48:51], v[160:163]
    ds_read_b128 v[76:79], v27 offset:1024
    v_add_u32 v15, 34816, v15
    v_mfma_f32_16x16x32_bf16 v[160:163], a[144:147], v[52:55], v[160:163]
    buffer_load_dwordx4 a[224:227], v36, s[36:39], s55 offen offset:3072 sc1
    v_lshlrev_b32 v113, 16, v142
    v_mfma_f32_16x16x32_bf16 v[160:163], a[148:151], v[56:59], v[160:163]
    ds_read_u16 v128, v155 offset:4096
    v_and_b32 v114, s60, v138
    v_mfma_f32_16x16x32_bf16 v[164:167], a[136:139], v[48:51], v[164:167]
    ds_read_b128 v[80:83], v25 offset:1280
    v_and_b32 v115, s60, v142
    v_mfma_f32_16x16x32_bf16 v[164:167], a[140:143], v[52:55], v[164:167]
    v_lshlrev_b32 v116, 16, v139
    v_lshlrev_b32 v117, 16, v143
    v_mfma_f32_16x16x32_bf16 v[164:167], a[144:147], v[56:59], v[164:167]
    s_waitcnt lgkmcnt(4)
    ds_read_b128 v[84:87], v12 offset:34816
    v_mfma_f32_16x16x32_bf16 v[164:167], a[148:151], v[60:63], v[164:167]
    s_add_u32 s55, s9, 45056
    buffer_load_dwordx4 a[228:231], v36, s[36:39], s55 offen offset:0 sc1
    v_and_b32 v118, s60, v139
    v_mfma_f32_16x16x32_bf16 v[168:171], a[136:139], v[52:55], v[168:171]
    v_and_b32 v119, s60, v143
    v_add_f32 v112, v112, v113
    v_mfma_f32_16x16x32_bf16 v[168:171], a[140:143], v[56:59], v[168:171]
    ds_read_b128 v[92:95], v12 offset:35072
    v_mfma_f32_16x16x32_bf16 v[168:171], a[144:147], v[60:63], v[168:171]
    ds_read_u16 v129, v155 offset:4224
    v_add_f32 v114, v114, v115
    v_add_f32 v116, v116, v117
    v_mfma_f32_16x16x32_bf16 v[168:171], a[148:151], v[64:67], v[168:171]
    ds_read_b128 v[96:99], v12 offset:35328
    v_add_f32 v118, v118, v119
    v_mfma_f32_16x16x32_bf16 v[172:175], a[136:139], v[56:59], v[172:175]
    buffer_load_dwordx4 a[232:235], v36, s[36:39], s55 offen offset:1024 sc1
    v_cvt_pk_bf16_f32 v138, v112, v114
    v_mfma_f32_16x16x32_bf16 v[172:175], a[140:143], v[60:63], v[172:175]
    ds_read_u16 v130, v155 offset:4352
    v_cvt_pk_bf16_f32 v139, v116, v118
    v_mfma_f32_16x16x32_bf16 v[172:175], a[144:147], v[64:67], v[172:175]
    ds_read_b128 v[100:103], v12 offset:35584
    v_mfma_f32_16x16x32_bf16 v[172:175], a[148:151], v[68:71], v[172:175]
    ds_write_b128 v31, v[136:139] offset:29696
    v_mfma_f32_16x16x32_bf16 v[176:179], a[136:139], v[60:63], v[176:179]
    ds_read_b128 v[40:43], v12 offset:35840
    v_mfma_f32_16x16x32_bf16 v[176:179], a[140:143], v[64:67], v[176:179]
    buffer_load_dwordx4 a[236:239], v36, s[36:39], s55 offen offset:2048 sc1
    v_mfma_f32_16x16x32_bf16 v[176:179], a[144:147], v[68:71], v[176:179]
    v_lshlrev_b32 v112, 16, v104
    v_lshlrev_b32 v113, 16, v108
    v_mfma_f32_16x16x32_bf16 v[176:179], a[148:151], v[72:75], v[176:179]
    ds_read_b128 v[44:47], v12 offset:36096
    ds_read_u16 v131, v155 offset:4480
    v_mfma_f32_16x16x32_bf16 v[180:183], a[136:139], v[64:67], v[180:183]
    v_and_b32 v114, s60, v104
    v_and_b32 v115, s60, v108
    v_mfma_f32_16x16x32_bf16 v[180:183], a[140:143], v[68:71], v[180:183]
    ds_read_b128 v[48:51], v12 offset:36352
    v_lshlrev_b32 v116, 16, v105
    v_mfma_f32_16x16x32_bf16 v[180:183], a[144:147], v[72:75], v[180:183]
    s_waitcnt lgkmcnt(7)
    s_add_u32 s55, s9, 49152
    buffer_load_dwordx4 a[240:243], v36, s[36:39], s55 offen offset:0 sc1
    ds_read_u16 v132, v155 offset:4608
    v_mfma_f32_16x16x32_bf16 v[180:183], a[148:151], v[88:91], v[180:183]
    ds_read_u16 v133, v155 offset:4736
    v_lshlrev_b32 v117, 16, v109
    v_mfma_f32_16x16x32_bf16 v[184:187], a[136:139], v[68:71], v[184:187]
    ds_read_b128 v[52:55], v12 offset:36608
    v_and_b32 v118, s60, v105
    v_mfma_f32_16x16x32_bf16 v[184:187], a[140:143], v[72:75], v[184:187]
    v_and_b32 v119, s60, v109
    v_add_f32 v112, v112, v113
    v_mfma_f32_16x16x32_bf16 v[184:187], a[144:147], v[88:91], v[184:187]
    ds_read_b128 v[56:59], v13 offset:36864
    v_add_f32 v114, v114, v115
    v_mfma_f32_16x16x32_bf16 v[184:187], a[148:151], v[76:79], v[184:187]
    buffer_load_dwordx4 a[244:247], v36, s[36:39], s55 offen offset:1024 sc1
    ds_read_u16 v134, v155 offset:4864
    v_mfma_f32_16x16x32_bf16 v[188:191], a[136:139], v[72:75], v[188:191]
    v_add_f32 v116, v116, v117
    v_add_f32 v118, v118, v119
    v_mfma_f32_16x16x32_bf16 v[188:191], a[140:143], v[88:91], v[188:191]
    ds_read_b128 v[60:63], v13 offset:37120
    v_cvt_pk_bf16_f32 v104, v112, v114
    v_mfma_f32_16x16x32_bf16 v[188:191], a[144:147], v[76:79], v[188:191]
    ds_read_u16 v135, v155 offset:4992
    v_cvt_pk_bf16_f32 v105, v116, v118
    v_mfma_f32_16x16x32_bf16 v[188:191], a[148:151], v[80:83], v[188:191]
    s_waitcnt vmcnt(27)
    ds_read_b128 v[64:67], v14 offset:34816
    v_lshlrev_b32 v112, 16, v106
    v_mfma_f32_16x16x32_bf16 v[224:227], a[152:155], v[84:87], v[224:227]
    buffer_load_dwordx4 a[248:251], v36, s[36:39], s55 offen offset:2048 sc1
    v_lshlrev_b32 v113, 16, v110
    v_mfma_f32_16x16x32_bf16 v[224:227], a[160:163], v[92:95], v[224:227]
    v_and_b32 v114, s60, v106
    v_mfma_f32_16x16x32_bf16 v[224:227], a[164:167], v[96:99], v[224:227]
    ds_read_b128 v[68:71], v14 offset:35072
    v_and_b32 v115, s60, v110
    v_mfma_f32_16x16x32_bf16 v[228:231], a[152:155], v[92:95], v[228:231]
    v_lshlrev_b32 v116, 16, v107
    v_lshlrev_b32 v117, 16, v111
    v_mfma_f32_16x16x32_bf16 v[228:231], a[160:163], v[96:99], v[228:231]
    s_waitcnt lgkmcnt(5)
    ds_read_b128 v[72:75], v14 offset:35328
    v_and_b32 v118, s60, v107
    v_mfma_f32_16x16x32_bf16 v[228:231], a[164:167], v[100:103], v[228:231]
    s_waitcnt lgkmcnt(3)
    buffer_load_dwordx4 a[252:255], v36, s[36:39], s55 offen offset:3072 sc1
    v_lshl_or_b32 v120, v121, 16, v120
    v_mfma_f32_16x16x32_bf16 v[232:235], a[152:155], v[96:99], v[232:235]
    v_and_b32 v119, s60, v111
    v_add_f32 v112, v112, v113
    v_mfma_f32_16x16x32_bf16 v[232:235], a[160:163], v[100:103], v[232:235]
    ds_read_b128 v[88:91], v14 offset:35584
    v_add_f32 v114, v114, v115
    v_mfma_f32_16x16x32_bf16 v[232:235], a[164:167], v[40:43], v[232:235]
    v_add_f32 v116, v116, v117
    v_lshl_or_b32 v121, v123, 16, v122
    v_mfma_f32_16x16x32_bf16 v[236:239], a[152:155], v[100:103], v[236:239]
    v_add_f32 v118, v118, v119
    v_cvt_pk_bf16_f32 v106, v112, v114
    v_mfma_f32_16x16x32_bf16 v[236:239], a[160:163], v[40:43], v[236:239]
    s_add_u32 s55, s9, 53248
    buffer_load_dwordx4 a[156:159], v36, s[36:39], s55 offen offset:0 sc1
    v_cvt_pk_bf16_f32 v107, v116, v118
    v_mfma_f32_16x16x32_bf16 v[236:239], a[164:167], v[44:47], v[236:239]
    ds_read_b128 v[76:79], v14 offset:35840
    v_mfma_f32_16x16x32_bf16 v[240:243], a[152:155], v[40:43], v[240:243]
    ds_write_b128 v148, v[104:107] offset:33792
    v_mfma_f32_16x16x32_bf16 v[240:243], a[160:163], v[44:47], v[240:243]
    v_lshl_or_b32 v122, v125, 16, v124
    v_lshl_or_b32 v123, v127, 16, v126
    v_mfma_f32_16x16x32_bf16 v[240:243], a[164:167], v[48:51], v[240:243]
    v_lshl_or_b32 v128, v129, 16, v128
    v_mfma_f32_16x16x32_bf16 v[244:247], a[152:155], v[44:47], v[244:247]
    ds_read_b128 v[80:83], v14 offset:36096
    v_mfma_f32_16x16x32_bf16 v[244:247], a[160:163], v[48:51], v[244:247]
    buffer_load_dwordx4 a[188:191], v36, s[36:39], s55 offen offset:1024 sc1
    v_lshl_or_b32 v129, v131, 16, v130
    v_mfma_f32_16x16x32_bf16 v[244:247], a[164:167], v[52:55], v[244:247]
    v_lshl_or_b32 v130, v133, 16, v132
    v_mfma_f32_16x16x32_bf16 v[248:251], a[152:155], v[48:51], v[248:251]
    v_lshl_or_b32 v131, v135, 16, v134
    v_mfma_f32_16x16x32_bf16 v[248:251], a[160:163], v[52:55], v[248:251]
    ds_read_b128 v[84:87], v14 offset:36352
    v_mfma_f32_16x16x32_bf16 v[248:251], a[164:167], v[56:59], v[248:251]
    buffer_load_dwordx4 a[128:131], v36, s[36:39], s55 offen offset:2048 sc1
    v_mfma_f32_16x16x32_bf16 v[252:255], a[152:155], v[52:55], v[252:255]
    ds_read_b128 v[92:95], v14 offset:36608
    v_mfma_f32_16x16x32_bf16 v[252:255], a[160:163], v[56:59], v[252:255]
    v_mfma_f32_16x16x32_bf16 v[252:255], a[164:167], v[60:63], v[252:255]
    s_waitcnt vmcnt(23) lgkmcnt(3)
    v_mfma_f32_16x16x32_bf16 v[192:195], a[168:171], v[64:67], v[192:195]
    ds_read_b128 v[96:99], v15 offset:36864
    v_mfma_f32_16x16x32_bf16 v[192:195], a[172:175], v[68:71], v[192:195]
    buffer_load_dwordx4 a[132:135], v36, s[36:39], s55 offen offset:3072 sc1
    v_mfma_f32_16x16x32_bf16 v[192:195], a[176:179], v[72:75], v[192:195]
    ds_read_b128 v[100:103], v15 offset:37120
    v_mfma_f32_16x16x32_bf16 v[192:195], a[180:183], v[88:91], v[192:195]
    v_mfma_f32_16x16x32_bf16 v[196:199], a[168:171], v[68:71], v[196:199]
    s_waitcnt vmcnt(23)
    s_barrier
    v_mfma_f32_16x16x32_bf16 v[196:199], a[172:175], v[72:75], v[196:199]
    ds_read_b128 v[40:43], v15 offset:37376
    v_mfma_f32_16x16x32_bf16 v[196:199], a[176:179], v[88:91], v[196:199]
    s_add_u32 m0, s54, 0
    v_add_u32 v28, 4294932480, v28
    v_add_u32 v29, 4294932480, v29
    v_mfma_f32_16x16x32_bf16 v[196:199], a[180:183], v[76:79], v[196:199]
    ds_read_b128 v[44:47], v20 offset:17408
    v_mfma_f32_16x16x32_bf16 v[200:203], a[168:171], v[72:75], v[200:203]
    buffer_load_dwordx4 v11, s[24:27], s71 offen  lds
    v_mfma_f32_16x16x32_bf16 v[200:203], a[172:175], v[88:91], v[200:203]
    ds_read_b128 v[104:107], v28 offset:0
    v_mfma_f32_16x16x32_bf16 v[200:203], a[176:179], v[76:79], v[200:203]
    s_waitcnt lgkmcnt(4)
    ds_read_b128 v[48:51], v22 offset:17408
    v_mfma_f32_16x16x32_bf16 v[200:203], a[180:183], v[80:83], v[200:203]
    s_add_u32 m0, s54, 8192
    ds_read_b128 v[108:111], v29 offset:0
    v_mfma_f32_16x16x32_bf16 v[204:207], a[168:171], v[88:91], v[204:207]
    ds_read_b128 v[52:55], v20 offset:17664
    v_mfma_f32_16x16x32_bf16 v[204:207], a[172:175], v[76:79], v[204:207]
    buffer_load_dwordx4 v3, s[24:27], s75 offen  lds
    v_mfma_f32_16x16x32_bf16 v[204:207], a[176:179], v[80:83], v[204:207]
    v_mfma_f32_16x16x32_bf16 v[204:207], a[180:183], v[84:87], v[204:207]
    ds_read_b128 v[56:59], v22 offset:17664
    v_mfma_f32_16x16x32_bf16 v[208:211], a[168:171], v[76:79], v[208:211]
    s_add_u32 s55, s9, 57344
    buffer_load_dwordx4 a[136:139], v36, s[36:39], s55 offen offset:0 sc1
    v_mfma_f32_16x16x32_bf16 v[208:211], a[172:175], v[80:83], v[208:211]
    s_waitcnt lgkmcnt(2)
    v_lshlrev_b32 v112, 16, v104
    v_mfma_f32_16x16x32_bf16 v[208:211], a[176:179], v[84:87], v[208:211]
    v_lshlrev_b32 v113, 16, v108
    v_mfma_f32_16x16x32_bf16 v[208:211], a[180:183], v[92:95], v[208:211]
    ds_read_b128 v[60:63], v20 offset:17920
    v_and_b32 v114, s60, v104
    v_mfma_f32_16x16x32_bf16 v[212:215], a[168:171], v[80:83], v[212:215]
    v_and_b32 v115, s60, v108
    v_mfma_f32_16x16x32_bf16 v[212:215], a[172:175], v[84:87], v[212:215]
    s_add_u32 m0, s54, 16384
    ds_read_b128 v[136:139], v28 offset:8192
    v_mfma_f32_16x16x32_bf16 v[212:215], a[176:179], v[92:95], v[212:215]
    buffer_load_dwordx4 v4, s[24:27], s75 offen  lds
    v_mfma_f32_16x16x32_bf16 v[212:215], a[180:183], v[96:99], v[212:215]
    ds_read_b128 v[64:67], v22 offset:17920
    v_mfma_f32_16x16x32_bf16 v[216:219], a[168:171], v[84:87], v[216:219]
    ds_read_b128 v[140:143], v29 offset:8192
    v_lshlrev_b32 v116, 16, v105
    v_mfma_f32_16x16x32_bf16 v[216:219], a[172:175], v[92:95], v[216:219]
    v_lshlrev_b32 v117, 16, v109
    v_and_b32 v118, s60, v105
    v_mfma_f32_16x16x32_bf16 v[216:219], a[176:179], v[96:99], v[216:219]
    s_add_u32 m0, s54, 24576
    ds_read_b128 v[68:71], v20 offset:18176
    v_mfma_f32_16x16x32_bf16 v[216:219], a[180:183], v[100:103], v[216:219]
    buffer_load_dwordx4 v5, s[24:27], s75 offen  lds
    v_and_b32 v119, s60, v109
    v_mfma_f32_16x16x32_bf16 v[220:223], a[168:171], v[92:95], v[220:223]
    ds_read_b128 v[72:75], v22 offset:18176
    v_add_f32 v112, v112, v113
    v_mfma_f32_16x16x32_bf16 v[220:223], a[172:175], v[96:99], v[220:223]
    v_add_f32 v114, v114, v115
    v_add_f32 v116, v116, v117
    v_mfma_f32_16x16x32_bf16 v[220:223], a[176:179], v[100:103], v[220:223]
    v_add_u32 v16, 34816, v16
    v_add_f32 v118, v118, v119
    v_mfma_f32_16x16x32_bf16 v[220:223], a[180:183], v[40:43], v[220:223]
    s_waitcnt vmcnt(23)
    ds_read_b128 v[88:91], v21 offset:18432
    v_add_u32 v17, 34816, v17
    v_mfma_f32_16x16x32_bf16 v[160:163], a[184:187], v[44:47], v[160:163]
    s_add_u32 m0, s54, 1024
    s_nop 0
    buffer_load_dwordx4 v6, s[24:27], s75 offen  lds
    v_add_u32 v18, 34816, v18
    v_cvt_pk_bf16_f32 v104, v112, v114
    v_mfma_f32_16x16x32_bf16 v[160:163], a[192:195], v[48:51], v[160:163]
    s_waitcnt lgkmcnt(4)
    ds_read_b128 v[76:79], v23 offset:18432
    v_add_u32 v19, 34816, v19
    v_mfma_f32_16x16x32_bf16 v[160:163], a[196:199], v[52:55], v[160:163]
    v_cvt_pk_bf16_f32 v105, v116, v118
    v_lshlrev_b32 v112, 16, v106
    v_mfma_f32_16x16x32_bf16 v[160:163], a[180:183], v[56:59], v[160:163]
    v_lshlrev_b32 v113, 16, v110
    v_mfma_f32_16x16x32_bf16 v[164:167], a[184:187], v[48:51], v[164:167]
    s_add_u32 m0, s54, 9216
    ds_read_b128 v[80:83], v21 offset:18688
    v_and_b32 v114, s60, v106
    v_mfma_f32_16x16x32_bf16 v[164:167], a[192:195], v[52:55], v[164:167]
    buffer_load_dwordx4 v7, s[24:27], s75 offen  lds
    v_and_b32 v115, s60, v110
    v_mfma_f32_16x16x32_bf16 v[164:167], a[196:199], v[56:59], v[164:167]
    ds_read_b128 v[84:87], v16 offset:34816
    v_mfma_f32_16x16x32_bf16 v[164:167], a[180:183], v[60:63], v[164:167]
    v_lshlrev_b32 v116, 16, v107
    v_lshlrev_b32 v117, 16, v111
    v_mfma_f32_16x16x32_bf16 v[168:171], a[184:187], v[52:55], v[168:171]
    v_and_b32 v118, s60, v107
    v_and_b32 v119, s60, v111
    v_mfma_f32_16x16x32_bf16 v[168:171], a[192:195], v[56:59], v[168:171]
    s_add_u32 m0, s54, 17408
    ds_read_b128 v[92:95], v16 offset:35072
    v_mfma_f32_16x16x32_bf16 v[168:171], a[196:199], v[60:63], v[168:171]
    buffer_load_dwordx4 v8, s[24:27], s75 offen  lds
    v_add_f32 v112, v112, v113
    v_mfma_f32_16x16x32_bf16 v[168:171], a[180:183], v[64:67], v[168:171]
    ds_read_b128 v[96:99], v16 offset:35328
    v_add_f32 v114, v114, v115
    v_mfma_f32_16x16x32_bf16 v[172:175], a[184:187], v[56:59], v[172:175]
    v_add_f32 v116, v116, v117
    v_add_f32 v118, v118, v119
    v_mfma_f32_16x16x32_bf16 v[172:175], a[192:195], v[60:63], v[172:175]
    v_cvt_pk_bf16_f32 v106, v112, v114
    v_mfma_f32_16x16x32_bf16 v[172:175], a[196:199], v[64:67], v[172:175]
    s_waitcnt lgkmcnt(3)
    ds_read_b128 v[100:103], v16 offset:35584
    v_cvt_pk_bf16_f32 v107, v116, v118
    v_mfma_f32_16x16x32_bf16 v[172:175], a[180:183], v[68:71], v[172:175]
    buffer_load_dwordx4 a[140:143], v36, s[36:39], s55 offen offset:1024 sc1
    v_mfma_f32_16x16x32_bf16 v[176:179], a[184:187], v[60:63], v[176:179]
    ds_read_b128 v[40:43], v16 offset:35840
    v_mfma_f32_16x16x32_bf16 v[176:179], a[192:195], v[64:67], v[176:179]
    ds_write_b128 v30, v[104:107] offset:0
    v_mfma_f32_16x16x32_bf16 v[176:179], a[196:199], v[68:71], v[176:179]
    v_lshlrev_b32 v112, 16, v136
    v_mfma_f32_16x16x32_bf16 v[176:179], a[180:183], v[72:75], v[176:179]
    s_add_u32 m0, s54, 25600
    ds_read_b128 v[44:47], v16 offset:36096
    v_mfma_f32_16x16x32_bf16 v[180:183], a[184:187], v[64:67], v[180:183]
    buffer_load_dwordx4 v9, s[24:27], s75 offen  lds
    v_lshlrev_b32 v113, 16, v140
    v_mfma_f32_16x16x32_bf16 v[180:183], a[192:195], v[68:71], v[180:183]
    ds_read_b128 v[48:51], v16 offset:36352
    v_and_b32 v114, s60, v136
    v_mfma_f32_16x16x32_bf16 v[180:183], a[196:199], v[72:75], v[180:183]
    v_and_b32 v115, s60, v140
    v_mfma_f32_16x16x32_bf16 v[180:183], a[180:183], v[88:91], v[180:183]
    ds_read_b128 v[104:107], v28 offset:16384
    v_mfma_f32_16x16x32_bf16 v[184:187], a[184:187], v[68:71], v[184:187]
    s_mov_b32 m0, 32768
    ds_read_b128 v[52:55], v16 offset:36608
    v_mfma_f32_16x16x32_bf16 v[184:187], a[192:195], v[72:75], v[184:187]
    buffer_load_dwordx4 v10, s[24:27], s75 offen  lds
    v_mfma_f32_16x16x32_bf16 v[184:187], a[196:199], v[88:91], v[184:187]
    ds_read_b128 v[56:59], v17 offset:36864
    v_mfma_f32_16x16x32_bf16 v[184:187], a[180:183], v[76:79], v[184:187]
    buffer_load_dword v1, v34, s[24:27], s72 offen
    v_mfma_f32_16x16x32_bf16 v[188:191], a[184:187], v[72:75], v[188:191]
    ds_read_b128 v[108:111], v29 offset:16384
    v_lshlrev_b32 v116, 16, v137
    v_mfma_f32_16x16x32_bf16 v[188:191], a[192:195], v[88:91], v[188:191]
    ds_read_b128 v[60:63], v17 offset:37120
    v_lshlrev_b32 v117, 16, v141
    v_mfma_f32_16x16x32_bf16 v[188:191], a[196:199], v[76:79], v[188:191]
    buffer_load_dwordx4 a[144:147], v36, s[36:39], s55 offen offset:2048 sc1
    v_and_b32 v118, s60, v137
    v_mfma_f32_16x16x32_bf16 v[188:191], a[180:183], v[80:83], v[188:191]
    s_waitcnt vmcnt(28) lgkmcnt(5)
    ds_read_b128 v[64:67], v18 offset:34816
    v_and_b32 v119, s60, v141
    v_mfma_f32_16x16x32_bf16 v[224:227], a[200:203], v[84:87], v[224:227]
    v_add_f32 v112, v112, v113
    v_add_f32 v114, v114, v115
    v_mfma_f32_16x16x32_bf16 v[224:227], a[204:207], v[92:95], v[224:227]
    v_add_f32 v116, v116, v117
    v_add_f32 v118, v118, v119
    v_mfma_f32_16x16x32_bf16 v[224:227], a[208:211], v[96:99], v[224:227]
    ds_read_b128 v[68:71], v18 offset:35072
    v_cvt_pk_bf16_f32 v136, v112, v114
    v_mfma_f32_16x16x32_bf16 v[228:231], a[200:203], v[92:95], v[228:231]
    buffer_load_dwordx4 a[148:151], v36, s[36:39], s55 offen offset:3072 sc1
    v_cvt_pk_bf16_f32 v137, v116, v118
    v_mfma_f32_16x16x32_bf16 v[228:231], a[204:207], v[96:99], v[228:231]
    ds_read_b128 v[72:75], v18 offset:35328
    v_lshlrev_b32 v112, 16, v138
    v_mfma_f32_16x16x32_bf16 v[228:231], a[208:211], v[100:103], v[228:231]
    v_lshlrev_b32 v113, 16, v142
    v_and_b32 v114, s60, v138
    v_mfma_f32_16x16x32_bf16 v[232:235], a[200:203], v[96:99], v[232:235]
    v_and_b32 v115, s60, v142
    v_lshlrev_b32 v116, 16, v139
    v_mfma_f32_16x16x32_bf16 v[232:235], a[204:207], v[100:103], v[232:235]
    ds_read_b128 v[88:91], v18 offset:35584
    v_lshlrev_b32 v117, 16, v143
    v_mfma_f32_16x16x32_bf16 v[232:235], a[208:211], v[40:43], v[232:235]
    s_add_u32 s55, s9, 61440
    buffer_load_dwordx4 a[152:155], v36, s[36:39], s55 offen offset:0 sc1
    v_and_b32 v118, s60, v139
    v_mfma_f32_16x16x32_bf16 v[236:239], a[200:203], v[100:103], v[236:239]
    v_and_b32 v119, s60, v143
    v_add_f32 v112, v112, v113
    v_mfma_f32_16x16x32_bf16 v[236:239], a[204:207], v[40:43], v[236:239]
    v_add_f32 v114, v114, v115
    v_mfma_f32_16x16x32_bf16 v[236:239], a[208:211], v[44:47], v[236:239]
    ds_read_b128 v[76:79], v18 offset:35840
    v_add_f32 v116, v116, v117
    v_mfma_f32_16x16x32_bf16 v[240:243], a[200:203], v[40:43], v[240:243]
    buffer_load_dwordx4 a[160:163], v36, s[36:39], s55 offen offset:1024 sc1
    v_add_f32 v118, v118, v119
    v_mfma_f32_16x16x32_bf16 v[240:243], a[204:207], v[44:47], v[240:243]
    v_cvt_pk_bf16_f32 v138, v112, v114
    v_mfma_f32_16x16x32_bf16 v[240:243], a[208:211], v[48:51], v[240:243]
    v_cvt_pk_bf16_f32 v139, v116, v118
    v_mfma_f32_16x16x32_bf16 v[244:247], a[200:203], v[44:47], v[244:247]
    ds_read_b128 v[80:83], v18 offset:36096
    v_mfma_f32_16x16x32_bf16 v[244:247], a[204:207], v[48:51], v[244:247]
    s_waitcnt lgkmcnt(3)
    ds_write_b128 v31, v[136:139] offset:4096
    v_mfma_f32_16x16x32_bf16 v[244:247], a[208:211], v[52:55], v[244:247]
    buffer_load_dwordx4 a[164:167], v36, s[36:39], s55 offen offset:2048 sc1
    v_mfma_f32_16x16x32_bf16 v[248:251], a[200:203], v[48:51], v[248:251]
    v_lshlrev_b32 v112, 16, v104
    v_lshlrev_b32 v113, 16, v108
    v_mfma_f32_16x16x32_bf16 v[248:251], a[204:207], v[52:55], v[248:251]
    ds_read_b128 v[84:87], v18 offset:36352
    v_mfma_f32_16x16x32_bf16 v[248:251], a[208:211], v[56:59], v[248:251]
    v_and_b32 v114, s60, v104
    v_and_b32 v115, s60, v108
    v_mfma_f32_16x16x32_bf16 v[252:255], a[200:203], v[52:55], v[252:255]
    ds_read_b128 v[92:95], v18 offset:36608
    v_mfma_f32_16x16x32_bf16 v[252:255], a[204:207], v[56:59], v[252:255]
    buffer_load_dwordx4 a[168:171], v36, s[36:39], s55 offen offset:3072 sc1
    v_mfma_f32_16x16x32_bf16 v[252:255], a[208:211], v[60:63], v[252:255]
    s_waitcnt vmcnt(29)
    ds_read_b128 v[136:139], v28 offset:24576
    v_mfma_f32_16x16x32_bf16 v[192:195], a[212:215], v[64:67], v[192:195]
    ds_read_b128 v[96:99], v19 offset:36864
    v_mfma_f32_16x16x32_bf16 v[192:195], a[216:219], v[68:71], v[192:195]
    ds_read_b128 v[140:143], v29 offset:24576
    v_lshlrev_b32 v116, 16, v105
    v_mfma_f32_16x16x32_bf16 v[192:195], a[220:223], v[72:75], v[192:195]
    s_waitcnt lgkmcnt(5)
    ds_read_b128 v[100:103], v19 offset:37120
    v_lshlrev_b32 v117, 16, v109
    v_mfma_f32_16x16x32_bf16 v[192:195], a[224:227], v[88:91], v[192:195]
    buffer_store_dwordx4 v[120:123], v36, s[36:39], s6 offen offset:0 sc1
    v_mfma_f32_16x16x32_bf16 v[196:199], a[212:215], v[68:71], v[196:199]
    v_and_b32 v118, s60, v105
    v_and_b32 v119, s60, v109
    v_mfma_f32_16x16x32_bf16 v[196:199], a[216:219], v[72:75], v[196:199]
    ds_read_b128 v[40:43], v19 offset:37376
    v_add_f32 v112, v112, v113
    v_mfma_f32_16x16x32_bf16 v[196:199], a[220:223], v[88:91], v[196:199]
    v_add_f32 v114, v114, v115
    v_add_f32 v116, v116, v117
    v_mfma_f32_16x16x32_bf16 v[196:199], a[224:227], v[76:79], v[196:199]
    ds_read_b128 v[44:47], v24 offset:17408
    v_add_f32 v118, v118, v119
    v_mfma_f32_16x16x32_bf16 v[200:203], a[212:215], v[72:75], v[200:203]
    buffer_store_dwordx4 v[128:131], v36, s[36:39], s6 offen offset:1024 sc1
    v_mfma_f32_16x16x32_bf16 v[200:203], a[216:219], v[88:91], v[200:203]
    v_cvt_pk_bf16_f32 v104, v112, v114
    v_cvt_pk_bf16_f32 v105, v116, v118
    v_mfma_f32_16x16x32_bf16 v[200:203], a[220:223], v[76:79], v[200:203]
    ds_read_b128 v[48:51], v26 offset:17408
    v_lshlrev_b32 v112, 16, v106
    v_mfma_f32_16x16x32_bf16 v[200:203], a[224:227], v[80:83], v[200:203]
    v_lshlrev_b32 v113, 16, v110
    v_and_b32 v114, s60, v106
    v_mfma_f32_16x16x32_bf16 v[204:207], a[212:215], v[88:91], v[204:207]
    ds_read_b128 v[52:55], v24 offset:17664
    v_and_b32 v115, s60, v110
    v_mfma_f32_16x16x32_bf16 v[204:207], a[216:219], v[76:79], v[204:207]
    s_add_u32 s55, s9, 65536
    buffer_load_dwordx4 a[172:175], v36, s[36:39], s55 offen offset:0 sc1
    v_mfma_f32_16x16x32_bf16 v[204:207], a[220:223], v[80:83], v[204:207]
    s_waitcnt lgkmcnt(4)
    v_lshlrev_b32 v116, 16, v107
    v_lshlrev_b32 v117, 16, v111
    v_mfma_f32_16x16x32_bf16 v[204:207], a[224:227], v[84:87], v[204:207]
    ds_read_b128 v[56:59], v26 offset:17664
    v_and_b32 v118, s60, v107
    v_mfma_f32_16x16x32_bf16 v[208:211], a[212:215], v[76:79], v[208:211]
    v_and_b32 v119, s60, v111
    v_add_f32 v112, v112, v113
    v_mfma_f32_16x16x32_bf16 v[208:211], a[216:219], v[80:83], v[208:211]
    v_add_f32 v114, v114, v115
    v_mfma_f32_16x16x32_bf16 v[208:211], a[220:223], v[84:87], v[208:211]
    buffer_load_dwordx4 a[176:179], v36, s[36:39], s55 offen offset:1024 sc1
    v_add_f32 v116, v116, v117
    v_mfma_f32_16x16x32_bf16 v[208:211], a[224:227], v[92:95], v[208:211]
    ds_read_b128 v[60:63], v24 offset:17920
    v_add_f32 v118, v118, v119
    v_mfma_f32_16x16x32_bf16 v[212:215], a[212:215], v[80:83], v[212:215]
    v_cvt_pk_bf16_f32 v106, v112, v114
    v_mfma_f32_16x16x32_bf16 v[212:215], a[216:219], v[84:87], v[212:215]
    v_cvt_pk_bf16_f32 v107, v116, v118
    v_mfma_f32_16x16x32_bf16 v[212:215], a[220:223], v[92:95], v[212:215]
    ds_write_b128 v30, v[104:107] offset:8192
    v_mfma_f32_16x16x32_bf16 v[212:215], a[224:227], v[96:99], v[212:215]
    ds_read_b128 v[64:67], v26 offset:17920
    v_mfma_f32_16x16x32_bf16 v[216:219], a[212:215], v[84:87], v[216:219]
    buffer_load_dwordx4 a[184:187], v36, s[36:39], s55 offen offset:2048 sc1
    v_mfma_f32_16x16x32_bf16 v[216:219], a[216:219], v[92:95], v[216:219]
    v_lshlrev_b32 v112, 16, v136
    v_mfma_f32_16x16x32_bf16 v[216:219], a[220:223], v[96:99], v[216:219]
    v_lshlrev_b32 v113, 16, v140
    v_and_b32 v114, s60, v136
    v_mfma_f32_16x16x32_bf16 v[216:219], a[224:227], v[100:103], v[216:219]
    ds_read_b128 v[68:71], v24 offset:18176
    v_and_b32 v115, s60, v140
    v_mfma_f32_16x16x32_bf16 v[220:223], a[212:215], v[92:95], v[220:223]
    buffer_load_dwordx4 a[192:195], v36, s[36:39], s55 offen offset:3072 sc1
    v_subrev_u32 v146, s54, v28
    v_mfma_f32_16x16x32_bf16 v[220:223], a[216:219], v[96:99], v[220:223]
    ds_read_b128 v[72:75], v26 offset:18176
    v_mfma_f32_16x16x32_bf16 v[220:223], a[220:223], v[100:103], v[220:223]
    s_waitcnt lgkmcnt(4)
    v_xor_b32 v147, 128, v146
    v_subrev_u32 v148, s53, v30
    v_mfma_f32_16x16x32_bf16 v[220:223], a[224:227], v[40:43], v[220:223]
    s_waitcnt vmcnt(32)
    ds_read_b128 v[104:107], v146 offset:32768
    v_mfma_f32_16x16x32_bf16 v[160:163], a[228:231], v[44:47], v[160:163]
    ds_read_b128 v[88:91], v25 offset:18432
    v_mfma_f32_16x16x32_bf16 v[160:163], a[232:235], v[48:51], v[160:163]
    s_add_u32 s55, s9, 69632
    buffer_load_dwordx4 a[196:199], v36, s[36:39], s55 offen offset:0 sc1
    v_mfma_f32_16x16x32_bf16 v[160:163], a[236:239], v[52:55], v[160:163]
    ds_read_b128 v[76:79], v27 offset:18432
    v_mfma_f32_16x16x32_bf16 v[160:163], a[224:227], v[56:59], v[160:163]
    ds_read_b128 v[108:111], v147 offset:32768
    v_lshlrev_b32 v116, 16, v137
    v_mfma_f32_16x16x32_bf16 v[164:167], a[228:231], v[48:51], v[164:167]
    s_cmp_lt_u32 s77, 16
    s_cbranch_scc0 L_ge2
    s_waitcnt vmcnt(49)
    v_mfma_f32_16x16x32_bf16 v[124:127], a[0:3], a[32:35], 0
    v_mfma_f32_16x16x32_bf16 v[124:127], a[4:7], a[36:39], v[124:127]
    v_mfma_f32_16x16x32_bf16 v[124:127], a[8:11], a[40:43], v[124:127]
    v_mfma_f32_16x16x32_bf16 v[124:127], a[12:15], a[44:47], v[124:127]
    v_mfma_f32_16x16x32_bf16 v[124:127], a[16:19], a[48:51], v[124:127]
    v_mfma_f32_16x16x32_bf16 v[124:127], a[20:23], a[52:55], v[124:127]
    v_mfma_f32_16x16x32_bf16 v[124:127], a[24:27], a[56:59], v[124:127]
    v_mfma_f32_16x16x32_bf16 v[124:127], a[28:31], a[60:63], v[124:127]
    s_nop 7
    v_mul_f32 v124, s63, v124
    v_mul_f32 v125, s63, v125
    v_mul_f32 v126, s63, v126
    v_mul_f32 v127, s63, v127
    v_exp_f32 v128, v124
    v_exp_f32 v129, v125
    v_exp_f32 v130, v126
    v_exp_f32 v131, v127
    v_max3_f32 v132, abs(v124), abs(v125), abs(v126)
    v_max_f32 v132, abs(v127), v132
    v_mov_b32 v133, 1119879168
    buffer_store_dwordx4 v[124:127], v144, s[36:39], s65 offen sc1
    v_cmp_nle_f32 vcc, v132, v133
    buffer_store_dwordx4 v[128:131], v144, s[36:39], s66 offen sc1
    s_cmp_lg_u64 vcc, 0
    s_cselect_b32 s56, 1, 0
    v_or_b32 v134, s56, v38
L_ge2:
    v_lshlrev_b32 v117, 16, v141
    v_mfma_f32_16x16x32_bf16 v[164:167], a[232:235], v[52:55], v[164:167]
    ds_read_b128 v[80:83], v25 offset:18688
    v_and_b32 v118, s60, v137
    v_mfma_f32_16x16x32_bf16 v[164:167], a[236:239], v[56:59], v[164:167]
    buffer_load_dwordx4 a[180:183], v36, s[36:39], s55 offen offset:1024 sc1
    v_and_b32 v119, s60, v141
    v_mfma_f32_16x16x32_bf16 v[164:167], a[224:227], v[60:63], v[164:167]
    ds_read_b128 v[84:87], v12 offset:0
    v_add_f32 v112, v112, v113
    v_mfma_f32_16x16x32_bf16 v[168:171], a[228:231], v[52:55], v[168:171]
    v_add_f32 v114, v114, v115
    v_add_f32 v116, v116, v117
    v_mfma_f32_16x16x32_bf16 v[168:171], a[232:235], v[56:59], v[168:171]
    v_add_f32 v118, v118, v119
    v_cvt_pk_bf16_f32 v136, v112, v114
    v_mfma_f32_16x16x32_bf16 v[168:171], a[236:239], v[60:63], v[168:171]
    s_waitcnt lgkmcnt(4)
    ds_read_b128 v[92:95], v12 offset:256
    v_cvt_pk_bf16_f32 v137, v116, v118
    v_mfma_f32_16x16x32_bf16 v[168:171], a[224:227], v[64:67], v[168:171]
    buffer_load_dwordx4 a[200:203], v36, s[36:39], s55 offen offset:2048 sc1
    v_lshlrev_b32 v112, 16, v138
    v_mfma_f32_16x16x32_bf16 v[172:175], a[228:231], v[56:59], v[172:175]
    ds_read_b128 v[96:99], v12 offset:512
    v_lshlrev_b32 v113, 16, v142
    v_mfma_f32_16x16x32_bf16 v[172:175], a[232:235], v[60:63], v[172:175]
    v_and_b32 v114, s60, v138
    v_and_b32 v115, s60, v142
    v_mfma_f32_16x16x32_bf16 v[172:175], a[236:239], v[64:67], v[172:175]
    v_lshlrev_b32 v116, 16, v139
    v_mfma_f32_16x16x32_bf16 v[172:175], a[224:227], v[68:71], v[172:175]
    ds_read_b128 v[100:103], v12 offset:768
    v_lshlrev_b32 v117, 16, v143
    v_mfma_f32_16x16x32_bf16 v[176:179], a[228:231], v[60:63], v[176:179]
    buffer_load_dwordx4 a[204:207], v36, s[36:39], s55 offen offset:3072 sc1
    v_and_b32 v118, s60, v139
    v_mfma_f32_16x16x32_bf16 v[176:179], a[232:235], v[64:67], v[176:179]
    v_and_b32 v119, s60, v143
    v_mfma_f32_16x16x32_bf16 v[176:179], a[236:239], v[68:71], v[176:179]
    v_add_f32 v112, v112, v113
    v_add_f32 v114, v114, v115
    v_mfma_f32_16x16x32_bf16 v[176:179], a[224:227], v[72:75], v[176:179]
    ds_read_b128 v[40:43], v12 offset:1024
    v_add_f32 v116, v116, v117
    v_mfma_f32_16x16x32_bf16 v[180:183], a[228:231], v[64:67], v[180:183]
    v_add_f32 v118, v118, v119
    v_mfma_f32_16x16x32_bf16 v[180:183], a[232:235], v[68:71], v[180:183]
    s_add_u32 s55, s9, 73728
    buffer_load_dwordx4 a[208:211], v36, s[36:39], s55 offen offset:0 sc1
    v_cvt_pk_bf16_f32 v138, v112, v114
    v_mfma_f32_16x16x32_bf16 v[180:183], a[236:239], v[72:75], v[180:183]
    v_cvt_pk_bf16_f32 v139, v116, v118
    v_mfma_f32_16x16x32_bf16 v[180:183], a[224:227], v[88:91], v[180:183]
    ds_read_b128 v[44:47], v12 offset:1280
    v_mfma_f32_16x16x32_bf16 v[184:187], a[228:231], v[68:71], v[184:187]
    ds_write_b128 v31, v[136:139] offset:12288
    v_mfma_f32_16x16x32_bf16 v[184:187], a[232:235], v[72:75], v[184:187]
    v_mfma_f32_16x16x32_bf16 v[184:187], a[236:239], v[88:91], v[184:187]
    s_waitcnt lgkmcnt(3)
    buffer_load_dwordx4 a[212:215], v36, s[36:39], s55 offen offset:1024 sc1
    v_lshlrev_b32 v112, 16, v104
    v_mfma_f32_16x16x32_bf16 v[184:187], a[224:227], v[76:79], v[184:187]
    ds_read_b128 v[48:51], v12 offset:1536
    v_lshlrev_b32 v113, 16, v108
    v_mfma_f32_16x16x32_bf16 v[188:191], a[228:231], v[72:75], v[188:191]
    v_and_b32 v114, s60, v104
    v_mfma_f32_16x16x32_bf16 v[188:191], a[232:235], v[88:91], v[188:191]
    ds_read_b128 v[52:55], v12 offset:1792
    v_and_b32 v115, s60, v108
    v_mfma_f32_16x16x32_bf16 v[188:191], a[236:239], v[76:79], v[188:191]
    v_lshlrev_b32 v116, 16, v105
    v_lshlrev_b32 v117, 16, v109
    v_mfma_f32_16x16x32_bf16 v[188:191], a[224:227], v[80:83], v[188:191]
    s_waitcnt vmcnt(34)
    buffer_load_dwordx4 a[216:219], v36, s[36:39], s55 offen offset:2048 sc1
    v_and_b32 v118, s60, v105
    v_mfma_f32_16x16x32_bf16 v[224:227], a[240:243], v[84:87], v[224:227]
    ds_read_b128 v[56:59], v13 offset:2048
    v_mfma_f32_16x16x32_bf16 v[224:227], a[244:247], v[92:95], v[224:227]
    v_and_b32 v119, s60, v109
    v_add_f32 v112, v112, v113
    v_mfma_f32_16x16x32_bf16 v[224:227], a[248:251], v[96:99], v[224:227]
    ds_read_b128 v[60:63], v13 offset:2304
    v_add_f32 v114, v114, v115
    v_mfma_f32_16x16x32_bf16 v[224:227], a[252:255], v[100:103], v[224:227]
    v_add_f32 v116, v116, v117
    v_mfma_f32_16x16x32_bf16 v[228:231], a[240:243], v[92:95], v[228:231]
    s_add_u32 s55, s9, 77824
    buffer_load_dwordx4 a[220:223], v36, s[36:39], s55 offen offset:0 sc1
    v_add_f32 v118, v118, v119
    v_mfma_f32_16x16x32_bf16 v[228:231], a[244:247], v[96:99], v[228:231]
    ds_read_b128 v[64:67], v13 offset:2560
    v_cvt_pk_bf16_f32 v104, v112, v114
    v_mfma_f32_16x16x32_bf16 v[228:231], a[248:251], v[100:103], v[228:231]
    s_waitcnt lgkmcnt(4)
    v_cvt_pk_bf16_f32 v105, v116, v118
    v_mfma_f32_16x16x32_bf16 v[228:231], a[252:255], v[40:43], v[228:231]
    ds_read_b128 v[68:71], v14 offset:0
    v_lshlrev_b32 v112, 16, v106
    v_mfma_f32_16x16x32_bf16 v[232:235], a[240:243], v[96:99], v[232:235]
    v_lshlrev_b32 v113, 16, v110
    v_and_b32 v114, s60, v106
    v_mfma_f32_16x16x32_bf16 v[232:235], a[244:247], v[100:103], v[232:235]
    buffer_load_dwordx4 a[228:231], v36, s[36:39], s55 offen offset:1024 sc1
    v_mfma_f32_16x16x32_bf16 v[232:235], a[248:251], v[40:43], v[232:235]
    ds_read_b128 v[72:75], v14 offset:256
    v_and_b32 v115, s60, v110
    v_mfma_f32_16x16x32_bf16 v[232:235], a[252:255], v[44:47], v[232:235]
    v_lshlrev_b32 v116, 16, v107
    v_lshlrev_b32 v117, 16, v111
    v_mfma_f32_16x16x32_bf16 v[236:239], a[240:243], v[100:103], v[236:239]
    ds_read_b128 v[88:91], v14 offset:512
    v_and_b32 v118, s60, v107
    v_mfma_f32_16x16x32_bf16 v[236:239], a[244:247], v[40:43], v[236:239]
    v_and_b32 v119, s60, v111
    v_mfma_f32_16x16x32_bf16 v[236:239], a[248:251], v[44:47], v[236:239]
    buffer_load_dwordx4 a[232:235], v36, s[36:39], s55 offen offset:2048 sc1
    v_add_f32 v112, v112, v113
    v_mfma_f32_16x16x32_bf16 v[236:239], a[252:255], v[48:51], v[236:239]
    ds_read_b128 v[76:79], v14 offset:768
    v_add_f32 v114, v114, v115
    v_mfma_f32_16x16x32_bf16 v[240:243], a[240:243], v[40:43], v[240:243]
    v_add_f32 v116, v116, v117
    v_mfma_f32_16x16x32_bf16 v[240:243], a[244:247], v[44:47], v[240:243]
    v_add_f32 v118, v118, v119
    v_cvt_pk_bf16_f32 v106, v112, v114
    v_mfma_f32_16x16x32_bf16 v[240:243], a[248:251], v[48:51], v[240:243]
    s_waitcnt lgkmcnt(3)
    v_cvt_pk_bf16_f32 v107, v116, v118
    v_mfma_f32_16x16x32_bf16 v[240:243], a[252:255], v[52:55], v[240:243]
    ds_read_b128 v[80:83], v14 offset:1024
    v_mfma_f32_16x16x32_bf16 v[244:247], a[240:243], v[44:47], v[244:247]
    buffer_load_dwordx4 a[236:239], v36, s[36:39], s55 offen offset:3072 sc1
    v_mfma_f32_16x16x32_bf16 v[244:247], a[244:247], v[48:51], v[244:247]
    ds_write_b128 v148, v[104:107] offset:16384
    v_mfma_f32_16x16x32_bf16 v[244:247], a[248:251], v[52:55], v[244:247]
    v_mfma_f32_16x16x32_bf16 v[244:247], a[252:255], v[56:59], v[244:247]
    ds_read_b128 v[84:87], v14 offset:1280
    v_mfma_f32_16x16x32_bf16 v[248:251], a[240:243], v[48:51], v[248:251]
    s_add_u32 s61, s67, 147456
    buffer_load_dwordx4 a[64:67], v36, s[36:39], s61 offen offset:0 sc1
    v_mfma_f32_16x16x32_bf16 v[248:251], a[244:247], v[52:55], v[248:251]
    v_mfma_f32_16x16x32_bf16 v[248:251], a[248:251], v[56:59], v[248:251]
    v_mfma_f32_16x16x32_bf16 v[248:251], a[252:255], v[60:63], v[248:251]
    ds_read_b128 v[92:95], v14 offset:1536
    v_mfma_f32_16x16x32_bf16 v[252:255], a[240:243], v[52:55], v[252:255]
    v_mfma_f32_16x16x32_bf16 v[252:255], a[244:247], v[56:59], v[252:255]
    ds_read_b128 v[96:99], v14 offset:1792
    v_mfma_f32_16x16x32_bf16 v[252:255], a[248:251], v[60:63], v[252:255]
    s_add_u32 s55, s9, 81920
    buffer_load_dwordx4 a[224:227], v36, s[36:39], s55 offen offset:0 sc1
    v_mfma_f32_16x16x32_bf16 v[252:255], a[252:255], v[64:67], v[252:255]
    s_waitcnt vmcnt(37)
    v_mfma_f32_16x16x32_bf16 v[192:195], a[156:159], v[68:71], v[192:195]
    s_waitcnt lgkmcnt(3)
    ds_read_b128 v[100:103], v15 offset:2048
    v_mfma_f32_16x16x32_bf16 v[192:195], a[188:191], v[72:75], v[192:195]
    v_mfma_f32_16x16x32_bf16 v[192:195], a[128:131], v[88:91], v[192:195]
    ds_read_b128 v[40:43], v15 offset:2304
    v_mfma_f32_16x16x32_bf16 v[192:195], a[132:135], v[76:79], v[192:195]
    buffer_load_dwordx4 a[240:243], v36, s[36:39], s55 offen offset:1024 sc1
    v_mfma_f32_16x16x32_bf16 v[196:199], a[156:159], v[72:75], v[196:199]
    s_waitcnt vmcnt(27)
    s_barrier
    v_mfma_f32_16x16x32_bf16 v[196:199], a[188:191], v[88:91], v[196:199]
    ds_read_b128 v[44:47], v15 offset:2560
    v_mfma_f32_16x16x32_bf16 v[196:199], a[128:131], v[76:79], v[196:199]
    v_add_u32 v28, 4294932480, v28
    v_add_u32 v29, 4294932480, v29
    v_mfma_f32_16x16x32_bf16 v[196:199], a[132:135], v[80:83], v[196:199]
    s_add_u32 m0, s54, 69632
    ds_read_b128 v[48:51], v20 offset:0
    v_mfma_f32_16x16x32_bf16 v[200:203], a[156:159], v[88:91], v[200:203]
    buffer_load_dwordx4 v2, s[24:27], s72 offen  lds
    v_mfma_f32_16x16x32_bf16 v[200:203], a[188:191], v[76:79], v[200:203]
    ds_read_b128 v[104:107], v28 offset:0
    v_mfma_f32_16x16x32_bf16 v[200:203], a[128:131], v[80:83], v[200:203]
    s_waitcnt lgkmcnt(4)
    ds_read_b128 v[52:55], v22 offset:0
    v_mfma_f32_16x16x32_bf16 v[200:203], a[132:135], v[84:87], v[200:203]
    ds_read_b128 v[108:111], v29 offset:0
    v_mfma_f32_16x16x32_bf16 v[204:207], a[156:159], v[76:79], v[204:207]
    s_add_u32 m0, s54, 77824
    ds_read_b128 v[56:59], v20 offset:256
    v_mfma_f32_16x16x32_bf16 v[204:207], a[188:191], v[80:83], v[204:207]
    buffer_load_dwordx4 v3, s[24:27], s72 offen  lds
    v_mfma_f32_16x16x32_bf16 v[204:207], a[128:131], v[84:87], v[204:207]
    v_mfma_f32_16x16x32_bf16 v[204:207], a[132:135], v[92:95], v[204:207]
    ds_read_b128 v[60:63], v22 offset:256
    v_mfma_f32_16x16x32_bf16 v[208:211], a[156:159], v[80:83], v[208:211]
    v_mfma_f32_16x16x32_bf16 v[208:211], a[188:191], v[84:87], v[208:211]
    s_waitcnt lgkmcnt(2)
    s_add_u32 m0, s54, 86016
    v_lshlrev_b32 v112, 16, v104
    v_mfma_f32_16x16x32_bf16 v[208:211], a[128:131], v[92:95], v[208:211]
    buffer_load_dwordx4 v4, s[24:27], s72 offen  lds
    v_mfma_f32_16x16x32_bf16 v[208:211], a[132:135], v[96:99], v[208:211]
    ds_read_b128 v[64:67], v20 offset:512
    v_lshlrev_b32 v113, 16, v108
    v_mfma_f32_16x16x32_bf16 v[212:215], a[156:159], v[84:87], v[212:215]
    v_and_b32 v114, s60, v104
    v_and_b32 v115, s60, v108
    v_mfma_f32_16x16x32_bf16 v[212:215], a[188:191], v[92:95], v[212:215]
    ds_read_b128 v[136:139], v28 offset:8192
    v_mfma_f32_16x16x32_bf16 v[212:215], a[128:131], v[96:99], v[212:215]
    buffer_load_dwordx4 a[244:247], v36, s[36:39], s55 offen offset:2048 sc1
    v_mfma_f32_16x16x32_bf16 v[212:215], a[132:135], v[100:103], v[212:215]
    ds_read_b128 v[68:71], v22 offset:512
    v_mfma_f32_16x16x32_bf16 v[216:219], a[156:159], v[92:95], v[216:219]
    ds_read_b128 v[140:143], v29 offset:8192
    v_lshlrev_b32 v116, 16, v105
    v_mfma_f32_16x16x32_bf16 v[216:219], a[188:191], v[96:99], v[216:219]
    v_lshlrev_b32 v117, 16, v109
    v_and_b32 v118, s60, v105
    v_mfma_f32_16x16x32_bf16 v[216:219], a[128:131], v[100:103], v[216:219]
    v_and_b32 v119, s60, v109
    v_add_f32 v112, v112, v113
    v_mfma_f32_16x16x32_bf16 v[216:219], a[132:135], v[40:43], v[216:219]
    s_add_u32 m0, s54, 94208
    ds_read_b128 v[72:75], v20 offset:768
    v_add_f32 v114, v114, v115
    v_mfma_f32_16x16x32_bf16 v[220:223], a[156:159], v[96:99], v[220:223]
    buffer_load_dwordx4 v5, s[24:27], s72 offen  lds
    v_add_f32 v116, v116, v117
    v_mfma_f32_16x16x32_bf16 v[220:223], a[188:191], v[100:103], v[220:223]
    ds_read_b128 v[88:91], v22 offset:768
    v_add_f32 v118, v118, v119
    v_mfma_f32_16x16x32_bf16 v[220:223], a[128:131], v[40:43], v[220:223]
    v_cvt_pk_bf16_f32 v104, v112, v114
    v_cvt_pk_bf16_f32 v105, v116, v118
    v_mfma_f32_16x16x32_bf16 v[220:223], a[132:135], v[44:47], v[220:223]
    s_waitcnt vmcnt(29)
    v_lshlrev_b32 v112, 16, v106
    v_mfma_f32_16x16x32_bf16 v[160:163], a[136:139], v[48:51], v[160:163]
    s_add_u32 m0, s54, 70656
    ds_read_b128 v[76:79], v21 offset:1024
    v_mfma_f32_16x16x32_bf16 v[160:163], a[140:143], v[52:55], v[160:163]
    s_waitcnt lgkmcnt(4)
    buffer_load_dwordx4 v6, s[24:27], s72 offen  lds
    v_lshlrev_b32 v113, 16, v110
    v_mfma_f32_16x16x32_bf16 v[160:163], a[144:147], v[56:59], v[160:163]
    ds_read_b128 v[80:83], v23 offset:1024
    v_and_b32 v114, s60, v106
    v_mfma_f32_16x16x32_bf16 v[160:163], a[148:151], v[60:63], v[160:163]
    v_and_b32 v115, s60, v110
    v_mfma_f32_16x16x32_bf16 v[164:167], a[136:139], v[52:55], v[164:167]
    v_lshlrev_b32 v116, 16, v107
    v_lshlrev_b32 v117, 16, v111
    v_mfma_f32_16x16x32_bf16 v[164:167], a[140:143], v[56:59], v[164:167]
    s_add_u32 m0, s54, 78848
    ds_read_b128 v[84:87], v21 offset:1280
    v_and_b32 v118, s60, v107
    v_mfma_f32_16x16x32_bf16 v[164:167], a[144:147], v[60:63], v[164:167]
    buffer_load_dwordx4 v7, s[24:27], s72 offen  lds
    v_and_b32 v119, s60, v111
    v_mfma_f32_16x16x32_bf16 v[164:167], a[148:151], v[64:67], v[164:167]
    ds_read_b128 v[92:95], v16 offset:0
    v_mfma_f32_16x16x32_bf16 v[168:171], a[136:139], v[56:59], v[168:171]
    v_add_f32 v112, v112, v113
    v_add_f32 v114, v114, v115
    v_mfma_f32_16x16x32_bf16 v[168:171], a[140:143], v[60:63], v[168:171]
    v_add_f32 v116, v116, v117
    v_mfma_f32_16x16x32_bf16 v[168:171], a[144:147], v[64:67], v[168:171]
    s_add_u32 m0, s54, 87040
    ds_read_b128 v[96:99], v16 offset:256
    v_mfma_f32_16x16x32_bf16 v[168:171], a[148:151], v[68:71], v[168:171]
    buffer_load_dwordx4 v8, s[24:27], s72 offen  lds
    v_add_f32 v118, v118, v119
    v_mfma_f32_16x16x32_bf16 v[172:175], a[136:139], v[60:63], v[172:175]
    ds_read_b128 v[100:103], v16 offset:512
    v_cvt_pk_bf16_f32 v106, v112, v114
    v_mfma_f32_16x16x32_bf16 v[172:175], a[140:143], v[64:67], v[172:175]
    v_cvt_pk_bf16_f32 v107, v116, v118
    v_mfma_f32_16x16x32_bf16 v[172:175], a[144:147], v[68:71], v[172:175]
    s_waitcnt lgkmcnt(4)
    ds_write_b128 v30, v[104:107] offset:17408
    v_mfma_f32_16x16x32_bf16 v[172:175], a[148:151], v[72:75], v[172:175]
    s_add_u32 m0, s54, 95232
    ds_read_b128 v[40:43], v16 offset:768
    v_mfma_f32_16x16x32_bf16 v[176:179], a[136:139], v[64:67], v[176:179]
    buffer_load_dwordx4 v9, s[24:27], s72 offen  lds
    v_mfma_f32_16x16x32_bf16 v[176:179], a[140:143], v[68:71], v[176:179]
    v_lshlrev_b32 v112, 16, v136
    v_lshlrev_b32 v113, 16, v140
    v_mfma_f32_16x16x32_bf16 v[176:179], a[144:147], v[72:75], v[176:179]
    v_and_b32 v114, s60, v136
    v_mfma_f32_16x16x32_bf16 v[176:179], a[148:151], v[88:91], v[176:179]
    ds_read_b128 v[44:47], v16 offset:1024
    v_and_b32 v115, s60, v140
    v_mfma_f32_16x16x32_bf16 v[180:183], a[136:139], v[68:71], v[180:183]
    buffer_load_dwordx4 a[68:71], v36, s[36:39], s61 offen offset:1024 sc1
    v_mfma_f32_16x16x32_bf16 v[180:183], a[140:143], v[72:75], v[180:183]
    ds_read_b128 v[104:107], v28 offset:16384
    v_mfma_f32_16x16x32_bf16 v[180:183], a[144:147], v[88:91], v[180:183]
    ds_read_b128 v[108:111], v29 offset:16384
    v_lshlrev_b32 v116, 16, v137
    v_mfma_f32_16x16x32_bf16 v[180:183], a[148:151], v[76:79], v[180:183]
    ds_read_b128 v[48:51], v16 offset:1280
    v_lshlrev_b32 v117, 16, v141
    v_mfma_f32_16x16x32_bf16 v[184:187], a[136:139], v[72:75], v[184:187]
    v_and_b32 v118, s60, v137
    v_and_b32 v119, s60, v141
    v_mfma_f32_16x16x32_bf16 v[184:187], a[140:143], v[88:91], v[184:187]
    s_mov_b32 m0, 102400
    v_add_f32 v112, v112, v113
    v_add_f32 v114, v114, v115
    v_mfma_f32_16x16x32_bf16 v[184:187], a[144:147], v[76:79], v[184:187]
    buffer_load_dwordx4 v10, s[24:27], s72 offen  lds
    v_add_f32 v116, v116, v117
    v_mfma_f32_16x16x32_bf16 v[184:187], a[148:151], v[80:83], v[184:187]
    ds_read_b128 v[52:55], v16 offset:1536
    v_mfma_f32_16x16x32_bf16 v[188:191], a[136:139], v[88:91], v[188:191]
    buffer_load_dword v1, v34, s[24:27], s76 offen
    v_add_f32 v118, v118, v119
    v_mfma_f32_16x16x32_bf16 v[188:191], a[140:143], v[76:79], v[188:191]
    ds_read_b128 v[56:59], v16 offset:1792
    v_cvt_pk_bf16_f32 v136, v112, v114
    v_mfma_f32_16x16x32_bf16 v[188:191], a[144:147], v[80:83], v[188:191]
    s_waitcnt lgkmcnt(5)
    s_add_u32 s55, s9, 86016
    buffer_load_dwordx4 a[248:251], v36, s[36:39], s55 offen offset:0 sc1
    v_cvt_pk_bf16_f32 v137, v116, v118
    v_mfma_f32_16x16x32_bf16 v[188:191], a[148:151], v[84:87], v[188:191]
    s_waitcnt vmcnt(33)
    v_lshlrev_b32 v112, 16, v138
    v_mfma_f32_16x16x32_bf16 v[224:227], a[152:155], v[92:95], v[224:227]
    ds_read_b128 v[60:63], v17 offset:2048
    v_lshlrev_b32 v113, 16, v142
    v_mfma_f32_16x16x32_bf16 v[224:227], a[160:163], v[96:99], v[224:227]
    v_and_b32 v114, s60, v138
    v_and_b32 v115, s60, v142
    v_mfma_f32_16x16x32_bf16 v[224:227], a[164:167], v[100:103], v[224:227]
    ds_read_b128 v[64:67], v17 offset:2304
    v_mfma_f32_16x16x32_bf16 v[224:227], a[168:171], v[40:43], v[224:227]
    buffer_load_dwordx4 a[252:255], v36, s[36:39], s55 offen offset:1024 sc1
    v_lshlrev_b32 v116, 16, v139
    v_mfma_f32_16x16x32_bf16 v[228:231], a[152:155], v[96:99], v[228:231]
    v_lshlrev_b32 v117, 16, v143
    v_and_b32 v118, s60, v139
    v_mfma_f32_16x16x32_bf16 v[228:231], a[160:163], v[100:103], v[228:231]
    ds_read_b128 v[68:71], v17 offset:2560
    v_and_b32 v119, s60, v143
    v_mfma_f32_16x16x32_bf16 v[228:231], a[164:167], v[40:43], v[228:231]
    v_add_f32 v112, v112, v113
    v_mfma_f32_16x16x32_bf16 v[228:231], a[168:171], v[44:47], v[228:231]
    ds_read_b128 v[72:75], v18 offset:0
    v_add_f32 v114, v114, v115
    v_mfma_f32_16x16x32_bf16 v[232:235], a[152:155], v[100:103], v[232:235]
    buffer_load_dwordx4 a[72:75], v36, s[36:39], s61 offen offset:2048 sc1
    v_add_f32 v116, v116, v117
    v_mfma_f32_16x16x32_bf16 v[232:235], a[160:163], v[40:43], v[232:235]
    v_add_f32 v118, v118, v119
    v_mfma_f32_16x16x32_bf16 v[232:235], a[164:167], v[44:47], v[232:235]
    s_waitcnt lgkmcnt(3)
    ds_read_b128 v[88:91], v18 offset:256
    v_cvt_pk_bf16_f32 v138, v112, v114
    v_mfma_f32_16x16x32_bf16 v[232:235], a[168:171], v[48:51], v[232:235]
    s_waitcnt vmcnt(33)
    buffer_store_dword v38, v39, s[36:39], s7 offen sc1
    v_mfma_f32_16x16x32_bf16 v[236:239], a[152:155], v[40:43], v[236:239]
    ds_read_b128 v[76:79], v18 offset:512
    v_cvt_pk_bf16_f32 v139, v116, v118
    v_min_u32 v149, 59, v0
    v_mfma_f32_16x16x32_bf16 v[236:239], a[160:163], v[44:47], v[236:239]
    buffer_load_dwordx4 a[156:159], v36, s[36:39], s55 offen offset:2048 sc1
    v_mfma_f32_16x16x32_bf16 v[236:239], a[164:167], v[48:51], v[236:239]
    ds_write_b128 v31, v[136:139] offset:21504
    v_mfma_f32_16x16x32_bf16 v[236:239], a[168:171], v[52:55], v[236:239]
    ds_read_b128 v[80:83], v18 offset:768
    v_mfma_f32_16x16x32_bf16 v[240:243], a[152:155], v[44:47], v[240:243]
    v_lshlrev_b32 v112, 16, v104
    v_mfma_f32_16x16x32_bf16 v[240:243], a[160:163], v[48:51], v[240:243]
    s_lshl_b32 s56, s8, 10
    v_lshlrev_b32 v113, 16, v108
    v_mfma_f32_16x16x32_bf16 v[240:243], a[164:167], v[52:55], v[240:243]
    s_add_u32 s55, s9, 90112
    buffer_load_dwordx4 a[188:191], v36, s[36:39], s55 offen offset:0 sc1
    v_mfma_f32_16x16x32_bf16 v[240:243], a[168:171], v[56:59], v[240:243]
    ds_read_b128 v[84:87], v18 offset:1024
    v_and_b32 v114, s60, v104
    v_mfma_f32_16x16x32_bf16 v[244:247], a[152:155], v[48:51], v[244:247]
    s_add_u32 s56, s56, 15073280
    v_and_b32 v115, s60, v108
    v_mfma_f32_16x16x32_bf16 v[244:247], a[160:163], v[52:55], v[244:247]
    ds_read_b128 v[136:139], v28 offset:24576
    v_lshl_add_u32 v149, v149, 4, s56
    v_mfma_f32_16x16x32_bf16 v[244:247], a[164:167], v[56:59], v[244:247]
    ds_read_b128 v[140:143], v29 offset:24576
    v_lshlrev_b32 v116, 16, v105
    v_mfma_f32_16x16x32_bf16 v[244:247], a[168:171], v[60:63], v[244:247]
    ds_read_b128 v[92:95], v18 offset:1280
    v_lshlrev_b32 v117, 16, v109
    v_mfma_f32_16x16x32_bf16 v[248:251], a[152:155], v[52:55], v[248:251]
    buffer_load_dwordx4 a[128:131], v36, s[36:39], s55 offen offset:1024 sc1
    v_and_b32 v118, s60, v105
    v_mfma_f32_16x16x32_bf16 v[248:251], a[160:163], v[56:59], v[248:251]
    v_and_b32 v119, s60, v109
    v_add_f32 v112, v112, v113
    v_mfma_f32_16x16x32_bf16 v[248:251], a[164:167], v[60:63], v[248:251]
    s_waitcnt lgkmcnt(4)
    v_add_f32 v114, v114, v115
    v_add_f32 v116, v116, v117
    v_mfma_f32_16x16x32_bf16 v[248:251], a[168:171], v[64:67], v[248:251]
    ds_read_b128 v[96:99], v18 offset:1536
    v_add_f32 v118, v118, v119
    v_mfma_f32_16x16x32_bf16 v[252:255], a[152:155], v[56:59], v[252:255]
    buffer_load_dwordx4 a[132:135], v36, s[36:39], s55 offen offset:2048 sc1
    v_mfma_f32_16x16x32_bf16 v[252:255], a[160:163], v[60:63], v[252:255]
    ds_read_b128 v[100:103], v18 offset:1792
    v_cvt_pk_bf16_f32 v104, v112, v114
    v_mfma_f32_16x16x32_bf16 v[252:255], a[164:167], v[64:67], v[252:255]
    v_cvt_pk_bf16_f32 v105, v116, v118
    v_lshlrev_b32 v112, 16, v106
    v_mfma_f32_16x16x32_bf16 v[252:255], a[168:171], v[68:71], v[252:255]
    s_waitcnt vmcnt(34)
    v_lshlrev_b32 v113, 16, v110
    v_mfma_f32_16x16x32_bf16 v[192:195], a[172:175], v[72:75], v[192:195]
    ds_read_b128 v[40:43], v19 offset:2048
    v_and_b32 v114, s60, v106
    v_mfma_f32_16x16x32_bf16 v[192:195], a[176:179], v[88:91], v[192:195]
    buffer_load_dwordx4 a[76:79], v36, s[36:39], s61 offen offset:3072 sc1
    v_and_b32 v115, s60, v110
    v_mfma_f32_16x16x32_bf16 v[192:195], a[184:187], v[76:79], v[192:195]
    ds_read_b128 v[44:47], v19 offset:2304
    v_lshlrev_b32 v116, 16, v107
    v_mfma_f32_16x16x32_bf16 v[192:195], a[192:195], v[80:83], v[192:195]
    v_lshlrev_b32 v117, 16, v111
    v_and_b32 v151, 15, v0
    v_mfma_f32_16x16x32_bf16 v[196:199], a[172:175], v[88:91], v[196:199]
    v_and_b32 v118, s60, v107
    v_and_b32 v119, s60, v111
    v_mfma_f32_16x16x32_bf16 v[196:199], a[176:179], v[76:79], v[196:199]
    ds_read_b128 v[48:51], v19 offset:2560
    v_add_f32 v112, v112, v113
    v_mfma_f32_16x16x32_bf16 v[196:199], a[184:187], v[80:83], v[196:199]
    s_waitcnt lgkmcnt(4)
    buffer_load_dwordx4 a[136:139], v36, s[36:39], s55 offen offset:3072 sc1
    v_mfma_f32_16x16x32_bf16 v[196:199], a[192:195], v[84:87], v[196:199]
    ds_read_b128 v[52:55], v24 offset:0
    v_add_f32 v114, v114, v115
    v_mfma_f32_16x16x32_bf16 v[200:203], a[172:175], v[76:79], v[200:203]
    v_add_f32 v116, v116, v117
    v_add_f32 v118, v118, v119
    v_mfma_f32_16x16x32_bf16 v[200:203], a[176:179], v[80:83], v[200:203]
    v_cvt_pk_bf16_f32 v106, v112, v114
    v_mfma_f32_16x16x32_bf16 v[200:203], a[184:187], v[84:87], v[200:203]
    ds_read_b128 v[56:59], v26 offset:0
    v_cvt_pk_bf16_f32 v107, v116, v118
    v_mfma_f32_16x16x32_bf16 v[200:203], a[192:195], v[92:95], v[200:203]
    s_add_u32 s61, s67, 151552
    s_lshl_b32 s56, s48, 8
    buffer_load_dwordx4 a[80:83], v36, s[36:39], s61 offen offset:0 sc1
    v_mfma_f32_16x16x32_bf16 v[204:207], a[172:175], v[80:83], v[204:207]
    s_add_u32 s56, s56, 15093760
    ds_read_b128 v[60:63], v24 offset:256
    v_mfma_f32_16x16x32_bf16 v[204:207], a[176:179], v[84:87], v[204:207]
    ds_write_b128 v30, v[104:107] offset:25600
    v_mfma_f32_16x16x32_bf16 v[204:207], a[184:187], v[92:95], v[204:207]
    v_lshlrev_b32 v112, 16, v136
    v_lshl_add_u32 v151, v151, 4, s56
    v_mfma_f32_16x16x32_bf16 v[204:207], a[192:195], v[96:99], v[204:207]
    ds_read_b128 v[64:67], v26 offset:256
    v_lshlrev_b32 v113, 16, v140
    v_mfma_f32_16x16x32_bf16 v[208:211], a[172:175], v[84:87], v[208:211]
    s_add_u32 s55, s9, 94208
    buffer_load_dwordx4 a[140:143], v36, s[36:39], s55 offen offset:0 sc1
    v_and_b32 v114, s60, v136
    v_mfma_f32_16x16x32_bf16 v[208:211], a[176:179], v[92:95], v[208:211]
    v_and_b32 v115, s60, v140
    v_mfma_f32_16x16x32_bf16 v[208:211], a[184:187], v[96:99], v[208:211]
    s_waitcnt lgkmcnt(4)
    v_subrev_u32 v146, s54, v28
    v_xor_b32 v147, 128, v146
    v_mfma_f32_16x16x32_bf16 v[208:211], a[192:195], v[100:103], v[208:211]
    ds_read_b128 v[68:71], v24 offset:512
    v_mfma_f32_16x16x32_bf16 v[212:215], a[172:175], v[92:95], v[212:215]
    v_subrev_u32 v148, s53, v30
    v_mfma_f32_16x16x32_bf16 v[212:215], a[176:179], v[96:99], v[212:215]
    s_mul_i32 s23, s8, 122880
    buffer_load_dwordx4 a[144:147], v36, s[36:39], s55 offen offset:1024 sc1
    v_mfma_f32_16x16x32_bf16 v[212:215], a[184:187], v[100:103], v[212:215]
    s_add_u32 s23, s23, 8388608
    ds_read_b128 v[104:107], v146 offset:32768
    v_mfma_f32_16x16x32_bf16 v[212:215], a[192:195], v[40:43], v[212:215]
    ds_read_b128 v[72:75], v26 offset:512
    v_mfma_f32_16x16x32_bf16 v[216:219], a[172:175], v[96:99], v[216:219]
    ds_read_b128 v[108:111], v147 offset:32768
    v_lshlrev_b32 v116, 16, v137
    v_mfma_f32_16x16x32_bf16 v[216:219], a[176:179], v[100:103], v[216:219]
    v_lshlrev_b32 v117, 16, v141
    v_and_b32 v118, s60, v137
    v_mfma_f32_16x16x32_bf16 v[216:219], a[184:187], v[40:43], v[216:219]
    ds_read_b128 v[88:91], v24 offset:768
    v_and_b32 v119, s60, v141
    v_mfma_f32_16x16x32_bf16 v[216:219], a[192:195], v[44:47], v[216:219]
    buffer_load_dwordx4 a[148:151], v36, s[36:39], s55 offen offset:2048 sc1
    v_add_f32 v112, v112, v113
    v_mfma_f32_16x16x32_bf16 v[220:223], a[172:175], v[100:103], v[220:223]
    ds_read_b128 v[76:79], v26 offset:768
    v_add_f32 v114, v114, v115
    v_mfma_f32_16x16x32_bf16 v[220:223], a[176:179], v[40:43], v[220:223]
    v_add_f32 v116, v116, v117
    v_add_f32 v118, v118, v119
    v_mfma_f32_16x16x32_bf16 v[220:223], a[184:187], v[44:47], v[220:223]
    v_add_u32 v12, 4294932480, v12
    v_cvt_pk_bf16_f32 v136, v112, v114
    v_mfma_f32_16x16x32_bf16 v[220:223], a[192:195], v[48:51], v[220:223]
    s_waitcnt vmcnt(36)
    ds_read_b128 v[80:83], v25 offset:1024
    v_add_u32 v13, 4294932480, v13
    v_mfma_f32_16x16x32_bf16 v[160:163], a[196:199], v[52:55], v[160:163]
    s_waitcnt lgkmcnt(5)
    buffer_load_dwordx4 a[84:87], v36, s[36:39], s61 offen offset:1024 sc1
    v_add_u32 v14, 4294932480, v14
    v_cvt_pk_bf16_f32 v137, v116, v118
    v_mfma_f32_16x16x32_bf16 v[160:163], a[180:183], v[56:59], v[160:163]
    ds_read_b128 v[84:87], v27 offset:1024
    v_add_u32 v15, 4294932480, v15
    v_mfma_f32_16x16x32_bf16 v[160:163], a[200:203], v[60:63], v[160:163]
    v_lshlrev_b32 v112, 16, v138
    v_lshlrev_b32 v113, 16, v142
    v_mfma_f32_16x16x32_bf16 v[160:163], a[204:207], v[64:67], v[160:163]
    v_and_b32 v114, s60, v138
    v_and_b32 v115, s60, v142
    v_mfma_f32_16x16x32_bf16 v[164:167], a[196:199], v[56:59], v[164:167]
    ds_read_b128 v[92:95], v25 offset:1280
    v_mfma_f32_16x16x32_bf16 v[164:167], a[180:183], v[60:63], v[164:167]
    s_add_u32 s55, s9, 98304
    buffer_load_dwordx4 a[152:155], v36, s[36:39], s55 offen offset:0 sc1
    v_mfma_f32_16x16x32_bf16 v[164:167], a[200:203], v[64:67], v[164:167]
    ds_read_b128 v[96:99], v12 offset:0
    v_lshlrev_b32 v116, 16, v139
    v_mfma_f32_16x16x32_bf16 v[164:167], a[204:207], v[68:71], v[164:167]
    v_lshlrev_b32 v117, 16, v143
    v_and_b32 v118, s60, v139
    v_mfma_f32_16x16x32_bf16 v[168:171], a[196:199], v[60:63], v[168:171]
    v_and_b32 v119, s60, v143
    v_add_f32 v112, v112, v113
    v_mfma_f32_16x16x32_bf16 v[168:171], a[180:183], v[64:67], v[168:171]
    ds_read_b128 v[100:103], v12 offset:256
    v_add_f32 v114, v114, v115
    v_mfma_f32_16x16x32_bf16 v[168:171], a[200:203], v[68:71], v[168:171]
    s_waitcnt lgkmcnt(4)
    buffer_load_dwordx4 a[160:163], v36, s[36:39], s55 offen offset:1024 sc1
    v_add_f32 v116, v116, v117
    v_mfma_f32_16x16x32_bf16 v[168:171], a[204:207], v[72:75], v[168:171]
    ds_read_b128 v[40:43], v12 offset:512
    v_add_f32 v118, v118, v119
    v_mfma_f32_16x16x32_bf16 v[172:175], a[196:199], v[64:67], v[172:175]
    v_cvt_pk_bf16_f32 v138, v112, v114
    v_mfma_f32_16x16x32_bf16 v[172:175], a[180:183], v[68:71], v[172:175]
    v_cvt_pk_bf16_f32 v139, v116, v118
    v_mfma_f32_16x16x32_bf16 v[172:175], a[200:203], v[72:75], v[172:175]
    ds_read_b128 v[44:47], v12 offset:768
    v_mfma_f32_16x16x32_bf16 v[172:175], a[204:207], v[88:91], v[172:175]
    buffer_load_dwordx4 a[164:167], v36, s[36:39], s55 offen offset:2048 sc1
    v_mfma_f32_16x16x32_bf16 v[176:179], a[196:199], v[68:71], v[176:179]
    ds_read_b128 v[48:51], v12 offset:1024
    v_mfma_f32_16x16x32_bf16 v[176:179], a[180:183], v[72:75], v[176:179]
    ds_write_b128 v31, v[136:139] offset:29696
    v_mfma_f32_16x16x32_bf16 v[176:179], a[200:203], v[88:91], v[176:179]
    v_lshlrev_b32 v112, 16, v104
    v_lshlrev_b32 v113, 16, v108
    v_mfma_f32_16x16x32_bf16 v[176:179], a[204:207], v[76:79], v[176:179]
    ds_read_b128 v[52:55], v12 offset:1280
    v_and_b32 v114, s60, v104
    v_mfma_f32_16x16x32_bf16 v[180:183], a[196:199], v[72:75], v[180:183]
    buffer_load_dwordx4 a[168:171], v36, s[36:39], s55 offen offset:3072 sc1
    v_and_b32 v115, s60, v108
    v_mfma_f32_16x16x32_bf16 v[180:183], a[180:183], v[88:91], v[180:183]
    ds_read_b128 v[56:59], v12 offset:1536
    v_lshlrev_b32 v116, 16, v105
    v_mfma_f32_16x16x32_bf16 v[180:183], a[200:203], v[76:79], v[180:183]
    v_lshlrev_b32 v117, 16, v109
    v_mfma_f32_16x16x32_bf16 v[180:183], a[204:207], v[80:83], v[180:183]
    v_and_b32 v118, s60, v105
    v_and_b32 v119, s60, v109
    v_mfma_f32_16x16x32_bf16 v[184:187], a[196:199], v[88:91], v[184:187]
    ds_read_b128 v[60:63], v12 offset:1792
    v_add_f32 v112, v112, v113
    v_mfma_f32_16x16x32_bf16 v[184:187], a[180:183], v[76:79], v[184:187]
    buffer_load_dwordx4 a[88:91], v36, s[36:39], s61 offen offset:2048 sc1
    v_mfma_f32_16x16x32_bf16 v[184:187], a[200:203], v[80:83], v[184:187]
    s_waitcnt lgkmcnt(4)
    ds_read_b128 v[64:67], v13 offset:2048
    v_add_f32 v114, v114, v115
    v_mfma_f32_16x16x32_bf16 v[184:187], a[204:207], v[84:87], v[184:187]
    v_add_f32 v116, v116, v117
    v_add_f32 v118, v118, v119
    v_mfma_f32_16x16x32_bf16 v[188:191], a[196:199], v[76:79], v[188:191]
    v_cvt_pk_bf16_f32 v104, v112, v114
    v_mfma_f32_16x16x32_bf16 v[188:191], a[180:183], v[80:83], v[188:191]
    ds_read_b128 v[68:71], v13 offset:2304
    v_cvt_pk_bf16_f32 v105, v116, v118
    v_mfma_f32_16x16x32_bf16 v[188:191], a[200:203], v[84:87], v[188:191]
    s_add_u32 s55, s9, 102400
    buffer_load_dwordx4 a[172:175], v36, s[36:39], s55 offen offset:0 sc1
    v_mfma_f32_16x16x32_bf16 v[188:191], a[204:207], v[92:95], v[188:191]
    s_waitcnt vmcnt(40)
    ds_read_b128 v[72:75], v14 offset:0
    v_lshlrev_b32 v112, 16, v106
    v_mfma_f32_16x16x32_bf16 v[224:227], a[208:211], v[96:99], v[224:227]
    v_lshlrev_b32 v113, 16, v110
    v_and_b32 v114, s60, v106
    v_mfma_f32_16x16x32_bf16 v[224:227], a[212:215], v[100:103], v[224:227]
    v_and_b32 v115, s60, v110
    v_lshlrev_b32 v116, 16, v107
    v_mfma_f32_16x16x32_bf16 v[224:227], a[216:219], v[40:43], v[224:227]
    ds_read_b128 v[88:91], v14 offset:256
    v_lshlrev_b32 v117, 16, v111
    v_mfma_f32_16x16x32_bf16 v[228:231], a[208:211], v[100:103], v[228:231]
    buffer_load_dwordx4 a[176:179], v36, s[36:39], s55 offen offset:1024 sc1
    v_mfma_f32_16x16x32_bf16 v[228:231], a[212:215], v[40:43], v[228:231]
    ds_read_b128 v[76:79], v14 offset:512
    v_and_b32 v118, s60, v107
    v_mfma_f32_16x16x32_bf16 v[228:231], a[216:219], v[44:47], v[228:231]
    v_and_b32 v119, s60, v111
    v_add_f32 v112, v112, v113
    v_mfma_f32_16x16x32_bf16 v[232:235], a[208:211], v[40:43], v[232:235]
    v_add_f32 v114, v114, v115
    v_mfma_f32_16x16x32_bf16 v[232:235], a[212:215], v[44:47], v[232:235]
    ds_read_b128 v[80:83], v14 offset:768
    v_add_f32 v116, v116, v117
    v_mfma_f32_16x16x32_bf16 v[232:235], a[216:219], v[48:51], v[232:235]
    buffer_load_dwordx4 a[92:95], v36, s[36:39], s61 offen offset:3072 sc1
    v_add_f32 v118, v118, v119
    v_mfma_f32_16x16x32_bf16 v[236:239], a[208:211], v[44:47], v[236:239]
    v_cvt_pk_bf16_f32 v106, v112, v114
    v_cvt_pk_bf16_f32 v107, v116, v118
    v_mfma_f32_16x16x32_bf16 v[236:239], a[212:215], v[48:51], v[236:239]
    s_cmp_lt_u32 s77, 16
    s_cbranch_scc0 L_ge3
    s_waitcnt vmcnt(48)
    buffer_store_dword v134, v39, s[36:39], s62 offen sc1
L_ge3:
    s_waitcnt lgkmcnt(3)
    v_mfma_f32_16x16x32_bf16 v[236:239], a[216:219], v[52:55], v[236:239]
    ds_read_b128 v[84:87], v14 offset:1024
    v_mfma_f32_16x16x32_bf16 v[240:243], a[208:211], v[48:51], v[240:243]
    buffer_load_dwordx4 a[184:187], v36, s[36:39], s55 offen offset:2048 sc1
    v_mfma_f32_16x16x32_bf16 v[240:243], a[212:215], v[52:55], v[240:243]
    ds_write_b128 v148, v[104:107] offset:33792
    v_mfma_f32_16x16x32_bf16 v[240:243], a[216:219], v[56:59], v[240:243]
    v_mfma_f32_16x16x32_bf16 v[244:247], a[208:211], v[52:55], v[244:247]
    ds_read_b128 v[92:95], v14 offset:1280
    v_mfma_f32_16x16x32_bf16 v[244:247], a[212:215], v[56:59], v[244:247]
    v_mfma_f32_16x16x32_bf16 v[244:247], a[216:219], v[60:63], v[244:247]
    buffer_load_dwordx4 a[192:195], v36, s[36:39], s55 offen offset:3072 sc1
    v_mfma_f32_16x16x32_bf16 v[248:251], a[208:211], v[56:59], v[248:251]
    v_mfma_f32_16x16x32_bf16 v[248:251], a[212:215], v[60:63], v[248:251]
    ds_read_b128 v[96:99], v14 offset:1536
    v_mfma_f32_16x16x32_bf16 v[248:251], a[216:219], v[64:67], v[248:251]
    v_mfma_f32_16x16x32_bf16 v[252:255], a[208:211], v[60:63], v[252:255]
    ds_read_b128 v[100:103], v14 offset:1792
    v_mfma_f32_16x16x32_bf16 v[252:255], a[212:215], v[64:67], v[252:255]
    s_add_u32 s61, s67, 155648
    buffer_load_dwordx4 a[96:99], v36, s[36:39], s61 offen offset:0 sc1
    v_mfma_f32_16x16x32_bf16 v[252:255], a[216:219], v[68:71], v[252:255]
    s_waitcnt vmcnt(41)
    v_mfma_f32_16x16x32_bf16 v[192:195], a[220:223], v[72:75], v[192:195]
    s_waitcnt lgkmcnt(3)
    ds_read_b128 v[40:43], v15 offset:2048
    v_mfma_f32_16x16x32_bf16 v[192:195], a[228:231], v[88:91], v[192:195]
    v_mfma_f32_16x16x32_bf16 v[192:195], a[232:235], v[76:79], v[192:195]
    ds_read_b128 v[44:47], v15 offset:2304
    v_mfma_f32_16x16x32_bf16 v[192:195], a[236:239], v[80:83], v[192:195]
    s_add_u32 s55, s9, 106496
    buffer_load_dwordx4 a[196:199], v36, s[36:39], s55 offen offset:0 sc1
    v_mfma_f32_16x16x32_bf16 v[196:199], a[220:223], v[88:91], v[196:199]
    s_waitcnt vmcnt(28)
    s_barrier
    v_mfma_f32_16x16x32_bf16 v[196:199], a[228:231], v[76:79], v[196:199]
    ds_read_b128 v[48:51], v15 offset:2560
    v_mfma_f32_16x16x32_bf16 v[196:199], a[232:235], v[80:83], v[196:199]
    v_add_u32 v28, 69632, v28
    v_add_u32 v29, 69632, v29
    v_mfma_f32_16x16x32_bf16 v[196:199], a[236:239], v[84:87], v[196:199]
    ds_read_b128 v[52:55], v20 offset:17408
    v_mfma_f32_16x16x32_bf16 v[200:203], a[220:223], v[76:79], v[200:203]
    s_add_u32 m0, s54, 34816
    ds_read_b128 v[104:107], v28 offset:0
    v_mfma_f32_16x16x32_bf16 v[200:203], a[228:231], v[80:83], v[200:203]
    buffer_load_dwordx4 v11, s[24:27], s72 offen  lds
    v_mfma_f32_16x16x32_bf16 v[200:203], a[232:235], v[84:87], v[200:203]
    s_waitcnt lgkmcnt(4)
    ds_read_b128 v[56:59], v22 offset:17408
    v_mfma_f32_16x16x32_bf16 v[200:203], a[236:239], v[92:95], v[200:203]
    ds_read_b128 v[108:111], v29 offset:0
    v_mfma_f32_16x16x32_bf16 v[204:207], a[220:223], v[80:83], v[204:207]
    ds_read_b128 v[60:63], v20 offset:17664
    v_mfma_f32_16x16x32_bf16 v[204:207], a[228:231], v[84:87], v[204:207]
    s_add_u32 m0, s54, 43008
    v_mfma_f32_16x16x32_bf16 v[204:207], a[232:235], v[92:95], v[204:207]
    buffer_load_dwordx4 v3, s[24:27], s76 offen  lds
    v_mfma_f32_16x16x32_bf16 v[204:207], a[236:239], v[96:99], v[204:207]
    ds_read_b128 v[64:67], v22 offset:17664
    v_mfma_f32_16x16x32_bf16 v[208:211], a[220:223], v[84:87], v[208:211]
    v_mfma_f32_16x16x32_bf16 v[208:211], a[228:231], v[92:95], v[208:211]
    s_waitcnt lgkmcnt(2)
    v_lshlrev_b32 v112, 16, v104
    v_mfma_f32_16x16x32_bf16 v[208:211], a[232:235], v[96:99], v[208:211]
    s_add_u32 m0, s54, 51200
    v_lshlrev_b32 v113, 16, v108
    v_mfma_f32_16x16x32_bf16 v[208:211], a[236:239], v[100:103], v[208:211]
    ds_read_b128 v[68:71], v20 offset:17920
    v_and_b32 v114, s60, v104
    v_mfma_f32_16x16x32_bf16 v[212:215], a[220:223], v[92:95], v[212:215]
    buffer_load_dwordx4 v4, s[24:27], s76 offen  lds
    v_and_b32 v115, s60, v108
    v_mfma_f32_16x16x32_bf16 v[212:215], a[228:231], v[96:99], v[212:215]
    ds_read_b128 v[136:139], v28 offset:8192
    v_mfma_f32_16x16x32_bf16 v[212:215], a[232:235], v[100:103], v[212:215]
    ds_read_b128 v[140:143], v29 offset:8192
    v_lshlrev_b32 v116, 16, v105
    v_mfma_f32_16x16x32_bf16 v[212:215], a[236:239], v[40:43], v[212:215]
    s_add_u32 m0, s54, 59392
    ds_read_b128 v[72:75], v22 offset:17920
    v_lshlrev_b32 v117, 16, v109
    v_mfma_f32_16x16x32_bf16 v[216:219], a[220:223], v[96:99], v[216:219]
    buffer_load_dwordx4 v5, s[24:27], s76 offen  lds
    v_and_b32 v118, s60, v105
    v_mfma_f32_16x16x32_bf16 v[216:219], a[228:231], v[100:103], v[216:219]
    v_and_b32 v119, s60, v109
    v_mfma_f32_16x16x32_bf16 v[216:219], a[232:235], v[40:43], v[216:219]
    ds_read_b128 v[88:91], v20 offset:18176
    v_add_f32 v112, v112, v113
    v_mfma_f32_16x16x32_bf16 v[216:219], a[236:239], v[44:47], v[216:219]
    v_add_f32 v114, v114, v115
    v_add_f32 v116, v116, v117
    v_mfma_f32_16x16x32_bf16 v[220:223], a[220:223], v[100:103], v[220:223]
    ds_read_b128 v[76:79], v22 offset:18176
    v_mfma_f32_16x16x32_bf16 v[220:223], a[228:231], v[40:43], v[220:223]
    buffer_load_dwordx4 a[180:183], v36, s[36:39], s55 offen offset:1024 sc1
    v_add_f32 v118, v118, v119
    v_mfma_f32_16x16x32_bf16 v[220:223], a[232:235], v[44:47], v[220:223]
    v_add_u32 v16, 4294932480, v16
    v_cvt_pk_bf16_f32 v104, v112, v114
    v_mfma_f32_16x16x32_bf16 v[220:223], a[236:239], v[48:51], v[220:223]
    ds_read_b128 v[80:83], v21 offset:18432
    v_add_u32 v17, 4294932480, v17
    v_mfma_f32_16x16x32_bf16 v[160:163], a[224:227], v[52:55], v[160:163]
    v_add_u32 v18, 4294932480, v18
    v_cvt_pk_bf16_f32 v105, v116, v118
    v_mfma_f32_16x16x32_bf16 v[160:163], a[240:243], v[56:59], v[160:163]
    s_waitcnt lgkmcnt(3)
    s_add_u32 m0, s54, 35840
    ds_read_b128 v[84:87], v23 offset:18432
    v_add_u32 v19, 4294932480, v19
    v_mfma_f32_16x16x32_bf16 v[160:163], a[244:247], v[60:63], v[160:163]
    buffer_load_dwordx4 v6, s[24:27], s76 offen  lds
    v_lshlrev_b32 v112, 16, v106
    v_mfma_f32_16x16x32_bf16 v[160:163], a[236:239], v[64:67], v[160:163]
    v_lshlrev_b32 v113, 16, v110
    v_and_b32 v114, s60, v106
    v_mfma_f32_16x16x32_bf16 v[164:167], a[224:227], v[56:59], v[164:167]
    ds_read_b128 v[92:95], v21 offset:18688
    v_mfma_f32_16x16x32_bf16 v[164:167], a[240:243], v[60:63], v[164:167]
    v_and_b32 v115, s60, v110
    v_lshlrev_b32 v116, 16, v107
    v_mfma_f32_16x16x32_bf16 v[164:167], a[244:247], v[64:67], v[164:167]
    s_add_u32 m0, s54, 44032
    ds_read_b128 v[96:99], v16 offset:0
    v_mfma_f32_16x16x32_bf16 v[164:167], a[236:239], v[68:71], v[164:167]
    buffer_load_dwordx4 v7, s[24:27], s76 offen  lds
    v_lshlrev_b32 v117, 16, v111
    v_mfma_f32_16x16x32_bf16 v[168:171], a[224:227], v[60:63], v[168:171]
    v_and_b32 v118, s60, v107
    v_and_b32 v119, s60, v111
    v_mfma_f32_16x16x32_bf16 v[168:171], a[240:243], v[64:67], v[168:171]
    ds_read_b128 v[100:103], v16 offset:256
    v_mfma_f32_16x16x32_bf16 v[168:171], a[244:247], v[68:71], v[168:171]
    v_add_f32 v112, v112, v113
    v_add_f32 v114, v114, v115
    v_mfma_f32_16x16x32_bf16 v[168:171], a[236:239], v[72:75], v[168:171]
    s_add_u32 m0, s54, 52224
    ds_read_b128 v[40:43], v16 offset:512
    v_add_f32 v116, v116, v117
    v_mfma_f32_16x16x32_bf16 v[172:175], a[224:227], v[64:67], v[172:175]
    buffer_load_dwordx4 v8, s[24:27], s76 offen  lds
    v_add_f32 v118, v118, v119
    v_mfma_f32_16x16x32_bf16 v[172:175], a[240:243], v[68:71], v[172:175]
    v_cvt_pk_bf16_f32 v106, v112, v114
    v_mfma_f32_16x16x32_bf16 v[172:175], a[244:247], v[72:75], v[172:175]
    s_waitcnt lgkmcnt(3)
    ds_read_b128 v[44:47], v16 offset:768
    v_cvt_pk_bf16_f32 v107, v116, v118
    v_mfma_f32_16x16x32_bf16 v[172:175], a[236:239], v[88:91], v[172:175]
    ds_write_b128 v30, v[104:107] offset:0
    v_mfma_f32_16x16x32_bf16 v[176:179], a[224:227], v[68:71], v[176:179]
    s_add_u32 m0, s54, 60416
    ds_read_b128 v[48:51], v16 offset:1024
    v_mfma_f32_16x16x32_bf16 v[176:179], a[240:243], v[72:75], v[176:179]
    buffer_load_dwordx4 v9, s[24:27], s76 offen  lds
    v_mfma_f32_16x16x32_bf16 v[176:179], a[244:247], v[88:91], v[176:179]
    v_lshlrev_b32 v112, 16, v136
    v_mfma_f32_16x16x32_bf16 v[176:179], a[236:239], v[76:79], v[176:179]
    ds_read_b128 v[52:55], v16 offset:1280
    v_lshlrev_b32 v113, 16, v140
    v_mfma_f32_16x16x32_bf16 v[180:183], a[224:227], v[72:75], v[180:183]
    v_and_b32 v114, s60, v136
    v_mfma_f32_16x16x32_bf16 v[180:183], a[240:243], v[88:91], v[180:183]
    s_mov_b32 m0, 67584
    ds_read_b128 v[56:59], v16 offset:1536
    v_and_b32 v115, s60, v140
    v_mfma_f32_16x16x32_bf16 v[180:183], a[244:247], v[76:79], v[180:183]
    buffer_load_dwordx4 v10, s[24:27], s76 offen  lds
    v_mfma_f32_16x16x32_bf16 v[180:183], a[236:239], v[80:83], v[180:183]
    ds_read_b128 v[104:107], v28 offset:16384
    v_mfma_f32_16x16x32_bf16 v[184:187], a[224:227], v[88:91], v[184:187]
    ds_read_b128 v[60:63], v16 offset:1792
L_rw1:
    v_mfma_f32_16x16x32_bf16 v[184:187], a[240:243], v[76:79], v[184:187]
    ds_read_b128 v[108:111], v29 offset:16384
    v_mov_b32 v153, L_rw1-L_pc+2048
    v_mfma_f32_16x16x32_bf16 v[184:187], a[244:247], v[80:83], v[184:187]
    ds_read_b128 v[64:67], v17 offset:2048
    v_lshlrev_b32 v116, 16, v137
    v_mfma_f32_16x16x32_bf16 v[184:187], a[236:239], v[84:87], v[184:187]
    buffer_load_dwordx4 a[200:203], v36, s[36:39], s55 offen offset:2048 sc1
    v_lshlrev_b32 v117, 16, v141
    v_mfma_f32_16x16x32_bf16 v[188:191], a[224:227], v[76:79], v[188:191]
    global_load_dword v1, v153, s[78:79]
    v_and_b32 v118, s60, v137
    v_mfma_f32_16x16x32_bf16 v[188:191], a[240:243], v[80:83], v[188:191]
    ds_read_b128 v[68:71], v17 offset:2304
    v_and_b32 v119, s60, v141
    v_mfma_f32_16x16x32_bf16 v[188:191], a[244:247], v[84:87], v[188:191]
    v_add_f32 v112, v112, v113
    v_add_f32 v114, v114, v115
    v_mfma_f32_16x16x32_bf16 v[188:191], a[236:239], v[92:95], v[188:191]
    s_waitcnt vmcnt(34) lgkmcnt(5)
    ds_read_b128 v[72:75], v18 offset:0
    v_add_f32 v116, v116, v117
    v_mfma_f32_16x16x32_bf16 v[224:227], a[248:251], v[96:99], v[224:227]
    buffer_load_dwordx4 a[204:207], v36, s[36:39], s55 offen offset:3072 sc1
    v_add_f32 v118, v118, v119
    v_mfma_f32_16x16x32_bf16 v[224:227], a[252:255], v[100:103], v[224:227]
    v_cvt_pk_bf16_f32 v136, v112, v114
    v_cvt_pk_bf16_f32 v137, v116, v118
    v_mfma_f32_16x16x32_bf16 v[224:227], a[156:159], v[40:43], v[224:227]
    ds_read_b128 v[88:91], v18 offset:256
    v_lshlrev_b32 v112, 16, v138
    v_mfma_f32_16x16x32_bf16 v[228:231], a[248:251], v[100:103], v[228:231]
    v_lshlrev_b32 v113, 16, v142
    v_and_b32 v114, s60, v138
    v_mfma_f32_16x16x32_bf16 v[228:231], a[252:255], v[40:43], v[228:231]
    ds_read_b128 v[76:79], v18 offset:512
    v_and_b32 v115, s60, v142
    v_mfma_f32_16x16x32_bf16 v[228:231], a[156:159], v[44:47], v[228:231]
    buffer_load_dwordx4 a[100:103], v36, s[36:39], s61 offen offset:1024 sc1
    v_mfma_f32_16x16x32_bf16 v[232:235], a[248:251], v[40:43], v[232:235]
    v_lshlrev_b32 v116, 16, v139
    v_lshlrev_b32 v117, 16, v143
    v_mfma_f32_16x16x32_bf16 v[232:235], a[252:255], v[44:47], v[232:235]
    ds_read_b128 v[80:83], v18 offset:768
    v_and_b32 v118, s60, v139
    v_mfma_f32_16x16x32_bf16 v[232:235], a[156:159], v[48:51], v[232:235]
    v_and_b32 v119, s60, v143
    v_add_f32 v112, v112, v113
    v_mfma_f32_16x16x32_bf16 v[236:239], a[248:251], v[44:47], v[236:239]
    s_add_u32 s55, s9, 110592
    buffer_load_dwordx4 a[208:211], v36, s[36:39], s55 offen offset:0 sc1
    v_mfma_f32_16x16x32_bf16 v[236:239], a[252:255], v[48:51], v[236:239]
    buffer_load_dword v150, v149, s[36:39], 0 offen sc1
    v_add_f32 v114, v114, v115
    v_mfma_f32_16x16x32_bf16 v[236:239], a[156:159], v[52:55], v[236:239]
    ds_read_b128 v[84:87], v18 offset:1024
    v_add_f32 v116, v116, v117
    v_mfma_f32_16x16x32_bf16 v[240:243], a[248:251], v[48:51], v[240:243]
    buffer_load_dword v152, v151, s[36:39], 0 offen sc1
    v_add_f32 v118, v118, v119
    v_mfma_f32_16x16x32_bf16 v[240:243], a[252:255], v[52:55], v[240:243]
    v_cvt_pk_bf16_f32 v138, v112, v114
    v_mfma_f32_16x16x32_bf16 v[240:243], a[156:159], v[56:59], v[240:243]
    buffer_load_dwordx4 a[212:215], v36, s[36:39], s55 offen offset:1024 sc1
    v_cvt_pk_bf16_f32 v139, v116, v118
    v_mfma_f32_16x16x32_bf16 v[244:247], a[248:251], v[52:55], v[244:247]
    ds_read_b128 v[92:95], v18 offset:1280
    v_mfma_f32_16x16x32_bf16 v[244:247], a[252:255], v[56:59], v[244:247]
    s_waitcnt lgkmcnt(3)
    ds_write_b128 v31, v[136:139] offset:4096
    v_mfma_f32_16x16x32_bf16 v[244:247], a[156:159], v[60:63], v[244:247]
    v_mfma_f32_16x16x32_bf16 v[248:251], a[248:251], v[56:59], v[248:251]
    v_lshlrev_b32 v112, 16, v104
    v_lshlrev_b32 v113, 16, v108
    v_mfma_f32_16x16x32_bf16 v[248:251], a[252:255], v[60:63], v[248:251]
    ds_read_b128 v[96:99], v18 offset:1536
    v_and_b32 v114, s60, v104
    v_mfma_f32_16x16x32_bf16 v[248:251], a[156:159], v[64:67], v[248:251]
    buffer_load_dwordx4 a[216:219], v36, s[36:39], s55 offen offset:2048 sc1
    v_and_b32 v115, s60, v108
    v_mfma_f32_16x16x32_bf16 v[252:255], a[248:251], v[60:63], v[252:255]
    ds_read_b128 v[100:103], v18 offset:1792
    v_mfma_f32_16x16x32_bf16 v[252:255], a[252:255], v[64:67], v[252:255]
    ds_read_b128 v[136:139], v28 offset:24576
    v_mfma_f32_16x16x32_bf16 v[252:255], a[156:159], v[68:71], v[252:255]
    s_waitcnt vmcnt(36)
    ds_read_b128 v[140:143], v29 offset:24576
    v_lshlrev_b32 v116, 16, v105
    v_mfma_f32_16x16x32_bf16 v[192:195], a[188:191], v[72:75], v[192:195]
    ds_read_b128 v[40:43], v19 offset:2048
    v_lshlrev_b32 v117, 16, v109
    v_mfma_f32_16x16x32_bf16 v[192:195], a[128:131], v[88:91], v[192:195]
    buffer_load_dwordx4 a[104:107], v36, s[36:39], s61 offen offset:2048 sc1
    v_and_b32 v118, s60, v105
    v_mfma_f32_16x16x32_bf16 v[192:195], a[132:135], v[76:79], v[192:195]
    s_waitcnt lgkmcnt(5)
    ds_read_b128 v[44:47], v19 offset:2304
    v_and_b32 v119, s60, v109
    v_mfma_f32_16x16x32_bf16 v[192:195], a[136:139], v[80:83], v[192:195]
    v_add_f32 v112, v112, v113
    v_add_f32 v114, v114, v115
    v_mfma_f32_16x16x32_bf16 v[196:199], a[188:191], v[88:91], v[196:199]
    v_add_f32 v116, v116, v117
    v_mfma_f32_16x16x32_bf16 v[196:199], a[128:131], v[76:79], v[196:199]
    ds_read_b128 v[48:51], v19 offset:2560
    v_add_f32 v118, v118, v119
    v_mfma_f32_16x16x32_bf16 v[196:199], a[132:135], v[80:83], v[196:199]
    s_lshl_b32 s56, s49, 1
    buffer_load_dwordx4 a[220:223], v36, s[36:39], s55 offen offset:3072 sc1
    v_cvt_pk_bf16_f32 v104, v112, v114
    v_mfma_f32_16x16x32_bf16 v[196:199], a[136:139], v[84:87], v[196:199]
    ds_read_b128 v[52:55], v24 offset:17408
    v_cvt_pk_bf16_f32 v105, v116, v118
    v_mfma_f32_16x16x32_bf16 v[200:203], a[188:191], v[76:79], v[200:203]
    v_lshlrev_b32 v112, 16, v106
    v_mfma_f32_16x16x32_bf16 v[200:203], a[128:131], v[80:83], v[200:203]
    v_lshlrev_b32 v113, 16, v110
    v_and_b32 v114, s60, v106
    v_mfma_f32_16x16x32_bf16 v[200:203], a[132:135], v[84:87], v[200:203]
    ds_read_b128 v[56:59], v26 offset:17408
    v_and_b32 v115, s60, v110
    v_mfma_f32_16x16x32_bf16 v[200:203], a[136:139], v[92:95], v[200:203]
    s_add_u32 s55, s9, 114688
    s_add_u32 s56, s56, 0
    buffer_load_dwordx4 a[228:231], v36, s[36:39], s55 offen offset:0 sc1
    v_mfma_f32_16x16x32_bf16 v[204:207], a[188:191], v[80:83], v[204:207]
    ds_read_b128 v[60:63], v24 offset:17664
    v_lshlrev_b32 v116, 16, v107
    v_mfma_f32_16x16x32_bf16 v[204:207], a[128:131], v[84:87], v[204:207]
    v_lshlrev_b32 v117, 16, v111
    v_and_b32 v118, s60, v107
    v_mfma_f32_16x16x32_bf16 v[204:207], a[132:135], v[92:95], v[204:207]
    s_waitcnt lgkmcnt(4)
    s_and_b32 s56, s56, 7
    v_and_b32 v119, s60, v111
    v_add_f32 v112, v112, v113
    v_mfma_f32_16x16x32_bf16 v[204:207], a[136:139], v[96:99], v[204:207]
    ds_read_b128 v[64:67], v26 offset:17664
    v_mfma_f32_16x16x32_bf16 v[208:211], a[188:191], v[84:87], v[208:211]
    buffer_load_dwordx4 a[108:111], v36, s[36:39], s61 offen offset:3072 sc1
    v_add_f32 v114, v114, v115
    v_mfma_f32_16x16x32_bf16 v[208:211], a[128:131], v[92:95], v[208:211]
    v_add_f32 v116, v116, v117
    v_add_f32 v118, v118, v119
    v_mfma_f32_16x16x32_bf16 v[208:211], a[132:135], v[96:99], v[208:211]
    s_mul_i32 s56, s56, 15360
    v_cvt_pk_bf16_f32 v106, v112, v114
    v_cvt_pk_bf16_f32 v107, v116, v118
    v_mfma_f32_16x16x32_bf16 v[208:211], a[136:139], v[100:103], v[208:211]
    ds_read_b128 v[68:71], v24 offset:17920
    v_mfma_f32_16x16x32_bf16 v[212:215], a[188:191], v[92:95], v[212:215]
    s_add_u32 s4, s56, s23
    buffer_load_dwordx4 a[232:235], v36, s[36:39], s55 offen offset:1024 sc1
    v_mfma_f32_16x16x32_bf16 v[212:215], a[128:131], v[96:99], v[212:215]
    ds_write_b128 v30, v[104:107] offset:8192
    v_mfma_f32_16x16x32_bf16 v[212:215], a[132:135], v[100:103], v[212:215]
    s_lshl_b32 s56, s49, 1
    v_mfma_f32_16x16x32_bf16 v[212:215], a[136:139], v[40:43], v[212:215]
    ds_read_b128 v[72:75], v26 offset:17920
    v_lshlrev_b32 v112, 16, v136
    v_mfma_f32_16x16x32_bf16 v[216:219], a[188:191], v[96:99], v[216:219]
    s_add_u32 s56, s56, 1
    v_lshlrev_b32 v113, 16, v140
    v_and_b32 v114, s60, v136
    v_mfma_f32_16x16x32_bf16 v[216:219], a[128:131], v[100:103], v[216:219]
    buffer_load_dwordx4 a[224:227], v36, s[36:39], s55 offen offset:2048 sc1
    v_and_b32 v115, s60, v140
    v_mfma_f32_16x16x32_bf16 v[216:219], a[132:135], v[40:43], v[216:219]
    v_subrev_u32 v146, s54, v28
    v_mfma_f32_16x16x32_bf16 v[216:219], a[136:139], v[44:47], v[216:219]
    ds_read_b128 v[88:91], v24 offset:18176
    v_xor_b32 v147, 128, v146
    v_mfma_f32_16x16x32_bf16 v[220:223], a[188:191], v[100:103], v[220:223]
    s_and_b32 s56, s56, 7
    v_subrev_u32 v148, s53, v30
    v_mfma_f32_16x16x32_bf16 v[220:223], a[128:131], v[40:43], v[220:223]
    s_mul_i32 s56, s56, 15360
    ds_read_b128 v[76:79], v26 offset:18176
    v_mfma_f32_16x16x32_bf16 v[220:223], a[132:135], v[44:47], v[220:223]
    s_waitcnt lgkmcnt(4)
    buffer_load_dwordx4 a[240:243], v36, s[36:39], s55 offen offset:3072 sc1
    v_mfma_f32_16x16x32_bf16 v[220:223], a[136:139], v[48:51], v[220:223]
    s_waitcnt vmcnt(39)
    ds_read_b128 v[104:107], v146 offset:32768
    v_add_u32 v12, 34816, v12
    v_mfma_f32_16x16x32_bf16 v[160:163], a[140:143], v[52:55], v[160:163]
    s_add_u32 s5, s56, s23
    ds_read_b128 v[80:83], v25 offset:18432
    v_add_u32 v13, 34816, v13
    v_mfma_f32_16x16x32_bf16 v[160:163], a[144:147], v[56:59], v[160:163]
    ds_read_b128 v[108:111], v147 offset:32768
    v_add_u32 v14, 34816, v14
    v_mfma_f32_16x16x32_bf16 v[160:163], a[148:151], v[60:63], v[160:163]
    ds_read_b128 v[84:87], v27 offset:18432
    v_add_u32 v15, 34816, v15
    v_mfma_f32_16x16x32_bf16 v[160:163], a[136:139], v[64:67], v[160:163]
    s_add_u32 s61, s67, 159744
    buffer_load_dwordx4 a[112:115], v36, s[36:39], s61 offen offset:0 sc1
    v_lshlrev_b32 v116, 16, v137
    v_mfma_f32_16x16x32_bf16 v[164:167], a[140:143], v[56:59], v[164:167]
    v_lshlrev_b32 v117, 16, v141
    v_and_b32 v118, s60, v137
    v_mfma_f32_16x16x32_bf16 v[164:167], a[144:147], v[60:63], v[164:167]
    ds_read_b128 v[92:95], v25 offset:18688
    v_and_b32 v119, s60, v141
    v_mfma_f32_16x16x32_bf16 v[164:167], a[148:151], v[64:67], v[164:167]
    v_add_f32 v112, v112, v113
    v_add_f32 v114, v114, v115
    v_mfma_f32_16x16x32_bf16 v[164:167], a[136:139], v[68:71], v[164:167]
    ds_read_b128 v[96:99], v12 offset:34816
    v_add_f32 v116, v116, v117
    v_mfma_f32_16x16x32_bf16 v[168:171], a[140:143], v[60:63], v[168:171]
    s_add_u32 s55, s9, 118784
    buffer_load_dwordx4 a[244:247], v36, s[36:39], s55 offen offset:0 sc1
    v_add_f32 v118, v118, v119
    v_mfma_f32_16x16x32_bf16 v[168:171], a[144:147], v[64:67], v[168:171]
    s_lshl_b32 s56, s49, 1
    v_cvt_pk_bf16_f32 v136, v112, v114
    v_cvt_pk_bf16_f32 v137, v116, v118
    v_mfma_f32_16x16x32_bf16 v[168:171], a[148:151], v[68:71], v[168:171]
    s_waitcnt lgkmcnt(4)
    ds_read_b128 v[100:103], v12 offset:35072
    v_lshlrev_b32 v112, 16, v138
    v_mfma_f32_16x16x32_bf16 v[168:171], a[136:139], v[72:75], v[168:171]
    v_lshlrev_b32 v113, 16, v142
    v_and_b32 v114, s60, v138
    v_mfma_f32_16x16x32_bf16 v[172:175], a[140:143], v[64:67], v[172:175]
    ds_read_b128 v[40:43], v12 offset:35328
    v_and_b32 v115, s60, v142
    v_mfma_f32_16x16x32_bf16 v[172:175], a[144:147], v[68:71], v[172:175]
    buffer_load_dwordx4 a[236:239], v36, s[36:39], s55 offen offset:1024 sc1
    v_mfma_f32_16x16x32_bf16 v[172:175], a[148:151], v[72:75], v[172:175]
    v_lshlrev_b32 v116, 16, v139
    v_lshlrev_b32 v117, 16, v143
    v_mfma_f32_16x16x32_bf16 v[172:175], a[136:139], v[88:91], v[172:175]
    s_add_u32 s56, s56, 2
    ds_read_b128 v[44:47], v12 offset:35584
    v_and_b32 v118, s60, v139
    v_mfma_f32_16x16x32_bf16 v[176:179], a[140:143], v[68:71], v[176:179]
    v_and_b32 v119, s60, v143
    v_mfma_f32_16x16x32_bf16 v[176:179], a[144:147], v[72:75], v[176:179]
    v_add_f32 v112, v112, v113
    v_add_f32 v114, v114, v115
    v_mfma_f32_16x16x32_bf16 v[176:179], a[148:151], v[88:91], v[176:179]
    buffer_load_dwordx4 a[248:251], v36, s[36:39], s55 offen offset:2048 sc1
    v_add_f32 v116, v116, v117
    v_mfma_f32_16x16x32_bf16 v[176:179], a[136:139], v[76:79], v[176:179]
    s_and_b32 s56, s56, 7
    ds_read_b128 v[48:51], v12 offset:35840
    v_add_f32 v118, v118, v119
    v_mfma_f32_16x16x32_bf16 v[180:183], a[140:143], v[72:75], v[180:183]
    v_cvt_pk_bf16_f32 v138, v112, v114
    v_mfma_f32_16x16x32_bf16 v[180:183], a[144:147], v[88:91], v[180:183]
    s_mul_i32 s56, s56, 15360
    v_cvt_pk_bf16_f32 v139, v116, v118
    v_mfma_f32_16x16x32_bf16 v[180:183], a[148:151], v[76:79], v[180:183]
    ds_write_b128 v31, v[136:139] offset:12288
    v_mfma_f32_16x16x32_bf16 v[180:183], a[136:139], v[80:83], v[180:183]
    s_add_u32 s6, s56, s23
    ds_read_b128 v[52:55], v12 offset:36096
    v_mfma_f32_16x16x32_bf16 v[184:187], a[140:143], v[88:91], v[184:187]
    buffer_load_dwordx4 a[252:255], v36, s[36:39], s55 offen offset:3072 sc1
    v_mfma_f32_16x16x32_bf16 v[184:187], a[144:147], v[76:79], v[184:187]
    s_waitcnt lgkmcnt(3)
    v_lshlrev_b32 v112, 16, v104
    v_lshlrev_b32 v113, 16, v108
    v_mfma_f32_16x16x32_bf16 v[184:187], a[148:151], v[80:83], v[184:187]
    s_lshl_b32 s56, s49, 1
    v_and_b32 v114, s60, v104
    v_mfma_f32_16x16x32_bf16 v[184:187], a[136:139], v[84:87], v[184:187]
    ds_read_b128 v[56:59], v12 offset:36352
    v_and_b32 v115, s60, v108
    v_mfma_f32_16x16x32_bf16 v[188:191], a[140:143], v[76:79], v[188:191]
    buffer_load_dwordx4 a[116:119], v36, s[36:39], s61 offen offset:1024 sc1
    v_lshlrev_b32 v116, 16, v105
    v_mfma_f32_16x16x32_bf16 v[188:191], a[144:147], v[80:83], v[188:191]
    s_add_u32 s56, s56, 3
    ds_read_b128 v[60:63], v12 offset:36608
    v_lshlrev_b32 v117, 16, v109
    v_mfma_f32_16x16x32_bf16 v[188:191], a[148:151], v[84:87], v[188:191]
    v_and_b32 v118, s60, v105
    v_mfma_f32_16x16x32_bf16 v[188:191], a[136:139], v[92:95], v[188:191]
    s_waitcnt vmcnt(40)
    v_and_b32 v119, s60, v109
    v_add_f32 v112, v112, v113
    v_mfma_f32_16x16x32_bf16 v[224:227], a[152:155], v[96:99], v[224:227]
    ds_read_b128 v[64:67], v13 offset:36864
    v_add_f32 v114, v114, v115
    v_mfma_f32_16x16x32_bf16 v[224:227], a[160:163], v[100:103], v[224:227]
    s_add_u32 s55, s9, 122880
    buffer_load_dwordx4 a[156:159], v36, s[36:39], s55 offen offset:0 sc1
    v_add_f32 v116, v116, v117
    v_mfma_f32_16x16x32_bf16 v[224:227], a[164:167], v[40:43], v[224:227]
    s_and_b32 s56, s56, 7
    ds_read_b128 v[68:71], v13 offset:37120
    v_add_f32 v118, v118, v119
    v_mfma_f32_16x16x32_bf16 v[224:227], a[168:171], v[44:47], v[224:227]
    v_cvt_pk_bf16_f32 v104, v112, v114
    v_mfma_f32_16x16x32_bf16 v[228:231], a[152:155], v[100:103], v[228:231]
    v_cvt_pk_bf16_f32 v105, v116, v118
    v_lshlrev_b32 v112, 16, v106
    v_mfma_f32_16x16x32_bf16 v[228:231], a[160:163], v[40:43], v[228:231]
    ds_read_b128 v[72:75], v13 offset:37376
    v_lshlrev_b32 v113, 16, v110
    v_mfma_f32_16x16x32_bf16 v[228:231], a[164:167], v[44:47], v[228:231]
    s_waitcnt lgkmcnt(4)
    s_mul_i32 s56, s56, 15360
    buffer_load_dwordx4 a[120:123], v36, s[36:39], s61 offen offset:2048 sc1
    v_mfma_f32_16x16x32_bf16 v[228:231], a[168:171], v[48:51], v[228:231]
    ds_read_b128 v[88:91], v14 offset:34816
    v_and_b32 v114, s60, v106
    v_mfma_f32_16x16x32_bf16 v[232:235], a[152:155], v[40:43], v[232:235]
    v_and_b32 v115, s60, v110
    v_lshlrev_b32 v116, 16, v107
    v_mfma_f32_16x16x32_bf16 v[232:235], a[160:163], v[44:47], v[232:235]
    s_add_u32 s7, s56, s23
    v_lshlrev_b32 v117, 16, v111
    v_mfma_f32_16x16x32_bf16 v[232:235], a[164:167], v[48:51], v[232:235]
    ds_read_b128 v[76:79], v14 offset:35072
    v_and_b32 v118, s60, v107
    v_mfma_f32_16x16x32_bf16 v[232:235], a[168:171], v[52:55], v[232:235]
    buffer_load_dwordx4 a[188:191], v36, s[36:39], s55 offen offset:1024 sc1
    v_and_b32 v119, s60, v111
    v_mfma_f32_16x16x32_bf16 v[236:239], a[152:155], v[44:47], v[236:239]
    ds_read_b128 v[80:83], v14 offset:35328
    v_add_f32 v112, v112, v113
    v_mfma_f32_16x16x32_bf16 v[236:239], a[160:163], v[48:51], v[236:239]
    v_add_f32 v114, v114, v115
    v_add_f32 v116, v116, v117
    v_mfma_f32_16x16x32_bf16 v[236:239], a[164:167], v[52:55], v[236:239]
    s_lshl_b32 s56, s49, 1
    v_add_f32 v118, v118, v119
    v_mfma_f32_16x16x32_bf16 v[236:239], a[168:171], v[56:59], v[236:239]
    ds_read_b128 v[84:87], v14 offset:35584
    v_cvt_pk_bf16_f32 v106, v112, v114
    v_mfma_f32_16x16x32_bf16 v[240:243], a[152:155], v[48:51], v[240:243]
    buffer_load_dwordx4 a[128:131], v36, s[36:39], s55 offen offset:2048 sc1
    v_cvt_pk_bf16_f32 v107, v116, v118
    v_mfma_f32_16x16x32_bf16 v[240:243], a[160:163], v[52:55], v[240:243]
    ds_write_b128 v148, v[104:107] offset:16384
    v_mfma_f32_16x16x32_bf16 v[240:243], a[164:167], v[56:59], v[240:243]
    s_waitcnt lgkmcnt(4)
    s_add_u32 s56, s56, 4
    s_and_b32 s56, s56, 7
    v_mfma_f32_16x16x32_bf16 v[240:243], a[168:171], v[60:63], v[240:243]
    ds_read_b128 v[92:95], v14 offset:35840
    v_mfma_f32_16x16x32_bf16 v[244:247], a[152:155], v[52:55], v[244:247]
    s_waitcnt vmcnt(20)
    v_cmp_ne_u32 vcc, s3, v150
    s_nop 0
    s_cbranch_vccnz L_cw2
L_cw2_b:
    v_mfma_f32_16x16x32_bf16 v[244:247], a[160:163], v[56:59], v[244:247]
    s_add_u32 s55, s9, 126976
    s_mul_i32 s56, s56, 15360
    buffer_load_dwordx4 a[132:135], v36, s[36:39], s55 offen offset:0 sc1
    v_mfma_f32_16x16x32_bf16 v[244:247], a[164:167], v[60:63], v[244:247]
    s_add_u32 s10, s56, s23
    s_lshl_b32 s56, s49, 1
    v_mfma_f32_16x16x32_bf16 v[244:247], a[168:171], v[64:67], v[244:247]
    ds_read_b128 v[96:99], v14 offset:36096
    v_mfma_f32_16x16x32_bf16 v[248:251], a[152:155], v[56:59], v[248:251]
    s_waitcnt vmcnt(20)
    v_cmp_ne_u32 vcc, s3, v152
    s_nop 0
    s_cbranch_vccnz L_cwf
L_cwf_b:
    v_mfma_f32_16x16x32_bf16 v[248:251], a[160:163], v[60:63], v[248:251]
    s_add_u32 s56, s56, 5
    s_and_b32 s56, s56, 7
    v_mfma_f32_16x16x32_bf16 v[248:251], a[164:167], v[64:67], v[248:251]
    buffer_load_dwordx4 a[140:143], v36, s[36:39], s55 offen offset:1024 sc1
    v_mfma_f32_16x16x32_bf16 v[248:251], a[168:171], v[68:71], v[248:251]
    s_mul_i32 s56, s56, 15360
    ds_read_b128 v[100:103], v14 offset:36352
    v_mfma_f32_16x16x32_bf16 v[252:255], a[152:155], v[60:63], v[252:255]
    s_add_u32 s11, s56, s23
    v_mfma_f32_16x16x32_bf16 v[252:255], a[160:163], v[64:67], v[252:255]
    s_lshl_b32 s56, s49, 1
    ds_read_b128 v[40:43], v14 offset:36608
    v_mfma_f32_16x16x32_bf16 v[252:255], a[164:167], v[68:71], v[252:255]
    s_add_u32 s56, s56, 6
    s_lshl2_add_u32 s64, s50, s49
    v_mfma_f32_16x16x32_bf16 v[252:255], a[168:171], v[72:75], v[252:255]
    s_and_b32 s56, s56, 7
    buffer_load_dwordx4 a[124:127], v36, s[36:39], s61 offen offset:3072 sc1
    v_mfma_f32_16x16x32_bf16 v[192:195], a[172:175], v[88:91], v[192:195]
    s_waitcnt lgkmcnt(3)
    s_mul_i32 s56, s56, 15360
    ds_read_b128 v[44:47], v15 offset:36864
    v_mfma_f32_16x16x32_bf16 v[192:195], a[176:179], v[76:79], v[192:195]
    s_add_u32 s12, s56, s23
    v_mfma_f32_16x16x32_bf16 v[192:195], a[184:187], v[80:83], v[192:195]
    s_lshl_b32 s56, s49, 1
    ds_read_b128 v[48:51], v15 offset:37120
    v_mfma_f32_16x16x32_bf16 v[192:195], a[192:195], v[84:87], v[192:195]
    s_add_u32 s56, s56, 7
    s_lshl2_add_u32 s64, s64, s48
    v_mfma_f32_16x16x32_bf16 v[196:199], a[172:175], v[76:79], v[196:199]
    s_barrier
    s_and_b32 s56, s56, 7
    buffer_load_dwordx4 a[144:147], v36, s[36:39], s55 offen offset:2048 sc1
    v_mfma_f32_16x16x32_bf16 v[196:199], a[176:179], v[80:83], v[196:199]
    ds_read_b128 v[52:55], v15 offset:37376
    v_mfma_f32_16x16x32_bf16 v[196:199], a[184:187], v[84:87], v[196:199]
    s_mul_i32 s56, s56, 15360
    s_add_u32 s13, s56, s23
    v_mfma_f32_16x16x32_bf16 v[196:199], a[192:195], v[92:95], v[196:199]
    ds_read_b128 v[56:59], v20 offset:0
    v_add_u32 v28, 4294932480, v28
    v_mfma_f32_16x16x32_bf16 v[200:203], a[172:175], v[80:83], v[200:203]
    v_add_u32 v29, 4294932480, v29
    v_mfma_f32_16x16x32_bf16 v[200:203], a[176:179], v[84:87], v[200:203]
    buffer_load_dwordx4 a[148:151], v36, s[36:39], s55 offen offset:3072 sc1
    v_mfma_f32_16x16x32_bf16 v[200:203], a[184:187], v[92:95], v[200:203]
    s_waitcnt lgkmcnt(3)
    s_lshl_b32 s64, s64, 12
    ds_read_b128 v[60:63], v22 offset:0
    v_mfma_f32_16x16x32_bf16 v[200:203], a[192:195], v[96:99], v[200:203]
    ds_read_b128 v[104:107], v28 offset:0
    v_mfma_f32_16x16x32_bf16 v[204:207], a[172:175], v[84:87], v[204:207]
    ds_read_b128 v[64:67], v20 offset:256
    v_mfma_f32_16x16x32_bf16 v[204:207], a[176:179], v[92:95], v[204:207]
    ds_read_b128 v[108:111], v29 offset:0
    v_mfma_f32_16x16x32_bf16 v[204:207], a[184:187], v[96:99], v[204:207]
    s_add_u32 s61, s67, 131072
    buffer_load_dwordx4 a[0:3], v36, s[36:39], s61 offen offset:0 sc1
    v_mfma_f32_16x16x32_bf16 v[204:207], a[192:195], v[100:103], v[204:207]
    s_add_u32 s64, s64, 10485760
    ds_read_b128 v[68:71], v22 offset:256
    v_mfma_f32_16x16x32_bf16 v[208:211], a[172:175], v[92:95], v[208:211]
    v_mfma_f32_16x16x32_bf16 v[208:211], a[176:179], v[96:99], v[208:211]
    v_mfma_f32_16x16x32_bf16 v[208:211], a[184:187], v[100:103], v[208:211]
    v_mfma_f32_16x16x32_bf16 v[208:211], a[192:195], v[40:43], v[208:211]
    ds_read_b128 v[72:75], v20 offset:512
    v_mov_b32 v120, -1
    v_mfma_f32_16x16x32_bf16 v[212:215], a[172:175], v[96:99], v[212:215]
    s_add_u32 s55, s9, 131072
    buffer_load_dwordx4 a[136:139], v36, s[36:39], s55 offen offset:0 sc1
    v_mfma_f32_16x16x32_bf16 v[212:215], a[176:179], v[100:103], v[212:215]
    s_waitcnt lgkmcnt(2)
    v_lshlrev_b32 v112, 16, v104
    v_lshlrev_b32 v113, 16, v108
    v_mfma_f32_16x16x32_bf16 v[212:215], a[184:187], v[40:43], v[212:215]
    v_and_b32 v114, s60, v104
    v_and_b32 v115, s60, v108
    v_mfma_f32_16x16x32_bf16 v[212:215], a[192:195], v[44:47], v[212:215]
    ds_read_b128 v[88:91], v22 offset:512
    v_mfma_f32_16x16x32_bf16 v[216:219], a[172:175], v[100:103], v[216:219]
    buffer_load_dwordx4 a[152:155], v36, s[36:39], s55 offen offset:1024 sc1
    v_mfma_f32_16x16x32_bf16 v[216:219], a[176:179], v[40:43], v[216:219]
    ds_read_b128 v[136:139], v28 offset:8192
    v_mfma_f32_16x16x32_bf16 v[216:219], a[184:187], v[44:47], v[216:219]
    ds_read_b128 v[140:143], v29 offset:8192
    v_lshlrev_b32 v116, 16, v105
    v_mfma_f32_16x16x32_bf16 v[216:219], a[192:195], v[48:51], v[216:219]
    ds_read_b128 v[76:79], v20 offset:768
    v_lshlrev_b32 v117, 16, v109
    v_mfma_f32_16x16x32_bf16 v[220:223], a[172:175], v[40:43], v[220:223]
    v_and_b32 v118, s60, v105
    v_and_b32 v119, s60, v109
    v_mfma_f32_16x16x32_bf16 v[220:223], a[176:179], v[44:47], v[220:223]
    ds_read_b128 v[80:83], v22 offset:768
    v_add_f32 v112, v112, v113
    v_mfma_f32_16x16x32_bf16 v[220:223], a[184:187], v[48:51], v[220:223]
    buffer_load_dwordx4 a[160:163], v36, s[36:39], s55 offen offset:2048 sc1
    v_add_f32 v114, v114, v115
    v_and_b32 v152, 15, v0
    v_mfma_f32_16x16x32_bf16 v[220:223], a[192:195], v[52:55], v[220:223]
    v_add_u32 v16, 34816, v16
    v_add_f32 v116, v116, v117
    v_mfma_f32_16x16x32_bf16 v[160:163], a[196:199], v[56:59], v[160:163]
    ds_read_b128 v[84:87], v21 offset:1024
    v_add_u32 v17, 34816, v17
    v_mfma_f32_16x16x32_bf16 v[160:163], a[180:183], v[60:63], v[160:163]
    v_add_u32 v18, 34816, v18
    v_add_f32 v118, v118, v119
    v_mfma_f32_16x16x32_bf16 v[160:163], a[200:203], v[64:67], v[160:163]
    s_waitcnt lgkmcnt(5)
    ds_read_b128 v[92:95], v23 offset:1024
    v_add_u32 v19, 34816, v19
    v_mfma_f32_16x16x32_bf16 v[160:163], a[204:207], v[68:71], v[160:163]
    buffer_load_dwordx4 a[4:7], v36, s[36:39], s61 offen offset:1024 sc1
    v_mov_b32 v121, -1
    v_cvt_pk_bf16_f32 v104, v112, v114
    v_mfma_f32_16x16x32_bf16 v[164:167], a[196:199], v[60:63], v[164:167]
    v_cvt_pk_bf16_f32 v105, v116, v118
    v_lshlrev_b32 v112, 16, v106
    v_mfma_f32_16x16x32_bf16 v[164:167], a[180:183], v[64:67], v[164:167]
    ds_read_b128 v[96:99], v21 offset:1280
    v_mfma_f32_16x16x32_bf16 v[164:167], a[200:203], v[68:71], v[164:167]
    v_lshlrev_b32 v113, 16, v110
    v_and_b32 v114, s60, v106
    v_mfma_f32_16x16x32_bf16 v[164:167], a[204:207], v[72:75], v[164:167]
    ds_read_b128 v[100:103], v16 offset:34816
    v_and_b32 v115, s60, v110
    v_mfma_f32_16x16x32_bf16 v[168:171], a[196:199], v[64:67], v[168:171]
    s_add_u32 s55, s9, 135168
    buffer_load_dwordx4 a[164:167], v36, s[36:39], s55 offen offset:0 sc1
    v_mfma_f32_16x16x32_bf16 v[168:171], a[180:183], v[68:71], v[168:171]
    v_lshlrev_b32 v116, 16, v107
    v_lshlrev_b32 v117, 16, v111
    v_mfma_f32_16x16x32_bf16 v[168:171], a[200:203], v[72:75], v[168:171]
    ds_read_b128 v[40:43], v16 offset:35072
    v_and_b32 v118, s60, v107
    v_mfma_f32_16x16x32_bf16 v[168:171], a[204:207], v[88:91], v[168:171]
    v_and_b32 v119, s60, v111
    v_add_f32 v112, v112, v113
    v_mfma_f32_16x16x32_bf16 v[172:175], a[196:199], v[68:71], v[172:175]
    ds_read_b128 v[44:47], v16 offset:35328
    v_mfma_f32_16x16x32_bf16 v[172:175], a[180:183], v[72:75], v[172:175]
    buffer_load_dwordx4 a[8:11], v36, s[36:39], s61 offen offset:2048 sc1
    v_add_f32 v114, v114, v115
    v_mfma_f32_16x16x32_bf16 v[172:175], a[200:203], v[88:91], v[172:175]
    s_waitcnt lgkmcnt(4)
    v_add_f32 v116, v116, v117
    v_add_f32 v118, v118, v119
    v_mfma_f32_16x16x32_bf16 v[172:175], a[204:207], v[76:79], v[172:175]
    ds_read_b128 v[48:51], v16 offset:35584
    v_cvt_pk_bf16_f32 v106, v112, v114
    v_mfma_f32_16x16x32_bf16 v[176:179], a[196:199], v[72:75], v[176:179]
    v_mov_b32 v122, -1
    v_lshlrev_b32 v153, 5, v152
    v_mfma_f32_16x16x32_bf16 v[176:179], a[180:183], v[88:91], v[176:179]
    buffer_load_dwordx4 a[168:171], v36, s[36:39], s55 offen offset:1024 sc1
    v_cvt_pk_bf16_f32 v107, v116, v118
    v_mfma_f32_16x16x32_bf16 v[176:179], a[200:203], v[76:79], v[176:179]
    ds_write_b128 v30, v[104:107] offset:17408
    v_mfma_f32_16x16x32_bf16 v[176:179], a[204:207], v[80:83], v[176:179]
    ds_read_b128 v[52:55], v16 offset:35840
    v_mfma_f32_16x16x32_bf16 v[180:183], a[196:199], v[88:91], v[180:183]
    v_mfma_f32_16x16x32_bf16 v[180:183], a[180:183], v[76:79], v[180:183]
    v_lshlrev_b32 v112, 16, v136
    v_lshlrev_b32 v113, 16, v140
    v_mfma_f32_16x16x32_bf16 v[180:183], a[200:203], v[80:83], v[180:183]
    buffer_load_dwordx4 a[172:175], v36, s[36:39], s55 offen offset:2048 sc1
    v_mfma_f32_16x16x32_bf16 v[180:183], a[204:207], v[84:87], v[180:183]
    ds_read_b128 v[56:59], v16 offset:36096
    v_and_b32 v114, s60, v136
    v_mfma_f32_16x16x32_bf16 v[184:187], a[196:199], v[76:79], v[184:187]
    v_and_b32 v115, s60, v140
    v_mfma_f32_16x16x32_bf16 v[184:187], a[180:183], v[80:83], v[184:187]
    ds_read_b128 v[104:107], v28 offset:16384
    v_bfe_u32 v154, v0, 4, 1
    v_mfma_f32_16x16x32_bf16 v[184:187], a[200:203], v[84:87], v[184:187]
    ds_read_b128 v[108:111], v29 offset:16384
    v_lshlrev_b32 v116, 16, v137
    v_mfma_f32_16x16x32_bf16 v[184:187], a[204:207], v[92:95], v[184:187]
    ds_read_b128 v[60:63], v16 offset:36352
    v_mov_b32 v123, -1
    v_mfma_f32_16x16x32_bf16 v[188:191], a[196:199], v[80:83], v[188:191]
    s_add_u32 s55, s9, 139264
    buffer_load_dwordx4 a[176:179], v36, s[36:39], s55 offen offset:0 sc1
    v_lshlrev_b32 v117, 16, v141
    v_mfma_f32_16x16x32_bf16 v[188:191], a[180:183], v[84:87], v[188:191]
    ds_read_b128 v[64:67], v16 offset:36608
    v_and_b32 v118, s60, v137
    v_mfma_f32_16x16x32_bf16 v[188:191], a[200:203], v[92:95], v[188:191]
    s_waitcnt lgkmcnt(5)
    v_and_b32 v119, s60, v141
    v_add_f32 v112, v112, v113
    v_mfma_f32_16x16x32_bf16 v[188:191], a[204:207], v[96:99], v[188:191]
    s_waitcnt vmcnt(30)
    v_add_f32 v114, v114, v115
    v_add_f32 v116, v116, v117
    v_mfma_f32_16x16x32_bf16 v[224:227], a[208:211], v[100:103], v[224:227]
    ds_read_b128 v[68:71], v17 offset:36864
    v_add_f32 v118, v118, v119
    v_mfma_f32_16x16x32_bf16 v[224:227], a[212:215], v[40:43], v[224:227]
    buffer_load_dwordx4 a[184:187], v36, s[36:39], s55 offen offset:1024 sc1
    v_mfma_f32_16x16x32_bf16 v[224:227], a[216:219], v[44:47], v[224:227]
    ds_read_b128 v[72:75], v17 offset:37120
    v_cvt_pk_bf16_f32 v136, v112, v114
    v_mfma_f32_16x16x32_bf16 v[224:227], a[220:223], v[48:51], v[224:227]
    v_cvt_pk_bf16_f32 v137, v116, v118
    v_lshlrev_b32 v112, 16, v138
    v_mfma_f32_16x16x32_bf16 v[228:231], a[208:211], v[40:43], v[228:231]
    v_lshlrev_b32 v113, 16, v142
    v_mfma_f32_16x16x32_bf16 v[228:231], a[212:215], v[44:47], v[228:231]
    ds_read_b128 v[88:91], v17 offset:37376
    v_and_b32 v114, s60, v138
    v_mfma_f32_16x16x32_bf16 v[228:231], a[216:219], v[48:51], v[228:231]
    buffer_load_dwordx4 a[12:15], v36, s[36:39], s61 offen offset:3072 sc1
    v_and_b32 v115, s60, v142
    v_mfma_f32_16x16x32_bf16 v[228:231], a[220:223], v[52:55], v[228:231]
    ds_read_b128 v[76:79], v18 offset:34816
    v_lshlrev_b32 v116, 16, v139
    v_mfma_f32_16x16x32_bf16 v[232:235], a[208:211], v[44:47], v[232:235]
    v_lshlrev_b32 v117, 16, v143
    v_mfma_f32_16x16x32_bf16 v[232:235], a[212:215], v[48:51], v[232:235]
    v_and_b32 v118, s60, v139
    v_and_b32 v119, s60, v143
    v_mfma_f32_16x16x32_bf16 v[232:235], a[216:219], v[52:55], v[232:235]
    s_waitcnt lgkmcnt(3)
    ds_read_b128 v[80:83], v18 offset:35072
    v_add_f32 v112, v112, v113
    v_mfma_f32_16x16x32_bf16 v[232:235], a[220:223], v[56:59], v[232:235]
    buffer_load_dwordx4 a[192:195], v36, s[36:39], s55 offen offset:2048 sc1
    v_add_f32 v114, v114, v115
    v_mfma_f32_16x16x32_bf16 v[236:239], a[208:211], v[48:51], v[236:239]
    ds_read_b128 v[84:87], v18 offset:35328
    v_lshl_add_u32 v153, v154, 4, v153
    v_mfma_f32_16x16x32_bf16 v[236:239], a[212:215], v[52:55], v[236:239]
    v_add_f32 v116, v116, v117
    v_add_f32 v118, v118, v119
    v_mfma_f32_16x16x32_bf16 v[236:239], a[216:219], v[56:59], v[236:239]
    v_cvt_pk_bf16_f32 v138, v112, v114
    v_mfma_f32_16x16x32_bf16 v[236:239], a[220:223], v[60:63], v[236:239]
    ds_read_b128 v[92:95], v18 offset:35584
    v_cvt_pk_bf16_f32 v139, v116, v118
    v_mfma_f32_16x16x32_bf16 v[240:243], a[208:211], v[52:55], v[240:243]
    buffer_load_dwordx4 a[196:199], v36, s[36:39], s55 offen offset:3072 sc1
    v_mfma_f32_16x16x32_bf16 v[240:243], a[212:215], v[56:59], v[240:243]
    ds_write_b128 v31, v[136:139] offset:21504
    v_mfma_f32_16x16x32_bf16 v[240:243], a[216:219], v[60:63], v[240:243]
    v_mfma_f32_16x16x32_bf16 v[240:243], a[220:223], v[64:67], v[240:243]
    ds_read_b128 v[96:99], v18 offset:35840
    v_lshlrev_b32 v112, 16, v104
    v_mfma_f32_16x16x32_bf16 v[244:247], a[208:211], v[56:59], v[244:247]
    s_add_u32 s61, s67, 135168
    buffer_load_dwordx4 a[16:19], v36, s[36:39], s61 offen offset:0 sc1
    v_lshlrev_b32 v113, 16, v108
    v_mfma_f32_16x16x32_bf16 v[244:247], a[212:215], v[60:63], v[244:247]
    v_and_b32 v114, s60, v104
    v_lshrrev_b32 v154, 5, v0
    v_mfma_f32_16x16x32_bf16 v[244:247], a[216:219], v[64:67], v[244:247]
    v_and_b32 v115, s60, v108
    v_mfma_f32_16x16x32_bf16 v[244:247], a[220:223], v[68:71], v[244:247]
    ds_read_b128 v[100:103], v18 offset:36096
    v_mfma_f32_16x16x32_bf16 v[248:251], a[208:211], v[60:63], v[248:251]
    ds_read_b128 v[136:139], v28 offset:24576
    v_mfma_f32_16x16x32_bf16 v[248:251], a[212:215], v[64:67], v[248:251]
    s_add_u32 s55, s9, 143360
    buffer_load_dwordx4 a[180:183], v36, s[36:39], s55 offen offset:0 sc1
    v_mfma_f32_16x16x32_bf16 v[248:251], a[216:219], v[68:71], v[248:251]
    s_waitcnt lgkmcnt(4)
    ds_read_b128 v[140:143], v29 offset:24576
    v_lshlrev_b32 v116, 16, v105
    v_mfma_f32_16x16x32_bf16 v[248:251], a[220:223], v[72:75], v[248:251]
    ds_read_b128 v[40:43], v18 offset:36352
    v_lshlrev_b32 v117, 16, v109
    v_mfma_f32_16x16x32_bf16 v[252:255], a[208:211], v[64:67], v[252:255]
    v_and_b32 v118, s60, v105
    v_and_b32 v119, s60, v109
    v_mfma_f32_16x16x32_bf16 v[252:255], a[212:215], v[68:71], v[252:255]
    ds_read_b128 v[44:47], v18 offset:36608
    v_add_f32 v112, v112, v113
    v_mfma_f32_16x16x32_bf16 v[252:255], a[216:219], v[72:75], v[252:255]
    buffer_load_dwordx4 a[200:203], v36, s[36:39], s55 offen offset:1024 sc1
    v_add_f32 v114, v114, v115
    v_mfma_f32_16x16x32_bf16 v[252:255], a[220:223], v[88:91], v[252:255]
    s_waitcnt vmcnt(32)
    v_add_f32 v116, v116, v117
    v_add_f32 v118, v118, v119
    v_mfma_f32_16x16x32_bf16 v[192:195], a[228:231], v[76:79], v[192:195]
    ds_read_b128 v[48:51], v19 offset:36864
    v_cvt_pk_bf16_f32 v104, v112, v114
    v_mfma_f32_16x16x32_bf16 v[192:195], a[232:235], v[80:83], v[192:195]
    v_cvt_pk_bf16_f32 v105, v116, v118
    v_lshlrev_b32 v112, 16, v106
    v_mfma_f32_16x16x32_bf16 v[192:195], a[224:227], v[84:87], v[192:195]
    ds_read_b128 v[52:55], v19 offset:37120
    v_lshlrev_b32 v113, 16, v110
    v_mfma_f32_16x16x32_bf16 v[192:195], a[240:243], v[92:95], v[192:195]
    buffer_load_dwordx4 a[204:207], v36, s[36:39], s55 offen offset:2048 sc1
    v_and_b32 v114, s60, v106
    v_mfma_f32_16x16x32_bf16 v[196:199], a[228:231], v[80:83], v[196:199]
    v_and_b32 v115, s60, v110
    v_lshlrev_b32 v116, 16, v107
    v_mul_u32_u24 v155, 8704, v154
    v_mfma_f32_16x16x32_bf16 v[196:199], a[232:235], v[84:87], v[196:199]
    ds_read_b128 v[56:59], v19 offset:37376
    v_lshlrev_b32 v117, 16, v111
    v_mfma_f32_16x16x32_bf16 v[196:199], a[224:227], v[92:95], v[196:199]
    s_waitcnt lgkmcnt(4)
    v_and_b32 v118, s60, v107
    v_mfma_f32_16x16x32_bf16 v[196:199], a[240:243], v[96:99], v[196:199]
    ds_read_b128 v[60:63], v24 offset:0
    v_and_b32 v119, s60, v111
    v_mfma_f32_16x16x32_bf16 v[200:203], a[228:231], v[84:87], v[200:203]
    buffer_load_dwordx4 a[20:23], v36, s[36:39], s61 offen offset:1024 sc1
    v_add_f32 v112, v112, v113
    v_mfma_f32_16x16x32_bf16 v[200:203], a[232:235], v[92:95], v[200:203]
    v_add_f32 v114, v114, v115
    v_mfma_f32_16x16x32_bf16 v[200:203], a[224:227], v[96:99], v[200:203]
    ds_read_b128 v[64:67], v26 offset:0
    v_add_f32 v116, v116, v117
    v_mfma_f32_16x16x32_bf16 v[200:203], a[240:243], v[100:103], v[200:203]
    v_add_f32 v118, v118, v119
    v_cvt_pk_bf16_f32 v106, v112, v114
    v_mfma_f32_16x16x32_bf16 v[204:207], a[228:231], v[92:95], v[204:207]
    ds_read_b128 v[68:71], v24 offset:256
    v_mfma_f32_16x16x32_bf16 v[204:207], a[232:235], v[96:99], v[204:207]
    buffer_load_dwordx4 a[24:27], v36, s[36:39], s61 offen offset:2048 sc1
    v_cvt_pk_bf16_f32 v107, v116, v118
    v_mfma_f32_16x16x32_bf16 v[204:207], a[224:227], v[100:103], v[204:207]
    ds_write_b128 v30, v[104:107] offset:25600
    v_mfma_f32_16x16x32_bf16 v[204:207], a[240:243], v[40:43], v[204:207]
    ds_read_b128 v[72:75], v26 offset:256
    v_mfma_f32_16x16x32_bf16 v[208:211], a[228:231], v[96:99], v[208:211]
    v_add_u32 v10, v153, v155
    v_mfma_f32_16x16x32_bf16 v[208:211], a[232:235], v[100:103], v[208:211]
    v_lshlrev_b32 v112, 16, v136
    v_lshlrev_b32 v113, 16, v140
    v_mfma_f32_16x16x32_bf16 v[208:211], a[224:227], v[40:43], v[208:211]
    s_waitcnt lgkmcnt(4)
    buffer_load_dwordx4 a[28:31], v36, s[36:39], s61 offen offset:3072 sc1
    v_and_b32 v114, s60, v136
    v_mfma_f32_16x16x32_bf16 v[208:211], a[240:243], v[44:47], v[208:211]
    ds_read_b128 v[88:91], v24 offset:512
    v_mfma_f32_16x16x32_bf16 v[212:215], a[228:231], v[100:103], v[212:215]
    v_and_b32 v115, s60, v140
    v_subrev_u32 v146, s54, v28
    v_mfma_f32_16x16x32_bf16 v[212:215], a[232:235], v[40:43], v[212:215]
    v_xor_b32 v147, 128, v146
    v_subrev_u32 v148, s53, v30
    v_mfma_f32_16x16x32_bf16 v[212:215], a[224:227], v[44:47], v[212:215]
    ds_read_b128 v[104:107], v146 offset:32768
    v_mfma_f32_16x16x32_bf16 v[212:215], a[240:243], v[48:51], v[212:215]
    ds_read_b128 v[76:79], v26 offset:512
    v_mfma_f32_16x16x32_bf16 v[216:219], a[228:231], v[40:43], v[216:219]
    s_add_u32 s61, s67, 139264
    buffer_load_dwordx4 a[32:35], v36, s[36:39], s61 offen offset:0 sc1
    v_mfma_f32_16x16x32_bf16 v[216:219], a[232:235], v[44:47], v[216:219]
    ds_read_b128 v[108:111], v147 offset:32768
    v_lshlrev_b32 v116, 16, v137
    v_mfma_f32_16x16x32_bf16 v[216:219], a[224:227], v[48:51], v[216:219]
    ds_read_b128 v[80:83], v24 offset:768
    v_lshlrev_b32 v117, 16, v141
    v_mfma_f32_16x16x32_bf16 v[216:219], a[240:243], v[52:55], v[216:219]
    v_and_b32 v118, s60, v137
    v_and_b32 v119, s60, v141
    v_mfma_f32_16x16x32_bf16 v[220:223], a[228:231], v[44:47], v[220:223]
    ds_read_b128 v[84:87], v26 offset:768
    v_add_f32 v112, v112, v113
    v_lshl_add_u32 v32, v154, 9, v153
    v_mfma_f32_16x16x32_bf16 v[220:223], a[232:235], v[48:51], v[220:223]
    buffer_load_dwordx4 a[36:39], v36, s[36:39], s61 offen offset:1024 sc1
    v_add_f32 v114, v114, v115
    v_mfma_f32_16x16x32_bf16 v[220:223], a[224:227], v[52:55], v[220:223]
    v_add_f32 v116, v116, v117
    v_add_f32 v118, v118, v119
    v_mfma_f32_16x16x32_bf16 v[220:223], a[240:243], v[56:59], v[220:223]
    s_waitcnt vmcnt(33)
    ds_read_b128 v[92:95], v25 offset:1024
    v_cvt_pk_bf16_f32 v136, v112, v114
    v_mfma_f32_16x16x32_bf16 v[160:163], a[244:247], v[60:63], v[160:163]
    s_waitcnt lgkmcnt(5)
    v_cvt_pk_bf16_f32 v137, v116, v118
    v_mfma_f32_16x16x32_bf16 v[160:163], a[236:239], v[64:67], v[160:163]
    ds_read_b128 v[96:99], v27 offset:1024
    v_lshlrev_b32 v112, 16, v138
    v_mfma_f32_16x16x32_bf16 v[160:163], a[248:251], v[68:71], v[160:163]
    buffer_load_dwordx4 a[40:43], v36, s[36:39], s61 offen offset:2048 sc1
    v_lshlrev_b32 v113, 16, v142
    v_mfma_f32_16x16x32_bf16 v[160:163], a[252:255], v[72:75], v[160:163]
    v_and_b32 v114, s60, v138
    v_mfma_f32_16x16x32_bf16 v[164:167], a[244:247], v[64:67], v[164:167]
    ds_read_b128 v[100:103], v25 offset:1280
    v_and_b32 v115, s60, v142
    v_mfma_f32_16x16x32_bf16 v[164:167], a[236:239], v[68:71], v[164:167]
    v_lshlrev_b32 v116, 16, v139
    v_lshlrev_b32 v117, 16, v143
    v_mfma_f32_16x16x32_bf16 v[164:167], a[248:251], v[72:75], v[164:167]
    ds_read_b128 v[40:43], v12 offset:0
    v_and_b32 v118, s60, v139
    v_mfma_f32_16x16x32_bf16 v[164:167], a[252:255], v[88:91], v[164:167]
    buffer_load_dwordx4 a[44:47], v36, s[36:39], s61 offen offset:3072 sc1
    v_mfma_f32_16x16x32_bf16 v[168:171], a[244:247], v[68:71], v[168:171]
    v_and_b32 v119, s60, v143
    v_add_f32 v112, v112, v113
    v_mfma_f32_16x16x32_bf16 v[168:171], a[236:239], v[72:75], v[168:171]
    ds_read_b128 v[44:47], v12 offset:256
    v_add_f32 v114, v114, v115
    v_mfma_f32_16x16x32_bf16 v[168:171], a[248:251], v[88:91], v[168:171]
    s_waitcnt lgkmcnt(4)
    v_add_f32 v116, v116, v117
    v_mfma_f32_16x16x32_bf16 v[168:171], a[252:255], v[76:79], v[168:171]
    ds_read_b128 v[48:51], v12 offset:512
    v_add_f32 v118, v118, v119
    v_mfma_f32_16x16x32_bf16 v[172:175], a[244:247], v[72:75], v[172:175]
    s_add_u32 s61, s67, 143360
    buffer_load_dwordx4 a[48:51], v36, s[36:39], s61 offen offset:0 sc1
    v_cvt_pk_bf16_f32 v138, v112, v114
    v_mfma_f32_16x16x32_bf16 v[172:175], a[236:239], v[88:91], v[172:175]
    s_lshr_b32 s57, s48, 1
    v_cvt_pk_bf16_f32 v139, v116, v118
    v_mfma_f32_16x16x32_bf16 v[172:175], a[248:251], v[76:79], v[172:175]
    ds_read_b128 v[52:55], v12 offset:768
    v_mfma_f32_16x16x32_bf16 v[172:175], a[252:255], v[80:83], v[172:175]
    ds_write_b128 v31, v[136:139] offset:29696
    v_mfma_f32_16x16x32_bf16 v[176:179], a[244:247], v[88:91], v[176:179]
    s_mul_i32 s57, s57, 17408
    ds_read_b128 v[56:59], v12 offset:1024
    v_mfma_f32_16x16x32_bf16 v[176:179], a[236:239], v[76:79], v[176:179]
    buffer_load_dwordx4 a[52:55], v36, s[36:39], s61 offen offset:1024 sc1
    v_mfma_f32_16x16x32_bf16 v[176:179], a[248:251], v[80:83], v[176:179]
    v_lshlrev_b32 v112, 16, v104
    v_lshlrev_b32 v113, 16, v108
    v_mfma_f32_16x16x32_bf16 v[176:179], a[252:255], v[84:87], v[176:179]
    ds_read_b128 v[60:63], v12 offset:1280
    v_and_b32 v114, s60, v104
    v_mfma_f32_16x16x32_bf16 v[180:183], a[244:247], v[76:79], v[180:183]
    s_and_b32 s58, s48, 1
    v_and_b32 v115, s60, v108
    v_mfma_f32_16x16x32_bf16 v[180:183], a[236:239], v[80:83], v[180:183]
    ds_read_b128 v[64:67], v12 offset:1536
    v_lshlrev_b32 v116, 16, v105
    v_mfma_f32_16x16x32_bf16 v[180:183], a[248:251], v[84:87], v[180:183]
    s_add_u32 s55, s4, 4096
    buffer_load_dwordx4 a[208:211], v36, s[36:39], s55 offen offset:0 sc1
    v_mfma_f32_16x16x32_bf16 v[180:183], a[252:255], v[92:95], v[180:183]
    v_lshlrev_b32 v117, 16, v109
    v_and_b32 v118, s60, v105
    v_mfma_f32_16x16x32_bf16 v[184:187], a[244:247], v[80:83], v[184:187]
    ds_read_b128 v[68:71], v12 offset:1792
    v_and_b32 v119, s60, v109
    v_mfma_f32_16x16x32_bf16 v[184:187], a[236:239], v[84:87], v[184:187]
    v_add_f32 v112, v112, v113
    v_mfma_f32_16x16x32_bf16 v[184:187], a[248:251], v[92:95], v[184:187]
    s_waitcnt lgkmcnt(3)
    ds_read_b128 v[72:75], v13 offset:2048
    v_add_f32 v114, v114, v115
    v_mfma_f32_16x16x32_bf16 v[184:187], a[252:255], v[96:99], v[184:187]
    s_mul_i32 s58, s58, 8704
    buffer_load_dwordx4 a[56:59], v36, s[36:39], s61 offen offset:2048 sc1
    v_add_f32 v116, v116, v117
    v_mfma_f32_16x16x32_bf16 v[188:191], a[244:247], v[84:87], v[188:191]
    v_add_f32 v118, v118, v119
    v_mfma_f32_16x16x32_bf16 v[188:191], a[236:239], v[92:95], v[188:191]
    ds_read_b128 v[88:91], v13 offset:2304
    v_cvt_pk_bf16_f32 v104, v112, v114
    v_mfma_f32_16x16x32_bf16 v[188:191], a[248:251], v[96:99], v[188:191]
    v_cvt_pk_bf16_f32 v105, v116, v118
    v_lshlrev_b32 v112, 16, v106
    v_mfma_f32_16x16x32_bf16 v[188:191], a[252:255], v[100:103], v[188:191]
    s_waitcnt vmcnt(34)
    ds_read_b128 v[76:79], v14 offset:0
    v_lshlrev_b32 v113, 16, v110
    v_mfma_f32_16x16x32_bf16 v[224:227], a[156:159], v[40:43], v[224:227]
    s_add_u32 s22, s57, s58
    buffer_load_dwordx4 a[212:215], v36, s[36:39], s55 offen offset:1024 sc1
    v_mfma_f32_16x16x32_bf16 v[224:227], a[188:191], v[44:47], v[224:227]
    v_and_b32 v114, s60, v106
    v_and_b32 v115, s60, v110
    v_mfma_f32_16x16x32_bf16 v[224:227], a[128:131], v[48:51], v[224:227]
    ds_read_b128 v[80:83], v14 offset:256
    v_lshlrev_b32 v116, 16, v107
    v_mfma_f32_16x16x32_bf16 v[228:231], a[156:159], v[44:47], v[228:231]
    v_lshlrev_b32 v117, 16, v111
    v_mfma_f32_16x16x32_bf16 v[228:231], a[188:191], v[48:51], v[228:231]
    ds_read_b128 v[84:87], v14 offset:512
    v_and_b32 v118, s60, v107
    v_mfma_f32_16x16x32_bf16 v[228:231], a[128:131], v[52:55], v[228:231]
    buffer_load_dwordx4 a[216:219], v36, s[36:39], s55 offen offset:2048 sc1
    v_and_b32 v119, s60, v111
    v_mfma_f32_16x16x32_bf16 v[232:235], a[156:159], v[48:51], v[232:235]
    v_add_f32 v112, v112, v113
    v_add_u32 v153, s22, v153
    v_mfma_f32_16x16x32_bf16 v[232:235], a[188:191], v[52:55], v[232:235]
    ds_read_b128 v[92:95], v14 offset:768
    v_add_f32 v114, v114, v115
    v_mfma_f32_16x16x32_bf16 v[232:235], a[128:131], v[56:59], v[232:235]
    v_add_f32 v116, v116, v117
    v_add_f32 v118, v118, v119
    v_mfma_f32_16x16x32_bf16 v[236:239], a[156:159], v[52:55], v[236:239]
    buffer_store_dwordx4 v[120:123], v36, s[36:39], s64 offen offset:0 sc1
    v_mfma_f32_16x16x32_bf16 v[236:239], a[188:191], v[56:59], v[236:239]
    s_waitcnt lgkmcnt(3)
    v_cvt_pk_bf16_f32 v106, v112, v114
    v_cvt_pk_bf16_f32 v107, v116, v118
    v_mfma_f32_16x16x32_bf16 v[236:239], a[128:131], v[60:63], v[236:239]
    ds_read_b128 v[96:99], v14 offset:1024
    v_mfma_f32_16x16x32_bf16 v[240:243], a[156:159], v[56:59], v[240:243]
    ds_write_b128 v148, v[104:107] offset:33792
    v_mfma_f32_16x16x32_bf16 v[240:243], a[188:191], v[60:63], v[240:243]
    v_mfma_f32_16x16x32_bf16 v[240:243], a[128:131], v[64:67], v[240:243]
    buffer_load_dwordx4 a[220:223], v36, s[36:39], s55 offen offset:3072 sc1
    v_mfma_f32_16x16x32_bf16 v[244:247], a[156:159], v[60:63], v[244:247]
    ds_read_b128 v[100:103], v14 offset:1280
    v_mfma_f32_16x16x32_bf16 v[244:247], a[188:191], v[64:67], v[244:247]
    v_mul_u32_u24 v155, 544, v154
    v_mfma_f32_16x16x32_bf16 v[244:247], a[128:131], v[68:71], v[244:247]
    v_mfma_f32_16x16x32_bf16 v[248:251], a[156:159], v[64:67], v[248:251]
    v_mfma_f32_16x16x32_bf16 v[248:251], a[188:191], v[68:71], v[248:251]
    ds_read_b128 v[40:43], v14 offset:1536
    v_add_u32 v34, v153, v155
    v_mfma_f32_16x16x32_bf16 v[248:251], a[128:131], v[72:75], v[248:251]
    s_add_u32 s55, s4, 0
    buffer_load_dwordx4 a[224:227], v36, s[36:39], s55 offen offset:3072 sc1
    v_mfma_f32_16x16x32_bf16 v[252:255], a[156:159], v[68:71], v[252:255]
    ds_read_b128 v[44:47], v14 offset:1792
    v_mfma_f32_16x16x32_bf16 v[252:255], a[188:191], v[72:75], v[252:255]
    v_mfma_f32_16x16x32_bf16 v[252:255], a[128:131], v[88:91], v[252:255]
    s_waitcnt vmcnt(34)
    v_mul_u32_u24 v155, 8128, v154
    v_mfma_f32_16x16x32_bf16 v[192:195], a[132:135], v[76:79], v[192:195]
    s_waitcnt lgkmcnt(3)
    ds_read_b128 v[48:51], v15 offset:2048
    v_mfma_f32_16x16x32_bf16 v[192:195], a[140:143], v[80:83], v[192:195]
    buffer_store_dwordx4 v[120:123], v36, s[36:39], s64 offen offset:1024 sc1
    v_mfma_f32_16x16x32_bf16 v[192:195], a[144:147], v[84:87], v[192:195]
    ds_read_b128 v[52:55], v15 offset:2304
    v_mfma_f32_16x16x32_bf16 v[192:195], a[148:151], v[92:95], v[192:195]
    v_mfma_f32_16x16x32_bf16 v[196:199], a[132:135], v[80:83], v[196:199]
    s_barrier
    v_sub_u32 v35, v153, v155
    v_mfma_f32_16x16x32_bf16 v[196:199], a[140:143], v[84:87], v[196:199]
    ds_read_b128 v[56:59], v15 offset:2560
    v_mfma_f32_16x16x32_bf16 v[196:199], a[144:147], v[92:95], v[196:199]
    buffer_load_dwordx4 a[60:63], v36, s[36:39], s61 offen offset:3072 sc1
    v_mfma_f32_16x16x32_bf16 v[196:199], a[148:151], v[96:99], v[196:199]
    ds_read_b128 v[60:63], v20 offset:17408
    v_mfma_f32_16x16x32_bf16 v[200:203], a[132:135], v[84:87], v[200:203]
    v_mfma_f32_16x16x32_bf16 v[200:203], a[140:143], v[92:95], v[200:203]
    s_lshl_b32 s77, s50, 17
    v_mfma_f32_16x16x32_bf16 v[200:203], a[144:147], v[96:99], v[200:203]
    s_waitcnt lgkmcnt(3)
    s_add_u32 s77, s77, 17825792
    ds_read_b128 v[64:67], v22 offset:17408
    v_mfma_f32_16x16x32_bf16 v[200:203], a[148:151], v[100:103], v[200:203]
    buffer_store_dwordx4 v[120:123], v36, s[36:39], s64 offen offset:2048 sc1
    v_mfma_f32_16x16x32_bf16 v[204:207], a[132:135], v[92:95], v[204:207]
    ds_read_b128 v[68:71], v20 offset:17664
    v_mfma_f32_16x16x32_bf16 v[204:207], a[140:143], v[96:99], v[204:207]
    s_lshl_b32 s65, s8, 13
    v_mfma_f32_16x16x32_bf16 v[204:207], a[144:147], v[100:103], v[204:207]
    s_add_u32 s65, s65, s77
    v_mfma_f32_16x16x32_bf16 v[204:207], a[148:151], v[40:43], v[204:207]
    ds_read_b128 v[72:75], v22 offset:17664
    v_mfma_f32_16x16x32_bf16 v[208:211], a[132:135], v[96:99], v[208:211]
    s_add_u32 s70, s65, 131072
    buffer_load_dwordx4 a[228:231], v36, s[36:39], s55 offen offset:2048 sc1
    v_mfma_f32_16x16x32_bf16 v[208:211], a[140:143], v[100:103], v[208:211]
    v_mfma_f32_16x16x32_bf16 v[208:211], a[144:147], v[40:43], v[208:211]
    s_add_u32 s71, s65, 135168
    v_mfma_f32_16x16x32_bf16 v[208:211], a[148:151], v[44:47], v[208:211]
    s_lshl_b32 s57, s50, 16
    ds_read_b128 v[88:91], v20 offset:17920
    v_mfma_f32_16x16x32_bf16 v[212:215], a[132:135], v[100:103], v[212:215]
    buffer_load_dwordx4 a[232:235], v36, s[36:39], s55 offen offset:1024 sc1
    v_mfma_f32_16x16x32_bf16 v[212:215], a[140:143], v[40:43], v[212:215]
    s_lshl_b32 s66, s8, 9
    v_mfma_f32_16x16x32_bf16 v[212:215], a[144:147], v[44:47], v[212:215]
    s_add_u32 s66, s66, s57
    v_mfma_f32_16x16x32_bf16 v[212:215], a[148:151], v[48:51], v[212:215]
    ds_read_b128 v[76:79], v22 offset:17920
    v_mfma_f32_16x16x32_bf16 v[216:219], a[132:135], v[40:43], v[216:219]
    s_add_u32 s66, s66, 10485760
    v_mfma_f32_16x16x32_bf16 v[216:219], a[140:143], v[44:47], v[216:219]
    buffer_store_dwordx4 v[120:123], v36, s[36:39], s64 offen offset:3072 sc1
    v_mfma_f32_16x16x32_bf16 v[216:219], a[144:147], v[48:51], v[216:219]
    s_waitcnt lgkmcnt(2)
    ds_read_b128 v[80:83], v20 offset:18176
    v_mfma_f32_16x16x32_bf16 v[216:219], a[148:151], v[52:55], v[216:219]
    s_mov_b32 s56, 3184710632
    v_mfma_f32_16x16x32_bf16 v[220:223], a[132:135], v[44:47], v[220:223]
    s_mov_b32 s57, s56
    ds_read_b128 v[84:87], v22 offset:18176
    v_mfma_f32_16x16x32_bf16 v[220:223], a[140:143], v[48:51], v[220:223]
    v_mfma_f32_16x16x32_bf16 v[220:223], a[144:147], v[52:55], v[220:223]
    s_mov_b32 s58, 1.0
    buffer_load_dwordx4 a[240:243], v36, s[36:39], s55 offen offset:0 sc1
    v_mfma_f32_16x16x32_bf16 v[220:223], a[148:151], v[56:59], v[220:223]
    s_waitcnt vmcnt(37)
    ds_read_b128 v[92:95], v21 offset:18432
    v_mfma_f32_16x16x32_bf16 v[160:163], a[136:139], v[60:63], v[160:163]
    s_mov_b32 s59, 1.0
    v_mfma_f32_16x16x32_bf16 v[160:163], a[152:155], v[64:67], v[160:163]
    ds_read_b128 v[96:99], v23 offset:18432
    v_mfma_f32_16x16x32_bf16 v[160:163], a[160:163], v[68:71], v[160:163]
    v_mfma_f32_16x16x32_bf16 v[160:163], a[148:151], v[72:75], v[160:163]
    s_add_u32 s55, s4, 8192
    buffer_load_dwordx4 a[236:239], v36, s[36:39], s55 offen offset:3072 sc1
    v_mfma_f32_16x16x32_bf16 v[164:167], a[136:139], v[64:67], v[164:167]
    ds_read_b128 v[100:103], v21 offset:18688
    v_mfma_f32_16x16x32_bf16 v[164:167], a[152:155], v[68:71], v[164:167]
    v_mfma_f32_16x16x32_bf16 v[164:167], a[160:163], v[72:75], v[164:167]
    s_waitcnt lgkmcnt(3)
    ds_read_b128 v[40:43], v16 offset:0
    v_mfma_f32_16x16x32_bf16 v[164:167], a[148:151], v[88:91], v[164:167]
    v_mfma_f32_16x16x32_bf16 v[168:171], a[136:139], v[68:71], v[168:171]
    s_add_u32 s55, s4, 12288
    buffer_load_dwordx4 a[244:247], v36, s[36:39], s55 offen offset:0 sc1
    v_mfma_f32_16x16x32_bf16 v[168:171], a[152:155], v[72:75], v[168:171]
    ds_read_b128 v[44:47], v16 offset:256
    v_mfma_f32_16x16x32_bf16 v[168:171], a[160:163], v[88:91], v[168:171]
    v_mfma_f32_16x16x32_bf16 v[168:171], a[148:151], v[76:79], v[168:171]
    ds_read_b128 v[48:51], v16 offset:512
    v_mfma_f32_16x16x32_bf16 v[172:175], a[136:139], v[72:75], v[172:175]
    v_mfma_f32_16x16x32_bf16 v[172:175], a[152:155], v[88:91], v[172:175]
    buffer_load_dwordx4 a[248:251], v36, s[36:39], s55 offen offset:1024 sc1
    v_mfma_f32_16x16x32_bf16 v[172:175], a[160:163], v[76:79], v[172:175]
    ds_read_b128 v[52:55], v16 offset:768
    v_mfma_f32_16x16x32_bf16 v[172:175], a[148:151], v[80:83], v[172:175]
    v_mfma_f32_16x16x32_bf16 v[176:179], a[136:139], v[88:91], v[176:179]
    ds_read_b128 v[56:59], v16 offset:1024
    v_mfma_f32_16x16x32_bf16 v[176:179], a[152:155], v[76:79], v[176:179]
    v_mfma_f32_16x16x32_bf16 v[176:179], a[160:163], v[80:83], v[176:179]
    buffer_load_dwordx4 a[252:255], v36, s[36:39], s55 offen offset:2048 sc1
    v_mfma_f32_16x16x32_bf16 v[176:179], a[148:151], v[84:87], v[176:179]
    ds_read_b128 v[60:63], v16 offset:1280
    v_mfma_f32_16x16x32_bf16 v[180:183], a[136:139], v[76:79], v[180:183]
    v_mfma_f32_16x16x32_bf16 v[180:183], a[152:155], v[80:83], v[180:183]
    ds_read_b128 v[64:67], v16 offset:1536
    v_mfma_f32_16x16x32_bf16 v[180:183], a[160:163], v[84:87], v[180:183]
    s_waitcnt lgkmcnt(4)
    v_mfma_f32_16x16x32_bf16 v[180:183], a[148:151], v[92:95], v[180:183]
    s_add_u32 s55, s4, 8192
    buffer_load_dwordx4 a[156:159], v36, s[36:39], s55 offen offset:2048 sc1
    v_mfma_f32_16x16x32_bf16 v[184:187], a[136:139], v[80:83], v[184:187]
    ds_read_b128 v[68:71], v16 offset:1792
    v_mfma_f32_16x16x32_bf16 v[184:187], a[152:155], v[84:87], v[184:187]
    v_mfma_f32_16x16x32_bf16 v[184:187], a[160:163], v[92:95], v[184:187]
    ds_read_b128 v[72:75], v17 offset:2048
    v_mfma_f32_16x16x32_bf16 v[184:187], a[148:151], v[96:99], v[184:187]
    v_mfma_f32_16x16x32_bf16 v[188:191], a[136:139], v[84:87], v[188:191]
    buffer_load_dwordx4 a[128:131], v36, s[36:39], s55 offen offset:1024 sc1
    v_mfma_f32_16x16x32_bf16 v[188:191], a[152:155], v[92:95], v[188:191]
    ds_read_b128 v[88:91], v17 offset:2304
    v_mfma_f32_16x16x32_bf16 v[188:191], a[160:163], v[96:99], v[188:191]
    v_mfma_f32_16x16x32_bf16 v[188:191], a[148:151], v[100:103], v[188:191]
    s_waitcnt vmcnt(38)
    ds_read_b128 v[76:79], v18 offset:0
    v_mfma_f32_16x16x32_bf16 v[224:227], a[164:167], v[40:43], v[224:227]
    v_mfma_f32_16x16x32_bf16 v[224:227], a[168:171], v[44:47], v[224:227]
    buffer_load_dwordx4 a[188:191], v36, s[36:39], s55 offen offset:0 sc1
    v_mfma_f32_16x16x32_bf16 v[224:227], a[172:175], v[48:51], v[224:227]
    ds_read_b128 v[80:83], v18 offset:256
    v_mfma_f32_16x16x32_bf16 v[228:231], a[164:167], v[44:47], v[228:231]
    v_mfma_f32_16x16x32_bf16 v[228:231], a[168:171], v[48:51], v[228:231]
    s_waitcnt lgkmcnt(3)
    ds_read_b128 v[84:87], v18 offset:512
    v_mfma_f32_16x16x32_bf16 v[228:231], a[172:175], v[52:55], v[228:231]
    v_mfma_f32_16x16x32_bf16 v[232:235], a[164:167], v[48:51], v[232:235]
    s_add_u32 s55, s5, 4096
    buffer_load_dwordx4 v[108:111], v36, s[36:39], s55 offen offset:0 sc1
    v_mfma_f32_16x16x32_bf16 v[232:235], a[168:171], v[52:55], v[232:235]
    ds_read_b128 v[92:95], v18 offset:768
    v_mfma_f32_16x16x32_bf16 v[232:235], a[172:175], v[56:59], v[232:235]
    v_mfma_f32_16x16x32_bf16 v[236:239], a[164:167], v[52:55], v[236:239]
    v_mfma_f32_16x16x32_bf16 v[236:239], a[168:171], v[56:59], v[236:239]
    v_mfma_f32_16x16x32_bf16 v[236:239], a[172:175], v[60:63], v[236:239]
    ds_read_b128 v[96:99], v18 offset:1024
    v_mfma_f32_16x16x32_bf16 v[240:243], a[164:167], v[56:59], v[240:243]
    buffer_load_dwordx4 v[112:115], v36, s[36:39], s55 offen offset:1024 sc1
    v_mfma_f32_16x16x32_bf16 v[240:243], a[168:171], v[60:63], v[240:243]
    v_mfma_f32_16x16x32_bf16 v[240:243], a[172:175], v[64:67], v[240:243]
    v_mfma_f32_16x16x32_bf16 v[244:247], a[164:167], v[60:63], v[244:247]
    ds_read_b128 v[100:103], v18 offset:1280
    v_mfma_f32_16x16x32_bf16 v[244:247], a[168:171], v[64:67], v[244:247]
    buffer_load_dwordx4 a[132:135], v36, s[36:39], s55 offen offset:2048 sc1
    v_mfma_f32_16x16x32_bf16 v[244:247], a[172:175], v[68:71], v[244:247]
    v_mfma_f32_16x16x32_bf16 v[248:251], a[164:167], v[64:67], v[248:251]
    v_mfma_f32_16x16x32_bf16 v[248:251], a[168:171], v[68:71], v[248:251]
    ds_read_b128 v[40:43], v18 offset:1536
    v_mfma_f32_16x16x32_bf16 v[248:251], a[172:175], v[72:75], v[248:251]
    v_mfma_f32_16x16x32_bf16 v[252:255], a[164:167], v[68:71], v[252:255]
    ds_read_b128 v[44:47], v18 offset:1792
    v_mfma_f32_16x16x32_bf16 v[252:255], a[168:171], v[72:75], v[252:255]
    s_waitcnt lgkmcnt(3)
    buffer_load_dwordx4 a[140:143], v36, s[36:39], s55 offen offset:3072 sc1
    v_mfma_f32_16x16x32_bf16 v[252:255], a[172:175], v[88:91], v[252:255]
    s_waitcnt vmcnt(38)
    v_mfma_f32_16x16x32_bf16 v[192:195], a[176:179], v[76:79], v[192:195]
    ds_read_b128 v[48:51], v19 offset:2048
    v_mfma_f32_16x16x32_bf16 v[192:195], a[184:187], v[80:83], v[192:195]
    v_mfma_f32_16x16x32_bf16 v[192:195], a[192:195], v[84:87], v[192:195]
    ds_read_b128 v[52:55], v19 offset:2304
    v_mfma_f32_16x16x32_bf16 v[192:195], a[196:199], v[92:95], v[192:195]
    s_add_u32 s55, s5, 0
    buffer_load_dwordx4 a[144:147], v36, s[36:39], s55 offen offset:3072 sc1
    v_mfma_f32_16x16x32_bf16 v[196:199], a[176:179], v[80:83], v[196:199]
    v_mfma_f32_16x16x32_bf16 v[196:199], a[184:187], v[84:87], v[196:199]
    ds_read_b128 v[56:59], v19 offset:2560
    v_mfma_f32_16x16x32_bf16 v[196:199], a[192:195], v[92:95], v[196:199]
    v_mfma_f32_16x16x32_bf16 v[196:199], a[196:199], v[96:99], v[196:199]
    ds_read_b128 v[60:63], v24 offset:17408
    v_mfma_f32_16x16x32_bf16 v[200:203], a[176:179], v[84:87], v[200:203]
    buffer_load_dwordx4 v[116:119], v36, s[36:39], s55 offen offset:2048 sc1
    v_mfma_f32_16x16x32_bf16 v[200:203], a[184:187], v[92:95], v[200:203]
    v_mfma_f32_16x16x32_bf16 v[200:203], a[192:195], v[96:99], v[200:203]
    s_waitcnt lgkmcnt(3)
    ds_read_b128 v[64:67], v26 offset:17408
    v_mfma_f32_16x16x32_bf16 v[200:203], a[196:199], v[100:103], v[200:203]
    v_mfma_f32_16x16x32_bf16 v[204:207], a[176:179], v[92:95], v[204:207]
    ds_read_b128 v[68:71], v24 offset:17664
    v_mfma_f32_16x16x32_bf16 v[204:207], a[184:187], v[96:99], v[204:207]
    buffer_load_dwordx4 v[124:127], v36, s[36:39], s55 offen offset:1024 sc1
    v_mfma_f32_16x16x32_bf16 v[204:207], a[192:195], v[100:103], v[204:207]
    v_mfma_f32_16x16x32_bf16 v[204:207], a[196:199], v[40:43], v[204:207]
    ds_read_b128 v[72:75], v26 offset:17664
    v_mfma_f32_16x16x32_bf16 v[208:211], a[176:179], v[96:99], v[208:211]
    v_mfma_f32_16x16x32_bf16 v[208:211], a[184:187], v[100:103], v[208:211]
    buffer_load_dwordx4 v[128:131], v36, s[36:39], s55 offen offset:0 sc1
    v_mfma_f32_16x16x32_bf16 v[208:211], a[192:195], v[40:43], v[208:211]
    v_mfma_f32_16x16x32_bf16 v[208:211], a[196:199], v[44:47], v[208:211]
    ds_read_b128 v[88:91], v24 offset:17920
    v_mfma_f32_16x16x32_bf16 v[212:215], a[176:179], v[100:103], v[212:215]
    v_mfma_f32_16x16x32_bf16 v[212:215], a[184:187], v[40:43], v[212:215]
    v_mfma_f32_16x16x32_bf16 v[212:215], a[192:195], v[44:47], v[212:215]
    s_add_u32 s55, s5, 8192
    buffer_load_dwordx4 a[136:139], v36, s[36:39], s55 offen offset:3072 sc1
    v_mfma_f32_16x16x32_bf16 v[212:215], a[196:199], v[48:51], v[212:215]
    ds_read_b128 v[76:79], v26 offset:17920
    v_mfma_f32_16x16x32_bf16 v[216:219], a[176:179], v[40:43], v[216:219]
    v_mfma_f32_16x16x32_bf16 v[216:219], a[184:187], v[44:47], v[216:219]
    v_mfma_f32_16x16x32_bf16 v[216:219], a[192:195], v[48:51], v[216:219]
    s_waitcnt lgkmcnt(2)
    v_mfma_f32_16x16x32_bf16 v[216:219], a[196:199], v[52:55], v[216:219]
    ds_read_b128 v[80:83], v24 offset:18176
    v_mfma_f32_16x16x32_bf16 v[220:223], a[176:179], v[44:47], v[220:223]
    s_add_u32 s55, s5, 12288
    buffer_load_dwordx4 a[148:151], v36, s[36:39], s55 offen offset:0 sc1
    v_mfma_f32_16x16x32_bf16 v[220:223], a[184:187], v[48:51], v[220:223]
    v_mfma_f32_16x16x32_bf16 v[220:223], a[192:195], v[52:55], v[220:223]
    v_mfma_f32_16x16x32_bf16 v[220:223], a[196:199], v[56:59], v[220:223]
    s_waitcnt vmcnt(40)
    ds_read_b128 v[84:87], v26 offset:18176
    v_mfma_f32_16x16x32_bf16 v[160:163], a[180:183], v[60:63], v[160:163]
    buffer_load_dwordx4 a[152:155], v36, s[36:39], s55 offen offset:1024 sc1
    v_mfma_f32_16x16x32_bf16 v[160:163], a[200:203], v[64:67], v[160:163]
    v_mfma_f32_16x16x32_bf16 v[160:163], a[204:207], v[68:71], v[160:163]
    s_nop 1
    v_add_f32_dpp v104, v224, v220 row_shl:1 row_mask:0xf bank_mask:0xf bound_ctrl:1
    v_add_f32_dpp v105, v225, v221 row_shl:1 row_mask:0xf bank_mask:0xf bound_ctrl:1
    v_mfma_f32_16x16x32_bf16 v[160:163], a[196:199], v[72:75], v[160:163]
    ds_read_b128 v[92:95], v25 offset:18432
    v_add_f32_dpp v106, v226, v222 row_shl:1 row_mask:0xf bank_mask:0xf bound_ctrl:1
    v_mfma_f32_16x16x32_bf16 v[164:167], a[180:183], v[64:67], v[164:167]
    v_add_f32_dpp v107, v227, v223 row_shl:1 row_mask:0xf bank_mask:0xf bound_ctrl:1
    v_add_f32 v224, v192, v224
    v_mfma_f32_16x16x32_bf16 v[164:167], a[200:203], v[68:71], v[164:167]
    buffer_load_dwordx4 a[160:163], v36, s[36:39], s55 offen offset:2048 sc1
    v_add_f32 v225, v193, v225
    v_mfma_f32_16x16x32_bf16 v[164:167], a[204:207], v[72:75], v[164:167]
    s_waitcnt lgkmcnt(2)
    v_add_f32 v226, v194, v226
    v_add_f32 v227, v195, v227
    v_mfma_f32_16x16x32_bf16 v[164:167], a[196:199], v[88:91], v[164:167]
    ds_read_b128 v[96:99], v27 offset:18432
    v_add_f32 v192, v192, v228
    v_mfma_f32_16x16x32_bf16 v[168:171], a[180:183], v[68:71], v[168:171]
    v_add_f32 v193, v193, v229
    v_add_f32 v194, v194, v230
    v_mfma_f32_16x16x32_bf16 v[168:171], a[200:203], v[72:75], v[168:171]
    v_add_f32 v195, v195, v231
    v_add_f32 v228, v196, v228
    v_mfma_f32_16x16x32_bf16 v[168:171], a[204:207], v[88:91], v[168:171]
    s_add_u32 s55, s5, 8192
    buffer_load_dwordx4 a[164:167], v36, s[36:39], s55 offen offset:2048 sc1
    v_add_f32 v229, v197, v229
    v_mfma_f32_16x16x32_bf16 v[168:171], a[196:199], v[76:79], v[168:171]
    ds_read_b128 v[100:103], v25 offset:18688
    v_add_f32 v230, v198, v230
    v_mfma_f32_16x16x32_bf16 v[172:175], a[180:183], v[72:75], v[172:175]
    v_add_f32 v231, v199, v231
    v_add_f32 v196, v196, v232
    v_mfma_f32_16x16x32_bf16 v[172:175], a[200:203], v[88:91], v[172:175]
    v_add_f32 v197, v197, v233
    v_add_f32 v198, v198, v234
    v_mfma_f32_16x16x32_bf16 v[172:175], a[204:207], v[76:79], v[172:175]
    v_add_f32 v199, v199, v235
    v_add_f32 v232, v200, v232
    v_mfma_f32_16x16x32_bf16 v[172:175], a[196:199], v[80:83], v[172:175]
    buffer_load_dwordx4 a[168:171], v36, s[36:39], s55 offen offset:1024 sc1
    v_add_f32 v233, v201, v233
    v_mfma_f32_16x16x32_bf16 v[176:179], a[180:183], v[88:91], v[176:179]
    v_add_f32 v234, v202, v234
    v_add_f32 v235, v203, v235
    v_mfma_f32_16x16x32_bf16 v[176:179], a[200:203], v[76:79], v[176:179]
    v_add_f32 v200, v200, v236
    v_add_f32 v201, v201, v237
    v_mfma_f32_16x16x32_bf16 v[176:179], a[204:207], v[80:83], v[176:179]
    s_waitcnt lgkmcnt(1)
    v_add_f32 v202, v202, v238
    v_add_f32 v203, v203, v239
    v_mfma_f32_16x16x32_bf16 v[176:179], a[196:199], v[84:87], v[176:179]
    v_add_f32 v236, v204, v236
    v_add_f32 v237, v205, v237
    v_add_f32 v238, v206, v238
    v_mfma_f32_16x16x32_bf16 v[180:183], a[180:183], v[76:79], v[180:183]
    buffer_load_dwordx4 a[172:175], v36, s[36:39], s55 offen offset:0 sc1
    v_add_f32 v239, v207, v239
    v_mfma_f32_16x16x32_bf16 v[180:183], a[200:203], v[80:83], v[180:183]
    v_add_f32 v204, v204, v240
    v_add_f32 v205, v205, v241
    v_add_f32 v206, v206, v242
    v_mfma_f32_16x16x32_bf16 v[180:183], a[204:207], v[84:87], v[180:183]
    v_add_f32 v207, v207, v243
    v_add_f32 v240, v208, v240
    v_mfma_f32_16x16x32_bf16 v[180:183], a[196:199], v[92:95], v[180:183]
    v_add_f32 v241, v209, v241
    v_add_f32 v242, v210, v242
    v_add_f32 v243, v211, v243
    v_mfma_f32_16x16x32_bf16 v[184:187], a[180:183], v[80:83], v[184:187]
    v_add_f32 v208, v208, v244
    v_add_f32 v209, v209, v245
    v_mfma_f32_16x16x32_bf16 v[184:187], a[200:203], v[84:87], v[184:187]
    v_add_f32 v210, v210, v246
    v_add_f32 v211, v211, v247
    v_add_f32 v244, v212, v244
    v_mfma_f32_16x16x32_bf16 v[184:187], a[204:207], v[92:95], v[184:187]
    v_add_f32 v245, v213, v245
    v_add_f32 v246, v214, v246
    v_mfma_f32_16x16x32_bf16 v[184:187], a[196:199], v[96:99], v[184:187]
    v_add_f32 v247, v215, v247
    v_add_f32 v212, v212, v248
    v_mfma_f32_16x16x32_bf16 v[188:191], a[180:183], v[84:87], v[188:191]
    v_add_f32 v213, v213, v249
    v_add_f32 v214, v214, v250
    v_add_f32 v215, v215, v251
    v_mfma_f32_16x16x32_bf16 v[188:191], a[200:203], v[92:95], v[188:191]
    v_add_f32 v248, v216, v248
    v_add_f32 v249, v217, v249
    v_mfma_f32_16x16x32_bf16 v[188:191], a[204:207], v[96:99], v[188:191]
    s_waitcnt lgkmcnt(0)
    v_add_f32 v250, v218, v250
    v_add_f32 v251, v219, v251
    v_add_f32 v216, v216, v252
    v_mfma_f32_16x16x32_bf16 v[188:191], a[196:199], v[100:103], v[188:191]
    v_add_f32 v217, v217, v253
    v_add_f32 v218, v218, v254
    v_add_f32 v219, v219, v255
    v_add_f32 v252, v220, v252
    v_add_f32 v253, v221, v253
    v_add_f32 v254, v222, v254
    v_add_f32 v255, v223, v255
    v_mov_b32 v12, 3222493025
    v_mov_b32 v13, 3222493025
    v_and_b32 v26, 15, v0
    s_cmp_eq_u32 s52, 31
    s_cselect_b32 s62, 15, 99
    v_cmp_eq_u32 s[62:63], s62, v26
    v_pk_add_f32 v[160:161], v[160:161], v[224:225] neg_lo:[0,1] neg_hi:[0,1]
    v_pk_add_f32 v[162:163], v[162:163], v[226:227] neg_lo:[0,1] neg_hi:[0,1]
    v_pk_mul_f32 v[14:15], v[160:161], v[160:161]
    v_pk_mul_f32 v[16:17], v[162:163], v[162:163]
    v_pk_mul_f32 v[18:19], v[192:193], v[192:193]
    v_pk_mul_f32 v[20:21], v[194:195], v[194:195]
    v_pk_fma_f32 v[14:15], v[14:15], s[56:57], v[12:13]
    v_pk_fma_f32 v[16:17], v[16:17], s[56:57], v[12:13]
    v_pk_fma_f32 v[18:19], v[18:19], s[56:57], v[12:13]
    v_pk_fma_f32 v[20:21], v[20:21], s[56:57], v[12:13]
    v_pk_mul_f32 v[14:15], v[14:15], v[160:161]
    v_pk_mul_f32 v[16:17], v[16:17], v[162:163]
    v_pk_mul_f32 v[18:19], v[18:19], v[192:193]
    v_pk_mul_f32 v[20:21], v[20:21], v[194:195]
    v_exp_f32 v14, v14
    v_exp_f32 v15, v15
    v_exp_f32 v16, v16
    v_exp_f32 v17, v17
    v_exp_f32 v18, v18
    v_exp_f32 v19, v19
    v_exp_f32 v20, v20
    v_exp_f32 v21, v21
    v_pk_add_f32 v[14:15], v[14:15], s[58:59]
    v_pk_add_f32 v[16:17], v[16:17], s[58:59]
    v_pk_add_f32 v[18:19], v[18:19], s[58:59]
    v_pk_add_f32 v[20:21], v[20:21], s[58:59]
    v_rcp_f32 v14, v14
    v_rcp_f32 v15, v15
    v_rcp_f32 v16, v16
    v_rcp_f32 v17, v17
    v_rcp_f32 v18, v18
    v_rcp_f32 v19, v19
    v_rcp_f32 v20, v20
    v_rcp_f32 v21, v21
    v_pk_mul_f32 v[14:15], v[14:15], v[160:161]
    v_pk_mul_f32 v[16:17], v[16:17], v[162:163]
    v_pk_mul_f32 v[18:19], v[18:19], v[192:193]
    v_pk_mul_f32 v[20:21], v[20:21], v[194:195]
    v_cvt_pk_bf16_f32 v160, v14, v15
    v_cvt_pk_bf16_f32 v162, v18, v19
    v_cvt_pk_bf16_f32 v161, v16, v17
    v_cvt_pk_bf16_f32 v163, v20, v21
    s_nop 0
    v_permlane32_swap_b32 v160, v162
    v_permlane32_swap_b32 v161, v163
    buffer_store_dwordx4 v[160:163], v32, s[36:39], s70 offen offset:0 sc1
    v_pk_add_f32 v[164:165], v[164:165], v[228:229] neg_lo:[0,1] neg_hi:[0,1]
    v_pk_add_f32 v[166:167], v[166:167], v[230:231] neg_lo:[0,1] neg_hi:[0,1]
    v_pk_mul_f32 v[14:15], v[164:165], v[164:165]
    v_pk_mul_f32 v[16:17], v[166:167], v[166:167]
    v_pk_mul_f32 v[18:19], v[196:197], v[196:197]
    v_pk_mul_f32 v[20:21], v[198:199], v[198:199]
    v_pk_fma_f32 v[14:15], v[14:15], s[56:57], v[12:13]
    v_pk_fma_f32 v[16:17], v[16:17], s[56:57], v[12:13]
    v_pk_fma_f32 v[18:19], v[18:19], s[56:57], v[12:13]
    v_pk_fma_f32 v[20:21], v[20:21], s[56:57], v[12:13]
    v_pk_mul_f32 v[14:15], v[14:15], v[164:165]
    v_pk_mul_f32 v[16:17], v[16:17], v[166:167]
    v_pk_mul_f32 v[18:19], v[18:19], v[196:197]
    v_pk_mul_f32 v[20:21], v[20:21], v[198:199]
    v_exp_f32 v14, v14
    v_exp_f32 v15, v15
    v_exp_f32 v16, v16
    v_exp_f32 v17, v17
    v_exp_f32 v18, v18
    v_exp_f32 v19, v19
    v_exp_f32 v20, v20
    v_exp_f32 v21, v21
    v_pk_add_f32 v[14:15], v[14:15], s[58:59]
    v_pk_add_f32 v[16:17], v[16:17], s[58:59]
    v_pk_add_f32 v[18:19], v[18:19], s[58:59]
    v_pk_add_f32 v[20:21], v[20:21], s[58:59]
    v_rcp_f32 v14, v14
    v_rcp_f32 v15, v15
    v_rcp_f32 v16, v16
    v_rcp_f32 v17, v17
    v_rcp_f32 v18, v18
    v_rcp_f32 v19, v19
    v_rcp_f32 v20, v20
    v_rcp_f32 v21, v21
    v_pk_mul_f32 v[14:15], v[14:15], v[164:165]
    v_pk_mul_f32 v[16:17], v[16:17], v[166:167]
    v_pk_mul_f32 v[18:19], v[18:19], v[196:197]
    v_pk_mul_f32 v[20:21], v[20:21], v[198:199]
    v_cvt_pk_bf16_f32 v164, v14, v15
    v_cvt_pk_bf16_f32 v166, v18, v19
    v_cvt_pk_bf16_f32 v165, v16, v17
    v_cvt_pk_bf16_f32 v167, v20, v21
    s_nop 0
    v_permlane32_swap_b32 v164, v166
    v_permlane32_swap_b32 v165, v167
    buffer_store_dwordx4 v[164:167], v32, s[36:39], s70 offen offset:1024 sc1
    v_pk_add_f32 v[168:169], v[168:169], v[232:233] neg_lo:[0,1] neg_hi:[0,1]
    v_pk_add_f32 v[170:171], v[170:171], v[234:235] neg_lo:[0,1] neg_hi:[0,1]
    v_pk_mul_f32 v[14:15], v[168:169], v[168:169]
    v_pk_mul_f32 v[16:17], v[170:171], v[170:171]
    v_pk_mul_f32 v[18:19], v[200:201], v[200:201]
    v_pk_mul_f32 v[20:21], v[202:203], v[202:203]
    v_pk_fma_f32 v[14:15], v[14:15], s[56:57], v[12:13]
    v_pk_fma_f32 v[16:17], v[16:17], s[56:57], v[12:13]
    v_pk_fma_f32 v[18:19], v[18:19], s[56:57], v[12:13]
    v_pk_fma_f32 v[20:21], v[20:21], s[56:57], v[12:13]
    v_pk_mul_f32 v[14:15], v[14:15], v[168:169]
    v_pk_mul_f32 v[16:17], v[16:17], v[170:171]
    v_pk_mul_f32 v[18:19], v[18:19], v[200:201]
    v_pk_mul_f32 v[20:21], v[20:21], v[202:203]
    v_exp_f32 v14, v14
    v_exp_f32 v15, v15
    v_exp_f32 v16, v16
    v_exp_f32 v17, v17
    v_exp_f32 v18, v18
    v_exp_f32 v19, v19
    v_exp_f32 v20, v20
    v_exp_f32 v21, v21
    v_pk_add_f32 v[14:15], v[14:15], s[58:59]
    v_pk_add_f32 v[16:17], v[16:17], s[58:59]
    v_pk_add_f32 v[18:19], v[18:19], s[58:59]
    v_pk_add_f32 v[20:21], v[20:21], s[58:59]
    v_rcp_f32 v14, v14
    v_rcp_f32 v15, v15
    v_rcp_f32 v16, v16
    v_rcp_f32 v17, v17
    v_rcp_f32 v18, v18
    v_rcp_f32 v19, v19
    v_rcp_f32 v20, v20
    v_rcp_f32 v21, v21
    v_pk_mul_f32 v[14:15], v[14:15], v[168:169]
    v_pk_mul_f32 v[16:17], v[16:17], v[170:171]
    v_pk_mul_f32 v[18:19], v[18:19], v[200:201]
    v_pk_mul_f32 v[20:21], v[20:21], v[202:203]
    v_cvt_pk_bf16_f32 v168, v14, v15
    v_cvt_pk_bf16_f32 v170, v18, v19
    v_cvt_pk_bf16_f32 v169, v16, v17
    v_cvt_pk_bf16_f32 v171, v20, v21
    s_nop 0
    v_permlane32_swap_b32 v168, v170
    v_permlane32_swap_b32 v169, v171
    buffer_store_dwordx4 v[168:171], v32, s[36:39], s70 offen offset:2048 sc1
    v_pk_add_f32 v[172:173], v[172:173], v[236:237] neg_lo:[0,1] neg_hi:[0,1]
    v_pk_add_f32 v[174:175], v[174:175], v[238:239] neg_lo:[0,1] neg_hi:[0,1]
    v_pk_mul_f32 v[14:15], v[172:173], v[172:173]
    v_pk_mul_f32 v[16:17], v[174:175], v[174:175]
    v_pk_mul_f32 v[18:19], v[204:205], v[204:205]
    v_pk_mul_f32 v[20:21], v[206:207], v[206:207]
    v_pk_fma_f32 v[14:15], v[14:15], s[56:57], v[12:13]
    v_pk_fma_f32 v[16:17], v[16:17], s[56:57], v[12:13]
    v_pk_fma_f32 v[18:19], v[18:19], s[56:57], v[12:13]
    v_pk_fma_f32 v[20:21], v[20:21], s[56:57], v[12:13]
    v_pk_mul_f32 v[14:15], v[14:15], v[172:173]
    v_pk_mul_f32 v[16:17], v[16:17], v[174:175]
    v_pk_mul_f32 v[18:19], v[18:19], v[204:205]
    v_pk_mul_f32 v[20:21], v[20:21], v[206:207]
    v_exp_f32 v14, v14
    v_exp_f32 v15, v15
    v_exp_f32 v16, v16
    v_exp_f32 v17, v17
    v_exp_f32 v18, v18
    v_exp_f32 v19, v19
    v_exp_f32 v20, v20
    v_exp_f32 v21, v21
    v_pk_add_f32 v[14:15], v[14:15], s[58:59]
    v_pk_add_f32 v[16:17], v[16:17], s[58:59]
    v_pk_add_f32 v[18:19], v[18:19], s[58:59]
    v_pk_add_f32 v[20:21], v[20:21], s[58:59]
    v_rcp_f32 v14, v14
    v_rcp_f32 v15, v15
    v_rcp_f32 v16, v16
    v_rcp_f32 v17, v17
    v_rcp_f32 v18, v18
    v_rcp_f32 v19, v19
    v_rcp_f32 v20, v20
    v_rcp_f32 v21, v21
    v_pk_mul_f32 v[14:15], v[14:15], v[172:173]
    v_pk_mul_f32 v[16:17], v[16:17], v[174:175]
    v_pk_mul_f32 v[18:19], v[18:19], v[204:205]
    v_pk_mul_f32 v[20:21], v[20:21], v[206:207]
    v_cvt_pk_bf16_f32 v172, v14, v15
    v_cvt_pk_bf16_f32 v174, v18, v19
    v_cvt_pk_bf16_f32 v173, v16, v17
    v_cvt_pk_bf16_f32 v175, v20, v21
    s_nop 0
    v_permlane32_swap_b32 v172, v174
    v_permlane32_swap_b32 v173, v175
    buffer_store_dwordx4 v[172:175], v32, s[36:39], s70 offen offset:3072 sc1
    v_pk_add_f32 v[176:177], v[176:177], v[240:241] neg_lo:[0,1] neg_hi:[0,1]
    v_pk_add_f32 v[178:179], v[178:179], v[242:243] neg_lo:[0,1] neg_hi:[0,1]
    v_pk_mul_f32 v[14:15], v[176:177], v[176:177]
    v_pk_mul_f32 v[16:17], v[178:179], v[178:179]
    v_pk_mul_f32 v[18:19], v[208:209], v[208:209]
    v_pk_mul_f32 v[20:21], v[210:211], v[210:211]
    v_pk_fma_f32 v[14:15], v[14:15], s[56:57], v[12:13]
    v_pk_fma_f32 v[16:17], v[16:17], s[56:57], v[12:13]
    v_pk_fma_f32 v[18:19], v[18:19], s[56:57], v[12:13]
    v_pk_fma_f32 v[20:21], v[20:21], s[56:57], v[12:13]
    v_pk_mul_f32 v[14:15], v[14:15], v[176:177]
    v_pk_mul_f32 v[16:17], v[16:17], v[178:179]
    v_pk_mul_f32 v[18:19], v[18:19], v[208:209]
    v_pk_mul_f32 v[20:21], v[20:21], v[210:211]
    v_exp_f32 v14, v14
    v_exp_f32 v15, v15
    v_exp_f32 v16, v16
    v_exp_f32 v17, v17
    v_exp_f32 v18, v18
    v_exp_f32 v19, v19
    v_exp_f32 v20, v20
    v_exp_f32 v21, v21
    v_pk_add_f32 v[14:15], v[14:15], s[58:59]
    v_pk_add_f32 v[16:17], v[16:17], s[58:59]
    v_pk_add_f32 v[18:19], v[18:19], s[58:59]
    v_pk_add_f32 v[20:21], v[20:21], s[58:59]
    v_rcp_f32 v14, v14
    v_rcp_f32 v15, v15
    v_rcp_f32 v16, v16
    v_rcp_f32 v17, v17
    v_rcp_f32 v18, v18
    v_rcp_f32 v19, v19
    v_rcp_f32 v20, v20
    v_rcp_f32 v21, v21
    v_pk_mul_f32 v[14:15], v[14:15], v[176:177]
    v_pk_mul_f32 v[16:17], v[16:17], v[178:179]
    v_pk_mul_f32 v[18:19], v[18:19], v[208:209]
    v_pk_mul_f32 v[20:21], v[20:21], v[210:211]
    v_cvt_pk_bf16_f32 v176, v14, v15
    v_cvt_pk_bf16_f32 v178, v18, v19
    v_cvt_pk_bf16_f32 v177, v16, v17
    v_cvt_pk_bf16_f32 v179, v20, v21
    s_nop 0
    v_permlane32_swap_b32 v176, v178
    v_permlane32_swap_b32 v177, v179
    buffer_store_dwordx4 v[176:179], v32, s[36:39], s71 offen offset:0 sc1
    v_pk_add_f32 v[180:181], v[180:181], v[244:245] neg_lo:[0,1] neg_hi:[0,1]
    v_pk_add_f32 v[182:183], v[182:183], v[246:247] neg_lo:[0,1] neg_hi:[0,1]
    v_pk_mul_f32 v[14:15], v[180:181], v[180:181]
    v_pk_mul_f32 v[16:17], v[182:183], v[182:183]
    v_pk_mul_f32 v[18:19], v[212:213], v[212:213]
    v_pk_mul_f32 v[20:21], v[214:215], v[214:215]
    v_pk_fma_f32 v[14:15], v[14:15], s[56:57], v[12:13]
    v_pk_fma_f32 v[16:17], v[16:17], s[56:57], v[12:13]
    v_pk_fma_f32 v[18:19], v[18:19], s[56:57], v[12:13]
    v_pk_fma_f32 v[20:21], v[20:21], s[56:57], v[12:13]
    v_pk_mul_f32 v[14:15], v[14:15], v[180:181]
    v_pk_mul_f32 v[16:17], v[16:17], v[182:183]
    v_pk_mul_f32 v[18:19], v[18:19], v[212:213]
    v_pk_mul_f32 v[20:21], v[20:21], v[214:215]
    v_exp_f32 v14, v14
    v_exp_f32 v15, v15
    v_exp_f32 v16, v16
    v_exp_f32 v17, v17
    v_exp_f32 v18, v18
    v_exp_f32 v19, v19
    v_exp_f32 v20, v20
    v_exp_f32 v21, v21
    v_pk_add_f32 v[14:15], v[14:15], s[58:59]
    v_pk_add_f32 v[16:17], v[16:17], s[58:59]
    v_pk_add_f32 v[18:19], v[18:19], s[58:59]
    v_pk_add_f32 v[20:21], v[20:21], s[58:59]
    v_rcp_f32 v14, v14
    v_rcp_f32 v15, v15
    v_rcp_f32 v16, v16
    v_rcp_f32 v17, v17
    v_rcp_f32 v18, v18
    v_rcp_f32 v19, v19
    v_rcp_f32 v20, v20
    v_rcp_f32 v21, v21
    v_pk_mul_f32 v[14:15], v[14:15], v[180:181]
    v_pk_mul_f32 v[16:17], v[16:17], v[182:183]
    v_pk_mul_f32 v[18:19], v[18:19], v[212:213]
    v_pk_mul_f32 v[20:21], v[20:21], v[214:215]
    v_cvt_pk_bf16_f32 v180, v14, v15
    v_cvt_pk_bf16_f32 v182, v18, v19
    v_cvt_pk_bf16_f32 v181, v16, v17
    v_cvt_pk_bf16_f32 v183, v20, v21
    s_nop 0
    v_permlane32_swap_b32 v180, v182
    v_permlane32_swap_b32 v181, v183
    buffer_store_dwordx4 v[180:183], v32, s[36:39], s71 offen offset:1024 sc1
    v_pk_add_f32 v[184:185], v[184:185], v[248:249] neg_lo:[0,1] neg_hi:[0,1]
    v_pk_add_f32 v[186:187], v[186:187], v[250:251] neg_lo:[0,1] neg_hi:[0,1]
    v_pk_mul_f32 v[14:15], v[184:185], v[184:185]
    v_pk_mul_f32 v[16:17], v[186:187], v[186:187]
    v_pk_mul_f32 v[18:19], v[216:217], v[216:217]
    v_pk_mul_f32 v[20:21], v[218:219], v[218:219]
    v_pk_fma_f32 v[14:15], v[14:15], s[56:57], v[12:13]
    v_pk_fma_f32 v[16:17], v[16:17], s[56:57], v[12:13]
    v_pk_fma_f32 v[18:19], v[18:19], s[56:57], v[12:13]
    v_pk_fma_f32 v[20:21], v[20:21], s[56:57], v[12:13]
    v_pk_mul_f32 v[14:15], v[14:15], v[184:185]
    v_pk_mul_f32 v[16:17], v[16:17], v[186:187]
    v_pk_mul_f32 v[18:19], v[18:19], v[216:217]
    v_pk_mul_f32 v[20:21], v[20:21], v[218:219]
    v_exp_f32 v14, v14
    v_exp_f32 v15, v15
    v_exp_f32 v16, v16
    v_exp_f32 v17, v17
    v_exp_f32 v18, v18
    v_exp_f32 v19, v19
    v_exp_f32 v20, v20
    v_exp_f32 v21, v21
    v_pk_add_f32 v[14:15], v[14:15], s[58:59]
    v_pk_add_f32 v[16:17], v[16:17], s[58:59]
    v_pk_add_f32 v[18:19], v[18:19], s[58:59]
    v_pk_add_f32 v[20:21], v[20:21], s[58:59]
    v_rcp_f32 v14, v14
    v_rcp_f32 v15, v15
    v_rcp_f32 v16, v16
    v_rcp_f32 v17, v17
    v_rcp_f32 v18, v18
    v_rcp_f32 v19, v19
    v_rcp_f32 v20, v20
    v_rcp_f32 v21, v21
    v_pk_mul_f32 v[14:15], v[14:15], v[184:185]
    v_pk_mul_f32 v[16:17], v[16:17], v[186:187]
    v_pk_mul_f32 v[18:19], v[18:19], v[216:217]
    v_pk_mul_f32 v[20:21], v[20:21], v[218:219]
    v_cvt_pk_bf16_f32 v184, v14, v15
    v_cvt_pk_bf16_f32 v186, v18, v19
    v_cvt_pk_bf16_f32 v185, v16, v17
    v_cvt_pk_bf16_f32 v187, v20, v21
    s_nop 0
    v_permlane32_swap_b32 v184, v186
    v_permlane32_swap_b32 v185, v187
    buffer_store_dwordx4 v[184:187], v32, s[36:39], s71 offen offset:2048 sc1
    v_pk_add_f32 v[188:189], v[188:189], v[252:253] neg_lo:[0,1] neg_hi:[0,1]
    v_pk_add_f32 v[190:191], v[190:191], v[254:255] neg_lo:[0,1] neg_hi:[0,1]
    v_pk_mul_f32 v[14:15], v[188:189], v[188:189]
    v_pk_mul_f32 v[16:17], v[190:191], v[190:191]
    v_pk_mul_f32 v[18:19], v[104:105], v[104:105]
    v_pk_mul_f32 v[20:21], v[106:107], v[106:107]
    v_pk_fma_f32 v[14:15], v[14:15], s[56:57], v[12:13]
    v_pk_fma_f32 v[16:17], v[16:17], s[56:57], v[12:13]
    v_pk_fma_f32 v[18:19], v[18:19], s[56:57], v[12:13]
    v_pk_fma_f32 v[20:21], v[20:21], s[56:57], v[12:13]
    v_pk_mul_f32 v[14:15], v[14:15], v[188:189]
    v_pk_mul_f32 v[16:17], v[16:17], v[190:191]
    v_pk_mul_f32 v[18:19], v[18:19], v[104:105]
    v_pk_mul_f32 v[20:21], v[20:21], v[106:107]
    v_exp_f32 v14, v14
    v_exp_f32 v15, v15
    v_exp_f32 v16, v16
    v_exp_f32 v17, v17
    v_exp_f32 v18, v18
    v_exp_f32 v19, v19
    v_exp_f32 v20, v20
    v_exp_f32 v21, v21
    v_pk_add_f32 v[14:15], v[14:15], s[58:59]
    v_pk_add_f32 v[16:17], v[16:17], s[58:59]
    v_pk_add_f32 v[18:19], v[18:19], s[58:59]
    v_pk_add_f32 v[20:21], v[20:21], s[58:59]
    v_rcp_f32 v14, v14
    v_rcp_f32 v15, v15
    v_rcp_f32 v16, v16
    v_rcp_f32 v17, v17
    v_rcp_f32 v18, v18
    v_rcp_f32 v19, v19
    v_rcp_f32 v20, v20
    v_rcp_f32 v21, v21
    v_pk_mul_f32 v[14:15], v[14:15], v[188:189]
    v_pk_mul_f32 v[16:17], v[16:17], v[190:191]
    v_pk_mul_f32 v[18:19], v[18:19], v[104:105]
    v_pk_mul_f32 v[20:21], v[20:21], v[106:107]
    v_cvt_pk_bf16_f32 v188, v14, v15
    v_cvt_pk_bf16_f32 v190, v18, v19
    v_cvt_pk_bf16_f32 v189, v16, v17
    v_cvt_pk_bf16_f32 v191, v20, v21
    s_nop 0
    v_permlane32_swap_b32 v188, v190
    v_permlane32_swap_b32 v189, v191
    buffer_store_dwordx4 v[188:191], v32, s[36:39], s71 offen offset:3072 sc1
    s_barrier
    ds_write_b128 v34, v[160:163] offset:3808
    ds_write_b128 v34, v[164:167] offset:4896
    ds_write_b128 v34, v[168:171] offset:5984
    ds_write_b128 v34, v[172:175] offset:7072
    ds_write_b128 v35, v[176:179] offset:8160
    v_cndmask_b32 v212, v180, 0, s[62:63]
    v_cndmask_b32 v213, v181, 0, s[62:63]
    v_cndmask_b32 v214, v182, 0, s[62:63]
    v_cndmask_b32 v215, v183, 0, s[62:63]
    ds_write_b128 v34, v[212:215] offset:576
    v_cndmask_b32 v216, v184, 0, s[62:63]
    v_cndmask_b32 v217, v185, 0, s[62:63]
    v_cndmask_b32 v218, v186, 0, s[62:63]
    v_cndmask_b32 v219, v187, 0, s[62:63]
    ds_write_b128 v34, v[216:219] offset:1664
    v_cndmask_b32 v220, v188, 0, s[62:63]
    v_cndmask_b32 v221, v189, 0, s[62:63]
    v_cndmask_b32 v222, v190, 0, s[62:63]
    v_cndmask_b32 v223, v191, 0, s[62:63]
    ds_write_b128 v34, v[220:223] offset:2752
    v_mov_b32 v16, 0xbf00bf00
    v_mov_b32 v17, 0xbf00bf00
    v_mov_b32 v18, 0xbf00bf00
    v_mov_b32 v19, 0xbf00bf00
    s_waitcnt lgkmcnt(0)
    s_barrier
    s_waitcnt vmcnt(35)
    v_mfma_f32_16x16x32_bf16 v[24:27], v[16:19], a[0:3], 0
    s_add_u32 s55, s6, 0
    buffer_load_dwordx4 a[176:179], v36, s[36:39], s55 offen offset:0 sc1
    v_mfma_f32_16x16x32_bf16 v[24:27], v[16:19], a[4:7], v[24:27]
    v_lshrrev_b32 v20, 4, v0
    v_mfma_f32_16x16x32_bf16 v[24:27], v[16:19], a[8:11], v[24:27]
    v_min_u32 v20, 2, v20
    v_mfma_f32_16x16x32_bf16 v[24:27], v[16:19], a[12:15], v[24:27]
    v_add_u32 v14, 52224, v10
    v_mfma_f32_16x16x32_bf16 v[24:27], v[16:19], a[16:19], v[24:27]
    s_sub_u32 s62, s52, 1
    v_mfma_f32_16x16x32_bf16 v[24:27], v[16:19], a[20:23], v[24:27]
    v_add_u32 v15, 104448, v10
    v_add_u32 v20, s62, v20
    v_mfma_f32_16x16x32_bf16 v[24:27], v[16:19], a[24:27], v[24:27]
    buffer_load_dwordx4 a[180:183], v36, s[36:39], s55 offen offset:1024 sc1
    v_mfma_f32_16x16x32_bf16 v[24:27], v[16:19], a[28:31], v[24:27]
    v_max_i32 v20, 0, v20
    v_mfma_f32_16x16x32_bf16 v[28:31], v[16:19], a[32:35], 0
    v_mfma_f32_16x16x32_bf16 v[28:31], v[16:19], a[36:39], v[28:31]
    v_min_u32 v20, 31, v20
    v_mfma_f32_16x16x32_bf16 v[28:31], v[16:19], a[40:43], v[28:31]
    s_lshl_b32 s62, s51, 5
    v_mfma_f32_16x16x32_bf16 v[28:31], v[16:19], a[44:47], v[28:31]
    ds_read_b128 v[192:195], v10 offset:4352
    v_add_u32 v20, s62, v20
    v_mfma_f32_16x16x32_bf16 v[28:31], v[16:19], a[48:51], v[28:31]
    buffer_load_dwordx4 a[184:187], v36, s[36:39], s55 offen offset:2048 sc1
    v_mov_b32 v34, v24
    v_mfma_f32_16x16x32_bf16 v[28:31], v[16:19], a[52:55], v[28:31]
    ds_read_b128 v[196:199], v10 offset:5440
    v_mfma_f32_16x16x32_bf16 v[28:31], v[16:19], a[56:59], v[28:31]
    v_mul_u32_u24 v20, 2048, v20
    v_mfma_f32_16x16x32_bf16 v[28:31], v[16:19], a[60:63], v[28:31]
    ds_read_b128 v[200:203], v10 offset:6528
    v_mfma_f32_16x16x32_bf16 v[24:27], v[16:19], a[64:67], 0
    v_and_b32 v21, 3, v0
    v_mfma_f32_16x16x32_bf16 v[24:27], v[16:19], a[68:71], v[24:27]
    ds_read_b128 v[204:207], v10 offset:7616
    v_mfma_f32_16x16x32_bf16 v[24:27], v[16:19], a[72:75], v[24:27]
    buffer_load_dwordx4 a[192:195], v36, s[36:39], s55 offen offset:3072 sc1
    v_lshl_add_u32 v20, v21, 7, v20
    v_mfma_f32_16x16x32_bf16 v[24:27], v[16:19], a[76:79], v[24:27]
    v_mfma_f32_16x16x32_bf16 v[24:27], v[16:19], a[80:83], v[24:27]
    v_mov_b32 v35, v28
    v_add_u32 v11, 4194304, v20
    v_mfma_f32_16x16x32_bf16 v[24:27], v[16:19], a[84:87], v[24:27]
    s_lshl_b32 s62, s49, 1
    v_mfma_f32_16x16x32_bf16 v[24:27], v[16:19], a[88:91], v[24:27]
    s_add_u32 s62, s62, 2
    ds_read_b128 v[208:211], v10 offset:32
    v_mfma_f32_16x16x32_bf16 v[24:27], v[16:19], a[92:95], v[24:27]
    s_and_b32 s62, s62, 7
    v_mfma_f32_16x16x32_bf16 v[28:31], v[16:19], a[96:99], 0
    s_add_u32 s55, s6, 4096
    s_lshl_b32 s63, s62, 14
    buffer_load_dwordx4 a[196:199], v36, s[36:39], s55 offen offset:0 sc1
    v_mfma_f32_16x16x32_bf16 v[28:31], v[16:19], a[100:103], v[28:31]
    s_add_u32 s14, s63, s77
    s_lshl_b32 s62, s49, 1
    v_mfma_f32_16x16x32_bf16 v[28:31], v[16:19], a[104:107], v[28:31]
    s_add_u32 s62, s62, 3
    v_mfma_f32_16x16x32_bf16 v[28:31], v[16:19], a[108:111], v[28:31]
    s_and_b32 s62, s62, 7
    s_lshl_b32 s63, s62, 14
    v_mfma_f32_16x16x32_bf16 v[28:31], v[16:19], a[112:115], v[28:31]
    ds_read_b128 v[212:215], v10 offset:1120
    v_mov_b32 v32, v24
    s_add_u32 s15, s63, s77
    v_mfma_f32_16x16x32_bf16 v[28:31], v[16:19], a[116:119], v[28:31]
    s_lshl_b32 s62, s49, 1
    s_add_u32 s62, s62, 4
    v_mfma_f32_16x16x32_bf16 v[28:31], v[16:19], a[120:123], v[28:31]
    buffer_load_dwordx4 a[200:203], v36, s[36:39], s55 offen offset:1024 sc1
    v_mfma_f32_16x16x32_bf16 v[28:31], v[16:19], a[124:127], v[28:31]
    s_waitcnt vmcnt(36) lgkmcnt(2)
    s_and_b32 s62, s62, 7
    s_lshl_b32 s63, s62, 14
    v_mfma_f32_16x16x32_bf16 v[160:163], a[208:211], v[192:195], 0
    s_add_u32 s16, s63, s77
    s_lshl_b32 s62, s49, 1
    v_mfma_f32_16x16x32_bf16 v[160:163], a[212:215], v[196:199], v[160:163]
    s_add_u32 s62, s62, 5
    v_mfma_f32_16x16x32_bf16 v[160:163], a[216:219], v[200:203], v[160:163]
    s_and_b32 s62, s62, 7
    s_lshl_b32 s63, s62, 14
    v_mfma_f32_16x16x32_bf16 v[160:163], a[220:223], v[204:207], v[160:163]
    s_add_u32 s17, s63, s77
    ds_read_b128 v[216:219], v10 offset:2208
    v_mfma_f32_16x16x32_bf16 v[164:167], a[224:227], v[192:195], 0
    buffer_load_dwordx4 a[204:207], v36, s[36:39], s55 offen offset:2048 sc1
    v_mov_b32 v33, v28
    s_lshl_b32 s62, s49, 1
    v_mfma_f32_16x16x32_bf16 v[164:167], a[208:211], v[196:199], v[164:167]
    s_add_u32 s62, s62, 6
    v_mfma_f32_16x16x32_bf16 v[164:167], a[212:215], v[200:203], v[164:167]
    s_and_b32 s62, s62, 7
    s_lshl_b32 s63, s62, 14
    v_mfma_f32_16x16x32_bf16 v[164:167], a[216:219], v[204:207], v[164:167]
    s_waitcnt lgkmcnt(1)
    s_add_u32 s20, s63, s77
    s_lshl_b32 s62, s49, 1
    v_mfma_f32_16x16x32_bf16 v[164:167], a[220:223], v[208:211], v[164:167]
    s_cmp_eq_u32 s48, 0
    s_cselect_b32 s68, s68, 2147483648
    v_mfma_f32_16x16x32_bf16 v[168:171], a[228:231], v[192:195], 0
    s_add_u32 s62, s62, 7
    s_and_b32 s62, s62, 7
    v_mfma_f32_16x16x32_bf16 v[168:171], a[224:227], v[196:199], v[168:171]
    s_lshl_b32 s63, s62, 14
    buffer_load_dwordx4 v[40:43], v36, s[36:39], s55 offen offset:3072 sc1
    v_mfma_f32_16x16x32_bf16 v[168:171], a[208:211], v[200:203], v[168:171]
    s_add_u32 s21, s63, s77
    v_mfma_f32_16x16x32_bf16 v[168:171], a[212:215], v[204:207], v[168:171]
    v_mfma_f32_16x16x32_bf16 v[168:171], a[216:219], v[208:211], v[168:171]
    s_cmp_eq_u32 s52, 0
    s_cselect_b32 s72, 2147483648, 0
    v_mov_b32 v24, s72
    v_mfma_f32_16x16x32_bf16 v[168:171], a[220:223], v[212:215], v[168:171]
    v_mov_b32 v25, 0x20000
    s_cmp_eq_u32 s52, 31
    s_cselect_b32 s72, 1, 0
    v_mfma_f32_16x16x32_bf16 v[172:175], a[232:235], v[192:195], 0
    s_lshl_b32 s72, s72, 31
    s_add_u32 s72, s72, 0x40000
    v_mov_b32 v26, s72
    v_mfma_f32_16x16x32_bf16 v[172:175], a[228:231], v[196:199], v[172:175]
    s_lshl_b32 s73, s48, 6
    s_mov_b32 s72, 1928
    ds_read_b128 v[220:223], v10 offset:3296
    v_mfma_f32_16x16x32_bf16 v[172:175], a[224:227], v[200:203], v[172:175]
    s_add_u32 s55, s6, 8192
    buffer_load_dwordx4 v[44:47], v36, s[36:39], s55 offen offset:0 sc1
    v_lshrrev_b32 v20, 1, v0
    v_mfma_f32_16x16x32_bf16 v[172:175], a[208:211], v[204:207], v[172:175]
    ds_read_b128 v[224:227], v10 offset:4384
    v_cmp_lt_u32 vcc, 7, v20
    v_mfma_f32_16x16x32_bf16 v[172:175], a[212:215], v[208:211], v[172:175]
    s_waitcnt vmcnt(9)
    s_barrier
    buffer_store_dword v38, v39, s[36:39], s68 offen sc1
    v_mfma_f32_16x16x32_bf16 v[172:175], a[216:219], v[212:215], v[172:175]
    s_waitcnt lgkmcnt(2)
    v_lshlrev_b32 v21, 1, v20
    v_add_u32 v21, 241, v21
    v_mfma_f32_16x16x32_bf16 v[172:175], a[220:223], v[216:219], v[172:175]
    v_cndmask_b32 v20, v20, v21, vcc
    v_cmp_eq_u32 vcc, 7, v20
    v_mfma_f32_16x16x32_bf16 v[176:179], a[240:243], v[192:195], 0
    buffer_load_dwordx4 v[48:51], v36, s[36:39], s55 offen offset:1024 sc1
    v_and_b32 v22, 1, v0
    v_mfma_f32_16x16x32_bf16 v[176:179], a[232:235], v[196:199], v[176:179]
    v_mov_b32 v21, 262
    v_cndmask_b32 v20, v20, v21, vcc
    v_mfma_f32_16x16x32_bf16 v[176:179], a[228:231], v[200:203], v[176:179]
    v_lshlrev_b32 v22, 4, v22
    v_and_b32 v21, 15, v20
    v_mfma_f32_16x16x32_bf16 v[176:179], a[224:227], v[204:207], v[176:179]
    v_mul_u32_u24 v21, 544, v21
    v_lshrrev_b32 v23, 4, v20
    v_mfma_f32_16x16x32_bf16 v[176:179], a[208:211], v[208:211], v[176:179]
    ds_read_b128 v[228:231], v10 offset:5472
    v_lshl_add_u32 v21, v23, 5, v21
    v_mfma_f32_16x16x32_bf16 v[176:179], a[212:215], v[212:215], v[176:179]
    v_add3_u32 v21, v21, v22, s22
    v_cmp_gt_u32 vcc, 16, v0
    v_mfma_f32_16x16x32_bf16 v[176:179], a[216:219], v[216:219], v[176:179]
    buffer_load_dwordx4 v[52:55], v36, s[36:39], s55 offen offset:2048 sc1
    v_mov_b32 v23, 155648
    s_nop 0
    v_mfma_f32_16x16x32_bf16 v[180:183], a[240:243], v[196:199], 0
    v_cndmask_b32 v8, v23, v21, vcc
    v_cndmask_b32 v27, v37, v22, vcc
    v_mfma_f32_16x16x32_bf16 v[180:183], a[232:235], v[200:203], v[180:183]
    ds_read_b128 v[232:235], v10 offset:6560
    v_and_b32 v20, 0x1ff, v20
    v_mfma_f32_16x16x32_bf16 v[180:183], a[228:231], v[204:207], v[180:183]
    v_subrev_u32 v20, 7, v20
    v_cmp_gt_i32 vcc, 0, v20
    v_mfma_f32_16x16x32_bf16 v[180:183], a[224:227], v[208:211], v[180:183]
    ds_read_b128 v[236:239], v10 offset:3808
    v_add_u32 v21, 250, v20
    v_mfma_f32_16x16x32_bf16 v[180:183], a[208:211], v[212:215], v[180:183]
    s_nop 0
    v_cndmask_b32 v20, v20, v21, vcc
    v_cndmask_b32 v23, v25, v24, vcc
    v_mfma_f32_16x16x32_bf16 v[180:183], a[212:215], v[216:219], v[180:183]
    s_waitcnt lgkmcnt(3)
    ds_read_b128 v[240:243], v10 offset:4896
    v_cmp_le_u32 vcc, 250, v20
    v_mfma_f32_16x16x32_bf16 v[180:183], a[216:219], v[220:223], v[180:183]
    buffer_load_dwordx4 v[56:59], v36, s[36:39], s55 offen offset:3072 sc1
    v_subrev_u32 v21, 250, v20
    v_mfma_f32_16x16x32_bf16 v[180:183], a[220:223], v[224:227], v[180:183]
    ds_read_b128 v[244:247], v10 offset:5984
    s_nop 0
    v_cndmask_b32 v20, v20, v21, vcc
    v_mfma_f32_16x16x32_bf16 v[184:187], a[240:243], v[200:203], 0
    v_cndmask_b32 v23, v23, v26, vcc
    v_and_b32 v21, 15, v20
    v_mfma_f32_16x16x32_bf16 v[184:187], a[232:235], v[204:207], v[184:187]
    ds_read_b128 v[248:251], v10 offset:7072
    v_lshl_add_u32 v22, v21, 9, v22
    v_mfma_f32_16x16x32_bf16 v[184:187], a[228:231], v[208:211], v[184:187]
    v_lshrrev_b32 v20, 4, v20
    v_mfma_f32_16x16x32_bf16 v[184:187], a[224:227], v[212:215], v[184:187]
    s_add_u32 s55, s6, 12288
    buffer_load_dwordx4 v[60:63], v36, s[36:39], s55 offen offset:0 sc1
    v_lshl_add_u32 v22, v20, 5, v22
    v_mfma_f32_16x16x32_bf16 v[184:187], a[208:211], v[216:219], v[184:187]
    v_add_u32 v7, v22, v23
    v_or_b32 v7, v27, v7
    v_mfma_f32_16x16x32_bf16 v[184:187], a[212:215], v[220:223], v[184:187]
    v_add_u32 v20, s73, v0
    v_add_u32 v20, 0, v20
    v_mfma_f32_16x16x32_bf16 v[184:187], a[216:219], v[224:227], v[184:187]
    s_waitcnt lgkmcnt(3)
    ds_read_b128 v[252:255], v10 offset:8160
    v_cmp_le_u32 vcc, 544, v20
    v_mfma_f32_16x16x32_bf16 v[184:187], a[220:223], v[228:231], v[184:187]
    v_subrev_u32 v21, 544, v20
    v_mov_b32 v22, 8192
    v_mfma_f32_16x16x32_bf16 v[188:191], a[240:243], v[204:207], 0
    v_cndmask_b32 v20, v20, v21, vcc
    v_cndmask_b32 v22, 0, v22, vcc
    v_mfma_f32_16x16x32_bf16 v[188:191], a[232:235], v[208:211], v[188:191]
    buffer_load_dwordx4 v[64:67], v36, s[36:39], s55 offen offset:1024 sc1
    v_mul_u32_u24 v21, s72, v20
    v_mfma_f32_16x16x32_bf16 v[188:191], a[228:231], v[212:215], v[188:191]
    v_lshrrev_b32 v21, 16, v21
    v_mul_u32_u24 v23, 34, v21
    v_mfma_f32_16x16x32_bf16 v[188:191], a[224:227], v[216:219], v[188:191]
    v_sub_u32 v20, v20, v23
    v_and_b32 v23, 1, v20
    v_mfma_f32_16x16x32_bf16 v[188:191], a[208:211], v[220:223], v[188:191]
    ds_read_b128 v[192:195], v10 offset:576
    v_lshl_add_u32 v22, v23, 4, v22
    v_mfma_f32_16x16x32_bf16 v[188:191], a[212:215], v[224:227], v[188:191]
    v_lshrrev_b32 v20, 1, v20
    v_lshl_add_u32 v20, v20, 4, v21
    v_mfma_f32_16x16x32_bf16 v[188:191], a[216:219], v[228:231], v[188:191]
    v_subrev_u32 v20, 7, v20
    v_cmp_gt_i32 vcc, 0, v20
    v_mfma_f32_16x16x32_bf16 v[188:191], a[220:223], v[232:235], v[188:191]
    buffer_load_dwordx4 a[208:211], v36, s[36:39], s55 offen offset:2048 sc1
    v_add_u32 v21, 250, v20
    v_mfma_f32_16x16x32_bf16 v[160:163], a[236:239], v[236:239], v[160:163]
    s_nop 0
    v_cndmask_b32 v20, v20, v21, vcc
    s_waitcnt lgkmcnt(1)
    v_mfma_f32_16x16x32_bf16 v[160:163], a[244:247], v[240:243], v[160:163]
    v_cndmask_b32 v23, v25, v24, vcc
    v_cmp_le_u32 vcc, 250, v20
    v_mfma_f32_16x16x32_bf16 v[160:163], a[248:251], v[244:247], v[160:163]
    v_subrev_u32 v21, 250, v20
    s_nop 0
    v_cndmask_b32 v20, v20, v21, vcc
    v_mfma_f32_16x16x32_bf16 v[160:163], a[252:255], v[248:251], v[160:163]
    ds_read_b128 v[196:199], v10 offset:1664
    v_cndmask_b32 v23, v23, v26, vcc
    v_mfma_f32_16x16x32_bf16 v[164:167], a[156:159], v[236:239], v[164:167]
    v_and_b32 v21, 15, v20
    v_lshl_add_u32 v22, v21, 9, v22
    v_mfma_f32_16x16x32_bf16 v[164:167], a[236:239], v[240:243], v[164:167]
    s_add_u32 s55, s7, 0
    buffer_load_dwordx4 a[212:215], v36, s[36:39], s55 offen offset:0 sc1
    v_lshrrev_b32 v20, 4, v20
    v_mfma_f32_16x16x32_bf16 v[164:167], a[244:247], v[244:247], v[164:167]
    v_lshl_add_u32 v22, v20, 5, v22
    v_add_u32 v2, v22, v23
    v_mfma_f32_16x16x32_bf16 v[164:167], a[248:251], v[248:251], v[164:167]
    v_add_u32 v20, s73, v0
    v_add_u32 v20, 256, v20
    v_mfma_f32_16x16x32_bf16 v[164:167], a[252:255], v[252:255], v[164:167]
    v_cmp_le_u32 vcc, 544, v20
    v_subrev_u32 v21, 544, v20
    v_mfma_f32_16x16x32_bf16 v[168:171], a[128:131], v[236:239], v[168:171]
    v_mov_b32 v22, 8192
    v_cndmask_b32 v20, v20, v21, vcc
    v_mfma_f32_16x16x32_bf16 v[168:171], a[156:159], v[240:243], v[168:171]
    ds_read_b128 v[200:203], v10 offset:2752
    v_cndmask_b32 v22, 0, v22, vcc
    v_mfma_f32_16x16x32_bf16 v[168:171], a[236:239], v[244:247], v[168:171]
    buffer_load_dwordx4 a[216:219], v36, s[36:39], s55 offen offset:1024 sc1
    v_mul_u32_u24 v21, s72, v20
    v_mfma_f32_16x16x32_bf16 v[168:171], a[244:247], v[248:251], v[168:171]
    v_lshrrev_b32 v21, 16, v21
    v_mul_u32_u24 v23, 34, v21
    v_mfma_f32_16x16x32_bf16 v[168:171], a[248:251], v[252:255], v[168:171]
    s_waitcnt lgkmcnt(1)
    v_sub_u32 v20, v20, v23
    v_and_b32 v23, 1, v20
    v_mfma_f32_16x16x32_bf16 v[168:171], a[252:255], v[192:195], v[168:171]
    v_lshl_add_u32 v22, v23, 4, v22
    v_lshrrev_b32 v20, 1, v20
    v_mfma_f32_16x16x32_bf16 v[172:175], a[188:191], v[236:239], v[172:175]
    v_lshl_add_u32 v20, v20, 4, v21
    v_subrev_u32 v20, 7, v20
    v_mfma_f32_16x16x32_bf16 v[172:175], a[128:131], v[240:243], v[172:175]
    v_cmp_gt_i32 vcc, 0, v20
    v_add_u32 v21, 250, v20
    v_mfma_f32_16x16x32_bf16 v[172:175], a[156:159], v[244:247], v[172:175]
    ds_read_b128 v[204:207], v10 offset:3840
    s_nop 0
    v_cndmask_b32 v20, v20, v21, vcc
    v_mfma_f32_16x16x32_bf16 v[172:175], a[236:239], v[248:251], v[172:175]
    buffer_load_dwordx4 v[68:71], v36, s[36:39], s55 offen offset:2048 sc1
    v_cndmask_b32 v23, v25, v24, vcc
    v_mfma_f32_16x16x32_bf16 v[172:175], a[244:247], v[252:255], v[172:175]
    v_cmp_le_u32 vcc, 250, v20
    v_subrev_u32 v21, 250, v20
    v_mfma_f32_16x16x32_bf16 v[172:175], a[248:251], v[192:195], v[172:175]
    s_nop 0
    v_cndmask_b32 v20, v20, v21, vcc
    v_mfma_f32_16x16x32_bf16 v[172:175], a[252:255], v[196:199], v[172:175]
    v_cndmask_b32 v23, v23, v26, vcc
    v_and_b32 v21, 15, v20
    v_mfma_f32_16x16x32_bf16 v[176:179], a[188:191], v[240:243], v[176:179]
    v_lshl_add_u32 v22, v21, 9, v22
    v_lshrrev_b32 v20, 4, v20
    v_mfma_f32_16x16x32_bf16 v[176:179], a[128:131], v[244:247], v[176:179]
    buffer_load_dwordx4 v[72:75], v36, s[36:39], s55 offen offset:3072 sc1
    v_lshl_add_u32 v22, v20, 5, v22
    v_mfma_f32_16x16x32_bf16 v[176:179], a[156:159], v[248:251], v[176:179]
    ds_read_b128 v[208:211], v10 offset:4928
    v_add_u32 v3, v22, v23
    v_mfma_f32_16x16x32_bf16 v[176:179], a[236:239], v[252:255], v[176:179]
    v_add_u32 v20, s73, v0
    v_add_u32 v20, 512, v20
    v_mfma_f32_16x16x32_bf16 v[176:179], a[244:247], v[192:195], v[176:179]
    v_cmp_le_u32 vcc, 544, v20
    v_subrev_u32 v21, 544, v20
    v_mfma_f32_16x16x32_bf16 v[176:179], a[248:251], v[196:199], v[176:179]
    s_waitcnt lgkmcnt(1)
    ds_read_b128 v[212:215], v10 offset:6016
    v_mov_b32 v22, 8192
    v_mfma_f32_16x16x32_bf16 v[176:179], a[252:255], v[200:203], v[176:179]
    v_cndmask_b32 v20, v20, v21, vcc
    v_cndmask_b32 v22, 0, v22, vcc
    v_mfma_f32_16x16x32_bf16 v[180:183], a[188:191], v[244:247], v[180:183]
    ds_read_b128 v[216:219], v10 offset:21760
    v_mul_u32_u24 v21, s72, v20
    v_mfma_f32_16x16x32_bf16 v[180:183], a[128:131], v[248:251], v[180:183]
    s_add_u32 s55, s7, 4096
    buffer_load_dwordx4 v[76:79], v36, s[36:39], s55 offen offset:0 sc1
    v_lshrrev_b32 v21, 16, v21
    v_mfma_f32_16x16x32_bf16 v[180:183], a[156:159], v[252:255], v[180:183]
    ds_read_b128 v[220:223], v10 offset:22848
    v_mul_u32_u24 v23, 34, v21
    v_mfma_f32_16x16x32_bf16 v[180:183], a[236:239], v[192:195], v[180:183]
    v_sub_u32 v20, v20, v23
    v_and_b32 v23, 1, v20
    v_mfma_f32_16x16x32_bf16 v[180:183], a[244:247], v[196:199], v[180:183]
    ds_read_b128 v[224:227], v10 offset:23936
    v_lshl_add_u32 v22, v23, 4, v22
    v_mfma_f32_16x16x32_bf16 v[180:183], a[248:251], v[200:203], v[180:183]
    v_lshrrev_b32 v20, 1, v20
    v_lshl_add_u32 v20, v20, 4, v21
    v_mfma_f32_16x16x32_bf16 v[180:183], a[252:255], v[204:207], v[180:183]
    ds_read_b128 v[228:231], v10 offset:25024
    v_subrev_u32 v20, 7, v20
    v_mfma_f32_16x16x32_bf16 v[184:187], a[188:191], v[248:251], v[184:187]
    buffer_load_dwordx4 v[80:83], v36, s[36:39], s55 offen offset:1024 sc1
    v_cmp_gt_i32 vcc, 0, v20
    v_mfma_f32_16x16x32_bf16 v[184:187], a[128:131], v[252:255], v[184:187]
    v_add_u32 v21, 250, v20
    s_nop 0
    v_cndmask_b32 v20, v20, v21, vcc
    v_mfma_f32_16x16x32_bf16 v[184:187], a[156:159], v[192:195], v[184:187]
    v_cndmask_b32 v23, v25, v24, vcc
    v_cmp_le_u32 vcc, 250, v20
    v_mfma_f32_16x16x32_bf16 v[184:187], a[236:239], v[196:199], v[184:187]
    v_subrev_u32 v21, 250, v20
    s_nop 0
    v_mfma_f32_16x16x32_bf16 v[184:187], a[244:247], v[200:203], v[184:187]
    ds_read_b128 v[232:235], v10 offset:17440
    v_cndmask_b32 v20, v20, v21, vcc
    v_mfma_f32_16x16x32_bf16 v[184:187], a[248:251], v[204:207], v[184:187]
    s_waitcnt lgkmcnt(3)
    buffer_load_dwordx4 v[84:87], v36, s[36:39], s55 offen offset:2048 sc1
    v_cndmask_b32 v23, v23, v26, vcc
    v_mfma_f32_16x16x32_bf16 v[184:187], a[252:255], v[208:211], v[184:187]
    v_and_b32 v21, 15, v20
    v_lshl_add_u32 v22, v21, 9, v22
    v_mfma_f32_16x16x32_bf16 v[188:191], a[188:191], v[252:255], v[188:191]
    v_lshrrev_b32 v20, 4, v20
    v_lshl_add_u32 v22, v20, 5, v22
    v_mfma_f32_16x16x32_bf16 v[188:191], a[128:131], v[192:195], v[188:191]
    v_add_u32 v4, v22, v23
    v_add_u32 v20, s73, v0
    v_mfma_f32_16x16x32_bf16 v[188:191], a[156:159], v[196:199], v[188:191]
    v_add_u32 v20, 768, v20
    v_cmp_le_u32 vcc, 544, v20
    v_mfma_f32_16x16x32_bf16 v[188:191], a[236:239], v[200:203], v[188:191]
    ds_read_b128 v[236:239], v10 offset:18528
    v_subrev_u32 v21, 544, v20
    v_mfma_f32_16x16x32_bf16 v[188:191], a[244:247], v[204:207], v[188:191]
    buffer_load_dwordx4 a[236:239], v36, s[36:39], s55 offen offset:3072 sc1
    v_mov_b32 v22, 8192
    v_mfma_f32_16x16x32_bf16 v[188:191], a[248:251], v[208:211], v[188:191]
    v_cndmask_b32 v20, v20, v21, vcc
    v_cndmask_b32 v22, 0, v22, vcc
    v_mfma_f32_16x16x32_bf16 v[188:191], a[252:255], v[212:215], v[188:191]
    buffer_load_dword v29, v11, s[36:39], 0 offen sc1
    v_mul_u32_u24 v21, s72, v20
    v_mfma_f32_16x16x32_bf16 v[160:163], v[108:111], v[216:219], v[160:163]
    v_lshrrev_b32 v21, 16, v21
    v_mul_u32_u24 v23, 34, v21
    v_mfma_f32_16x16x32_bf16 v[160:163], v[112:115], v[220:223], v[160:163]
    s_waitcnt lgkmcnt(1)
    v_sub_u32 v20, v20, v23
    v_and_b32 v23, 1, v20
    v_mfma_f32_16x16x32_bf16 v[160:163], a[132:135], v[224:227], v[160:163]
    v_lshl_add_u32 v22, v23, 4, v22
    v_lshrrev_b32 v20, 1, v20
    v_mfma_f32_16x16x32_bf16 v[160:163], a[140:143], v[228:231], v[160:163]
    ds_read_b128 v[240:243], v10 offset:19616
    v_lshl_add_u32 v20, v20, 4, v21
    v_mfma_f32_16x16x32_bf16 v[164:167], a[144:147], v[216:219], v[164:167]
    s_add_u32 s55, s7, 8192
    buffer_load_dwordx4 a[244:247], v36, s[36:39], s55 offen offset:0 sc1
    v_subrev_u32 v20, 7, v20
    v_mfma_f32_16x16x32_bf16 v[164:167], v[108:111], v[220:223], v[164:167]
    v_cmp_gt_i32 vcc, 0, v20
    v_add_u32 v21, 250, v20
    v_mfma_f32_16x16x32_bf16 v[164:167], v[112:115], v[224:227], v[164:167]
    s_nop 0
    v_cndmask_b32 v20, v20, v21, vcc
    v_cndmask_b32 v23, v25, v24, vcc
    v_mfma_f32_16x16x32_bf16 v[164:167], a[132:135], v[228:231], v[164:167]
    v_cmp_le_u32 vcc, 250, v20
    v_subrev_u32 v21, 250, v20
    v_mfma_f32_16x16x32_bf16 v[164:167], a[140:143], v[232:235], v[164:167]
    s_nop 0
    v_cndmask_b32 v20, v20, v21, vcc
    v_mfma_f32_16x16x32_bf16 v[168:171], v[116:119], v[216:219], v[168:171]
    buffer_load_dwordx4 a[248:251], v36, s[36:39], s55 offen offset:1024 sc1
    v_cndmask_b32 v23, v23, v26, vcc
    v_mfma_f32_16x16x32_bf16 v[168:171], a[144:147], v[220:223], v[168:171]
    v_and_b32 v21, 15, v20
    v_lshl_add_u32 v22, v21, 9, v22
    v_mfma_f32_16x16x32_bf16 v[168:171], v[108:111], v[224:227], v[168:171]
    v_lshrrev_b32 v20, 4, v20
    v_lshl_add_u32 v22, v20, 5, v22
    v_mfma_f32_16x16x32_bf16 v[168:171], v[112:115], v[228:231], v[168:171]
    v_add_u32 v5, v22, v23
    v_add_u32 v20, 1024, v0
    v_mfma_f32_16x16x32_bf16 v[168:171], a[132:135], v[232:235], v[168:171]
    s_waitcnt lgkmcnt(0)
    v_cmp_le_u32 vcc, 544, v20
    v_subrev_u32 v21, 544, v20
    v_mfma_f32_16x16x32_bf16 v[168:171], a[140:143], v[236:239], v[168:171]
    v_mov_b32 v22, 8192
    v_cndmask_b32 v20, v20, v21, vcc
    v_mfma_f32_16x16x32_bf16 v[172:175], v[124:127], v[216:219], v[172:175]
    buffer_load_dwordx4 a[252:255], v36, s[36:39], s55 offen offset:2048 sc1
    v_cndmask_b32 v22, 0, v22, vcc
    v_mfma_f32_16x16x32_bf16 v[172:175], v[116:119], v[220:223], v[172:175]
    ds_read_b128 v[244:247], v10 offset:20704
    v_mul_u32_u24 v21, s72, v20
    v_mfma_f32_16x16x32_bf16 v[172:175], a[144:147], v[224:227], v[172:175]
    v_lshrrev_b32 v21, 16, v21
    v_mul_u32_u24 v23, 34, v21
    v_mfma_f32_16x16x32_bf16 v[172:175], v[108:111], v[228:231], v[172:175]
    ds_read_b128 v[248:251], v10 offset:21792
    v_sub_u32 v20, v20, v23
    v_mfma_f32_16x16x32_bf16 v[172:175], v[112:115], v[232:235], v[172:175]
    v_and_b32 v23, 1, v20
    v_lshl_add_u32 v22, v23, 4, v22
    v_mfma_f32_16x16x32_bf16 v[172:175], a[132:135], v[236:239], v[172:175]
    v_lshrrev_b32 v20, 1, v20
    v_lshl_add_u32 v20, v20, 4, v21
    v_mfma_f32_16x16x32_bf16 v[172:175], a[140:143], v[240:243], v[172:175]
    buffer_load_dwordx4 v[88:91], v36, s[36:39], s55 offen offset:3072 sc1
    v_subrev_u32 v20, 7, v20
    v_mfma_f32_16x16x32_bf16 v[176:179], v[128:131], v[216:219], v[176:179]
    v_cmp_gt_i32 vcc, 0, v20
    v_add_u32 v21, 250, v20
    v_mfma_f32_16x16x32_bf16 v[176:179], v[124:127], v[220:223], v[176:179]
    s_nop 0
    v_cndmask_b32 v20, v20, v21, vcc
    v_cndmask_b32 v23, v25, v24, vcc
    v_mfma_f32_16x16x32_bf16 v[176:179], v[116:119], v[224:227], v[176:179]
    v_cmp_le_u32 vcc, 250, v20
    v_subrev_u32 v21, 250, v20
    v_mfma_f32_16x16x32_bf16 v[176:179], a[144:147], v[228:231], v[176:179]
    s_nop 0
    v_cndmask_b32 v20, v20, v21, vcc
    v_mfma_f32_16x16x32_bf16 v[176:179], v[108:111], v[232:235], v[176:179]
    ds_read_b128 v[252:255], v10 offset:22880
    v_cndmask_b32 v23, v23, v26, vcc
    v_mfma_f32_16x16x32_bf16 v[176:179], v[112:115], v[236:239], v[176:179]
    s_add_u32 s55, s7, 12288
    buffer_load_dwordx4 v[92:95], v36, s[36:39], s55 offen offset:0 sc1
    v_and_b32 v21, 15, v20
    v_mfma_f32_16x16x32_bf16 v[176:179], a[132:135], v[240:243], v[176:179]
    v_lshl_add_u32 v22, v21, 9, v22
    v_lshrrev_b32 v20, 4, v20
    v_mfma_f32_16x16x32_bf16 v[180:183], v[128:131], v[220:223], v[180:183]
    v_lshl_add_u32 v22, v20, 5, v22
    v_add_u32 v6, v22, v23
    v_mfma_f32_16x16x32_bf16 v[180:183], v[124:127], v[224:227], v[180:183]
    s_lshl_b32 s62, s49, 1
    s_add_u32 s62, s62, s48
    ds_read_b128 v[192:195], v10 offset:23968
    v_mfma_f32_16x16x32_bf16 v[180:183], v[116:119], v[228:231], v[180:183]
    s_add_u32 s62, s62, 2
    s_and_b32 s62, s62, 7
    s_lshl_b32 s63, s62, 14
    v_mfma_f32_16x16x32_bf16 v[180:183], a[144:147], v[232:235], v[180:183]
    s_add_u32 s22, s63, s77
    s_lshl_b32 s62, s49, 1
    ds_read_b128 v[196:199], v10 offset:21216
    v_mfma_f32_16x16x32_bf16 v[180:183], v[108:111], v[236:239], v[180:183]
    s_and_b32 s63, s48, 1
    s_add_u32 s62, s62, s63
    buffer_load_dwordx4 v[96:99], v36, s[36:39], s55 offen offset:1024 sc1
    v_mfma_f32_16x16x32_bf16 v[180:183], v[112:115], v[240:243], v[180:183]
    s_waitcnt lgkmcnt(3)
    s_add_u32 s62, s62, 6
    ds_read_b128 v[200:203], v10 offset:22304
    v_mfma_f32_16x16x32_bf16 v[180:183], a[132:135], v[244:247], v[180:183]
    s_and_b32 s62, s62, 7
    s_lshl_b32 s63, s62, 14
    s_add_u32 s23, s63, s77
    v_mfma_f32_16x16x32_bf16 v[180:183], a[140:143], v[248:251], v[180:183]
    s_mul_i32 s72, s48, 17408
    s_and_b32 s73, s48, 1
    ds_read_b128 v[204:207], v10 offset:23392
    v_mfma_f32_16x16x32_bf16 v[184:187], v[128:131], v[224:227], v[184:187]
    s_mul_i32 s73, s73, 17408
    v_mfma_f32_16x16x32_bf16 v[184:187], v[124:127], v[228:231], v[184:187]
    ds_read_b128 v[208:211], v10 offset:24480
    v_mfma_f32_16x16x32_bf16 v[184:187], v[116:119], v[232:235], v[184:187]
    buffer_load_dwordx4 v[100:103], v36, s[36:39], s55 offen offset:2048 sc1
    v_mfma_f32_16x16x32_bf16 v[184:187], a[144:147], v[236:239], v[184:187]
    v_mfma_f32_16x16x32_bf16 v[184:187], v[108:111], v[240:243], v[184:187]
    s_waitcnt vmcnt(7)
    v_cmp_ne_u32 vcc, s3, v29
    s_nop 0
    s_cbranch_vccnz L_ch
L_ch_b:
    v_mfma_f32_16x16x32_bf16 v[184:187], v[112:115], v[244:247], v[184:187]
    buffer_load_dwordx4 v[16:19], v7, s[36:39], s65 offen sc1
    v_mfma_f32_16x16x32_bf16 v[184:187], a[132:135], v[248:251], v[184:187]
    s_waitcnt lgkmcnt(3)
    ds_read_b128 v[212:215], v10 offset:25568
    v_mfma_f32_16x16x32_bf16 v[184:187], a[140:143], v[252:255], v[184:187]
    s_add_u32 m0, s53, 34816
    v_mfma_f32_16x16x32_bf16 v[188:191], v[128:131], v[228:231], v[188:191]
    buffer_load_dwordx4 v2, s[36:39], s14 offen sc1 lds
    v_mfma_f32_16x16x32_bf16 v[188:191], v[124:127], v[232:235], v[188:191]
    v_mfma_f32_16x16x32_bf16 v[188:191], v[116:119], v[236:239], v[188:191]
    v_mfma_f32_16x16x32_bf16 v[188:191], a[144:147], v[240:243], v[188:191]
    v_mfma_f32_16x16x32_bf16 v[188:191], v[108:111], v[244:247], v[188:191]
    s_add_u32 m0, s53, 38912
    ds_read_b128 v[216:219], v10 offset:17984
    v_mfma_f32_16x16x32_bf16 v[188:191], v[112:115], v[248:251], v[188:191]
    buffer_load_dwordx4 v3, s[36:39], s14 offen sc1 lds
    v_mfma_f32_16x16x32_bf16 v[188:191], a[132:135], v[252:255], v[188:191]
    v_mfma_f32_16x16x32_bf16 v[188:191], a[140:143], v[192:195], v[188:191]
    v_mfma_f32_16x16x32_bf16 v[160:163], a[136:139], v[196:199], v[160:163]
    s_waitcnt lgkmcnt(1)
    v_mfma_f32_16x16x32_bf16 v[160:163], a[148:151], v[200:203], v[160:163]
    s_add_u32 m0, s53, 43008
    v_mfma_f32_16x16x32_bf16 v[160:163], a[152:155], v[204:207], v[160:163]
    buffer_load_dwordx4 v4, s[36:39], s14 offen sc1 lds
    v_mfma_f32_16x16x32_bf16 v[160:163], a[160:163], v[208:211], v[160:163]
    ds_read_b128 v[220:223], v10 offset:19072
    v_mfma_f32_16x16x32_bf16 v[164:167], a[164:167], v[196:199], v[164:167]
    v_mfma_f32_16x16x32_bf16 v[164:167], a[136:139], v[200:203], v[164:167]
    v_mfma_f32_16x16x32_bf16 v[164:167], a[148:151], v[204:207], v[164:167]
    s_add_u32 m0, s53, 47104
    v_mfma_f32_16x16x32_bf16 v[164:167], a[152:155], v[208:211], v[164:167]
    buffer_load_dwordx4 v5, s[36:39], s14 offen sc1 lds
    v_mfma_f32_16x16x32_bf16 v[164:167], a[160:163], v[212:215], v[164:167]
    v_mfma_f32_16x16x32_bf16 v[168:171], a[168:171], v[196:199], v[168:171]
    v_mfma_f32_16x16x32_bf16 v[168:171], a[164:167], v[200:203], v[168:171]
    ds_read_b128 v[224:227], v10 offset:20160
    v_mfma_f32_16x16x32_bf16 v[168:171], a[136:139], v[204:207], v[168:171]
    s_add_u32 m0, s72, 51200
    v_mfma_f32_16x16x32_bf16 v[168:171], a[148:151], v[208:211], v[168:171]
    buffer_load_dwordx4 v6, s[36:39], s22 offen sc1 lds
    v_mfma_f32_16x16x32_bf16 v[168:171], a[152:155], v[212:215], v[168:171]
    s_waitcnt lgkmcnt(1)
    v_mfma_f32_16x16x32_bf16 v[168:171], a[160:163], v[216:219], v[168:171]
    v_mfma_f32_16x16x32_bf16 v[172:175], a[172:175], v[196:199], v[172:175]
    v_mfma_f32_16x16x32_bf16 v[172:175], a[168:171], v[200:203], v[172:175]
    s_add_u32 m0, s53, 52224
    v_mfma_f32_16x16x32_bf16 v[172:175], a[164:167], v[204:207], v[172:175]
    ds_read_b128 v[228:231], v10 offset:21248
    v_mfma_f32_16x16x32_bf16 v[172:175], a[136:139], v[208:211], v[172:175]
    buffer_load_dwordx4 v2, s[36:39], s15 offen sc1 lds
    v_mfma_f32_16x16x32_bf16 v[172:175], a[148:151], v[212:215], v[172:175]
    v_mfma_f32_16x16x32_bf16 v[172:175], a[152:155], v[216:219], v[172:175]
    v_mfma_f32_16x16x32_bf16 v[172:175], a[160:163], v[220:223], v[172:175]
    s_add_u32 m0, s53, 56320
    v_mfma_f32_16x16x32_bf16 v[176:179], a[172:175], v[200:203], v[176:179]
    buffer_load_dwordx4 v3, s[36:39], s15 offen sc1 lds
    v_mfma_f32_16x16x32_bf16 v[176:179], a[168:171], v[204:207], v[176:179]
    ds_read_b128 v[232:235], v10 offset:22336
    v_mfma_f32_16x16x32_bf16 v[176:179], a[164:167], v[208:211], v[176:179]
    v_mfma_f32_16x16x32_bf16 v[176:179], a[136:139], v[212:215], v[176:179]
    ds_read_b128 v[236:239], v10 offset:23424
    v_mfma_f32_16x16x32_bf16 v[176:179], a[148:151], v[216:219], v[176:179]
    s_add_u32 m0, s53, 60416
    v_mfma_f32_16x16x32_bf16 v[176:179], a[152:155], v[220:223], v[176:179]
    s_waitcnt lgkmcnt(2)
    buffer_load_dwordx4 v4, s[36:39], s15 offen sc1 lds
    v_mfma_f32_16x16x32_bf16 v[176:179], a[160:163], v[224:227], v[176:179]
    v_mfma_f32_16x16x32_bf16 v[180:183], a[172:175], v[204:207], v[180:183]
    v_mfma_f32_16x16x32_bf16 v[180:183], a[168:171], v[208:211], v[180:183]
    v_mfma_f32_16x16x32_bf16 v[180:183], a[164:167], v[212:215], v[180:183]
    s_add_u32 s55, s10, 0
    buffer_load_dwordx4 v[104:107], v36, s[36:39], s55 offen offset:0 sc1
    v_mfma_f32_16x16x32_bf16 v[180:183], a[136:139], v[216:219], v[180:183]
    s_waitcnt vmcnt(9)
    ds_write_b128 v8, v[16:19]
    v_mfma_f32_16x16x32_bf16 v[180:183], a[148:151], v[220:223], v[180:183]
    v_mfma_f32_16x16x32_bf16 v[180:183], a[152:155], v[224:227], v[180:183]
    v_mfma_f32_16x16x32_bf16 v[180:183], a[160:163], v[228:231], v[180:183]
    v_mfma_f32_16x16x32_bf16 v[184:187], a[172:175], v[208:211], v[184:187]
    s_add_u32 m0, s53, 64512
    v_mfma_f32_16x16x32_bf16 v[184:187], a[168:171], v[212:215], v[184:187]
    buffer_load_dwordx4 v5, s[36:39], s15 offen sc1 lds
    v_mfma_f32_16x16x32_bf16 v[184:187], a[164:167], v[216:219], v[184:187]
    v_mfma_f32_16x16x32_bf16 v[184:187], a[136:139], v[220:223], v[184:187]
    v_mfma_f32_16x16x32_bf16 v[184:187], a[148:151], v[224:227], v[184:187]
    s_waitcnt lgkmcnt(0)
    s_barrier
    v_mfma_f32_16x16x32_bf16 v[184:187], a[152:155], v[228:231], v[184:187]
    ds_read_b128 v[240:243], v10 offset:0
    v_mfma_f32_16x16x32_bf16 v[184:187], a[160:163], v[232:235], v[184:187]
    buffer_load_dwordx4 a[132:135], v36, s[36:39], s55 offen offset:1024 sc1
    v_mfma_f32_16x16x32_bf16 v[188:191], a[172:175], v[212:215], v[188:191]
    ds_read_b128 v[244:247], v10 offset:1088
    v_mfma_f32_16x16x32_bf16 v[188:191], a[168:171], v[216:219], v[188:191]
    ds_read_b128 v[248:251], v10 offset:2176
    v_mfma_f32_16x16x32_bf16 v[188:191], a[164:167], v[220:223], v[188:191]
    ds_read_b128 v[252:255], v10 offset:3264
    v_mfma_f32_16x16x32_bf16 v[188:191], a[136:139], v[224:227], v[188:191]
    ds_read_b128 v[192:195], v10 offset:3296
    v_mfma_f32_16x16x32_bf16 v[188:191], a[148:151], v[228:231], v[188:191]
    ds_read_b128 v[196:199], v10 offset:544
    v_mfma_f32_16x16x32_bf16 v[188:191], a[152:155], v[232:235], v[188:191]
    buffer_load_dwordx4 v[108:111], v36, s[36:39], s55 offen offset:2048 sc1
    v_mfma_f32_16x16x32_bf16 v[188:191], a[160:163], v[236:239], v[188:191]
    s_waitcnt lgkmcnt(5)
    ds_read_b128 v[200:203], v10 offset:1632
    v_mfma_f32_16x16x32_bf16 v[160:163], a[240:243], v[240:243], v[160:163]
    s_waitcnt lgkmcnt(5)
    ds_read_b128 v[204:207], v10 offset:2720
    v_mfma_f32_16x16x32_bf16 v[160:163], a[232:235], v[244:247], v[160:163]
    s_waitcnt lgkmcnt(5)
    ds_read_b128 v[208:211], v10 offset:17408
    v_mfma_f32_16x16x32_bf16 v[160:163], a[228:231], v[248:251], v[160:163]
    s_waitcnt lgkmcnt(5)
    ds_read_b128 v[212:215], v10 offset:18496
    v_mfma_f32_16x16x32_bf16 v[160:163], a[224:227], v[252:255], v[160:163]
    ds_read_b128 v[216:219], v10 offset:19584
    v_mfma_f32_16x16x32_bf16 v[164:167], a[240:243], v[244:247], v[164:167]
    buffer_load_dwordx4 v[112:115], v36, s[36:39], s55 offen offset:3072 sc1
    v_mfma_f32_16x16x32_bf16 v[164:167], a[232:235], v[248:251], v[164:167]
    ds_read_b128 v[220:223], v10 offset:20672
    v_mfma_f32_16x16x32_bf16 v[164:167], a[228:231], v[252:255], v[164:167]
    ds_read_b128 v[224:227], v10 offset:20704
    v_mfma_f32_16x16x32_bf16 v[168:171], a[240:243], v[248:251], v[168:171]
    ds_read_b128 v[228:231], v10 offset:17952
    v_mfma_f32_16x16x32_bf16 v[168:171], a[232:235], v[252:255], v[168:171]
    ds_read_b128 v[232:235], v10 offset:19040
    v_mfma_f32_16x16x32_bf16 v[172:175], a[240:243], v[252:255], v[172:175]
    s_waitcnt lgkmcnt(8)
    s_add_u32 s55, s10, 4096
    buffer_load_dwordx4 v[120:123], v36, s[36:39], s55 offen offset:0 sc1
    v_mfma_f32_16x16x32_bf16 v[176:179], a[220:223], v[192:195], v[176:179]
    ds_read_b128 v[236:239], v10 offset:20128
    v_mfma_f32_16x16x32_bf16 v[160:163], a[188:191], v[196:199], v[160:163]
    buffer_load_dwordx4 v[132:135], v36, s[36:39], s55 offen offset:1024 sc1
    v_mfma_f32_16x16x32_bf16 v[160:163], a[128:131], v[200:203], v[160:163]
    s_waitcnt lgkmcnt(6)
    v_mfma_f32_16x16x32_bf16 v[160:163], a[156:159], v[204:207], v[160:163]
    v_mfma_f32_16x16x32_bf16 v[164:167], a[188:191], v[200:203], v[164:167]
    s_waitcnt vmcnt(10)
    s_barrier
    v_mfma_f32_16x16x32_bf16 v[164:167], a[128:131], v[204:207], v[164:167]
    ds_read_b128 v[240:243], v10 offset:34816
    v_mfma_f32_16x16x32_bf16 v[168:171], a[188:191], v[204:207], v[168:171]
    s_add_u32 m0, s53, 69632
    ds_read_b128 v[244:247], v10 offset:35904
    v_mfma_f32_16x16x32_bf16 v[160:163], v[128:131], v[208:211], v[160:163]
    ds_read_b128 v[248:251], v10 offset:36992
    v_mfma_f32_16x16x32_bf16 v[160:163], v[124:127], v[212:215], v[160:163]
    s_waitcnt lgkmcnt(4)
    buffer_load_dwordx4 v2, s[36:39], s16 offen sc1 lds
    v_mfma_f32_16x16x32_bf16 v[160:163], v[116:119], v[216:219], v[160:163]
    ds_read_b128 v[252:255], v10 offset:38080
    v_mfma_f32_16x16x32_bf16 v[160:163], a[144:147], v[220:223], v[160:163]
    ds_read_b128 v[192:195], v10 offset:39168
    v_mfma_f32_16x16x32_bf16 v[164:167], v[128:131], v[212:215], v[164:167]
    ds_read_b128 v[196:199], v10 offset:40256
    v_mfma_f32_16x16x32_bf16 v[164:167], v[124:127], v[216:219], v[164:167]
    ds_read_b128 v[200:203], v10 offset:41344
    v_mfma_f32_16x16x32_bf16 v[164:167], v[116:119], v[220:223], v[164:167]
    buffer_load_dwordx4 v[136:139], v36, s[36:39], s55 offen offset:2048 sc1
    v_mfma_f32_16x16x32_bf16 v[168:171], v[128:131], v[216:219], v[168:171]
    ds_read_b128 v[204:207], v10 offset:42432
    v_mfma_f32_16x16x32_bf16 v[168:171], v[124:127], v[220:223], v[168:171]
    v_mfma_f32_16x16x32_bf16 v[172:175], v[128:131], v[220:223], v[172:175]
    s_add_u32 m0, s53, 73728
    v_mfma_f32_16x16x32_bf16 v[176:179], a[140:143], v[224:227], v[176:179]
    buffer_load_dwordx4 v3, s[36:39], s16 offen sc1 lds
    v_mfma_f32_16x16x32_bf16 v[160:163], a[172:175], v[228:231], v[160:163]
    v_mfma_f32_16x16x32_bf16 v[160:163], a[168:171], v[232:235], v[160:163]
    s_waitcnt lgkmcnt(4)
    v_mfma_f32_16x16x32_bf16 v[160:163], a[164:167], v[236:239], v[160:163]
    v_mfma_f32_16x16x32_bf16 v[164:167], a[172:175], v[232:235], v[164:167]
    ds_read_b128 v[208:211], v10 offset:34848
    v_mfma_f32_16x16x32_bf16 v[164:167], a[168:171], v[236:239], v[164:167]
    buffer_load_dwordx4 v[140:143], v36, s[36:39], s55 offen offset:3072 sc1
    v_mfma_f32_16x16x32_bf16 v[168:171], a[172:175], v[236:239], v[168:171]
    v_mfma_f32_16x16x32_bf16 v[160:163], a[176:179], v[240:243], v[160:163]
    v_mfma_f32_16x16x32_bf16 v[160:163], a[180:183], v[244:247], v[160:163]
    v_mfma_f32_16x16x32_bf16 v[160:163], a[184:187], v[248:251], v[160:163]
    s_add_u32 m0, s53, 77824
    v_mfma_f32_16x16x32_bf16 v[160:163], a[192:195], v[252:255], v[160:163]
    s_waitcnt lgkmcnt(1)
    buffer_load_dwordx4 v4, s[36:39], s16 offen sc1 lds
    v_mfma_f32_16x16x32_bf16 v[160:163], a[196:199], v[192:195], v[160:163]
    v_mfma_f32_16x16x32_bf16 v[160:163], a[200:203], v[196:199], v[160:163]
    ds_read_b128 v[212:215], v10 offset:35936
    v_mfma_f32_16x16x32_bf16 v[160:163], a[204:207], v[200:203], v[160:163]
    v_mfma_f32_16x16x32_bf16 v[160:163], v[40:43], v[204:207], v[160:163]
    s_add_u32 m0, s53, 81920
    v_mfma_f32_16x16x32_bf16 v[164:167], a[176:179], v[244:247], v[164:167]
    buffer_load_dwordx4 v5, s[36:39], s16 offen sc1 lds
    v_mfma_f32_16x16x32_bf16 v[164:167], a[180:183], v[248:251], v[164:167]
    v_mfma_f32_16x16x32_bf16 v[164:167], a[184:187], v[252:255], v[164:167]
    v_mfma_f32_16x16x32_bf16 v[164:167], a[192:195], v[192:195], v[164:167]
    v_mfma_f32_16x16x32_bf16 v[164:167], a[196:199], v[196:199], v[164:167]
    s_add_u32 s55, s10, 8192
    buffer_load_dwordx4 v[144:147], v36, s[36:39], s55 offen offset:0 sc1
    v_mfma_f32_16x16x32_bf16 v[164:167], a[200:203], v[200:203], v[164:167]
    ds_read_b128 v[216:219], v10 offset:37024
    v_mfma_f32_16x16x32_bf16 v[164:167], a[204:207], v[204:207], v[164:167]
    s_waitcnt lgkmcnt(2)
    v_mfma_f32_16x16x32_bf16 v[164:167], v[40:43], v[208:211], v[164:167]
    v_mfma_f32_16x16x32_bf16 v[168:171], a[176:179], v[248:251], v[168:171]
    v_mfma_f32_16x16x32_bf16 v[168:171], a[180:183], v[252:255], v[168:171]
    buffer_load_dwordx4 a[136:139], v36, s[36:39], s55 offen offset:1024 sc1
    v_mfma_f32_16x16x32_bf16 v[168:171], a[184:187], v[192:195], v[168:171]
    v_mfma_f32_16x16x32_bf16 v[168:171], a[192:195], v[196:199], v[168:171]
    v_mfma_f32_16x16x32_bf16 v[168:171], a[196:199], v[200:203], v[168:171]
L_rw2:
    v_mfma_f32_16x16x32_bf16 v[168:171], a[200:203], v[204:207], v[168:171]
    ds_read_b128 v[220:223], v10 offset:38112
    v_mov_b32 v18, L_rw2-L_pc+2048
    v_mfma_f32_16x16x32_bf16 v[168:171], a[204:207], v[208:211], v[168:171]
    s_waitcnt lgkmcnt(2)
    buffer_load_dwordx4 a[148:151], v36, s[36:39], s55 offen offset:2048 sc1
    v_mfma_f32_16x16x32_bf16 v[168:171], v[40:43], v[212:215], v[168:171]
    global_load_dword v19, v18, s[78:79]
    v_mfma_f32_16x16x32_bf16 v[172:175], a[176:179], v[252:255], v[172:175]
    v_mfma_f32_16x16x32_bf16 v[172:175], a[180:183], v[192:195], v[172:175]
    v_mfma_f32_16x16x32_bf16 v[172:175], a[184:187], v[196:199], v[172:175]
    v_mfma_f32_16x16x32_bf16 v[172:175], a[192:195], v[200:203], v[172:175]
    buffer_load_dwordx4 a[152:155], v36, s[36:39], s55 offen offset:3072 sc1
    v_mfma_f32_16x16x32_bf16 v[172:175], a[196:199], v[204:207], v[172:175]
    v_mfma_f32_16x16x32_bf16 v[172:175], a[200:203], v[208:211], v[172:175]
    ds_read_b128 v[224:227], v10 offset:39200
    v_mfma_f32_16x16x32_bf16 v[172:175], a[204:207], v[212:215], v[172:175]
    s_waitcnt lgkmcnt(2)
    v_and_b32 v17, 15, v0
    v_mfma_f32_16x16x32_bf16 v[172:175], v[40:43], v[216:219], v[172:175]
    v_lshlrev_b32 v17, 4, v17
    v_mfma_f32_16x16x32_bf16 v[176:179], a[176:179], v[192:195], v[176:179]
    s_add_u32 s55, s10, 12288
    buffer_load_dwordx4 a[156:159], v36, s[36:39], s55 offen offset:0 sc1
    v_add_u32 v17, 15094784, v17
    v_mfma_f32_16x16x32_bf16 v[176:179], a[180:183], v[196:199], v[176:179]
    v_mfma_f32_16x16x32_bf16 v[176:179], a[184:187], v[200:203], v[176:179]
    v_mfma_f32_16x16x32_bf16 v[176:179], a[192:195], v[204:207], v[176:179]
    v_mfma_f32_16x16x32_bf16 v[176:179], a[196:199], v[208:211], v[176:179]
    ds_read_b128 v[228:231], v10 offset:40288
    v_mfma_f32_16x16x32_bf16 v[176:179], a[200:203], v[212:215], v[176:179]
    buffer_load_dwordx4 a[128:131], v36, s[36:39], s55 offen offset:1024 sc1
    v_mfma_f32_16x16x32_bf16 v[176:179], a[204:207], v[216:219], v[176:179]
    s_waitcnt lgkmcnt(2)
    ds_read_b128 v[232:235], v10 offset:41376
    v_mfma_f32_16x16x32_bf16 v[176:179], v[40:43], v[220:223], v[176:179]
    v_mfma_f32_16x16x32_bf16 v[180:183], a[176:179], v[196:199], v[180:183]
    ds_read_b128 v[236:239], v10 offset:35360
    v_mfma_f32_16x16x32_bf16 v[180:183], a[180:183], v[200:203], v[180:183]
    v_mfma_f32_16x16x32_bf16 v[180:183], a[184:187], v[204:207], v[180:183]
    ds_read_b128 v[240:243], v10 offset:36448
    v_mfma_f32_16x16x32_bf16 v[180:183], a[192:195], v[208:211], v[180:183]
    buffer_load_dwordx4 a[144:147], v36, s[36:39], s55 offen offset:2048 sc1
    v_mfma_f32_16x16x32_bf16 v[180:183], a[196:199], v[212:215], v[180:183]
    ds_read_b128 v[244:247], v10 offset:37536
    v_mfma_f32_16x16x32_bf16 v[180:183], a[200:203], v[216:219], v[180:183]
    v_mfma_f32_16x16x32_bf16 v[180:183], a[204:207], v[220:223], v[180:183]
    s_waitcnt lgkmcnt(4)
    ds_read_b128 v[248:251], v10 offset:38624
    v_mfma_f32_16x16x32_bf16 v[180:183], v[40:43], v[224:227], v[180:183]
    s_add_u32 s55, s11, 0
    buffer_load_dwordx4 v[116:119], v36, s[36:39], s55 offen offset:0 sc1
    v_mfma_f32_16x16x32_bf16 v[184:187], a[176:179], v[200:203], v[184:187]
    ds_read_b128 v[252:255], v10 offset:39712
    v_mfma_f32_16x16x32_bf16 v[184:187], a[180:183], v[204:207], v[184:187]
    v_mfma_f32_16x16x32_bf16 v[184:187], a[184:187], v[208:211], v[184:187]
    ds_read_b128 v[192:195], v10 offset:40800
    v_mfma_f32_16x16x32_bf16 v[184:187], a[192:195], v[212:215], v[184:187]
    v_mfma_f32_16x16x32_bf16 v[184:187], a[196:199], v[216:219], v[184:187]
    ds_read_b128 v[196:199], v10 offset:41888
    v_mfma_f32_16x16x32_bf16 v[184:187], a[200:203], v[220:223], v[184:187]
    buffer_load_dwordx4 v[124:127], v36, s[36:39], s55 offen offset:1024 sc1
    v_mfma_f32_16x16x32_bf16 v[184:187], a[204:207], v[224:227], v[184:187]
    v_mfma_f32_16x16x32_bf16 v[184:187], v[40:43], v[228:231], v[184:187]
    v_mfma_f32_16x16x32_bf16 v[188:191], a[176:179], v[204:207], v[188:191]
    v_mfma_f32_16x16x32_bf16 v[188:191], a[180:183], v[208:211], v[188:191]
    buffer_load_dwordx4 v[128:131], v36, s[36:39], s55 offen offset:2048 sc1
    v_mfma_f32_16x16x32_bf16 v[188:191], a[184:187], v[212:215], v[188:191]
    v_mfma_f32_16x16x32_bf16 v[188:191], a[192:195], v[216:219], v[188:191]
    ds_read_b128 v[200:203], v10 offset:42976
    v_mfma_f32_16x16x32_bf16 v[188:191], a[196:199], v[220:223], v[188:191]
    v_mfma_f32_16x16x32_bf16 v[188:191], a[200:203], v[224:227], v[188:191]
    v_mfma_f32_16x16x32_bf16 v[188:191], a[204:207], v[228:231], v[188:191]
    s_waitcnt lgkmcnt(1)
    buffer_load_dwordx4 v[148:151], v36, s[36:39], s55 offen offset:3072 sc1
    v_mfma_f32_16x16x32_bf16 v[188:191], v[40:43], v[232:235], v[188:191]
    v_mfma_f32_16x16x32_bf16 v[160:163], v[44:47], v[236:239], v[160:163]
    v_mfma_f32_16x16x32_bf16 v[160:163], v[48:51], v[240:243], v[160:163]
    v_mfma_f32_16x16x32_bf16 v[160:163], v[52:55], v[244:247], v[160:163]
    ds_read_b128 v[204:207], v10 offset:35392
    v_mfma_f32_16x16x32_bf16 v[160:163], v[56:59], v[248:251], v[160:163]
    s_add_u32 s55, s11, 4096
    buffer_load_dwordx4 v[152:155], v36, s[36:39], s55 offen offset:0 sc1
    v_mfma_f32_16x16x32_bf16 v[160:163], v[60:63], v[252:255], v[160:163]
    v_mfma_f32_16x16x32_bf16 v[160:163], v[64:67], v[192:195], v[160:163]
    v_mfma_f32_16x16x32_bf16 v[160:163], a[208:211], v[196:199], v[160:163]
    v_mfma_f32_16x16x32_bf16 v[164:167], v[44:47], v[240:243], v[164:167]
    v_mfma_f32_16x16x32_bf16 v[164:167], v[48:51], v[244:247], v[164:167]
    buffer_load_dwordx4 v[156:159], v36, s[36:39], s55 offen offset:1024 sc1
    v_mfma_f32_16x16x32_bf16 v[164:167], v[52:55], v[248:251], v[164:167]
    ds_read_b128 v[208:211], v10 offset:36480
    v_mfma_f32_16x16x32_bf16 v[164:167], v[56:59], v[252:255], v[164:167]
    v_mfma_f32_16x16x32_bf16 v[164:167], v[60:63], v[192:195], v[164:167]
    v_mfma_f32_16x16x32_bf16 v[164:167], v[64:67], v[196:199], v[164:167]
    s_waitcnt lgkmcnt(1)
    v_mfma_f32_16x16x32_bf16 v[164:167], a[208:211], v[200:203], v[164:167]
    buffer_load_dwordx4 v[40:43], v36, s[36:39], s55 offen offset:2048 sc1
    v_mfma_f32_16x16x32_bf16 v[168:171], v[44:47], v[244:247], v[168:171]
    v_mfma_f32_16x16x32_bf16 v[168:171], v[48:51], v[248:251], v[168:171]
    v_mfma_f32_16x16x32_bf16 v[168:171], v[52:55], v[252:255], v[168:171]
    ds_read_b128 v[212:215], v10 offset:37568
    v_mfma_f32_16x16x32_bf16 v[168:171], v[56:59], v[192:195], v[168:171]
    v_mfma_f32_16x16x32_bf16 v[168:171], v[60:63], v[196:199], v[168:171]
    s_add_u32 m0, s73, 120832
    v_mfma_f32_16x16x32_bf16 v[168:171], v[64:67], v[200:203], v[168:171]
    buffer_load_dwordx4 v6, s[36:39], s23 offen sc1 lds
    v_mfma_f32_16x16x32_bf16 v[168:171], a[208:211], v[204:207], v[168:171]
    v_mfma_f32_16x16x32_bf16 v[172:175], v[44:47], v[248:251], v[172:175]
    v_mfma_f32_16x16x32_bf16 v[172:175], v[48:51], v[252:255], v[172:175]
    buffer_load_dword v16, v17, s[36:39], 0 offen sc1
    v_mfma_f32_16x16x32_bf16 v[172:175], v[52:55], v[192:195], v[172:175]
    ds_read_b128 v[216:219], v10 offset:38656
    v_mfma_f32_16x16x32_bf16 v[172:175], v[56:59], v[196:199], v[172:175]
    s_waitcnt vmcnt(28)
    s_barrier
    v_mfma_f32_16x16x32_bf16 v[172:175], v[60:63], v[200:203], v[172:175]
    v_mfma_f32_16x16x32_bf16 v[172:175], v[64:67], v[204:207], v[172:175]
    s_waitcnt lgkmcnt(1)
    s_add_u32 m0, s53, 87040
    v_mfma_f32_16x16x32_bf16 v[172:175], a[208:211], v[208:211], v[172:175]
    ds_read_b128 v[220:223], v10 offset:39744
    v_mfma_f32_16x16x32_bf16 v[176:179], v[44:47], v[252:255], v[176:179]
    buffer_load_dwordx4 v2, s[36:39], s17 offen sc1 lds
    v_mfma_f32_16x16x32_bf16 v[176:179], v[48:51], v[192:195], v[176:179]
    ds_read_b128 v[224:227], v10 offset:40832
    v_mfma_f32_16x16x32_bf16 v[176:179], v[52:55], v[196:199], v[176:179]
    v_mfma_f32_16x16x32_bf16 v[176:179], v[56:59], v[200:203], v[176:179]
    ds_read_b128 v[228:231], v14 offset:0
    v_mfma_f32_16x16x32_bf16 v[176:179], v[60:63], v[204:207], v[176:179]
    v_mfma_f32_16x16x32_bf16 v[176:179], v[64:67], v[208:211], v[176:179]
    ds_read_b128 v[232:235], v14 offset:1088
    v_mfma_f32_16x16x32_bf16 v[176:179], a[208:211], v[212:215], v[176:179]
    s_add_u32 m0, s53, 91136
    v_mfma_f32_16x16x32_bf16 v[180:183], v[44:47], v[192:195], v[180:183]
    ds_read_b128 v[236:239], v14 offset:2176
    v_mfma_f32_16x16x32_bf16 v[180:183], v[48:51], v[196:199], v[180:183]
    buffer_load_dwordx4 v3, s[36:39], s17 offen sc1 lds
    v_mfma_f32_16x16x32_bf16 v[180:183], v[52:55], v[200:203], v[180:183]
    ds_read_b128 v[240:243], v14 offset:3264
    v_mfma_f32_16x16x32_bf16 v[180:183], v[56:59], v[204:207], v[180:183]
    v_mfma_f32_16x16x32_bf16 v[180:183], v[60:63], v[208:211], v[180:183]
    ds_read_b128 v[244:247], v14 offset:4352
    v_mfma_f32_16x16x32_bf16 v[180:183], v[64:67], v[212:215], v[180:183]
    s_waitcnt lgkmcnt(5)
    v_mfma_f32_16x16x32_bf16 v[180:183], a[208:211], v[216:219], v[180:183]
    ds_read_b128 v[248:251], v14 offset:5440
    v_mfma_f32_16x16x32_bf16 v[184:187], v[44:47], v[196:199], v[184:187]
    s_add_u32 m0, s53, 95232
    v_mfma_f32_16x16x32_bf16 v[184:187], v[48:51], v[200:203], v[184:187]
    ds_read_b128 v[252:255], v14 offset:6528
    v_mfma_f32_16x16x32_bf16 v[184:187], v[52:55], v[204:207], v[184:187]
    buffer_load_dwordx4 v4, s[36:39], s17 offen sc1 lds
    v_mfma_f32_16x16x32_bf16 v[184:187], v[56:59], v[208:211], v[184:187]
    ds_read_b128 v[192:195], v14 offset:7616
    v_mfma_f32_16x16x32_bf16 v[184:187], v[60:63], v[212:215], v[184:187]
    v_mfma_f32_16x16x32_bf16 v[184:187], v[64:67], v[216:219], v[184:187]
    v_mfma_f32_16x16x32_bf16 v[184:187], a[208:211], v[220:223], v[184:187]
    v_mfma_f32_16x16x32_bf16 v[188:191], v[44:47], v[200:203], v[188:191]
    buffer_load_dwordx4 v[44:47], v36, s[36:39], s55 offen offset:3072 sc1
    v_mfma_f32_16x16x32_bf16 v[188:191], v[48:51], v[204:207], v[188:191]
    v_mfma_f32_16x16x32_bf16 v[188:191], v[52:55], v[208:211], v[188:191]
    v_mfma_f32_16x16x32_bf16 v[188:191], v[56:59], v[212:215], v[188:191]
    v_mfma_f32_16x16x32_bf16 v[188:191], v[60:63], v[216:219], v[188:191]
    ds_read_b128 v[196:199], v14 offset:32
    v_mfma_f32_16x16x32_bf16 v[188:191], v[64:67], v[220:223], v[188:191]
    s_add_u32 m0, s53, 99328
    v_mfma_f32_16x16x32_bf16 v[188:191], a[208:211], v[224:227], v[188:191]
    s_waitcnt lgkmcnt(1)
    buffer_load_dwordx4 v5, s[36:39], s17 offen sc1 lds
    v_mfma_f32_16x16x32_bf16 v[160:163], a[212:215], v[228:231], v[160:163]
    v_mfma_f32_16x16x32_bf16 v[160:163], a[216:219], v[232:235], v[160:163]
    v_mfma_f32_16x16x32_bf16 v[160:163], v[68:71], v[236:239], v[160:163]
    v_mfma_f32_16x16x32_bf16 v[160:163], v[72:75], v[240:243], v[160:163]
    s_add_u32 s55, s11, 8192
    buffer_load_dwordx4 v[48:51], v36, s[36:39], s55 offen offset:0 sc1
    v_mfma_f32_16x16x32_bf16 v[160:163], v[76:79], v[244:247], v[160:163]
    v_mfma_f32_16x16x32_bf16 v[160:163], v[80:83], v[248:251], v[160:163]
    ds_read_b128 v[200:203], v14 offset:1120
    v_mfma_f32_16x16x32_bf16 v[160:163], v[84:87], v[252:255], v[160:163]
    v_mfma_f32_16x16x32_bf16 v[160:163], a[236:239], v[192:195], v[160:163]
    v_mfma_f32_16x16x32_bf16 v[164:167], a[212:215], v[232:235], v[164:167]
    buffer_load_dwordx4 v[52:55], v36, s[36:39], s55 offen offset:1024 sc1
    v_mfma_f32_16x16x32_bf16 v[164:167], a[216:219], v[236:239], v[164:167]
    v_mfma_f32_16x16x32_bf16 v[164:167], v[68:71], v[240:243], v[164:167]
    v_mfma_f32_16x16x32_bf16 v[164:167], v[72:75], v[244:247], v[164:167]
    v_mfma_f32_16x16x32_bf16 v[164:167], v[76:79], v[248:251], v[164:167]
    v_mfma_f32_16x16x32_bf16 v[164:167], v[80:83], v[252:255], v[164:167]
    ds_read_b128 v[204:207], v14 offset:2208
    v_mfma_f32_16x16x32_bf16 v[164:167], v[84:87], v[192:195], v[164:167]
    s_waitcnt lgkmcnt(2)
    buffer_load_dwordx4 v[56:59], v36, s[36:39], s55 offen offset:2048 sc1
    v_mfma_f32_16x16x32_bf16 v[164:167], a[236:239], v[196:199], v[164:167]
    v_mfma_f32_16x16x32_bf16 v[168:171], a[212:215], v[236:239], v[168:171]
    v_mfma_f32_16x16x32_bf16 v[168:171], a[216:219], v[240:243], v[168:171]
    v_mfma_f32_16x16x32_bf16 v[168:171], v[68:71], v[244:247], v[168:171]
    buffer_load_dwordx4 v[60:63], v36, s[36:39], s55 offen offset:3072 sc1
    v_mfma_f32_16x16x32_bf16 v[168:171], v[72:75], v[248:251], v[168:171]
    v_mfma_f32_16x16x32_bf16 v[168:171], v[76:79], v[252:255], v[168:171]
    v_mfma_f32_16x16x32_bf16 v[168:171], v[80:83], v[192:195], v[168:171]
    ds_read_b128 v[208:211], v14 offset:3296
    v_mfma_f32_16x16x32_bf16 v[168:171], v[84:87], v[196:199], v[168:171]
    s_waitcnt lgkmcnt(2)
    v_mfma_f32_16x16x32_bf16 v[168:171], a[236:239], v[200:203], v[168:171]
    s_add_u32 s55, s11, 12288
    buffer_load_dwordx4 v[64:67], v36, s[36:39], s55 offen offset:0 sc1
    v_mfma_f32_16x16x32_bf16 v[172:175], a[212:215], v[240:243], v[172:175]
    v_mfma_f32_16x16x32_bf16 v[172:175], a[216:219], v[244:247], v[172:175]
    v_mfma_f32_16x16x32_bf16 v[172:175], v[68:71], v[248:251], v[172:175]
    v_mfma_f32_16x16x32_bf16 v[172:175], v[72:75], v[252:255], v[172:175]
    v_mfma_f32_16x16x32_bf16 v[172:175], v[76:79], v[192:195], v[172:175]
    v_mfma_f32_16x16x32_bf16 v[172:175], v[80:83], v[196:199], v[172:175]
    ds_read_b128 v[212:215], v14 offset:4384
    v_mfma_f32_16x16x32_bf16 v[172:175], v[84:87], v[200:203], v[172:175]
    s_waitcnt lgkmcnt(2)
    v_mfma_f32_16x16x32_bf16 v[172:175], a[236:239], v[204:207], v[172:175]
    v_mfma_f32_16x16x32_bf16 v[176:179], a[212:215], v[244:247], v[176:179]
    v_mfma_f32_16x16x32_bf16 v[176:179], a[216:219], v[248:251], v[176:179]
    v_mfma_f32_16x16x32_bf16 v[176:179], v[68:71], v[252:255], v[176:179]
    s_waitcnt vmcnt(10)
    v_and_b32 v18, -2, v16
    v_cmp_ne_u32 vcc, s3, v18
    s_nop 0
    s_cbranch_vccnz L_cg
L_cg_b:
    v_mfma_f32_16x16x32_bf16 v[176:179], v[72:75], v[192:195], v[176:179]
    v_mfma_f32_16x16x32_bf16 v[176:179], v[76:79], v[196:199], v[176:179]
    ds_read_b128 v[216:219], v14 offset:5472
    v_mfma_f32_16x16x32_bf16 v[176:179], v[80:83], v[200:203], v[176:179]
    v_mfma_f32_16x16x32_bf16 v[176:179], v[84:87], v[204:207], v[176:179]
    s_waitcnt lgkmcnt(2)
    ds_read_b128 v[220:223], v14 offset:6560
    v_cmp_ne_u32 vcc, v16, v18
    v_mfma_f32_16x16x32_bf16 v[176:179], a[236:239], v[208:211], v[176:179]
    s_lshl_b32 s62, s51, 13
    v_mfma_f32_16x16x32_bf16 v[180:183], a[212:215], v[248:251], v[180:183]
    s_add_u32 s62, s62, s54
    ds_read_b128 v[224:227], v14 offset:544
    v_mfma_f32_16x16x32_bf16 v[180:183], a[216:219], v[252:255], v[180:183]
    s_add_u32 s62, s62, 14942208
    v_mfma_f32_16x16x32_bf16 v[180:183], v[68:71], v[192:195], v[180:183]
    s_add_u32 s63, s62, 16384
    ds_read_b128 v[228:231], v14 offset:1632
    v_mfma_f32_16x16x32_bf16 v[180:183], v[72:75], v[196:199], v[180:183]
    s_mov_b64 s[74:75], vcc
    v_mfma_f32_16x16x32_bf16 v[180:183], v[76:79], v[200:203], v[180:183]
    ds_read_b128 v[232:235], v14 offset:2720
    s_cmp_lg_u64 s[74:75], 0
    s_cselect_b32 s63, s62, s63
    v_mfma_f32_16x16x32_bf16 v[180:183], v[80:83], v[204:207], v[180:183]
    v_mfma_f32_16x16x32_bf16 v[180:183], v[84:87], v[208:211], v[180:183]
    s_waitcnt lgkmcnt(4)
    s_add_u32 m0, s54, 139264
    ds_read_b128 v[236:239], v14 offset:3808
    v_mfma_f32_16x16x32_bf16 v[180:183], a[236:239], v[212:215], v[180:183]
    buffer_load_dwordx4 v36, s[36:39], s63 offen offset:0 sc1 lds
    v_mfma_f32_16x16x32_bf16 v[184:187], a[212:215], v[252:255], v[184:187]
    ds_read_b128 v[240:243], v14 offset:4896
    v_mfma_f32_16x16x32_bf16 v[184:187], a[216:219], v[192:195], v[184:187]
    v_mfma_f32_16x16x32_bf16 v[184:187], v[68:71], v[196:199], v[184:187]
    ds_read_b128 v[244:247], v14 offset:5984
    v_mfma_f32_16x16x32_bf16 v[184:187], v[72:75], v[200:203], v[184:187]
    s_add_u32 m0, s54, 139264
    v_mfma_f32_16x16x32_bf16 v[184:187], v[76:79], v[204:207], v[184:187]
    ds_read_b128 v[248:251], v14 offset:7072
    v_mfma_f32_16x16x32_bf16 v[184:187], v[80:83], v[208:211], v[184:187]
    buffer_load_dwordx4 v36, s[36:39], s63 offen offset:1024 sc1 lds
    v_mfma_f32_16x16x32_bf16 v[184:187], v[84:87], v[212:215], v[184:187]
    v_mfma_f32_16x16x32_bf16 v[184:187], a[236:239], v[216:219], v[184:187]
    v_mfma_f32_16x16x32_bf16 v[188:191], a[212:215], v[192:195], v[188:191]
    v_mfma_f32_16x16x32_bf16 v[188:191], a[216:219], v[196:199], v[188:191]
    v_mfma_f32_16x16x32_bf16 v[188:191], v[68:71], v[200:203], v[188:191]
    buffer_load_dwordx4 v[68:71], v36, s[36:39], s55 offen offset:1024 sc1
    v_mfma_f32_16x16x32_bf16 v[188:191], v[72:75], v[204:207], v[188:191]
    ds_read_b128 v[252:255], v14 offset:8160
    v_mfma_f32_16x16x32_bf16 v[188:191], v[76:79], v[208:211], v[188:191]
    v_mfma_f32_16x16x32_bf16 v[188:191], v[80:83], v[212:215], v[188:191]
    v_mfma_f32_16x16x32_bf16 v[188:191], v[84:87], v[216:219], v[188:191]
    s_waitcnt lgkmcnt(1)
    v_mfma_f32_16x16x32_bf16 v[188:191], a[236:239], v[220:223], v[188:191]
    v_mfma_f32_16x16x32_bf16 v[160:163], a[244:247], v[224:227], v[160:163]
    buffer_load_dwordx4 v[72:75], v36, s[36:39], s55 offen offset:2048 sc1
    v_mfma_f32_16x16x32_bf16 v[160:163], a[248:251], v[228:231], v[160:163]
    v_mfma_f32_16x16x32_bf16 v[160:163], a[252:255], v[232:235], v[160:163]
    ds_read_b128 v[192:195], v14 offset:576
    v_mfma_f32_16x16x32_bf16 v[160:163], v[88:91], v[236:239], v[160:163]
    v_mfma_f32_16x16x32_bf16 v[160:163], v[92:95], v[240:243], v[160:163]
    v_mfma_f32_16x16x32_bf16 v[160:163], v[96:99], v[244:247], v[160:163]
    v_mfma_f32_16x16x32_bf16 v[160:163], v[100:103], v[248:251], v[160:163]
    s_add_u32 s55, s12, 0
    buffer_load_dwordx4 v[76:79], v36, s[36:39], s55 offen offset:0 sc1
    v_mfma_f32_16x16x32_bf16 v[164:167], a[244:247], v[228:231], v[164:167]
    v_mfma_f32_16x16x32_bf16 v[164:167], a[248:251], v[232:235], v[164:167]
    v_mfma_f32_16x16x32_bf16 v[164:167], a[252:255], v[236:239], v[164:167]
    ds_read_b128 v[196:199], v14 offset:1664
    v_mfma_f32_16x16x32_bf16 v[164:167], v[88:91], v[240:243], v[164:167]
    v_mfma_f32_16x16x32_bf16 v[164:167], v[92:95], v[244:247], v[164:167]
    v_mfma_f32_16x16x32_bf16 v[164:167], v[96:99], v[248:251], v[164:167]
    s_waitcnt lgkmcnt(1)
    buffer_load_dwordx4 v[80:83], v36, s[36:39], s55 offen offset:1024 sc1
    v_mfma_f32_16x16x32_bf16 v[164:167], v[100:103], v[252:255], v[164:167]
    v_mfma_f32_16x16x32_bf16 v[168:171], a[244:247], v[232:235], v[168:171]
    v_mfma_f32_16x16x32_bf16 v[168:171], a[248:251], v[236:239], v[168:171]
    v_mfma_f32_16x16x32_bf16 v[168:171], a[252:255], v[240:243], v[168:171]
    ds_read_b128 v[200:203], v14 offset:2752
    v_mfma_f32_16x16x32_bf16 v[168:171], v[88:91], v[244:247], v[168:171]
    v_mfma_f32_16x16x32_bf16 v[168:171], v[92:95], v[248:251], v[168:171]
    buffer_load_dwordx4 v[84:87], v36, s[36:39], s55 offen offset:2048 sc1
    v_mfma_f32_16x16x32_bf16 v[168:171], v[96:99], v[252:255], v[168:171]
    v_mfma_f32_16x16x32_bf16 v[168:171], v[100:103], v[192:195], v[168:171]
    v_mfma_f32_16x16x32_bf16 v[172:175], a[244:247], v[236:239], v[172:175]
    v_mfma_f32_16x16x32_bf16 v[172:175], a[248:251], v[240:243], v[172:175]
    v_mfma_f32_16x16x32_bf16 v[172:175], a[252:255], v[244:247], v[172:175]
    ds_read_b128 v[204:207], v14 offset:3840
    v_mfma_f32_16x16x32_bf16 v[172:175], v[88:91], v[248:251], v[172:175]
    s_barrier
    v_mfma_f32_16x16x32_bf16 v[172:175], v[92:95], v[252:255], v[172:175]
    v_mfma_f32_16x16x32_bf16 v[172:175], v[96:99], v[192:195], v[172:175]
    s_waitcnt lgkmcnt(1)
    s_add_u32 m0, s53, 104448
    v_mfma_f32_16x16x32_bf16 v[172:175], v[100:103], v[196:199], v[172:175]
    ds_read_b128 v[208:211], v14 offset:4928
    v_mfma_f32_16x16x32_bf16 v[176:179], a[244:247], v[240:243], v[176:179]
    buffer_load_dwordx4 v2, s[36:39], s20 offen sc1 lds
    v_mfma_f32_16x16x32_bf16 v[176:179], a[248:251], v[244:247], v[176:179]
    ds_read_b128 v[212:215], v14 offset:6016
    v_mfma_f32_16x16x32_bf16 v[176:179], a[252:255], v[248:251], v[176:179]
    v_mfma_f32_16x16x32_bf16 v[176:179], v[88:91], v[252:255], v[176:179]
    ds_read_b128 v[216:219], v14 offset:17408
    v_mfma_f32_16x16x32_bf16 v[176:179], v[92:95], v[192:195], v[176:179]
    v_mfma_f32_16x16x32_bf16 v[176:179], v[96:99], v[196:199], v[176:179]
    ds_read_b128 v[220:223], v14 offset:18496
    v_mfma_f32_16x16x32_bf16 v[176:179], v[100:103], v[200:203], v[176:179]
    s_add_u32 m0, s53, 108544
    v_mfma_f32_16x16x32_bf16 v[180:183], a[244:247], v[244:247], v[180:183]
    ds_read_b128 v[224:227], v14 offset:19584
    v_mfma_f32_16x16x32_bf16 v[180:183], a[248:251], v[248:251], v[180:183]
    buffer_load_dwordx4 v3, s[36:39], s20 offen sc1 lds
    v_mfma_f32_16x16x32_bf16 v[180:183], a[252:255], v[252:255], v[180:183]
    ds_read_b128 v[228:231], v14 offset:20672
    v_mfma_f32_16x16x32_bf16 v[180:183], v[88:91], v[192:195], v[180:183]
    v_mfma_f32_16x16x32_bf16 v[180:183], v[92:95], v[196:199], v[180:183]
    ds_read_b128 v[232:235], v14 offset:21760
    v_mfma_f32_16x16x32_bf16 v[180:183], v[96:99], v[200:203], v[180:183]
    s_waitcnt lgkmcnt(5)
    v_mfma_f32_16x16x32_bf16 v[180:183], v[100:103], v[204:207], v[180:183]
    ds_read_b128 v[236:239], v14 offset:22848
    v_mfma_f32_16x16x32_bf16 v[184:187], a[244:247], v[248:251], v[184:187]
    s_add_u32 m0, s53, 112640
    v_mfma_f32_16x16x32_bf16 v[184:187], a[248:251], v[252:255], v[184:187]
    ds_read_b128 v[240:243], v14 offset:23936
    v_mfma_f32_16x16x32_bf16 v[184:187], a[252:255], v[192:195], v[184:187]
    buffer_load_dwordx4 v4, s[36:39], s20 offen sc1 lds
    v_mfma_f32_16x16x32_bf16 v[184:187], v[88:91], v[196:199], v[184:187]
    ds_read_b128 v[244:247], v14 offset:25024
    v_mfma_f32_16x16x32_bf16 v[184:187], v[92:95], v[200:203], v[184:187]
    v_mfma_f32_16x16x32_bf16 v[184:187], v[96:99], v[204:207], v[184:187]
    v_mfma_f32_16x16x32_bf16 v[184:187], v[100:103], v[208:211], v[184:187]
    v_mfma_f32_16x16x32_bf16 v[188:191], a[244:247], v[252:255], v[188:191]
    v_mfma_f32_16x16x32_bf16 v[188:191], a[248:251], v[192:195], v[188:191]
    s_add_u32 m0, s53, 116736
    v_mfma_f32_16x16x32_bf16 v[188:191], a[252:255], v[196:199], v[188:191]
    buffer_load_dwordx4 v5, s[36:39], s20 offen sc1 lds
    v_mfma_f32_16x16x32_bf16 v[188:191], v[88:91], v[200:203], v[188:191]
    v_mfma_f32_16x16x32_bf16 v[188:191], v[92:95], v[204:207], v[188:191]
    ds_read_b128 v[248:251], v14 offset:17440
    v_mfma_f32_16x16x32_bf16 v[188:191], v[96:99], v[208:211], v[188:191]
    v_mfma_f32_16x16x32_bf16 v[188:191], v[100:103], v[212:215], v[188:191]
    s_waitcnt lgkmcnt(1)
    buffer_load_dwordx4 v[88:91], v36, s[36:39], s55 offen offset:3072 sc1
    v_mfma_f32_16x16x32_bf16 v[160:163], v[104:107], v[216:219], v[160:163]
    v_mfma_f32_16x16x32_bf16 v[160:163], a[132:135], v[220:223], v[160:163]
    v_mfma_f32_16x16x32_bf16 v[160:163], v[108:111], v[224:227], v[160:163]
    v_mfma_f32_16x16x32_bf16 v[160:163], v[112:115], v[228:231], v[160:163]
    v_mfma_f32_16x16x32_bf16 v[160:163], v[120:123], v[232:235], v[160:163]
    s_add_u32 s55, s12, 4096
    buffer_load_dwordx4 v[92:95], v36, s[36:39], s55 offen offset:0 sc1
    v_mfma_f32_16x16x32_bf16 v[160:163], v[132:135], v[236:239], v[160:163]
    ds_read_b128 v[252:255], v14 offset:18528
    v_mfma_f32_16x16x32_bf16 v[160:163], v[136:139], v[240:243], v[160:163]
    v_mfma_f32_16x16x32_bf16 v[160:163], v[140:143], v[244:247], v[160:163]
    v_mfma_f32_16x16x32_bf16 v[164:167], v[104:107], v[220:223], v[164:167]
    v_mfma_f32_16x16x32_bf16 v[164:167], a[132:135], v[224:227], v[164:167]
    buffer_load_dwordx4 v[96:99], v36, s[36:39], s55 offen offset:1024 sc1
    v_mfma_f32_16x16x32_bf16 v[164:167], v[108:111], v[228:231], v[164:167]
    v_mfma_f32_16x16x32_bf16 v[164:167], v[112:115], v[232:235], v[164:167]
    v_mfma_f32_16x16x32_bf16 v[164:167], v[120:123], v[236:239], v[164:167]
    v_mfma_f32_16x16x32_bf16 v[164:167], v[132:135], v[240:243], v[164:167]
    ds_read_b128 v[192:195], v14 offset:19616
    v_mfma_f32_16x16x32_bf16 v[164:167], v[136:139], v[244:247], v[164:167]
    s_waitcnt lgkmcnt(2)
    buffer_load_dwordx4 v[100:103], v36, s[36:39], s55 offen offset:2048 sc1
    v_mfma_f32_16x16x32_bf16 v[164:167], v[140:143], v[248:251], v[164:167]
    v_mfma_f32_16x16x32_bf16 v[168:171], v[104:107], v[224:227], v[168:171]
    v_mfma_f32_16x16x32_bf16 v[168:171], a[132:135], v[228:231], v[168:171]
    v_mfma_f32_16x16x32_bf16 v[168:171], v[108:111], v[232:235], v[168:171]
    v_mfma_f32_16x16x32_bf16 v[168:171], v[112:115], v[236:239], v[168:171]
    v_mfma_f32_16x16x32_bf16 v[168:171], v[120:123], v[240:243], v[168:171]
L_rw3:
    v_mfma_f32_16x16x32_bf16 v[168:171], v[132:135], v[244:247], v[168:171]
    ds_read_b128 v[196:199], v14 offset:20704
    v_mov_b32 v18, L_rw3-L_pc+2048
    v_mfma_f32_16x16x32_bf16 v[168:171], v[136:139], v[248:251], v[168:171]
    s_waitcnt lgkmcnt(2)
    global_load_dword v19, v18, s[78:79]
    v_mfma_f32_16x16x32_bf16 v[168:171], v[140:143], v[252:255], v[168:171]
    v_mfma_f32_16x16x32_bf16 v[172:175], v[104:107], v[228:231], v[172:175]
    v_mfma_f32_16x16x32_bf16 v[172:175], a[132:135], v[232:235], v[172:175]
    v_mfma_f32_16x16x32_bf16 v[172:175], v[108:111], v[236:239], v[172:175]
    v_mfma_f32_16x16x32_bf16 v[172:175], v[112:115], v[240:243], v[172:175]
    v_mfma_f32_16x16x32_bf16 v[172:175], v[120:123], v[244:247], v[172:175]
    v_mfma_f32_16x16x32_bf16 v[172:175], v[132:135], v[248:251], v[172:175]
    ds_read_b128 v[200:203], v14 offset:21792
    v_mfma_f32_16x16x32_bf16 v[172:175], v[136:139], v[252:255], v[172:175]
    s_waitcnt lgkmcnt(2)
    v_mfma_f32_16x16x32_bf16 v[172:175], v[140:143], v[192:195], v[172:175]
    v_mfma_f32_16x16x32_bf16 v[176:179], v[104:107], v[232:235], v[176:179]
    v_mfma_f32_16x16x32_bf16 v[176:179], a[132:135], v[236:239], v[176:179]
    v_mfma_f32_16x16x32_bf16 v[176:179], v[108:111], v[240:243], v[176:179]
    v_mfma_f32_16x16x32_bf16 v[176:179], v[112:115], v[244:247], v[176:179]
    v_mfma_f32_16x16x32_bf16 v[176:179], v[120:123], v[248:251], v[176:179]
    ds_read_b128 v[204:207], v14 offset:22880
    v_mfma_f32_16x16x32_bf16 v[176:179], v[132:135], v[252:255], v[176:179]
    v_mfma_f32_16x16x32_bf16 v[176:179], v[136:139], v[192:195], v[176:179]
    s_waitcnt lgkmcnt(2)
    ds_read_b128 v[208:211], v14 offset:23968
    v_mfma_f32_16x16x32_bf16 v[176:179], v[140:143], v[196:199], v[176:179]
    v_mfma_f32_16x16x32_bf16 v[180:183], v[104:107], v[236:239], v[180:183]
    ds_read_b128 v[212:215], v14 offset:17952
    v_mfma_f32_16x16x32_bf16 v[180:183], a[132:135], v[240:243], v[180:183]
    v_mfma_f32_16x16x32_bf16 v[180:183], v[108:111], v[244:247], v[180:183]
    ds_read_b128 v[216:219], v14 offset:19040
    v_mfma_f32_16x16x32_bf16 v[180:183], v[112:115], v[248:251], v[180:183]
    v_mfma_f32_16x16x32_bf16 v[180:183], v[120:123], v[252:255], v[180:183]
    ds_read_b128 v[220:223], v14 offset:20128
    v_mfma_f32_16x16x32_bf16 v[180:183], v[132:135], v[192:195], v[180:183]
    v_mfma_f32_16x16x32_bf16 v[180:183], v[136:139], v[196:199], v[180:183]
    s_waitcnt lgkmcnt(4)
    ds_read_b128 v[224:227], v14 offset:21216
    v_mfma_f32_16x16x32_bf16 v[180:183], v[140:143], v[200:203], v[180:183]
    v_mfma_f32_16x16x32_bf16 v[184:187], v[104:107], v[240:243], v[184:187]
    ds_read_b128 v[228:231], v14 offset:22304
    v_mfma_f32_16x16x32_bf16 v[184:187], a[132:135], v[244:247], v[184:187]
    v_mfma_f32_16x16x32_bf16 v[184:187], v[108:111], v[248:251], v[184:187]
    ds_read_b128 v[232:235], v14 offset:23392
    v_mfma_f32_16x16x32_bf16 v[184:187], v[112:115], v[252:255], v[184:187]
    v_mfma_f32_16x16x32_bf16 v[184:187], v[120:123], v[192:195], v[184:187]
    ds_read_b128 v[236:239], v14 offset:24480
    v_mfma_f32_16x16x32_bf16 v[184:187], v[132:135], v[196:199], v[184:187]
    v_mfma_f32_16x16x32_bf16 v[184:187], v[136:139], v[200:203], v[184:187]
    v_mfma_f32_16x16x32_bf16 v[184:187], v[140:143], v[204:207], v[184:187]
    v_mfma_f32_16x16x32_bf16 v[188:191], v[104:107], v[244:247], v[188:191]
    buffer_load_dwordx4 v[104:107], v36, s[36:39], s55 offen offset:3072 sc1
    v_mfma_f32_16x16x32_bf16 v[188:191], a[132:135], v[248:251], v[188:191]
    v_mfma_f32_16x16x32_bf16 v[188:191], v[108:111], v[252:255], v[188:191]
    v_mfma_f32_16x16x32_bf16 v[188:191], v[112:115], v[192:195], v[188:191]
    ds_read_b128 v[240:243], v14 offset:25568
    v_mfma_f32_16x16x32_bf16 v[188:191], v[120:123], v[196:199], v[188:191]
    v_mfma_f32_16x16x32_bf16 v[188:191], v[132:135], v[200:203], v[188:191]
    v_mfma_f32_16x16x32_bf16 v[188:191], v[136:139], v[204:207], v[188:191]
    s_waitcnt lgkmcnt(1)
    s_add_u32 s55, s12, 8192
    buffer_load_dwordx4 v[108:111], v36, s[36:39], s55 offen offset:0 sc1
    v_mfma_f32_16x16x32_bf16 v[188:191], v[140:143], v[208:211], v[188:191]
    v_mfma_f32_16x16x32_bf16 v[160:163], v[144:147], v[212:215], v[160:163]
    v_mfma_f32_16x16x32_bf16 v[160:163], a[136:139], v[216:219], v[160:163]
    v_mfma_f32_16x16x32_bf16 v[160:163], a[148:151], v[220:223], v[160:163]
    ds_read_b128 v[244:247], v14 offset:17984
    v_lshrrev_b32 v28, 5, v0
    v_mfma_f32_16x16x32_bf16 v[160:163], a[152:155], v[224:227], v[160:163]
    v_mfma_f32_16x16x32_bf16 v[160:163], a[156:159], v[228:231], v[160:163]
    buffer_load_dwordx4 v[112:115], v36, s[36:39], s55 offen offset:1024 sc1
    v_mfma_f32_16x16x32_bf16 v[160:163], a[128:131], v[232:235], v[160:163]
    v_and_b32 v29, 15, v0
    v_mfma_f32_16x16x32_bf16 v[160:163], a[144:147], v[236:239], v[160:163]
    v_mfma_f32_16x16x32_bf16 v[164:167], v[144:147], v[216:219], v[164:167]
    v_lshrrev_b32 v9, 2, v29
    v_mfma_f32_16x16x32_bf16 v[164:167], a[136:139], v[220:223], v[164:167]
    v_mfma_f32_16x16x32_bf16 v[164:167], a[148:151], v[224:227], v[164:167]
    ds_read_b128 v[248:251], v14 offset:19072
    v_lshlrev_b32 v16, 14, v9
    v_mfma_f32_16x16x32_bf16 v[164:167], a[152:155], v[228:231], v[164:167]
    buffer_load_dwordx4 v[120:123], v36, s[36:39], s55 offen offset:2048 sc1
    v_mfma_f32_16x16x32_bf16 v[164:167], a[156:159], v[232:235], v[164:167]
    v_mfma_f32_16x16x32_bf16 v[164:167], a[128:131], v[236:239], v[164:167]
    s_waitcnt lgkmcnt(1)
    v_and_b32 v9, 3, v0
    v_mfma_f32_16x16x32_bf16 v[164:167], a[144:147], v[240:243], v[164:167]
    v_mfma_f32_16x16x32_bf16 v[168:171], v[144:147], v[220:223], v[168:171]
    v_lshl_add_u32 v16, v9, 6, v16
    v_mfma_f32_16x16x32_bf16 v[168:171], a[136:139], v[224:227], v[168:171]
    v_mfma_f32_16x16x32_bf16 v[168:171], a[148:151], v[228:231], v[168:171]
    ds_read_b128 v[252:255], v14 offset:20160
    v_mfma_f32_16x16x32_bf16 v[168:171], a[152:155], v[232:235], v[168:171]
    buffer_load_dwordx4 v[132:135], v36, s[36:39], s55 offen offset:3072 sc1
    v_lshl_add_u32 v16, v28, 4, v16
    v_mfma_f32_16x16x32_bf16 v[168:171], a[156:159], v[236:239], v[168:171]
    v_mfma_f32_16x16x32_bf16 v[168:171], a[128:131], v[240:243], v[168:171]
    v_bfe_u32 v9, v0, 4, 1
    v_mfma_f32_16x16x32_bf16 v[168:171], a[144:147], v[244:247], v[168:171]
    v_mfma_f32_16x16x32_bf16 v[172:175], v[144:147], v[224:227], v[172:175]
    s_add_u32 s61, s67, 8192
    buffer_load_dwordx4 a[160:163], v36, s[36:39], s61 offen offset:0 sc1
    v_mfma_f32_16x16x32_bf16 v[172:175], a[136:139], v[228:231], v[172:175]
    v_lshl_add_u32 v16, v9, 8, v16
    v_mfma_f32_16x16x32_bf16 v[172:175], a[148:151], v[232:235], v[172:175]
    ds_read_b128 v[192:195], v14 offset:21248
    v_mfma_f32_16x16x32_bf16 v[172:175], a[152:155], v[236:239], v[172:175]
    s_waitcnt vmcnt(27)
    s_barrier
    v_mfma_f32_16x16x32_bf16 v[172:175], a[156:159], v[240:243], v[172:175]
    v_add_u32 v20, s54, v36
    v_mfma_f32_16x16x32_bf16 v[172:175], a[128:131], v[244:247], v[172:175]
    s_waitcnt lgkmcnt(1)
    s_add_u32 s55, s12, 12288
    buffer_load_dwordx4 v[136:139], v36, s[36:39], s55 offen offset:0 sc1
    v_mfma_f32_16x16x32_bf16 v[172:175], a[144:147], v[248:251], v[172:175]
    ds_read_b128 v[196:199], v14 offset:22336
    v_mfma_f32_16x16x32_bf16 v[176:179], v[144:147], v[228:231], v[176:179]
    v_mfma_f32_16x16x32_bf16 v[176:179], a[136:139], v[232:235], v[176:179]
    s_lshl_b32 s62, s48, 8
    ds_read_b128 v[200:203], v14 offset:23424
    v_mfma_f32_16x16x32_bf16 v[176:179], a[148:151], v[236:239], v[176:179]
    s_add_u32 s62, s62, 139264
    v_mfma_f32_16x16x32_bf16 v[176:179], a[152:155], v[240:243], v[176:179]
    ds_read_b128 v[204:207], v14 offset:34816
    v_lshrrev_b32 v9, 4, v0
    v_mfma_f32_16x16x32_bf16 v[176:179], a[156:159], v[244:247], v[176:179]
    buffer_load_dwordx4 v[140:143], v36, s[36:39], s55 offen offset:1024 sc1
    v_mfma_f32_16x16x32_bf16 v[176:179], a[128:131], v[248:251], v[176:179]
    ds_read_b128 v[208:211], v14 offset:35904
    v_mfma_f32_16x16x32_bf16 v[176:179], a[144:147], v[252:255], v[176:179]
    v_lshl_add_u32 v21, v9, 5, s62
    v_mfma_f32_16x16x32_bf16 v[180:183], v[144:147], v[232:235], v[180:183]
    ds_read_b128 v[212:215], v14 offset:36992
    v_mfma_f32_16x16x32_bf16 v[180:183], a[136:139], v[236:239], v[180:183]
    s_add_u32 m0, s53, 121856
    v_mfma_f32_16x16x32_bf16 v[180:183], a[148:151], v[240:243], v[180:183]
    ds_read_b128 v[216:219], v14 offset:38080
    v_mfma_f32_16x16x32_bf16 v[180:183], a[152:155], v[244:247], v[180:183]
    buffer_load_dwordx4 v2, s[36:39], s21 offen sc1 lds
    v_lshlrev_b32 v9, 3, v9
    v_mfma_f32_16x16x32_bf16 v[180:183], a[156:159], v[248:251], v[180:183]
    ds_read_b128 v[220:223], v14 offset:39168
    v_mfma_f32_16x16x32_bf16 v[180:183], a[128:131], v[252:255], v[180:183]
    s_waitcnt lgkmcnt(5)
    v_mfma_f32_16x16x32_bf16 v[180:183], a[144:147], v[192:195], v[180:183]
    s_add_u32 m0, s53, 125952
    s_lshl_b32 s62, s48, 7
    ds_read_b128 v[224:227], v14 offset:40256
    v_mfma_f32_16x16x32_bf16 v[184:187], v[144:147], v[236:239], v[184:187]
    buffer_load_dwordx4 v3, s[36:39], s21 offen sc1 lds
    v_mfma_f32_16x16x32_bf16 v[184:187], a[136:139], v[240:243], v[184:187]
    ds_read_b128 v[228:231], v14 offset:41344
    v_lshl_add_u32 v28, v29, 3, s62
    v_mfma_f32_16x16x32_bf16 v[184:187], a[148:151], v[244:247], v[184:187]
    v_mfma_f32_16x16x32_bf16 v[184:187], a[152:155], v[248:251], v[184:187]
    ds_read_b128 v[232:235], v14 offset:42432
    v_mfma_f32_16x16x32_bf16 v[184:187], a[156:159], v[252:255], v[184:187]
    s_add_u32 m0, s53, 130048
    s_lshl_b32 s62, s49, 5
    v_mfma_f32_16x16x32_bf16 v[184:187], a[128:131], v[192:195], v[184:187]
    s_sub_u32 s63, 125, s62
    buffer_load_dwordx4 v4, s[36:39], s21 offen sc1 lds
    v_mfma_f32_16x16x32_bf16 v[184:187], a[144:147], v[196:199], v[184:187]
    v_add_u32 v23, 0, v9
    v_mfma_f32_16x16x32_bf16 v[188:191], v[144:147], v[240:243], v[188:191]
    v_mfma_f32_16x16x32_bf16 v[188:191], a[136:139], v[244:247], v[188:191]
    v_cmp_gt_u32 vcc, s63, v23
    v_mfma_f32_16x16x32_bf16 v[188:191], a[148:151], v[248:251], v[188:191]
    buffer_load_dwordx4 v[144:147], v36, s[36:39], s55 offen offset:2048 sc1
    v_mfma_f32_16x16x32_bf16 v[188:191], a[152:155], v[252:255], v[188:191]
    v_mfma_f32_16x16x32_bf16 v[188:191], a[156:159], v[192:195], v[188:191]
    ds_read_b128 v[236:239], v14 offset:34848
    v_lshl_add_u32 v23, v23, 12, v28
    v_mfma_f32_16x16x32_bf16 v[188:191], a[128:131], v[196:199], v[188:191]
    v_mfma_f32_16x16x32_bf16 v[188:191], a[144:147], v[200:203], v[188:191]
    s_nop 0
    s_waitcnt lgkmcnt(1)
    v_mfma_f32_16x16x32_bf16 v[160:163], v[116:119], v[204:207], v[160:163]
    s_add_u32 m0, s53, 134144
    v_cndmask_b32 v23, v37, v23, vcc
    v_mfma_f32_16x16x32_bf16 v[160:163], v[124:127], v[208:211], v[160:163]
    buffer_load_dwordx4 v5, s[36:39], s21 offen sc1 lds
    v_mfma_f32_16x16x32_bf16 v[160:163], v[128:131], v[212:215], v[160:163]
    v_mfma_f32_16x16x32_bf16 v[160:163], v[148:151], v[216:219], v[160:163]
    v_add_u32 v24, 1, v9
    v_mfma_f32_16x16x32_bf16 v[160:163], v[152:155], v[220:223], v[160:163]
    v_mfma_f32_16x16x32_bf16 v[160:163], v[156:159], v[224:227], v[160:163]
    ds_read_b128 v[240:243], v14 offset:35936
    v_cmp_gt_u32 vcc, s63, v24
    v_mfma_f32_16x16x32_bf16 v[160:163], v[40:43], v[228:231], v[160:163]
    s_add_u32 s61, s67, 24576
    buffer_load_dwordx4 a[224:227], v36, s[36:39], s61 offen offset:0 sc1
    v_mfma_f32_16x16x32_bf16 v[160:163], v[44:47], v[232:235], v[160:163]
    v_mfma_f32_16x16x32_bf16 v[164:167], v[116:119], v[208:211], v[164:167]
    v_lshl_add_u32 v24, v24, 12, v28
    v_mfma_f32_16x16x32_bf16 v[164:167], v[124:127], v[212:215], v[164:167]
    v_mfma_f32_16x16x32_bf16 v[164:167], v[128:131], v[216:219], v[164:167]
    s_add_u32 s61, s67, 24576
    buffer_load_dwordx4 a[228:231], v36, s[36:39], s61 offen offset:1024 sc1
    v_mfma_f32_16x16x32_bf16 v[164:167], v[148:151], v[220:223], v[164:167]
    s_nop 0
    v_cndmask_b32 v24, v37, v24, vcc
    v_mfma_f32_16x16x32_bf16 v[164:167], v[152:155], v[224:227], v[164:167]
    v_mfma_f32_16x16x32_bf16 v[164:167], v[156:159], v[228:231], v[164:167]
    ds_read_b128 v[244:247], v14 offset:37024
    v_mfma_f32_16x16x32_bf16 v[164:167], v[40:43], v[232:235], v[164:167]
    s_waitcnt lgkmcnt(2)
    v_add_u32 v25, 2, v9
    v_mfma_f32_16x16x32_bf16 v[164:167], v[44:47], v[236:239], v[164:167]
    s_add_u32 s61, s67, 24576
    buffer_load_dwordx4 a[232:235], v36, s[36:39], s61 offen offset:2048 sc1
    v_mfma_f32_16x16x32_bf16 v[168:171], v[116:119], v[212:215], v[168:171]
    v_mfma_f32_16x16x32_bf16 v[168:171], v[124:127], v[216:219], v[168:171]
    v_cmp_gt_u32 vcc, s63, v25
    v_mfma_f32_16x16x32_bf16 v[168:171], v[128:131], v[220:223], v[168:171]
    v_mfma_f32_16x16x32_bf16 v[168:171], v[148:151], v[224:227], v[168:171]
    v_lshl_add_u32 v25, v25, 12, v28
    v_mfma_f32_16x16x32_bf16 v[168:171], v[152:155], v[228:231], v[168:171]
    s_add_u32 s61, s67, 28672
    buffer_load_dwordx4 a[240:243], v36, s[36:39], s61 offen offset:0 sc1
    v_mfma_f32_16x16x32_bf16 v[168:171], v[156:159], v[232:235], v[168:171]
    ds_read_b128 v[248:251], v14 offset:38112
    v_mfma_f32_16x16x32_bf16 v[168:171], v[40:43], v[236:239], v[168:171]
    s_nop 0
    s_waitcnt lgkmcnt(2)
    v_mfma_f32_16x16x32_bf16 v[168:171], v[44:47], v[240:243], v[168:171]
    v_cndmask_b32 v25, v37, v25, vcc
    v_mfma_f32_16x16x32_bf16 v[172:175], v[116:119], v[216:219], v[172:175]
    v_mfma_f32_16x16x32_bf16 v[172:175], v[124:127], v[220:223], v[172:175]
    s_add_u32 s61, s67, 20480
    buffer_load_dwordx4 a[220:223], v36, s[36:39], s61 offen offset:3072 sc1
    v_add_u32 v26, 3, v9
    v_mfma_f32_16x16x32_bf16 v[172:175], v[128:131], v[224:227], v[172:175]
    v_mfma_f32_16x16x32_bf16 v[172:175], v[148:151], v[228:231], v[172:175]
    v_mfma_f32_16x16x32_bf16 v[172:175], v[152:155], v[232:235], v[172:175]
    v_cmp_gt_u32 vcc, s63, v26
    v_mfma_f32_16x16x32_bf16 v[172:175], v[156:159], v[236:239], v[172:175]
    ds_read_b128 v[252:255], v14 offset:39200
    v_mfma_f32_16x16x32_bf16 v[172:175], v[40:43], v[240:243], v[172:175]
    s_waitcnt lgkmcnt(2)
    s_add_u32 s61, s67, 12288
    buffer_load_dwordx4 a[188:191], v36, s[36:39], s61 offen offset:3072 sc1
    v_mfma_f32_16x16x32_bf16 v[172:175], v[44:47], v[244:247], v[172:175]
    v_lshl_add_u32 v26, v26, 12, v28
    v_mfma_f32_16x16x32_bf16 v[176:179], v[116:119], v[220:223], v[176:179]
    v_mfma_f32_16x16x32_bf16 v[176:179], v[124:127], v[224:227], v[176:179]
    s_nop 0
    v_mfma_f32_16x16x32_bf16 v[176:179], v[128:131], v[228:231], v[176:179]
    v_cndmask_b32 v26, v37, v26, vcc
    v_mfma_f32_16x16x32_bf16 v[176:179], v[148:151], v[232:235], v[176:179]
    s_add_u32 s61, s67, 0
    buffer_load_dwordx4 a[140:143], v36, s[36:39], s61 offen offset:3072 sc1
    v_mfma_f32_16x16x32_bf16 v[176:179], v[152:155], v[236:239], v[176:179]
    ds_read_b128 v[192:195], v14 offset:40288
    v_mfma_f32_16x16x32_bf16 v[176:179], v[156:159], v[240:243], v[176:179]
    v_add_u32 v27, 4, v9
    v_mfma_f32_16x16x32_bf16 v[176:179], v[40:43], v[244:247], v[176:179]
    s_waitcnt lgkmcnt(2)
    ds_read_b128 v[196:199], v14 offset:41376
    v_mfma_f32_16x16x32_bf16 v[176:179], v[44:47], v[248:251], v[176:179]
    v_mfma_f32_16x16x32_bf16 v[180:183], v[116:119], v[224:227], v[180:183]
    ds_read_b128 v[200:203], v14 offset:35360
    v_cmp_gt_u32 vcc, s63, v27
    v_mfma_f32_16x16x32_bf16 v[180:183], v[124:127], v[228:231], v[180:183]
    s_add_u32 s61, s67, 8192
    buffer_load_dwordx4 a[164:167], v36, s[36:39], s61 offen offset:1024 sc1
    v_mfma_f32_16x16x32_bf16 v[180:183], v[128:131], v[232:235], v[180:183]
    ds_read_b128 v[204:207], v14 offset:36448
    v_mfma_f32_16x16x32_bf16 v[180:183], v[148:151], v[236:239], v[180:183]
    v_lshl_add_u32 v27, v27, 12, v28
    v_mfma_f32_16x16x32_bf16 v[180:183], v[152:155], v[240:243], v[180:183]
    ds_read_b128 v[208:211], v14 offset:37536
    v_mfma_f32_16x16x32_bf16 v[180:183], v[156:159], v[244:247], v[180:183]
    s_add_u32 s61, s67, 8192
    buffer_load_dwordx4 a[168:171], v36, s[36:39], s61 offen offset:2048 sc1
    v_mfma_f32_16x16x32_bf16 v[180:183], v[40:43], v[248:251], v[180:183]
    s_waitcnt lgkmcnt(4)
    ds_read_b128 v[212:215], v14 offset:38624
    v_mfma_f32_16x16x32_bf16 v[180:183], v[44:47], v[252:255], v[180:183]
    s_nop 0
    v_mfma_f32_16x16x32_bf16 v[184:187], v[116:119], v[228:231], v[184:187]
    ds_read_b128 v[216:219], v14 offset:39712
    v_cndmask_b32 v27, v37, v27, vcc
    v_mfma_f32_16x16x32_bf16 v[184:187], v[124:127], v[232:235], v[184:187]
    v_mfma_f32_16x16x32_bf16 v[184:187], v[128:131], v[236:239], v[184:187]
    ds_read_b128 v[220:223], v14 offset:40800
    v_mfma_f32_16x16x32_bf16 v[184:187], v[148:151], v[240:243], v[184:187]
    s_add_u32 s61, s67, 8192
    buffer_load_dwordx4 a[172:175], v36, s[36:39], s61 offen offset:3072 sc1
    v_add_u32 v30, 5, v9
    v_mfma_f32_16x16x32_bf16 v[184:187], v[152:155], v[244:247], v[184:187]
    ds_read_b128 v[224:227], v14 offset:41888
    v_mfma_f32_16x16x32_bf16 v[184:187], v[156:159], v[248:251], v[184:187]
    v_mfma_f32_16x16x32_bf16 v[184:187], v[40:43], v[252:255], v[184:187]
    v_cmp_gt_u32 vcc, s63, v30
    v_mfma_f32_16x16x32_bf16 v[184:187], v[44:47], v[192:195], v[184:187]
    s_add_u32 s61, s67, 12288
    buffer_load_dwordx4 a[176:179], v36, s[36:39], s61 offen offset:0 sc1
    v_mfma_f32_16x16x32_bf16 v[188:191], v[116:119], v[232:235], v[188:191]
    v_mfma_f32_16x16x32_bf16 v[188:191], v[124:127], v[236:239], v[188:191]
    v_lshl_add_u32 v30, v30, 12, v28
    v_mfma_f32_16x16x32_bf16 v[188:191], v[128:131], v[240:243], v[188:191]
    v_mfma_f32_16x16x32_bf16 v[188:191], v[148:151], v[244:247], v[188:191]
    ds_read_b128 v[228:231], v14 offset:42976
    s_nop 0
    v_mfma_f32_16x16x32_bf16 v[188:191], v[152:155], v[248:251], v[188:191]
    s_add_u32 s55, s13, 0
    buffer_load_dwordx4 v[116:119], v36, s[36:39], s55 offen offset:0 sc1
    v_mfma_f32_16x16x32_bf16 v[188:191], v[156:159], v[252:255], v[188:191]
    v_cndmask_b32 v30, v37, v30, vcc
    v_mfma_f32_16x16x32_bf16 v[188:191], v[40:43], v[192:195], v[188:191]
    s_waitcnt lgkmcnt(1)
    v_mfma_f32_16x16x32_bf16 v[188:191], v[44:47], v[196:199], v[188:191]
    s_waitcnt vmcnt(37)
    v_add_u32 v31, 6, v9
    v_mfma_f32_16x16x32_bf16 v[160:163], v[48:51], v[200:203], v[160:163]
    v_mfma_f32_16x16x32_bf16 v[160:163], v[52:55], v[204:207], v[160:163]
    buffer_load_dwordx4 v[40:43], v36, s[36:39], s55 offen offset:1024 sc1
    v_cmp_gt_u32 vcc, s63, v31
    v_mfma_f32_16x16x32_bf16 v[160:163], v[56:59], v[208:211], v[160:163]
    ds_read_b128 v[232:235], v14 offset:35392
    v_mfma_f32_16x16x32_bf16 v[160:163], v[60:63], v[212:215], v[160:163]
    v_mfma_f32_16x16x32_bf16 v[160:163], v[64:67], v[216:219], v[160:163]
    v_lshl_add_u32 v31, v31, 12, v28
    v_mfma_f32_16x16x32_bf16 v[160:163], v[68:71], v[220:223], v[160:163]
    v_mfma_f32_16x16x32_bf16 v[160:163], v[72:75], v[224:227], v[160:163]
    buffer_load_dwordx4 v[44:47], v36, s[36:39], s55 offen offset:2048 sc1
    v_mfma_f32_16x16x32_bf16 v[164:167], v[48:51], v[204:207], v[164:167]
    s_nop 0
    v_mfma_f32_16x16x32_bf16 v[164:167], v[52:55], v[208:211], v[164:167]
    v_cndmask_b32 v31, v37, v31, vcc
    v_mfma_f32_16x16x32_bf16 v[164:167], v[56:59], v[212:215], v[164:167]
    ds_read_b128 v[236:239], v14 offset:36480
    v_mfma_f32_16x16x32_bf16 v[164:167], v[60:63], v[216:219], v[164:167]
    v_add_u32 v11, 7, v9
    v_mfma_f32_16x16x32_bf16 v[164:167], v[64:67], v[220:223], v[164:167]
    buffer_load_dwordx4 v[124:127], v36, s[36:39], s55 offen offset:3072 sc1
    v_mfma_f32_16x16x32_bf16 v[164:167], v[68:71], v[224:227], v[164:167]
    s_waitcnt lgkmcnt(1)
    v_mfma_f32_16x16x32_bf16 v[164:167], v[72:75], v[228:231], v[164:167]
    v_cmp_gt_u32 vcc, s63, v11
    v_mfma_f32_16x16x32_bf16 v[168:171], v[48:51], v[208:211], v[168:171]
    v_mfma_f32_16x16x32_bf16 v[168:171], v[52:55], v[212:215], v[168:171]
    v_lshl_add_u32 v11, v11, 12, v28
    v_mfma_f32_16x16x32_bf16 v[168:171], v[56:59], v[216:219], v[168:171]
    ds_read_b128 v[240:243], v14 offset:37568
    v_mfma_f32_16x16x32_bf16 v[168:171], v[60:63], v[220:223], v[168:171]
    s_add_u32 s55, s13, 4096
    buffer_load_dwordx4 v[128:131], v36, s[36:39], s55 offen offset:0 sc1
    v_mfma_f32_16x16x32_bf16 v[168:171], v[64:67], v[224:227], v[168:171]
    s_nop 0
    v_mfma_f32_16x16x32_bf16 v[168:171], v[68:71], v[228:231], v[168:171]
    v_cndmask_b32 v11, v37, v11, vcc
    v_mfma_f32_16x16x32_bf16 v[168:171], v[72:75], v[232:235], v[168:171]
    v_mfma_f32_16x16x32_bf16 v[172:175], v[48:51], v[212:215], v[172:175]
    s_add_u32 s61, s67, 12288
    buffer_load_dwordx4 a[180:183], v36, s[36:39], s61 offen offset:1024 sc1
    v_mfma_f32_16x16x32_bf16 v[172:175], v[52:55], v[216:219], v[172:175]
    s_mul_i32 s63, s50, 125
    s_add_u32 s63, s63, s62
    v_mfma_f32_16x16x32_bf16 v[172:175], v[56:59], v[220:223], v[172:175]
    ds_read_b128 v[244:247], v14 offset:38656
    v_mfma_f32_16x16x32_bf16 v[172:175], v[60:63], v[224:227], v[172:175]
    s_waitcnt vmcnt(35)
    s_barrier
    s_lshl2_add_u32 s70, s50, s49
    v_mfma_f32_16x16x32_bf16 v[172:175], v[64:67], v[228:231], v[172:175]
    s_lshl_b32 s70, s70, 14
    v_mfma_f32_16x16x32_bf16 v[172:175], v[68:71], v[232:235], v[172:175]
    s_waitcnt lgkmcnt(1)
    s_add_u32 s70, s70, 10485760
    buffer_load_dwordx4 v[148:151], v36, s[36:39], s55 offen offset:1024 sc1
    v_mfma_f32_16x16x32_bf16 v[172:175], v[72:75], v[236:239], v[172:175]
    ds_read_b128 v[248:251], v14 offset:39744
    v_mfma_f32_16x16x32_bf16 v[176:179], v[48:51], v[216:219], v[176:179]
    s_add_u32 s76, s66, 8192
    v_mfma_f32_16x16x32_bf16 v[176:179], v[52:55], v[220:223], v[176:179]
    s_lshl_b32 s71, s63, 12
    ds_read_b128 v[252:255], v14 offset:40832
    v_mfma_f32_16x16x32_bf16 v[176:179], v[56:59], v[224:227], v[176:179]
    s_mov_b32 s40, s18
    v_mfma_f32_16x16x32_bf16 v[176:179], v[60:63], v[228:231], v[176:179]
    s_mov_b32 s41, s19
    ds_read_b128 v[192:195], v15 offset:0
    v_mfma_f32_16x16x32_bf16 v[176:179], v[64:67], v[232:235], v[176:179]
    buffer_load_dwordx4 v[152:155], v36, s[36:39], s55 offen offset:2048 sc1
    v_mfma_f32_16x16x32_bf16 v[176:179], v[68:71], v[236:239], v[176:179]
    s_mov_b32 s42, 32768000
    ds_read_b128 v[196:199], v15 offset:1088
    v_mfma_f32_16x16x32_bf16 v[176:179], v[72:75], v[240:243], v[176:179]
    s_mov_b32 s72, 1077455419
    v_mfma_f32_16x16x32_bf16 v[180:183], v[48:51], v[220:223], v[180:183]
    ds_read_b128 v[200:203], v15 offset:2176
    v_mfma_f32_16x16x32_bf16 v[180:183], v[52:55], v[224:227], v[180:183]
    buffer_load_dwordx4 v[156:159], v36, s[36:39], s55 offen offset:3072 sc1
    v_mfma_f32_16x16x32_bf16 v[180:183], v[56:59], v[228:231], v[180:183]
    ds_read_b128 v[204:207], v15 offset:3264
    v_mfma_f32_16x16x32_bf16 v[180:183], v[60:63], v[232:235], v[180:183]
    v_mfma_f32_16x16x32_bf16 v[180:183], v[64:67], v[236:239], v[180:183]
    ds_read_b128 v[208:211], v15 offset:4352
    v_mfma_f32_16x16x32_bf16 v[180:183], v[68:71], v[240:243], v[180:183]
    s_waitcnt lgkmcnt(5)
    v_mfma_f32_16x16x32_bf16 v[180:183], v[72:75], v[244:247], v[180:183]
    ds_read_b128 v[212:215], v15 offset:5440
    v_mfma_f32_16x16x32_bf16 v[184:187], v[48:51], v[224:227], v[184:187]
    s_add_u32 s61, s67, 12288
    buffer_load_dwordx4 a[184:187], v36, s[36:39], s61 offen offset:2048 sc1
    v_mfma_f32_16x16x32_bf16 v[184:187], v[52:55], v[228:231], v[184:187]
    ds_read_b128 v[216:219], v15 offset:6528
    v_mfma_f32_16x16x32_bf16 v[184:187], v[56:59], v[232:235], v[184:187]
    v_mfma_f32_16x16x32_bf16 v[184:187], v[60:63], v[236:239], v[184:187]
    ds_read_b128 v[220:223], v15 offset:7616
    v_mfma_f32_16x16x32_bf16 v[184:187], v[64:67], v[240:243], v[184:187]
    s_add_u32 s61, s67, 16384
    buffer_load_dwordx4 a[192:195], v36, s[36:39], s61 offen offset:0 sc1
    v_mfma_f32_16x16x32_bf16 v[184:187], v[68:71], v[244:247], v[184:187]
    v_mfma_f32_16x16x32_bf16 v[184:187], v[72:75], v[248:251], v[184:187]
    v_mfma_f32_16x16x32_bf16 v[188:191], v[48:51], v[228:231], v[188:191]
    v_mfma_f32_16x16x32_bf16 v[188:191], v[52:55], v[232:235], v[188:191]
    v_mfma_f32_16x16x32_bf16 v[188:191], v[56:59], v[236:239], v[188:191]
    s_add_u32 s55, s13, 8192
    buffer_load_dwordx4 v[48:51], v36, s[36:39], s55 offen offset:0 sc1
    v_mfma_f32_16x16x32_bf16 v[188:191], v[60:63], v[240:243], v[188:191]
    v_mfma_f32_16x16x32_bf16 v[188:191], v[64:67], v[244:247], v[188:191]
    ds_read_b128 v[224:227], v15 offset:32
    v_mfma_f32_16x16x32_bf16 v[188:191], v[68:71], v[248:251], v[188:191]
    v_mfma_f32_16x16x32_bf16 v[188:191], v[72:75], v[252:255], v[188:191]
    s_waitcnt vmcnt(35) lgkmcnt(1)
    v_mfma_f32_16x16x32_bf16 v[160:163], v[76:79], v[192:195], v[160:163]
    buffer_load_dwordx4 v[52:55], v36, s[36:39], s55 offen offset:1024 sc1
    v_mfma_f32_16x16x32_bf16 v[160:163], v[80:83], v[196:199], v[160:163]
    v_mfma_f32_16x16x32_bf16 v[160:163], v[84:87], v[200:203], v[160:163]
    v_mfma_f32_16x16x32_bf16 v[160:163], v[88:91], v[204:207], v[160:163]
    v_mfma_f32_16x16x32_bf16 v[160:163], v[92:95], v[208:211], v[160:163]
    ds_read_b128 v[228:231], v15 offset:1120
    v_mfma_f32_16x16x32_bf16 v[160:163], v[96:99], v[212:215], v[160:163]
    buffer_load_dwordx4 v[56:59], v36, s[36:39], s55 offen offset:2048 sc1
    v_mfma_f32_16x16x32_bf16 v[160:163], v[100:103], v[216:219], v[160:163]
    ds_read_b128 v[232:235], v15 offset:2208
    v_mfma_f32_16x16x32_bf16 v[160:163], v[104:107], v[220:223], v[160:163]
    v_mfma_f32_16x16x32_bf16 v[164:167], v[76:79], v[196:199], v[164:167]
    ds_read_b128 v[236:239], v15 offset:544
    v_mfma_f32_16x16x32_bf16 v[164:167], v[80:83], v[200:203], v[164:167]
    v_mfma_f32_16x16x32_bf16 v[164:167], v[84:87], v[204:207], v[164:167]
    ds_read_b128 v[240:243], v15 offset:1632
    v_mfma_f32_16x16x32_bf16 v[164:167], v[88:91], v[208:211], v[164:167]
    s_add_u32 s61, s67, 16384
    buffer_load_dwordx4 a[196:199], v36, s[36:39], s61 offen offset:1024 sc1
    v_mfma_f32_16x16x32_bf16 v[164:167], v[92:95], v[212:215], v[164:167]
    ds_read_b128 v[244:247], v15 offset:2720
    v_mfma_f32_16x16x32_bf16 v[164:167], v[96:99], v[216:219], v[164:167]
    v_mfma_f32_16x16x32_bf16 v[164:167], v[100:103], v[220:223], v[164:167]
    s_waitcnt lgkmcnt(4)
    ds_read_b128 v[248:251], v15 offset:3808
    v_mfma_f32_16x16x32_bf16 v[164:167], v[104:107], v[224:227], v[164:167]
    buffer_load_dwordx4 v[60:63], v36, s[36:39], s55 offen offset:3072 sc1
    v_mfma_f32_16x16x32_bf16 v[168:171], v[76:79], v[200:203], v[168:171]
    ds_read_b128 v[252:255], v15 offset:4896
    v_mfma_f32_16x16x32_bf16 v[168:171], v[80:83], v[204:207], v[168:171]
    v_mfma_f32_16x16x32_bf16 v[168:171], v[84:87], v[208:211], v[168:171]
    ds_read_b128 v[192:195], v15 offset:5984
    v_mfma_f32_16x16x32_bf16 v[168:171], v[88:91], v[212:215], v[168:171]
    v_mfma_f32_16x16x32_bf16 v[168:171], v[92:95], v[216:219], v[168:171]
    ds_read_b128 v[196:199], v15 offset:7072
    v_mfma_f32_16x16x32_bf16 v[168:171], v[96:99], v[220:223], v[168:171]
    s_add_u32 s55, s13, 12288
    buffer_load_dwordx4 v[64:67], v36, s[36:39], s55 offen offset:0 sc1
    v_mfma_f32_16x16x32_bf16 v[168:171], v[100:103], v[224:227], v[168:171]
    v_mfma_f32_16x16x32_bf16 v[168:171], v[104:107], v[228:231], v[168:171]
    v_mfma_f32_16x16x32_bf16 v[172:175], v[76:79], v[204:207], v[172:175]
    v_mfma_f32_16x16x32_bf16 v[172:175], v[80:83], v[208:211], v[172:175]
    buffer_load_dwordx4 v[68:71], v36, s[36:39], s55 offen offset:1024 sc1
    v_mfma_f32_16x16x32_bf16 v[172:175], v[84:87], v[212:215], v[172:175]
    v_mfma_f32_16x16x32_bf16 v[172:175], v[88:91], v[216:219], v[172:175]
    ds_read_b128 v[200:203], v15 offset:8160
    v_mfma_f32_16x16x32_bf16 v[172:175], v[92:95], v[220:223], v[172:175]
    s_waitcnt vmcnt(29)
    s_barrier
    v_mfma_f32_16x16x32_bf16 v[172:175], v[96:99], v[224:227], v[172:175]
    v_mfma_f32_16x16x32_bf16 v[172:175], v[100:103], v[228:231], v[172:175]
    s_waitcnt lgkmcnt(1)
    buffer_load_dwordx4 v[72:75], v36, s[36:39], s55 offen offset:2048 sc1
    v_mfma_f32_16x16x32_bf16 v[172:175], v[104:107], v[232:235], v[172:175]
    ds_read_b128 v[204:207], v15 offset:576
    v_mfma_f32_16x16x32_bf16 v[160:163], v[108:111], v[236:239], v[160:163]
    v_mfma_f32_16x16x32_bf16 v[160:163], v[112:115], v[240:243], v[160:163]
    ds_read_b128 v[208:211], v15 offset:1664
    v_mfma_f32_16x16x32_bf16 v[160:163], v[120:123], v[244:247], v[160:163]
    v_mfma_f32_16x16x32_bf16 v[160:163], v[132:135], v[248:251], v[160:163]
    ds_read_b128 v[212:215], v15 offset:17408
    v_mfma_f32_16x16x32_bf16 v[160:163], v[136:139], v[252:255], v[160:163]
    s_add_u32 s61, s67, 16384
    buffer_load_dwordx4 a[200:203], v36, s[36:39], s61 offen offset:2048 sc1
    v_mfma_f32_16x16x32_bf16 v[160:163], v[140:143], v[192:195], v[160:163]
    ds_read_b128 v[216:219], v15 offset:18496
    v_mfma_f32_16x16x32_bf16 v[160:163], v[144:147], v[196:199], v[160:163]
    v_mfma_f32_16x16x32_bf16 v[164:167], v[108:111], v[240:243], v[164:167]
    ds_read_b128 v[220:223], v15 offset:19584
    v_mfma_f32_16x16x32_bf16 v[164:167], v[112:115], v[244:247], v[164:167]
    s_add_u32 s61, s67, 16384
    buffer_load_dwordx4 a[204:207], v36, s[36:39], s61 offen offset:3072 sc1
    v_mfma_f32_16x16x32_bf16 v[164:167], v[120:123], v[248:251], v[164:167]
    ds_read_b128 v[224:227], v15 offset:20672
    v_mfma_f32_16x16x32_bf16 v[164:167], v[132:135], v[252:255], v[164:167]
    v_mfma_f32_16x16x32_bf16 v[164:167], v[136:139], v[192:195], v[164:167]
    ds_read_b128 v[228:231], v15 offset:21760
    v_mfma_f32_16x16x32_bf16 v[164:167], v[140:143], v[196:199], v[164:167]
    s_waitcnt lgkmcnt(5)
    v_mfma_f32_16x16x32_bf16 v[164:167], v[144:147], v[200:203], v[164:167]
    ds_read_b128 v[232:235], v15 offset:22848
    v_mfma_f32_16x16x32_bf16 v[168:171], v[108:111], v[244:247], v[168:171]
    s_add_u32 s61, s67, 20480
    buffer_load_dwordx4 a[208:211], v36, s[36:39], s61 offen offset:0 sc1
    v_mfma_f32_16x16x32_bf16 v[168:171], v[112:115], v[248:251], v[168:171]
    ds_read_b128 v[236:239], v15 offset:23936
    v_mfma_f32_16x16x32_bf16 v[168:171], v[120:123], v[252:255], v[168:171]
    v_mfma_f32_16x16x32_bf16 v[168:171], v[132:135], v[192:195], v[168:171]
    ds_read_b128 v[240:243], v15 offset:25024
    v_mfma_f32_16x16x32_bf16 v[168:171], v[136:139], v[196:199], v[168:171]
    s_add_u32 s61, s67, 20480
    buffer_load_dwordx4 a[212:215], v36, s[36:39], s61 offen offset:1024 sc1
    v_mfma_f32_16x16x32_bf16 v[168:171], v[140:143], v[200:203], v[168:171]
    v_mfma_f32_16x16x32_bf16 v[168:171], v[144:147], v[204:207], v[168:171]
    v_mfma_f32_16x16x32_bf16 v[172:175], v[108:111], v[248:251], v[172:175]
    v_mfma_f32_16x16x32_bf16 v[172:175], v[112:115], v[252:255], v[172:175]
    v_mfma_f32_16x16x32_bf16 v[172:175], v[120:123], v[192:195], v[172:175]
    s_add_u32 s61, s67, 20480
    buffer_load_dwordx4 a[216:219], v36, s[36:39], s61 offen offset:2048 sc1
    v_mfma_f32_16x16x32_bf16 v[172:175], v[132:135], v[196:199], v[172:175]
    v_mfma_f32_16x16x32_bf16 v[172:175], v[136:139], v[200:203], v[172:175]
    ds_read_b128 v[244:247], v15 offset:17440
    v_mfma_f32_16x16x32_bf16 v[172:175], v[140:143], v[204:207], v[172:175]
    v_mfma_f32_16x16x32_bf16 v[172:175], v[144:147], v[208:211], v[172:175]
    s_waitcnt vmcnt(15) lgkmcnt(1)
    v_mfma_f32_16x16x32_bf16 v[160:163], v[116:119], v[212:215], v[160:163]
    s_add_u32 s61, s67, 24576
    buffer_load_dwordx4 a[236:239], v36, s[36:39], s61 offen offset:3072 sc1
    v_mfma_f32_16x16x32_bf16 v[160:163], v[40:43], v[216:219], v[160:163]
    v_mfma_f32_16x16x32_bf16 v[160:163], v[44:47], v[220:223], v[160:163]
    v_mfma_f32_16x16x32_bf16 v[160:163], v[124:127], v[224:227], v[160:163]
    v_mfma_f32_16x16x32_bf16 v[160:163], v[128:131], v[228:231], v[160:163]
    ds_read_b128 v[248:251], v15 offset:18528
    v_mfma_f32_16x16x32_bf16 v[160:163], v[148:151], v[232:235], v[160:163]
    s_add_u32 s61, s67, 28672
    buffer_load_dwordx4 a[244:247], v36, s[36:39], s61 offen offset:1024 sc1
    v_mfma_f32_16x16x32_bf16 v[160:163], v[152:155], v[236:239], v[160:163]
    ds_read_b128 v[252:255], v15 offset:19616
    v_mfma_f32_16x16x32_bf16 v[160:163], v[156:159], v[240:243], v[160:163]
    v_mfma_f32_16x16x32_bf16 v[164:167], v[116:119], v[216:219], v[164:167]
    ds_read_b128 v[192:195], v15 offset:17952
    v_mfma_f32_16x16x32_bf16 v[164:167], v[40:43], v[220:223], v[164:167]
    v_mfma_f32_16x16x32_bf16 v[164:167], v[44:47], v[224:227], v[164:167]
    ds_read_b128 v[196:199], v15 offset:19040
    v_mfma_f32_16x16x32_bf16 v[164:167], v[124:127], v[228:231], v[164:167]
    s_add_u32 s61, s67, 28672
    buffer_load_dwordx4 a[248:251], v36, s[36:39], s61 offen offset:2048 sc1
    v_mfma_f32_16x16x32_bf16 v[164:167], v[128:131], v[232:235], v[164:167]
    ds_read_b128 v[200:203], v15 offset:20128
    v_mfma_f32_16x16x32_bf16 v[164:167], v[148:151], v[236:239], v[164:167]
    v_mfma_f32_16x16x32_bf16 v[164:167], v[152:155], v[240:243], v[164:167]
    s_waitcnt lgkmcnt(4)
    ds_read_b128 v[204:207], v15 offset:21216
    v_mfma_f32_16x16x32_bf16 v[164:167], v[156:159], v[244:247], v[164:167]
    s_add_u32 s61, s67, 28672
    buffer_load_dwordx4 a[252:255], v36, s[36:39], s61 offen offset:3072 sc1
    v_mfma_f32_16x16x32_bf16 v[168:171], v[116:119], v[220:223], v[168:171]
    ds_read_b128 v[208:211], v15 offset:22304
    v_mfma_f32_16x16x32_bf16 v[168:171], v[40:43], v[224:227], v[168:171]
    v_mfma_f32_16x16x32_bf16 v[168:171], v[44:47], v[228:231], v[168:171]
    ds_read_b128 v[212:215], v15 offset:23392
    v_mfma_f32_16x16x32_bf16 v[168:171], v[124:127], v[232:235], v[168:171]
    v_mfma_f32_16x16x32_bf16 v[168:171], v[128:131], v[236:239], v[168:171]
    ds_read_b128 v[216:219], v15 offset:24480
    v_mfma_f32_16x16x32_bf16 v[168:171], v[148:151], v[240:243], v[168:171]
    s_add_u32 s61, s67, 0
    buffer_load_dwordx4 a[132:135], v36, s[36:39], s61 offen offset:1024 sc1
    v_mfma_f32_16x16x32_bf16 v[168:171], v[152:155], v[244:247], v[168:171]
    v_mfma_f32_16x16x32_bf16 v[168:171], v[156:159], v[248:251], v[168:171]
    v_mfma_f32_16x16x32_bf16 v[172:175], v[116:119], v[224:227], v[172:175]
    v_mfma_f32_16x16x32_bf16 v[172:175], v[40:43], v[228:231], v[172:175]
    s_add_u32 s61, s67, 0
    buffer_load_dwordx4 a[136:139], v36, s[36:39], s61 offen offset:2048 sc1
    v_mfma_f32_16x16x32_bf16 v[172:175], v[44:47], v[232:235], v[172:175]
    v_mfma_f32_16x16x32_bf16 v[172:175], v[124:127], v[236:239], v[172:175]
    ds_read_b128 v[220:223], v15 offset:25568
    v_mfma_f32_16x16x32_bf16 v[172:175], v[128:131], v[240:243], v[172:175]
    v_mfma_f32_16x16x32_bf16 v[172:175], v[148:151], v[244:247], v[172:175]
    v_mfma_f32_16x16x32_bf16 v[172:175], v[152:155], v[248:251], v[172:175]
    s_waitcnt lgkmcnt(1)
    s_add_u32 s61, s67, 4096
    buffer_load_dwordx4 a[148:151], v36, s[36:39], s61 offen offset:1024 sc1
    v_mfma_f32_16x16x32_bf16 v[172:175], v[156:159], v[252:255], v[172:175]
    s_waitcnt vmcnt(12)
    ds_read_b128 v[224:227], v15 offset:17984
    v_mfma_f32_16x16x32_bf16 v[160:163], v[48:51], v[192:195], v[160:163]
    v_mfma_f32_16x16x32_bf16 v[160:163], v[52:55], v[196:199], v[160:163]
    ds_read_b128 v[228:231], v15 offset:19072
    v_mfma_f32_16x16x32_bf16 v[160:163], v[56:59], v[200:203], v[160:163]
    v_mfma_f32_16x16x32_bf16 v[160:163], v[60:63], v[204:207], v[160:163]
    ds_read_b128 v[232:235], v15 offset:4352
    v_mfma_f32_16x16x32_bf16 v[160:163], v[64:67], v[208:211], v[160:163]
    s_add_u32 s61, s67, 4096
    buffer_load_dwordx4 a[152:155], v36, s[36:39], s61 offen offset:2048 sc1
    v_mfma_f32_16x16x32_bf16 v[160:163], v[68:71], v[212:215], v[160:163]
    ds_read_b128 v[236:239], v15 offset:5440
    v_mfma_f32_16x16x32_bf16 v[160:163], v[72:75], v[216:219], v[160:163]
    v_mfma_f32_16x16x32_bf16 v[164:167], v[48:51], v[196:199], v[164:167]
    ds_read_b128 v[240:243], v15 offset:6528
    v_mfma_f32_16x16x32_bf16 v[164:167], v[52:55], v[200:203], v[164:167]
    s_add_u32 s61, s67, 4096
    buffer_load_dwordx4 a[156:159], v36, s[36:39], s61 offen offset:3072 sc1
    v_mfma_f32_16x16x32_bf16 v[164:167], v[56:59], v[204:207], v[164:167]
    ds_read_b128 v[244:247], v15 offset:7616
    v_mfma_f32_16x16x32_bf16 v[164:167], v[60:63], v[208:211], v[164:167]
    v_mfma_f32_16x16x32_bf16 v[164:167], v[64:67], v[212:215], v[164:167]
    ds_read_b128 v[248:251], v15 offset:32
    v_mfma_f32_16x16x32_bf16 v[164:167], v[68:71], v[216:219], v[164:167]
    s_waitcnt lgkmcnt(5)
    v_mfma_f32_16x16x32_bf16 v[164:167], v[72:75], v[220:223], v[164:167]
    ds_read_b128 v[252:255], v15 offset:1120
    v_mfma_f32_16x16x32_bf16 v[168:171], v[48:51], v[200:203], v[168:171]
    s_add_u32 s61, s67, 0
    buffer_load_dwordx4 a[128:131], v36, s[36:39], s61 offen offset:0 sc1
    v_mfma_f32_16x16x32_bf16 v[168:171], v[52:55], v[204:207], v[168:171]
    ds_read_b128 v[192:195], v15 offset:2208
    v_mfma_f32_16x16x32_bf16 v[168:171], v[56:59], v[208:211], v[168:171]
    v_mfma_f32_16x16x32_bf16 v[168:171], v[60:63], v[212:215], v[168:171]
    ds_read_b128 v[196:199], v15 offset:3296
    v_mfma_f32_16x16x32_bf16 v[168:171], v[64:67], v[216:219], v[168:171]
    s_add_u32 s61, s67, 4096
    buffer_load_dwordx4 a[144:147], v36, s[36:39], s61 offen offset:0 sc1
    v_mfma_f32_16x16x32_bf16 v[168:171], v[68:71], v[220:223], v[168:171]
    v_mfma_f32_16x16x32_bf16 v[168:171], v[72:75], v[224:227], v[168:171]
    v_mfma_f32_16x16x32_bf16 v[172:175], v[48:51], v[204:207], v[172:175]
    v_mfma_f32_16x16x32_bf16 v[172:175], v[52:55], v[208:211], v[172:175]
    v_mfma_f32_16x16x32_bf16 v[172:175], v[56:59], v[212:215], v[172:175]
    v_mfma_f32_16x16x32_bf16 v[172:175], v[60:63], v[216:219], v[172:175]
    v_mfma_f32_16x16x32_bf16 v[172:175], v[64:67], v[220:223], v[172:175]
    ds_read_b128 v[200:203], v15 offset:4384
    v_mfma_f32_16x16x32_bf16 v[172:175], v[68:71], v[224:227], v[172:175]
    v_mfma_f32_16x16x32_bf16 v[172:175], v[72:75], v[228:231], v[172:175]
    v_pk_mul_f32 v[2:3], v[160:161], v[160:161]
    v_pk_mul_f32 v[4:5], v[162:163], v[162:163]
    v_pk_mul_f32 v[6:7], v[164:165], v[164:165]
    v_pk_mul_f32 v[8:9], v[166:167], v[166:167]
    v_pk_fma_f32 v[2:3], v[2:3], s[56:57], v[12:13]
    v_pk_fma_f32 v[4:5], v[4:5], s[56:57], v[12:13]
    v_pk_fma_f32 v[6:7], v[6:7], s[56:57], v[12:13]
    v_pk_fma_f32 v[8:9], v[8:9], s[56:57], v[12:13]
    v_pk_mul_f32 v[2:3], v[2:3], v[160:161]
    v_pk_mul_f32 v[4:5], v[4:5], v[162:163]
    v_pk_mul_f32 v[6:7], v[6:7], v[164:165]
    v_pk_mul_f32 v[8:9], v[8:9], v[166:167]
    v_exp_f32 v2, v2
    v_exp_f32 v3, v3
    v_exp_f32 v4, v4
    v_exp_f32 v5, v5
    v_exp_f32 v6, v6
    v_exp_f32 v7, v7
    v_exp_f32 v8, v8
    v_exp_f32 v9, v9
    v_pk_add_f32 v[2:3], v[2:3], s[58:59]
    v_pk_add_f32 v[4:5], v[4:5], s[58:59]
    v_pk_add_f32 v[6:7], v[6:7], s[58:59]
    v_pk_add_f32 v[8:9], v[8:9], s[58:59]
    v_rcp_f32 v2, v2
    v_rcp_f32 v3, v3
    v_rcp_f32 v4, v4
    v_rcp_f32 v5, v5
    v_rcp_f32 v6, v6
    v_rcp_f32 v7, v7
    v_rcp_f32 v8, v8
    v_rcp_f32 v9, v9
    v_pk_mul_f32 v[2:3], v[2:3], v[160:161]
    v_pk_mul_f32 v[4:5], v[4:5], v[162:163]
    v_pk_mul_f32 v[6:7], v[6:7], v[164:165]
    v_pk_mul_f32 v[8:9], v[8:9], v[166:167]
    v_cvt_pk_bf16_f32 v160, v2, v3
    v_cvt_pk_bf16_f32 v162, v6, v7
    v_cvt_pk_bf16_f32 v161, v4, v5
    v_cvt_pk_bf16_f32 v163, v8, v9
    s_nop 0
    v_permlane32_swap_b32 v160, v162
    v_permlane32_swap_b32 v161, v163
    buffer_store_dwordx4 v[160:163], v16, s[36:39], s66 offen offset:0 sc1
    v_pk_mul_f32 v[2:3], v[168:169], v[168:169]
    v_pk_mul_f32 v[4:5], v[170:171], v[170:171]
    v_pk_mul_f32 v[6:7], v[172:173], v[172:173]
    v_pk_mul_f32 v[8:9], v[174:175], v[174:175]
    v_pk_fma_f32 v[2:3], v[2:3], s[56:57], v[12:13]
    v_pk_fma_f32 v[4:5], v[4:5], s[56:57], v[12:13]
    v_pk_fma_f32 v[6:7], v[6:7], s[56:57], v[12:13]
    v_pk_fma_f32 v[8:9], v[8:9], s[56:57], v[12:13]
    v_pk_mul_f32 v[2:3], v[2:3], v[168:169]
    v_pk_mul_f32 v[4:5], v[4:5], v[170:171]
    v_pk_mul_f32 v[6:7], v[6:7], v[172:173]
    v_pk_mul_f32 v[8:9], v[8:9], v[174:175]
    v_exp_f32 v2, v2
    v_exp_f32 v3, v3
    v_exp_f32 v4, v4
    v_exp_f32 v5, v5
    v_exp_f32 v6, v6
    v_exp_f32 v7, v7
    v_exp_f32 v8, v8
    v_exp_f32 v9, v9
    v_pk_add_f32 v[2:3], v[2:3], s[58:59]
    v_pk_add_f32 v[4:5], v[4:5], s[58:59]
    v_pk_add_f32 v[6:7], v[6:7], s[58:59]
    v_pk_add_f32 v[8:9], v[8:9], s[58:59]
    v_rcp_f32 v2, v2
    v_rcp_f32 v3, v3
    v_rcp_f32 v4, v4
    v_rcp_f32 v5, v5
    v_rcp_f32 v6, v6
    v_rcp_f32 v7, v7
    v_rcp_f32 v8, v8
    v_rcp_f32 v9, v9
    v_pk_mul_f32 v[2:3], v[2:3], v[168:169]
    v_pk_mul_f32 v[4:5], v[4:5], v[170:171]
    v_pk_mul_f32 v[6:7], v[6:7], v[172:173]
    v_pk_mul_f32 v[8:9], v[8:9], v[174:175]
    v_cvt_pk_bf16_f32 v168, v2, v3
    v_cvt_pk_bf16_f32 v170, v6, v7
    v_cvt_pk_bf16_f32 v169, v4, v5
    v_cvt_pk_bf16_f32 v171, v8, v9
    s_nop 0
    v_permlane32_swap_b32 v168, v170
    v_permlane32_swap_b32 v169, v171
    buffer_store_dwordx4 v[168:171], v16, s[36:39], s66 offen offset:32 sc1
    s_waitcnt lgkmcnt(1)
    v_mfma_f32_16x16x32_bf16 v[176:179], v[76:79], v[232:235], v[176:179]
    v_mfma_f32_16x16x32_bf16 v[176:179], v[80:83], v[236:239], v[176:179]
    v_mfma_f32_16x16x32_bf16 v[176:179], v[84:87], v[240:243], v[176:179]
    v_mfma_f32_16x16x32_bf16 v[176:179], v[88:91], v[244:247], v[176:179]
    v_mfma_f32_16x16x32_bf16 v[176:179], v[92:95], v[248:251], v[176:179]
    ds_read_b128 v[204:207], v15 offset:5472
    v_mfma_f32_16x16x32_bf16 v[176:179], v[96:99], v[252:255], v[176:179]
    v_mfma_f32_16x16x32_bf16 v[176:179], v[100:103], v[192:195], v[176:179]
    ds_read_b128 v[208:211], v15 offset:6560
    v_mfma_f32_16x16x32_bf16 v[176:179], v[104:107], v[196:199], v[176:179]
    v_mfma_f32_16x16x32_bf16 v[180:183], v[76:79], v[236:239], v[180:183]
    ds_read_b128 v[212:215], v15 offset:4896
    v_mfma_f32_16x16x32_bf16 v[180:183], v[80:83], v[240:243], v[180:183]
    v_mfma_f32_16x16x32_bf16 v[180:183], v[84:87], v[244:247], v[180:183]
    ds_read_b128 v[216:219], v15 offset:5984
    v_mfma_f32_16x16x32_bf16 v[180:183], v[88:91], v[248:251], v[180:183]
    v_mfma_f32_16x16x32_bf16 v[180:183], v[92:95], v[252:255], v[180:183]
    ds_read_b128 v[220:223], v15 offset:7072
    v_mfma_f32_16x16x32_bf16 v[180:183], v[96:99], v[192:195], v[180:183]
    v_mfma_f32_16x16x32_bf16 v[180:183], v[100:103], v[196:199], v[180:183]
    s_waitcnt lgkmcnt(4)
    ds_read_b128 v[224:227], v15 offset:8160
    v_mfma_f32_16x16x32_bf16 v[180:183], v[104:107], v[200:203], v[180:183]
    v_mfma_f32_16x16x32_bf16 v[184:187], v[76:79], v[240:243], v[184:187]
    ds_read_b128 v[228:231], v15 offset:576
    v_mfma_f32_16x16x32_bf16 v[184:187], v[80:83], v[244:247], v[184:187]
    v_mfma_f32_16x16x32_bf16 v[184:187], v[84:87], v[248:251], v[184:187]
    ds_read_b128 v[232:235], v15 offset:1664
    v_mfma_f32_16x16x32_bf16 v[184:187], v[88:91], v[252:255], v[184:187]
    v_mfma_f32_16x16x32_bf16 v[184:187], v[92:95], v[192:195], v[184:187]
    ds_read_b128 v[236:239], v15 offset:2752
    v_mfma_f32_16x16x32_bf16 v[184:187], v[96:99], v[196:199], v[184:187]
    v_mfma_f32_16x16x32_bf16 v[184:187], v[100:103], v[200:203], v[184:187]
    v_mfma_f32_16x16x32_bf16 v[184:187], v[104:107], v[204:207], v[184:187]
    v_mfma_f32_16x16x32_bf16 v[188:191], v[76:79], v[244:247], v[188:191]
    v_mfma_f32_16x16x32_bf16 v[188:191], v[80:83], v[248:251], v[188:191]
    v_mfma_f32_16x16x32_bf16 v[188:191], v[84:87], v[252:255], v[188:191]
    v_mfma_f32_16x16x32_bf16 v[188:191], v[88:91], v[192:195], v[188:191]
    ds_read_b128 v[240:243], v15 offset:3840
    v_mfma_f32_16x16x32_bf16 v[188:191], v[92:95], v[196:199], v[188:191]
    v_mfma_f32_16x16x32_bf16 v[188:191], v[96:99], v[200:203], v[188:191]
    v_mfma_f32_16x16x32_bf16 v[188:191], v[100:103], v[204:207], v[188:191]
    s_waitcnt lgkmcnt(1)
    v_mfma_f32_16x16x32_bf16 v[188:191], v[104:107], v[208:211], v[188:191]
    ds_read_b128 v[244:247], v15 offset:4928
    v_mfma_f32_16x16x32_bf16 v[176:179], v[108:111], v[212:215], v[176:179]
    v_mfma_f32_16x16x32_bf16 v[176:179], v[112:115], v[216:219], v[176:179]
    ds_read_b128 v[248:251], v15 offset:6016
    v_mfma_f32_16x16x32_bf16 v[176:179], v[120:123], v[220:223], v[176:179]
    v_mfma_f32_16x16x32_bf16 v[176:179], v[132:135], v[224:227], v[176:179]
    ds_read_b128 v[252:255], v15 offset:21760
    v_mfma_f32_16x16x32_bf16 v[176:179], v[136:139], v[228:231], v[176:179]
    v_mfma_f32_16x16x32_bf16 v[176:179], v[140:143], v[232:235], v[176:179]
    ds_read_b128 v[192:195], v15 offset:22848
    v_mfma_f32_16x16x32_bf16 v[176:179], v[144:147], v[236:239], v[176:179]
    v_mfma_f32_16x16x32_bf16 v[180:183], v[108:111], v[216:219], v[180:183]
    ds_read_b128 v[196:199], v15 offset:23936
    v_mfma_f32_16x16x32_bf16 v[180:183], v[112:115], v[220:223], v[180:183]
    v_mfma_f32_16x16x32_bf16 v[180:183], v[120:123], v[224:227], v[180:183]
    ds_read_b128 v[200:203], v15 offset:25024
    v_mfma_f32_16x16x32_bf16 v[180:183], v[132:135], v[228:231], v[180:183]
    v_mfma_f32_16x16x32_bf16 v[180:183], v[136:139], v[232:235], v[180:183]
    ds_read_b128 v[204:207], v15 offset:17440
    v_mfma_f32_16x16x32_bf16 v[180:183], v[140:143], v[236:239], v[180:183]
    s_waitcnt lgkmcnt(5)
    v_mfma_f32_16x16x32_bf16 v[180:183], v[144:147], v[240:243], v[180:183]
    ds_read_b128 v[208:211], v15 offset:18528
    v_mfma_f32_16x16x32_bf16 v[184:187], v[108:111], v[220:223], v[184:187]
    v_mfma_f32_16x16x32_bf16 v[184:187], v[112:115], v[224:227], v[184:187]
    ds_read_b128 v[212:215], v15 offset:19616
    v_mfma_f32_16x16x32_bf16 v[184:187], v[120:123], v[228:231], v[184:187]
    v_mfma_f32_16x16x32_bf16 v[184:187], v[132:135], v[232:235], v[184:187]
    ds_read_b128 v[216:219], v15 offset:20704
    v_mfma_f32_16x16x32_bf16 v[184:187], v[136:139], v[236:239], v[184:187]
    v_mfma_f32_16x16x32_bf16 v[184:187], v[140:143], v[240:243], v[184:187]
    v_mfma_f32_16x16x32_bf16 v[184:187], v[144:147], v[244:247], v[184:187]
    v_mfma_f32_16x16x32_bf16 v[188:191], v[108:111], v[224:227], v[188:191]
    v_mfma_f32_16x16x32_bf16 v[188:191], v[112:115], v[228:231], v[188:191]
    v_mfma_f32_16x16x32_bf16 v[188:191], v[120:123], v[232:235], v[188:191]
    v_mfma_f32_16x16x32_bf16 v[188:191], v[132:135], v[236:239], v[188:191]
    v_mfma_f32_16x16x32_bf16 v[188:191], v[136:139], v[240:243], v[188:191]
    ds_read_b128 v[220:223], v15 offset:21792
    v_mfma_f32_16x16x32_bf16 v[188:191], v[140:143], v[244:247], v[188:191]
    v_mfma_f32_16x16x32_bf16 v[188:191], v[144:147], v[248:251], v[188:191]
    s_waitcnt lgkmcnt(1)
    v_mfma_f32_16x16x32_bf16 v[176:179], v[116:119], v[252:255], v[176:179]
    v_mfma_f32_16x16x32_bf16 v[176:179], v[40:43], v[192:195], v[176:179]
    v_mfma_f32_16x16x32_bf16 v[176:179], v[44:47], v[196:199], v[176:179]
    v_mfma_f32_16x16x32_bf16 v[176:179], v[124:127], v[200:203], v[176:179]
    v_mfma_f32_16x16x32_bf16 v[176:179], v[128:131], v[204:207], v[176:179]
    ds_read_b128 v[224:227], v15 offset:22880
    v_mfma_f32_16x16x32_bf16 v[176:179], v[148:151], v[208:211], v[176:179]
    v_mfma_f32_16x16x32_bf16 v[176:179], v[152:155], v[212:215], v[176:179]
    ds_read_b128 v[228:231], v15 offset:23968
    v_mfma_f32_16x16x32_bf16 v[176:179], v[156:159], v[216:219], v[176:179]
    v_mfma_f32_16x16x32_bf16 v[180:183], v[116:119], v[192:195], v[180:183]
    ds_read_b128 v[232:235], v15 offset:22304
    v_mfma_f32_16x16x32_bf16 v[180:183], v[40:43], v[196:199], v[180:183]
    v_mfma_f32_16x16x32_bf16 v[180:183], v[44:47], v[200:203], v[180:183]
    ds_read_b128 v[236:239], v15 offset:23392
    v_mfma_f32_16x16x32_bf16 v[180:183], v[124:127], v[204:207], v[180:183]
    v_mfma_f32_16x16x32_bf16 v[180:183], v[128:131], v[208:211], v[180:183]
    ds_read_b128 v[240:243], v15 offset:24480
    v_mfma_f32_16x16x32_bf16 v[180:183], v[148:151], v[212:215], v[180:183]
    v_mfma_f32_16x16x32_bf16 v[180:183], v[152:155], v[216:219], v[180:183]
    s_waitcnt lgkmcnt(4)
    ds_read_b128 v[244:247], v15 offset:25568
    v_mfma_f32_16x16x32_bf16 v[180:183], v[156:159], v[220:223], v[180:183]
    v_mfma_f32_16x16x32_bf16 v[184:187], v[116:119], v[196:199], v[184:187]
    ds_read_b128 v[248:251], v15 offset:17984
    v_mfma_f32_16x16x32_bf16 v[184:187], v[40:43], v[200:203], v[184:187]
    v_mfma_f32_16x16x32_bf16 v[184:187], v[44:47], v[204:207], v[184:187]
    ds_read_b128 v[252:255], v15 offset:19072
    v_mfma_f32_16x16x32_bf16 v[184:187], v[124:127], v[208:211], v[184:187]
    v_mfma_f32_16x16x32_bf16 v[184:187], v[128:131], v[212:215], v[184:187]
    ds_read_b128 v[192:195], v15 offset:20160
    v_mfma_f32_16x16x32_bf16 v[184:187], v[148:151], v[216:219], v[184:187]
    s_add_u32 s62, s70, 0
    buffer_load_dwordx4 v[76:79], v36, s[36:39], s62 offen offset:0 sc1
    v_mfma_f32_16x16x32_bf16 v[184:187], v[152:155], v[220:223], v[184:187]
    v_mfma_f32_16x16x32_bf16 v[184:187], v[156:159], v[224:227], v[184:187]
    v_mfma_f32_16x16x32_bf16 v[188:191], v[116:119], v[200:203], v[188:191]
    v_mfma_f32_16x16x32_bf16 v[188:191], v[40:43], v[204:207], v[188:191]
    buffer_load_dwordx4 v[80:83], v36, s[36:39], s62 offen offset:1024 sc1
    v_mfma_f32_16x16x32_bf16 v[188:191], v[44:47], v[208:211], v[188:191]
    v_mfma_f32_16x16x32_bf16 v[188:191], v[124:127], v[212:215], v[188:191]
    ds_read_b128 v[196:199], v15 offset:21248
    v_mfma_f32_16x16x32_bf16 v[188:191], v[128:131], v[216:219], v[188:191]
    v_mfma_f32_16x16x32_bf16 v[188:191], v[148:151], v[220:223], v[188:191]
    v_mfma_f32_16x16x32_bf16 v[188:191], v[152:155], v[224:227], v[188:191]
    s_waitcnt lgkmcnt(1)
    buffer_load_dwordx4 v[84:87], v36, s[36:39], s62 offen offset:2048 sc1
    v_mfma_f32_16x16x32_bf16 v[188:191], v[156:159], v[228:231], v[188:191]
    v_mfma_f32_16x16x32_bf16 v[176:179], v[48:51], v[232:235], v[176:179]
    v_mfma_f32_16x16x32_bf16 v[176:179], v[52:55], v[236:239], v[176:179]
    v_mfma_f32_16x16x32_bf16 v[176:179], v[56:59], v[240:243], v[176:179]
    ds_read_b128 v[200:203], v15 offset:22336
    v_mfma_f32_16x16x32_bf16 v[176:179], v[60:63], v[244:247], v[176:179]
    buffer_load_dwordx4 v[88:91], v36, s[36:39], s62 offen offset:3072 sc1
    v_mfma_f32_16x16x32_bf16 v[176:179], v[64:67], v[248:251], v[176:179]
    v_mfma_f32_16x16x32_bf16 v[176:179], v[68:71], v[252:255], v[176:179]
    v_mfma_f32_16x16x32_bf16 v[176:179], v[72:75], v[192:195], v[176:179]
    v_mfma_f32_16x16x32_bf16 v[180:183], v[48:51], v[236:239], v[180:183]
    v_mfma_f32_16x16x32_bf16 v[180:183], v[52:55], v[240:243], v[180:183]
    s_add_u32 s62, s70, 4096
    buffer_load_dwordx4 v[92:95], v36, s[36:39], s62 offen offset:0 sc1
    v_mfma_f32_16x16x32_bf16 v[180:183], v[56:59], v[244:247], v[180:183]
    ds_read_b128 v[204:207], v15 offset:23424
    v_mfma_f32_16x16x32_bf16 v[180:183], v[60:63], v[248:251], v[180:183]
    v_mfma_f32_16x16x32_bf16 v[180:183], v[64:67], v[252:255], v[180:183]
    v_mfma_f32_16x16x32_bf16 v[180:183], v[68:71], v[192:195], v[180:183]
    s_waitcnt lgkmcnt(1)
    v_mfma_f32_16x16x32_bf16 v[180:183], v[72:75], v[196:199], v[180:183]
    buffer_load_dwordx4 v[96:99], v36, s[36:39], s62 offen offset:1024 sc1
    v_mfma_f32_16x16x32_bf16 v[184:187], v[48:51], v[240:243], v[184:187]
    v_mfma_f32_16x16x32_bf16 v[184:187], v[52:55], v[244:247], v[184:187]
    v_mfma_f32_16x16x32_bf16 v[184:187], v[56:59], v[248:251], v[184:187]
    v_mfma_f32_16x16x32_bf16 v[184:187], v[60:63], v[252:255], v[184:187]
    v_mfma_f32_16x16x32_bf16 v[184:187], v[64:67], v[192:195], v[184:187]
    buffer_load_dwordx4 v[100:103], v36, s[36:39], s62 offen offset:2048 sc1
    v_mfma_f32_16x16x32_bf16 v[184:187], v[68:71], v[196:199], v[184:187]
    v_mfma_f32_16x16x32_bf16 v[184:187], v[72:75], v[200:203], v[184:187]
    v_mfma_f32_16x16x32_bf16 v[188:191], v[48:51], v[244:247], v[188:191]
    v_mfma_f32_16x16x32_bf16 v[188:191], v[52:55], v[248:251], v[188:191]
    v_mfma_f32_16x16x32_bf16 v[188:191], v[56:59], v[252:255], v[188:191]
    buffer_load_dwordx4 v[132:135], v36, s[36:39], s62 offen offset:3072 sc1
    v_mfma_f32_16x16x32_bf16 v[188:191], v[60:63], v[192:195], v[188:191]
    v_mfma_f32_16x16x32_bf16 v[188:191], v[64:67], v[196:199], v[188:191]
    v_mfma_f32_16x16x32_bf16 v[188:191], v[68:71], v[200:203], v[188:191]
    s_waitcnt lgkmcnt(0)
    v_mfma_f32_16x16x32_bf16 v[188:191], v[72:75], v[204:207], v[188:191]
    s_barrier
    v_pk_mul_f32 v[2:3], v[176:177], v[176:177]
    v_pk_mul_f32 v[4:5], v[178:179], v[178:179]
    v_pk_mul_f32 v[6:7], v[180:181], v[180:181]
    v_pk_mul_f32 v[8:9], v[182:183], v[182:183]
    v_pk_fma_f32 v[2:3], v[2:3], s[56:57], v[12:13]
    v_pk_fma_f32 v[4:5], v[4:5], s[56:57], v[12:13]
    v_pk_fma_f32 v[6:7], v[6:7], s[56:57], v[12:13]
    v_pk_fma_f32 v[8:9], v[8:9], s[56:57], v[12:13]
    v_pk_mul_f32 v[2:3], v[2:3], v[176:177]
    v_pk_mul_f32 v[4:5], v[4:5], v[178:179]
    v_pk_mul_f32 v[6:7], v[6:7], v[180:181]
    v_pk_mul_f32 v[8:9], v[8:9], v[182:183]
    v_exp_f32 v2, v2
    v_exp_f32 v3, v3
    v_exp_f32 v4, v4
    v_exp_f32 v5, v5
    v_exp_f32 v6, v6
    v_exp_f32 v7, v7
    v_exp_f32 v8, v8
    v_exp_f32 v9, v9
    v_pk_add_f32 v[2:3], v[2:3], s[58:59]
    v_pk_add_f32 v[4:5], v[4:5], s[58:59]
    v_pk_add_f32 v[6:7], v[6:7], s[58:59]
    v_pk_add_f32 v[8:9], v[8:9], s[58:59]
    v_rcp_f32 v2, v2
    v_rcp_f32 v3, v3
    v_rcp_f32 v4, v4
    v_rcp_f32 v5, v5
    v_rcp_f32 v6, v6
    v_rcp_f32 v7, v7
    v_rcp_f32 v8, v8
    v_rcp_f32 v9, v9
    v_pk_mul_f32 v[2:3], v[2:3], v[176:177]
    v_pk_mul_f32 v[4:5], v[4:5], v[178:179]
    v_pk_mul_f32 v[6:7], v[6:7], v[180:181]
    v_pk_mul_f32 v[8:9], v[8:9], v[182:183]
    v_cvt_pk_bf16_f32 v176, v2, v3
    v_cvt_pk_bf16_f32 v178, v6, v7
    v_cvt_pk_bf16_f32 v177, v4, v5
    v_cvt_pk_bf16_f32 v179, v8, v9
    s_nop 0
    v_permlane32_swap_b32 v176, v178
    v_permlane32_swap_b32 v177, v179
    buffer_store_dwordx4 v[176:179], v16, s[36:39], s76 offen offset:0 sc1
    v_pk_mul_f32 v[2:3], v[184:185], v[184:185]
    v_pk_mul_f32 v[4:5], v[186:187], v[186:187]
    v_pk_mul_f32 v[6:7], v[188:189], v[188:189]
    v_pk_mul_f32 v[8:9], v[190:191], v[190:191]
    v_pk_fma_f32 v[2:3], v[2:3], s[56:57], v[12:13]
    v_pk_fma_f32 v[4:5], v[4:5], s[56:57], v[12:13]
    v_pk_fma_f32 v[6:7], v[6:7], s[56:57], v[12:13]
    v_pk_fma_f32 v[8:9], v[8:9], s[56:57], v[12:13]
    v_pk_mul_f32 v[2:3], v[2:3], v[184:185]
    v_pk_mul_f32 v[4:5], v[4:5], v[186:187]
    v_pk_mul_f32 v[6:7], v[6:7], v[188:189]
    v_pk_mul_f32 v[8:9], v[8:9], v[190:191]
    v_exp_f32 v2, v2
    v_exp_f32 v3, v3
    v_exp_f32 v4, v4
    v_exp_f32 v5, v5
    v_exp_f32 v6, v6
    v_exp_f32 v7, v7
    v_exp_f32 v8, v8
    v_exp_f32 v9, v9
    v_pk_add_f32 v[2:3], v[2:3], s[58:59]
    v_pk_add_f32 v[4:5], v[4:5], s[58:59]
    v_pk_add_f32 v[6:7], v[6:7], s[58:59]
    v_pk_add_f32 v[8:9], v[8:9], s[58:59]
    v_rcp_f32 v2, v2
    v_rcp_f32 v3, v3
    v_rcp_f32 v4, v4
    v_rcp_f32 v5, v5
    v_rcp_f32 v6, v6
    v_rcp_f32 v7, v7
    v_rcp_f32 v8, v8
    v_rcp_f32 v9, v9
    v_pk_mul_f32 v[2:3], v[2:3], v[184:185]
    v_pk_mul_f32 v[4:5], v[4:5], v[186:187]
    v_pk_mul_f32 v[6:7], v[6:7], v[188:189]
    v_pk_mul_f32 v[8:9], v[8:9], v[190:191]
    v_cvt_pk_bf16_f32 v184, v2, v3
    v_cvt_pk_bf16_f32 v186, v6, v7
    v_cvt_pk_bf16_f32 v185, v4, v5
    v_cvt_pk_bf16_f32 v187, v8, v9
    s_nop 0
    v_permlane32_swap_b32 v184, v186
    v_permlane32_swap_b32 v185, v187
    buffer_store_dwordx4 v[184:187], v16, s[36:39], s76 offen offset:32 sc1
    s_waitcnt vmcnt(2)
    v_max3_u32 v1, v76, v77, v78
    v_max3_u32 v1, v79, v80, v1
    v_max3_u32 v1, v81, v82, v1
    v_max3_u32 v1, v83, v84, v1
    v_max3_u32 v1, v85, v86, v1
    v_max3_u32 v1, v87, v88, v1
    v_max3_u32 v1, v89, v90, v1
    v_max3_u32 v1, v91, v92, v1
    v_max3_u32 v1, v93, v94, v1
    v_max3_u32 v1, v95, v96, v1
    v_max3_u32 v1, v97, v98, v1
    v_max3_u32 v1, v99, v100, v1
    v_max3_u32 v1, v101, v102, v1
    v_max3_u32 v1, v103, v132, v1
    v_max3_u32 v1, v133, v134, v1
    v_max_u32 v1, v135, v1
    v_cmp_eq_u32 vcc, -1, v1
    s_nop 0
    s_cbranch_vccnz L_cfa
L_cfa_b:
    s_cmp_lg_u64 s[74:75], 0
    s_cbranch_scc1 L_slow
    v_mfma_f32_16x16x32_bf16 v[192:195], a[128:131], v[76:79], 0
    ds_read_b128 v[240:243], v21 offset:0
    v_mfma_f32_16x16x32_bf16 v[192:195], a[132:135], v[80:83], v[192:195]
    ds_read_b128 v[244:247], v21 offset:16
    v_mfma_f32_16x16x32_bf16 v[192:195], a[136:139], v[84:87], v[192:195]
    ds_read_b128 v[248:251], v21 offset:128
    v_mfma_f32_16x16x32_bf16 v[192:195], a[140:143], v[88:91], v[192:195]
    ds_read_b128 v[252:255], v21 offset:144
    v_mfma_f32_16x16x32_bf16 v[192:195], a[144:147], v[92:95], v[192:195]
    v_mfma_f32_16x16x32_bf16 v[192:195], a[148:151], v[96:99], v[192:195]
    v_mfma_f32_16x16x32_bf16 v[192:195], a[152:155], v[100:103], v[192:195]
    v_mfma_f32_16x16x32_bf16 v[192:195], a[156:159], v[132:135], v[192:195]
    v_mov_b32 v224, v34
    v_mov_b32 v225, v34
    v_mfma_f32_16x16x32_bf16 v[200:203], a[160:163], v[76:79], 0
    v_mov_b32 v226, v34
    v_mov_b32 v227, v34
    v_mfma_f32_16x16x32_bf16 v[200:203], a[164:167], v[80:83], v[200:203]
    v_mov_b32 v228, v35
    v_mov_b32 v229, v35
    v_mfma_f32_16x16x32_bf16 v[200:203], a[168:171], v[84:87], v[200:203]
    v_mov_b32 v230, v35
    v_mov_b32 v231, v35
    v_mfma_f32_16x16x32_bf16 v[200:203], a[172:175], v[88:91], v[200:203]
    v_mul_f32 v192, s72, v192
    v_mul_f32 v193, s72, v193
    v_mfma_f32_16x16x32_bf16 v[200:203], a[176:179], v[92:95], v[200:203]
    v_mul_f32 v194, s72, v194
    v_mul_f32 v195, s72, v195
    v_mfma_f32_16x16x32_bf16 v[200:203], a[180:183], v[96:99], v[200:203]
    v_exp_f32 v192, v192
    v_exp_f32 v193, v193
    v_mfma_f32_16x16x32_bf16 v[200:203], a[184:187], v[100:103], v[200:203]
    v_exp_f32 v194, v194
    v_mfma_f32_16x16x32_bf16 v[200:203], a[188:191], v[132:135], v[200:203]
    v_exp_f32 v195, v195
    v_mov_b32 v232, v32
    v_mfma_f32_16x16x32_bf16 v[208:211], a[192:195], v[76:79], 0
    v_mov_b32 v233, v32
    v_mfma_f32_16x16x32_bf16 v[208:211], a[196:199], v[80:83], v[208:211]
    v_mov_b32 v234, v32
    v_mov_b32 v235, v32
    v_mfma_f32_16x16x32_bf16 v[208:211], a[200:203], v[84:87], v[208:211]
    v_mfma_f32_16x16x32_bf16 v[208:211], a[204:207], v[88:91], v[208:211]
    v_mul_f32 v200, s72, v200
    v_mul_f32 v201, s72, v201
    v_mfma_f32_16x16x32_bf16 v[208:211], a[208:211], v[92:95], v[208:211]
    v_mul_f32 v202, s72, v202
    v_mul_f32 v203, s72, v203
    v_mfma_f32_16x16x32_bf16 v[208:211], a[212:215], v[96:99], v[208:211]
    v_exp_f32 v200, v200
    v_exp_f32 v201, v201
    v_mfma_f32_16x16x32_bf16 v[208:211], a[216:219], v[100:103], v[208:211]
    v_exp_f32 v202, v202
    v_mfma_f32_16x16x32_bf16 v[208:211], a[220:223], v[132:135], v[208:211]
    v_exp_f32 v203, v203
    v_mov_b32 v236, v33
    v_mfma_f32_16x16x32_bf16 v[216:219], a[224:227], v[76:79], 0
    v_mov_b32 v237, v33
    v_mfma_f32_16x16x32_bf16 v[216:219], a[228:231], v[80:83], v[216:219]
    v_mov_b32 v238, v33
    v_mov_b32 v239, v33
    v_mfma_f32_16x16x32_bf16 v[216:219], a[232:235], v[84:87], v[216:219]
    v_mfma_f32_16x16x32_bf16 v[216:219], a[236:239], v[88:91], v[216:219]
    v_mul_f32 v208, s72, v208
    v_mul_f32 v209, s72, v209
    v_mfma_f32_16x16x32_bf16 v[216:219], a[240:243], v[92:95], v[216:219]
    v_mul_f32 v210, s72, v210
    v_mul_f32 v211, s72, v211
    v_mfma_f32_16x16x32_bf16 v[216:219], a[244:247], v[96:99], v[216:219]
    s_waitcnt lgkmcnt(0)
    v_fma_f32 v104, v240, v192, 1.0
    v_fma_f32 v105, v241, v193, 1.0
    v_mfma_f32_16x16x32_bf16 v[216:219], a[248:251], v[100:103], v[216:219]
    v_fma_f32 v106, v242, v194, 1.0
    v_fma_f32 v107, v243, v195, 1.0
    v_mfma_f32_16x16x32_bf16 v[216:219], a[252:255], v[132:135], v[216:219]
    v_fma_f32 v108, v244, v200, 1.0
    v_fma_f32 v109, v245, v201, 1.0
    v_exp_f32 v208, v208
    v_exp_f32 v209, v209
    v_exp_f32 v210, v210
    v_exp_f32 v211, v211
    v_fma_f32 v110, v246, v202, 1.0
    v_fma_f32 v111, v247, v203, 1.0
    v_mul_f32 v216, s72, v216
    v_mul_f32 v217, s72, v217
    v_mul_f32 v218, s72, v218
    v_mul_f32 v219, s72, v219
    v_exp_f32 v216, v216
    v_exp_f32 v217, v217
    v_exp_f32 v218, v218
    v_exp_f32 v219, v219
    v_rcp_f32 v104, v104
    v_rcp_f32 v105, v105
    v_rcp_f32 v106, v106
    v_rcp_f32 v107, v107
    v_rcp_f32 v108, v108
    v_rcp_f32 v109, v109
    v_rcp_f32 v110, v110
    v_rcp_f32 v111, v111
    v_cvt_pk_bf16_f32 v120, v104, v105
    v_cvt_pk_bf16_f32 v121, v106, v107
    v_cvt_pk_bf16_f32 v122, v108, v109
    v_cvt_pk_bf16_f32 v123, v110, v111
    ds_write_b128 v20, v[120:123] offset:0
    v_fma_f32 v112, v248, v208, 1.0
    v_fma_f32 v113, v249, v209, 1.0
    v_fma_f32 v114, v250, v210, 1.0
    v_fma_f32 v115, v251, v211, 1.0
    v_fma_f32 v116, v252, v216, 1.0
    v_fma_f32 v117, v253, v217, 1.0
    v_fma_f32 v118, v254, v218, 1.0
    v_fma_f32 v119, v255, v219, 1.0
    v_rcp_f32 v112, v112
    v_rcp_f32 v113, v113
    v_rcp_f32 v114, v114
    v_rcp_f32 v115, v115
    v_rcp_f32 v116, v116
    v_rcp_f32 v117, v117
    v_rcp_f32 v118, v118
    v_rcp_f32 v119, v119
    v_cvt_pk_bf16_f32 v124, v112, v113
    v_cvt_pk_bf16_f32 v125, v114, v115
    v_cvt_pk_bf16_f32 v126, v116, v117
    v_cvt_pk_bf16_f32 v127, v118, v119
    ds_write_b128 v20, v[124:127] offset:1024
    ds_read_b128 v[240:243], v21 offset:1024
    ds_read_b128 v[244:247], v21 offset:1040
    ds_read_b128 v[248:251], v21 offset:1152
    ds_read_b128 v[252:255], v21 offset:1168
    s_waitcnt lgkmcnt(4)
    s_barrier
    ds_read_b128 v[72:75], v36 offset:0
    ds_read_b128 v[76:79], v36 offset:1024
    ds_read_b128 v[80:83], v36 offset:2048
    ds_read_b128 v[84:87], v36 offset:3072
    ds_read_b128 v[88:91], v36 offset:4096
    ds_read_b128 v[92:95], v36 offset:5120
    ds_read_b128 v[96:99], v36 offset:6144
    ds_read_b128 v[100:103], v36 offset:7168
    s_waitcnt lgkmcnt(11)
    v_fma_f32 v104, v240, v192, 1.0
    v_fma_f32 v105, v241, v193, 1.0
    v_fma_f32 v106, v242, v194, 1.0
    v_fma_f32 v107, v243, v195, 1.0
    s_waitcnt lgkmcnt(10)
    v_fma_f32 v108, v244, v200, 1.0
    v_fma_f32 v109, v245, v201, 1.0
    v_fma_f32 v110, v246, v202, 1.0
    v_fma_f32 v111, v247, v203, 1.0
    v_rcp_f32 v104, v104
    v_rcp_f32 v105, v105
    v_rcp_f32 v106, v106
    v_rcp_f32 v107, v107
    v_rcp_f32 v108, v108
    v_rcp_f32 v109, v109
    v_rcp_f32 v110, v110
    v_rcp_f32 v111, v111
    v_cvt_pk_bf16_f32 v120, v104, v105
    v_cvt_pk_bf16_f32 v121, v106, v107
    v_cvt_pk_bf16_f32 v122, v108, v109
    v_cvt_pk_bf16_f32 v123, v110, v111
    ds_write_b128 v20, v[120:123] offset:8192
    s_waitcnt lgkmcnt(10)
    v_fma_f32 v112, v248, v208, 1.0
    v_fma_f32 v113, v249, v209, 1.0
    v_fma_f32 v114, v250, v210, 1.0
    v_fma_f32 v115, v251, v211, 1.0
    s_waitcnt lgkmcnt(9)
    v_fma_f32 v116, v252, v216, 1.0
    v_fma_f32 v117, v253, v217, 1.0
    v_fma_f32 v118, v254, v218, 1.0
    v_fma_f32 v119, v255, v219, 1.0
    v_rcp_f32 v112, v112
    v_rcp_f32 v113, v113
    v_rcp_f32 v114, v114
    v_rcp_f32 v115, v115
    v_rcp_f32 v116, v116
    v_rcp_f32 v117, v117
    v_rcp_f32 v118, v118
    v_rcp_f32 v119, v119
    v_cvt_pk_bf16_f32 v124, v112, v113
    v_cvt_pk_bf16_f32 v125, v114, v115
    v_cvt_pk_bf16_f32 v126, v116, v117
    v_cvt_pk_bf16_f32 v127, v118, v119
    ds_write_b128 v20, v[124:127] offset:9216
    ds_read_b128 v[240:243], v21 offset:2048
    ds_read_b128 v[244:247], v21 offset:2064
    ds_read_b128 v[248:251], v21 offset:2176
    ds_read_b128 v[252:255], v21 offset:2192
    s_waitcnt lgkmcnt(13)
    v_mfma_f32_16x16x32_bf16 v[160:163], v[72:75], a[0:3], v[224:227]
    s_waitcnt lgkmcnt(3)
    v_fma_f32 v104, v240, v192, 1.0
    v_fma_f32 v105, v241, v193, 1.0
    v_fma_f32 v106, v242, v194, 1.0
    v_mfma_f32_16x16x32_bf16 v[160:163], v[76:79], a[4:7], v[160:163]
    s_waitcnt lgkmcnt(2)
    v_fma_f32 v107, v243, v195, 1.0
    v_fma_f32 v108, v244, v200, 1.0
    v_mfma_f32_16x16x32_bf16 v[160:163], v[80:83], a[8:11], v[160:163]
    v_fma_f32 v109, v245, v201, 1.0
    v_fma_f32 v110, v246, v202, 1.0
    v_fma_f32 v111, v247, v203, 1.0
    v_mfma_f32_16x16x32_bf16 v[160:163], v[84:87], a[12:15], v[160:163]
    s_add_u32 s62, s70, 8192
    buffer_load_dwordx4 v[128:131], v36, s[36:39], s62 offen offset:0 sc1
    v_rcp_f32 v104, v104
    v_mfma_f32_16x16x32_bf16 v[160:163], v[88:91], a[16:19], v[160:163]
    ds_read_b128 v[240:243], v21 offset:3072
    v_rcp_f32 v105, v105
    v_mfma_f32_16x16x32_bf16 v[160:163], v[92:95], a[20:23], v[160:163]
    ds_read_b128 v[244:247], v21 offset:3088
    v_rcp_f32 v106, v106
    v_mfma_f32_16x16x32_bf16 v[160:163], v[96:99], a[24:27], v[160:163]
    s_barrier
    buffer_load_dwordx4 v[132:135], v36, s[36:39], s62 offen offset:1024 sc1
    v_rcp_f32 v107, v107
    v_mfma_f32_16x16x32_bf16 v[160:163], v[100:103], a[28:31], v[160:163]
    ds_read_b128 v[40:43], v36 offset:8192
    v_rcp_f32 v108, v108
    v_mfma_f32_16x16x32_bf16 v[164:167], v[72:75], a[32:35], v[228:231]
    ds_read_b128 v[44:47], v36 offset:9216
    v_rcp_f32 v109, v109
    v_mfma_f32_16x16x32_bf16 v[164:167], v[76:79], a[36:39], v[164:167]
    buffer_load_dwordx4 v[136:139], v36, s[36:39], s62 offen offset:2048 sc1
    v_rcp_f32 v110, v110
    v_mfma_f32_16x16x32_bf16 v[164:167], v[80:83], a[40:43], v[164:167]
    ds_read_b128 v[48:51], v36 offset:10240
    v_rcp_f32 v111, v111
    v_mfma_f32_16x16x32_bf16 v[164:167], v[84:87], a[44:47], v[164:167]
    ds_read_b128 v[52:55], v36 offset:11264
    v_cvt_pk_bf16_f32 v120, v104, v105
    v_mfma_f32_16x16x32_bf16 v[164:167], v[88:91], a[48:51], v[164:167]
    buffer_load_dwordx4 v[140:143], v36, s[36:39], s62 offen offset:3072 sc1
    v_cvt_pk_bf16_f32 v121, v106, v107
    v_mfma_f32_16x16x32_bf16 v[164:167], v[92:95], a[52:55], v[164:167]
    ds_read_b128 v[56:59], v36 offset:12288
    v_cvt_pk_bf16_f32 v122, v108, v109
    v_mfma_f32_16x16x32_bf16 v[164:167], v[96:99], a[56:59], v[164:167]
    ds_read_b128 v[60:63], v36 offset:13312
    v_cvt_pk_bf16_f32 v123, v110, v111
    v_mfma_f32_16x16x32_bf16 v[164:167], v[100:103], a[60:63], v[164:167]
    s_waitcnt lgkmcnt(6)
    s_add_u32 s62, s70, 12288
    buffer_load_dwordx4 v[144:147], v36, s[36:39], s62 offen offset:0 sc1
    v_fma_f32 v112, v248, v208, 1.0
    v_mfma_f32_16x16x32_bf16 v[168:171], v[72:75], a[64:67], v[232:235]
    ds_write_b128 v20, v[120:123] offset:16384
    v_mfma_f32_16x16x32_bf16 v[168:171], v[76:79], a[68:71], v[168:171]
    ds_read_b128 v[64:67], v36 offset:14336
    v_fma_f32 v113, v249, v209, 1.0
    v_mfma_f32_16x16x32_bf16 v[168:171], v[80:83], a[72:75], v[168:171]
    buffer_load_dwordx4 v[148:151], v36, s[36:39], s62 offen offset:1024 sc1
    v_fma_f32 v114, v250, v210, 1.0
    v_mfma_f32_16x16x32_bf16 v[168:171], v[84:87], a[76:79], v[168:171]
    ds_read_b128 v[68:71], v36 offset:15360
    v_fma_f32 v115, v251, v211, 1.0
    v_mfma_f32_16x16x32_bf16 v[168:171], v[88:91], a[80:83], v[168:171]
    v_fma_f32 v116, v252, v216, 1.0
    v_fma_f32 v117, v253, v217, 1.0
    v_mfma_f32_16x16x32_bf16 v[168:171], v[92:95], a[84:87], v[168:171]
    buffer_load_dwordx4 v[152:155], v36, s[36:39], s62 offen offset:2048 sc1
    v_fma_f32 v118, v254, v218, 1.0
    v_fma_f32 v119, v255, v219, 1.0
    v_mfma_f32_16x16x32_bf16 v[168:171], v[96:99], a[88:91], v[168:171]
    ds_read_b128 v[248:251], v21 offset:3200
    v_rcp_f32 v112, v112
    v_mfma_f32_16x16x32_bf16 v[168:171], v[100:103], a[92:95], v[168:171]
    ds_read_b128 v[252:255], v21 offset:3216
    v_rcp_f32 v113, v113
    v_mfma_f32_16x16x32_bf16 v[172:175], v[72:75], a[96:99], v[236:239]
    buffer_load_dwordx4 v[156:159], v36, s[36:39], s62 offen offset:3072 sc1
    v_rcp_f32 v114, v114
    v_mfma_f32_16x16x32_bf16 v[172:175], v[76:79], a[100:103], v[172:175]
    v_rcp_f32 v115, v115
    v_mfma_f32_16x16x32_bf16 v[172:175], v[80:83], a[104:107], v[172:175]
    v_rcp_f32 v116, v116
    v_mfma_f32_16x16x32_bf16 v[172:175], v[84:87], a[108:111], v[172:175]
    v_rcp_f32 v117, v117
    v_mfma_f32_16x16x32_bf16 v[172:175], v[88:91], a[112:115], v[172:175]
    v_rcp_f32 v118, v118
    v_rcp_f32 v119, v119
    v_mfma_f32_16x16x32_bf16 v[172:175], v[92:95], a[116:119], v[172:175]
    v_cvt_pk_bf16_f32 v124, v112, v113
    v_cvt_pk_bf16_f32 v125, v114, v115
    v_mfma_f32_16x16x32_bf16 v[172:175], v[96:99], a[120:123], v[172:175]
    v_cvt_pk_bf16_f32 v126, v116, v117
    v_cvt_pk_bf16_f32 v127, v118, v119
    v_mfma_f32_16x16x32_bf16 v[172:175], v[100:103], a[124:127], v[172:175]
    s_waitcnt lgkmcnt(2)
    ds_write_b128 v20, v[124:127] offset:17408
    v_mfma_f32_16x16x32_bf16 v[176:179], v[40:43], a[0:3], v[224:227]
    v_fma_f32 v104, v240, v192, 1.0
    v_fma_f32 v105, v241, v193, 1.0
    v_fma_f32 v106, v242, v194, 1.0
    v_mfma_f32_16x16x32_bf16 v[176:179], v[44:47], a[4:7], v[176:179]
    s_add_u32 s73, s71, 0
    v_fma_f32 v107, v243, v195, 1.0
    v_fma_f32 v108, v244, v200, 1.0
    v_fma_f32 v109, v245, v201, 1.0
    v_mfma_f32_16x16x32_bf16 v[176:179], v[48:51], a[8:11], v[176:179]
    v_fma_f32 v110, v246, v202, 1.0
    v_fma_f32 v111, v247, v203, 1.0
    v_cvt_pk_bf16_f32 v2, v160, v164
    v_mfma_f32_16x16x32_bf16 v[176:179], v[52:55], a[12:15], v[176:179]
    ds_read_b128 v[240:243], v21 offset:4096
    v_cvt_pk_bf16_f32 v3, v168, v172
    v_mfma_f32_16x16x32_bf16 v[176:179], v[56:59], a[16:19], v[176:179]
    ds_read_b128 v[244:247], v21 offset:4112
    v_rcp_f32 v104, v104
    v_mfma_f32_16x16x32_bf16 v[176:179], v[60:63], a[20:23], v[176:179]
    buffer_store_dwordx2 v[2:3], v23, s[40:43], s73 offen sc1
    v_rcp_f32 v105, v105
    v_mfma_f32_16x16x32_bf16 v[176:179], v[64:67], a[24:27], v[176:179]
    s_waitcnt lgkmcnt(2)
    s_barrier
    v_rcp_f32 v106, v106
    v_mfma_f32_16x16x32_bf16 v[176:179], v[68:71], a[28:31], v[176:179]
    ds_read_b128 v[72:75], v36 offset:16384
    v_rcp_f32 v107, v107
    v_mfma_f32_16x16x32_bf16 v[180:183], v[40:43], a[32:35], v[228:231]
    ds_read_b128 v[76:79], v36 offset:17408
    v_cvt_pk_bf16_f32 v4, v161, v165
    v_cvt_pk_bf16_f32 v5, v169, v173
    v_mfma_f32_16x16x32_bf16 v[180:183], v[44:47], a[36:39], v[180:183]
    buffer_store_dwordx2 v[4:5], v24, s[40:43], s73 offen sc1
    v_mfma_f32_16x16x32_bf16 v[180:183], v[48:51], a[40:43], v[180:183]
    ds_read_b128 v[80:83], v36 offset:18432
    v_rcp_f32 v108, v108
    v_mfma_f32_16x16x32_bf16 v[180:183], v[52:55], a[44:47], v[180:183]
    ds_read_b128 v[84:87], v36 offset:19456
    v_rcp_f32 v109, v109
    v_mfma_f32_16x16x32_bf16 v[180:183], v[56:59], a[48:51], v[180:183]
    ds_read_b128 v[88:91], v36 offset:20480
    v_rcp_f32 v110, v110
    v_mfma_f32_16x16x32_bf16 v[180:183], v[60:63], a[52:55], v[180:183]
    ds_read_b128 v[92:95], v36 offset:21504
    v_rcp_f32 v111, v111
    v_mfma_f32_16x16x32_bf16 v[180:183], v[64:67], a[56:59], v[180:183]
    ds_read_b128 v[96:99], v36 offset:22528
    v_cvt_pk_bf16_f32 v120, v104, v105
    v_cvt_pk_bf16_f32 v121, v106, v107
    v_mfma_f32_16x16x32_bf16 v[180:183], v[68:71], a[60:63], v[180:183]
    ds_read_b128 v[100:103], v36 offset:23552
    v_cvt_pk_bf16_f32 v122, v108, v109
    v_cvt_pk_bf16_f32 v123, v110, v111
    v_mfma_f32_16x16x32_bf16 v[184:187], v[40:43], a[64:67], v[232:235]
    ds_write_b128 v20, v[120:123] offset:0
    v_mfma_f32_16x16x32_bf16 v[184:187], v[44:47], a[68:71], v[184:187]
    v_fma_f32 v112, v248, v208, 1.0
    v_fma_f32 v113, v249, v209, 1.0
    v_mfma_f32_16x16x32_bf16 v[184:187], v[48:51], a[72:75], v[184:187]
    v_fma_f32 v114, v250, v210, 1.0
    v_fma_f32 v115, v251, v211, 1.0
    v_fma_f32 v116, v252, v216, 1.0
    v_mfma_f32_16x16x32_bf16 v[184:187], v[52:55], a[76:79], v[184:187]
    v_fma_f32 v117, v253, v217, 1.0
    v_fma_f32 v118, v254, v218, 1.0
    v_mfma_f32_16x16x32_bf16 v[184:187], v[56:59], a[80:83], v[184:187]
    v_fma_f32 v119, v255, v219, 1.0
    v_cvt_pk_bf16_f32 v6, v162, v166
    v_cvt_pk_bf16_f32 v7, v170, v174
    v_mfma_f32_16x16x32_bf16 v[184:187], v[60:63], a[84:87], v[184:187]
    ds_read_b128 v[248:251], v21 offset:4224
    v_rcp_f32 v112, v112
    v_mfma_f32_16x16x32_bf16 v[184:187], v[64:67], a[88:91], v[184:187]
    ds_read_b128 v[252:255], v21 offset:4240
    v_rcp_f32 v113, v113
    v_mfma_f32_16x16x32_bf16 v[184:187], v[68:71], a[92:95], v[184:187]
    buffer_store_dwordx2 v[6:7], v25, s[40:43], s73 offen sc1
    v_rcp_f32 v114, v114
    v_mfma_f32_16x16x32_bf16 v[188:191], v[40:43], a[96:99], v[236:239]
    v_rcp_f32 v115, v115
    v_mfma_f32_16x16x32_bf16 v[188:191], v[44:47], a[100:103], v[188:191]
    v_cvt_pk_bf16_f32 v8, v163, v167
    v_cvt_pk_bf16_f32 v9, v171, v175
    v_mfma_f32_16x16x32_bf16 v[188:191], v[48:51], a[104:107], v[188:191]
    buffer_store_dwordx2 v[8:9], v26, s[40:43], s73 offen sc1
    v_rcp_f32 v116, v116
    v_mfma_f32_16x16x32_bf16 v[188:191], v[52:55], a[108:111], v[188:191]
    v_rcp_f32 v117, v117
    v_mfma_f32_16x16x32_bf16 v[188:191], v[56:59], a[112:115], v[188:191]
    v_rcp_f32 v118, v118
    v_rcp_f32 v119, v119
    v_mfma_f32_16x16x32_bf16 v[188:191], v[60:63], a[116:119], v[188:191]
    v_cvt_pk_bf16_f32 v124, v112, v113
    v_cvt_pk_bf16_f32 v125, v114, v115
    v_mfma_f32_16x16x32_bf16 v[188:191], v[64:67], a[120:123], v[188:191]
    v_cvt_pk_bf16_f32 v126, v116, v117
    v_cvt_pk_bf16_f32 v127, v118, v119
    v_mfma_f32_16x16x32_bf16 v[188:191], v[68:71], a[124:127], v[188:191]
    s_waitcnt lgkmcnt(1)
    ds_write_b128 v20, v[124:127] offset:1024
    v_mfma_f32_16x16x32_bf16 v[160:163], v[72:75], a[0:3], v[224:227]
    v_fma_f32 v104, v240, v192, 1.0
    v_fma_f32 v105, v241, v193, 1.0
    v_fma_f32 v106, v242, v194, 1.0
    v_mfma_f32_16x16x32_bf16 v[160:163], v[76:79], a[4:7], v[160:163]
    s_add_u32 s73, s71, 512
    v_fma_f32 v107, v243, v195, 1.0
    v_fma_f32 v108, v244, v200, 1.0
    v_fma_f32 v109, v245, v201, 1.0
    v_fma_f32 v110, v246, v202, 1.0
    v_mfma_f32_16x16x32_bf16 v[160:163], v[80:83], a[8:11], v[160:163]
    v_fma_f32 v111, v247, v203, 1.0
    v_cvt_pk_bf16_f32 v2, v176, v180
    v_cvt_pk_bf16_f32 v3, v184, v188
    v_mfma_f32_16x16x32_bf16 v[160:163], v[84:87], a[12:15], v[160:163]
    ds_read_b128 v[240:243], v21 offset:5120
    v_rcp_f32 v104, v104
    v_mfma_f32_16x16x32_bf16 v[160:163], v[88:91], a[16:19], v[160:163]
    ds_read_b128 v[244:247], v21 offset:5136
    v_rcp_f32 v105, v105
    v_rcp_f32 v106, v106
    v_mfma_f32_16x16x32_bf16 v[160:163], v[92:95], a[20:23], v[160:163]
    buffer_store_dwordx2 v[2:3], v23, s[40:43], s73 offen sc1
    v_mfma_f32_16x16x32_bf16 v[160:163], v[96:99], a[24:27], v[160:163]
    s_waitcnt lgkmcnt(2)
    s_barrier
    v_rcp_f32 v107, v107
    v_cvt_pk_bf16_f32 v4, v177, v181
    v_cvt_pk_bf16_f32 v5, v185, v189
    v_mfma_f32_16x16x32_bf16 v[160:163], v[100:103], a[28:31], v[160:163]
    buffer_store_dwordx2 v[4:5], v24, s[40:43], s73 offen sc1
    v_rcp_f32 v108, v108
    v_mfma_f32_16x16x32_bf16 v[164:167], v[72:75], a[32:35], v[228:231]
    ds_read_b128 v[40:43], v36 offset:0
    v_rcp_f32 v109, v109
    v_mfma_f32_16x16x32_bf16 v[164:167], v[76:79], a[36:39], v[164:167]
    ds_read_b128 v[44:47], v36 offset:1024
    v_rcp_f32 v110, v110
    v_mfma_f32_16x16x32_bf16 v[164:167], v[80:83], a[40:43], v[164:167]
    ds_read_b128 v[48:51], v36 offset:2048
    v_rcp_f32 v111, v111
    v_cvt_pk_bf16_f32 v120, v104, v105
    v_mfma_f32_16x16x32_bf16 v[164:167], v[84:87], a[44:47], v[164:167]
    ds_read_b128 v[52:55], v36 offset:3072
    v_cvt_pk_bf16_f32 v121, v106, v107
    v_cvt_pk_bf16_f32 v122, v108, v109
    v_cvt_pk_bf16_f32 v123, v110, v111
    v_mfma_f32_16x16x32_bf16 v[164:167], v[88:91], a[48:51], v[164:167]
    ds_write_b128 v20, v[120:123] offset:8192
    v_mfma_f32_16x16x32_bf16 v[164:167], v[92:95], a[52:55], v[164:167]
    ds_read_b128 v[56:59], v36 offset:4096
    v_fma_f32 v112, v248, v208, 1.0
    v_fma_f32 v113, v249, v209, 1.0
    v_mfma_f32_16x16x32_bf16 v[164:167], v[96:99], a[56:59], v[164:167]
    ds_read_b128 v[60:63], v36 offset:5120
    v_fma_f32 v114, v250, v210, 1.0
    v_fma_f32 v115, v251, v211, 1.0
    v_mfma_f32_16x16x32_bf16 v[164:167], v[100:103], a[60:63], v[164:167]
    ds_read_b128 v[64:67], v36 offset:6144
    v_fma_f32 v116, v252, v216, 1.0
    v_fma_f32 v117, v253, v217, 1.0
    v_fma_f32 v118, v254, v218, 1.0
    v_mfma_f32_16x16x32_bf16 v[168:171], v[72:75], a[64:67], v[232:235]
    ds_read_b128 v[68:71], v36 offset:7168
    v_fma_f32 v119, v255, v219, 1.0
    v_cvt_pk_bf16_f32 v6, v178, v182
    v_mfma_f32_16x16x32_bf16 v[168:171], v[76:79], a[68:71], v[168:171]
    ds_read_b128 v[248:251], v21 offset:5248
    v_cvt_pk_bf16_f32 v7, v186, v190
    v_rcp_f32 v112, v112
    v_mfma_f32_16x16x32_bf16 v[168:171], v[80:83], a[72:75], v[168:171]
    ds_read_b128 v[252:255], v21 offset:5264
    v_rcp_f32 v113, v113
    v_mfma_f32_16x16x32_bf16 v[168:171], v[84:87], a[76:79], v[168:171]
    buffer_store_dwordx2 v[6:7], v25, s[40:43], s73 offen sc1
    v_rcp_f32 v114, v114
    v_mfma_f32_16x16x32_bf16 v[168:171], v[88:91], a[80:83], v[168:171]
    v_rcp_f32 v115, v115
    v_cvt_pk_bf16_f32 v8, v179, v183
    v_mfma_f32_16x16x32_bf16 v[168:171], v[92:95], a[84:87], v[168:171]
    v_cvt_pk_bf16_f32 v9, v187, v191
    v_rcp_f32 v116, v116
    v_mfma_f32_16x16x32_bf16 v[168:171], v[96:99], a[88:91], v[168:171]
    buffer_store_dwordx2 v[8:9], v26, s[40:43], s73 offen sc1
    v_rcp_f32 v117, v117
    v_mfma_f32_16x16x32_bf16 v[168:171], v[100:103], a[92:95], v[168:171]
    v_rcp_f32 v118, v118
    v_rcp_f32 v119, v119
    v_mfma_f32_16x16x32_bf16 v[172:175], v[72:75], a[96:99], v[236:239]
    v_cvt_pk_bf16_f32 v124, v112, v113
    v_cvt_pk_bf16_f32 v125, v114, v115
    v_cvt_pk_bf16_f32 v126, v116, v117
    v_mfma_f32_16x16x32_bf16 v[172:175], v[76:79], a[100:103], v[172:175]
    s_waitcnt vmcnt(8)
    v_cvt_pk_bf16_f32 v127, v118, v119
    v_max3_u32 v1, v128, v129, v130
    v_max3_u32 v1, v131, v132, v1
    v_mfma_f32_16x16x32_bf16 v[172:175], v[80:83], a[104:107], v[172:175]
    ds_write_b128 v20, v[124:127] offset:9216
    v_mfma_f32_16x16x32_bf16 v[172:175], v[84:87], a[108:111], v[172:175]
    v_max3_u32 v1, v133, v134, v1
    v_max3_u32 v1, v135, v136, v1
    v_max3_u32 v1, v137, v138, v1
    v_mfma_f32_16x16x32_bf16 v[172:175], v[88:91], a[112:115], v[172:175]
    v_max3_u32 v1, v139, v140, v1
    v_max3_u32 v1, v141, v142, v1
    v_max3_u32 v1, v143, v144, v1
    v_mfma_f32_16x16x32_bf16 v[172:175], v[92:95], a[116:119], v[172:175]
    v_max3_u32 v1, v145, v146, v1
    v_max3_u32 v1, v147, v148, v1
    v_max3_u32 v1, v149, v150, v1
    v_max3_u32 v1, v151, v152, v1
    v_mfma_f32_16x16x32_bf16 v[172:175], v[96:99], a[120:123], v[172:175]
    v_max3_u32 v1, v153, v154, v1
    v_max3_u32 v1, v155, v156, v1
    v_max3_u32 v1, v157, v158, v1
    v_max_u32 v1, v159, v1
    v_mfma_f32_16x16x32_bf16 v[172:175], v[100:103], a[124:127], v[172:175]
    v_cmp_eq_u32 vcc, -1, v1
    s_nop 0
    s_cbranch_vccnz L_cfbf
L_cfbf_b:
    s_waitcnt lgkmcnt(1)
    v_mfma_f32_16x16x32_bf16 v[176:179], v[40:43], a[0:3], v[224:227]
    v_fma_f32 v104, v240, v192, 1.0
    v_fma_f32 v105, v241, v193, 1.0
    v_mfma_f32_16x16x32_bf16 v[176:179], v[44:47], a[4:7], v[176:179]
    s_add_u32 s73, s71, 1024
    v_fma_f32 v106, v242, v194, 1.0
    v_fma_f32 v107, v243, v195, 1.0
    v_mfma_f32_16x16x32_bf16 v[176:179], v[48:51], a[8:11], v[176:179]
L_rw4:
    v_mov_b32 v18, L_rw4-L_pc+2048
    v_fma_f32 v108, v244, v200, 1.0
    v_mfma_f32_16x16x32_bf16 v[176:179], v[52:55], a[12:15], v[176:179]
    v_fma_f32 v109, v245, v201, 1.0
    v_fma_f32 v110, v246, v202, 1.0
    v_mfma_f32_16x16x32_bf16 v[176:179], v[56:59], a[16:19], v[176:179]
    global_load_dword v19, v18, s[78:79]
    v_fma_f32 v111, v247, v203, 1.0
    v_mfma_f32_16x16x32_bf16 v[176:179], v[60:63], a[20:23], v[176:179]
    ds_read_b128 v[240:243], v21 offset:6144
    v_cvt_pk_bf16_f32 v2, v160, v164
    v_mfma_f32_16x16x32_bf16 v[176:179], v[64:67], a[24:27], v[176:179]
    s_waitcnt lgkmcnt(1)
    s_barrier
    ds_read_b128 v[244:247], v21 offset:6160
    v_cvt_pk_bf16_f32 v3, v168, v172
    v_mfma_f32_16x16x32_bf16 v[176:179], v[68:71], a[28:31], v[176:179]
    buffer_store_dwordx2 v[2:3], v23, s[40:43], s73 offen sc1
    v_mfma_f32_16x16x32_bf16 v[180:183], v[40:43], a[32:35], v[228:231]
    ds_read_b128 v[72:75], v36 offset:8192
    v_rcp_f32 v104, v104
    v_mfma_f32_16x16x32_bf16 v[180:183], v[44:47], a[36:39], v[180:183]
    ds_read_b128 v[76:79], v36 offset:9216
    v_rcp_f32 v105, v105
    v_mfma_f32_16x16x32_bf16 v[180:183], v[48:51], a[40:43], v[180:183]
    ds_read_b128 v[80:83], v36 offset:10240
    v_rcp_f32 v106, v106
    v_mfma_f32_16x16x32_bf16 v[180:183], v[52:55], a[44:47], v[180:183]
    ds_read_b128 v[84:87], v36 offset:11264
    v_rcp_f32 v107, v107
    v_mfma_f32_16x16x32_bf16 v[180:183], v[56:59], a[48:51], v[180:183]
    ds_read_b128 v[88:91], v36 offset:12288
    v_cvt_pk_bf16_f32 v4, v161, v165
    v_mfma_f32_16x16x32_bf16 v[180:183], v[60:63], a[52:55], v[180:183]
    ds_read_b128 v[92:95], v36 offset:13312
    v_cvt_pk_bf16_f32 v5, v169, v173
    v_mfma_f32_16x16x32_bf16 v[180:183], v[64:67], a[56:59], v[180:183]
    buffer_store_dwordx2 v[4:5], v24, s[40:43], s73 offen sc1
    v_mfma_f32_16x16x32_bf16 v[180:183], v[68:71], a[60:63], v[180:183]
    ds_read_b128 v[96:99], v36 offset:14336
    v_rcp_f32 v108, v108
    v_mfma_f32_16x16x32_bf16 v[184:187], v[40:43], a[64:67], v[232:235]
    ds_read_b128 v[100:103], v36 offset:15360
    v_rcp_f32 v109, v109
    v_mfma_f32_16x16x32_bf16 v[184:187], v[44:47], a[68:71], v[184:187]
    v_rcp_f32 v110, v110
    v_mfma_f32_16x16x32_bf16 v[184:187], v[48:51], a[72:75], v[184:187]
    v_rcp_f32 v111, v111
    v_mfma_f32_16x16x32_bf16 v[184:187], v[52:55], a[76:79], v[184:187]
    v_cvt_pk_bf16_f32 v120, v104, v105
    v_cvt_pk_bf16_f32 v121, v106, v107
    v_mfma_f32_16x16x32_bf16 v[184:187], v[56:59], a[80:83], v[184:187]
    v_cvt_pk_bf16_f32 v122, v108, v109
    v_cvt_pk_bf16_f32 v123, v110, v111
    v_mfma_f32_16x16x32_bf16 v[184:187], v[60:63], a[84:87], v[184:187]
    ds_write_b128 v20, v[120:123] offset:16384
    v_mfma_f32_16x16x32_bf16 v[184:187], v[64:67], a[88:91], v[184:187]
    v_fma_f32 v112, v248, v208, 1.0
    v_fma_f32 v113, v249, v209, 1.0
    v_mfma_f32_16x16x32_bf16 v[184:187], v[68:71], a[92:95], v[184:187]
    v_fma_f32 v114, v250, v210, 1.0
    v_fma_f32 v115, v251, v211, 1.0
    v_mfma_f32_16x16x32_bf16 v[188:191], v[40:43], a[96:99], v[236:239]
    v_fma_f32 v116, v252, v216, 1.0
    v_fma_f32 v117, v253, v217, 1.0
    v_mfma_f32_16x16x32_bf16 v[188:191], v[44:47], a[100:103], v[188:191]
    v_fma_f32 v118, v254, v218, 1.0
    v_fma_f32 v119, v255, v219, 1.0
    v_mfma_f32_16x16x32_bf16 v[188:191], v[48:51], a[104:107], v[188:191]
    ds_read_b128 v[248:251], v21 offset:6272
    v_cvt_pk_bf16_f32 v6, v162, v166
    v_mfma_f32_16x16x32_bf16 v[188:191], v[52:55], a[108:111], v[188:191]
    ds_read_b128 v[252:255], v21 offset:6288
    v_cvt_pk_bf16_f32 v7, v170, v174
    v_mfma_f32_16x16x32_bf16 v[188:191], v[56:59], a[112:115], v[188:191]
    buffer_store_dwordx2 v[6:7], v25, s[40:43], s73 offen sc1
    v_mfma_f32_16x16x32_bf16 v[188:191], v[60:63], a[116:119], v[188:191]
    v_rcp_f32 v112, v112
    v_mfma_f32_16x16x32_bf16 v[188:191], v[64:67], a[120:123], v[188:191]
    v_rcp_f32 v113, v113
    v_mfma_f32_16x16x32_bf16 v[188:191], v[68:71], a[124:127], v[188:191]
    v_rcp_f32 v114, v114
    v_mfma_f32_16x16x32_bf16 v[196:199], a[128:131], v[128:131], 0
    v_rcp_f32 v115, v115
    v_mfma_f32_16x16x32_bf16 v[196:199], a[132:135], v[132:135], v[196:199]
    v_cvt_pk_bf16_f32 v8, v163, v167
    v_cvt_pk_bf16_f32 v9, v171, v175
    v_mfma_f32_16x16x32_bf16 v[196:199], a[136:139], v[136:139], v[196:199]
    buffer_store_dwordx2 v[8:9], v26, s[40:43], s73 offen sc1
    v_mfma_f32_16x16x32_bf16 v[196:199], a[140:143], v[140:143], v[196:199]
    v_rcp_f32 v116, v116
    v_mfma_f32_16x16x32_bf16 v[196:199], a[144:147], v[144:147], v[196:199]
    v_rcp_f32 v117, v117
    v_mfma_f32_16x16x32_bf16 v[196:199], a[148:151], v[148:151], v[196:199]
    v_rcp_f32 v118, v118
    v_mfma_f32_16x16x32_bf16 v[196:199], a[152:155], v[152:155], v[196:199]
    v_rcp_f32 v119, v119
    v_mfma_f32_16x16x32_bf16 v[196:199], a[156:159], v[156:159], v[196:199]
    v_cvt_pk_bf16_f32 v124, v112, v113
    v_cvt_pk_bf16_f32 v125, v114, v115
    v_mfma_f32_16x16x32_bf16 v[204:207], a[160:163], v[128:131], 0
    v_cvt_pk_bf16_f32 v126, v116, v117
    v_cvt_pk_bf16_f32 v127, v118, v119
    v_mfma_f32_16x16x32_bf16 v[204:207], a[164:167], v[132:135], v[204:207]
    ds_write_b128 v20, v[124:127] offset:17408
    v_mfma_f32_16x16x32_bf16 v[204:207], a[168:171], v[136:139], v[204:207]
    v_mfma_f32_16x16x32_bf16 v[204:207], a[172:175], v[140:143], v[204:207]
    v_mul_f32 v196, s72, v196
    v_mul_f32 v197, s72, v197
    v_mfma_f32_16x16x32_bf16 v[204:207], a[176:179], v[144:147], v[204:207]
    v_mul_f32 v198, s72, v198
    v_mul_f32 v199, s72, v199
    v_mfma_f32_16x16x32_bf16 v[204:207], a[180:183], v[148:151], v[204:207]
    v_exp_f32 v196, v196
    v_mfma_f32_16x16x32_bf16 v[204:207], a[184:187], v[152:155], v[204:207]
    v_exp_f32 v197, v197
    v_mfma_f32_16x16x32_bf16 v[204:207], a[188:191], v[156:159], v[204:207]
    v_exp_f32 v198, v198
    v_mfma_f32_16x16x32_bf16 v[212:215], a[192:195], v[128:131], 0
    v_exp_f32 v199, v199
    v_mfma_f32_16x16x32_bf16 v[212:215], a[196:199], v[132:135], v[212:215]
    v_mfma_f32_16x16x32_bf16 v[212:215], a[200:203], v[136:139], v[212:215]
    v_mfma_f32_16x16x32_bf16 v[212:215], a[204:207], v[140:143], v[212:215]
    s_nop 1
    v_mul_f32 v204, s72, v204
    v_mul_f32 v205, s72, v205
    v_mfma_f32_16x16x32_bf16 v[212:215], a[208:211], v[144:147], v[212:215]
    v_mul_f32 v206, s72, v206
    v_mul_f32 v207, s72, v207
    v_mfma_f32_16x16x32_bf16 v[212:215], a[212:215], v[148:151], v[212:215]
    v_exp_f32 v204, v204
    v_mfma_f32_16x16x32_bf16 v[212:215], a[216:219], v[152:155], v[212:215]
    v_exp_f32 v205, v205
    v_mfma_f32_16x16x32_bf16 v[212:215], a[220:223], v[156:159], v[212:215]
    v_exp_f32 v206, v206
    v_mfma_f32_16x16x32_bf16 v[220:223], a[224:227], v[128:131], 0
    v_exp_f32 v207, v207
    v_mfma_f32_16x16x32_bf16 v[220:223], a[228:231], v[132:135], v[220:223]
    v_mfma_f32_16x16x32_bf16 v[220:223], a[232:235], v[136:139], v[220:223]
    v_mfma_f32_16x16x32_bf16 v[220:223], a[236:239], v[140:143], v[220:223]
    s_nop 1
    v_mul_f32 v212, s72, v212
    v_mul_f32 v213, s72, v213
    v_mfma_f32_16x16x32_bf16 v[220:223], a[240:243], v[144:147], v[220:223]
    v_mul_f32 v214, s72, v214
    v_mul_f32 v215, s72, v215
    v_mfma_f32_16x16x32_bf16 v[220:223], a[244:247], v[148:151], v[220:223]
    v_exp_f32 v212, v212
    v_mfma_f32_16x16x32_bf16 v[220:223], a[248:251], v[152:155], v[220:223]
    v_exp_f32 v213, v213
    v_mfma_f32_16x16x32_bf16 v[220:223], a[252:255], v[156:159], v[220:223]
    s_waitcnt lgkmcnt(0)
    v_exp_f32 v214, v214
    v_exp_f32 v215, v215
    v_mfma_f32_16x16x32_bf16 v[160:163], v[72:75], a[0:3], v[224:227]
    v_fma_f32 v104, v240, v192, 1.0
    v_fma_f32 v105, v241, v193, 1.0
    v_fma_f32 v106, v242, v194, 1.0
    v_mfma_f32_16x16x32_bf16 v[160:163], v[76:79], a[4:7], v[160:163]
    s_add_u32 s73, s71, 1536
    v_fma_f32 v107, v243, v195, 1.0
    v_fma_f32 v108, v244, v200, 1.0
    v_fma_f32 v109, v245, v201, 1.0
    v_fma_f32 v110, v246, v202, 1.0
    v_mfma_f32_16x16x32_bf16 v[160:163], v[80:83], a[8:11], v[160:163]
    v_fma_f32 v111, v247, v203, 1.0
    v_mul_f32 v220, s72, v220
    v_mul_f32 v221, s72, v221
    v_mfma_f32_16x16x32_bf16 v[160:163], v[84:87], a[12:15], v[160:163]
    ds_read_b128 v[240:243], v21 offset:7168
    v_mul_f32 v222, s72, v222
    v_mul_f32 v223, s72, v223
    v_mfma_f32_16x16x32_bf16 v[160:163], v[88:91], a[16:19], v[160:163]
    ds_read_b128 v[244:247], v21 offset:7184
    v_exp_f32 v220, v220
    v_mfma_f32_16x16x32_bf16 v[160:163], v[92:95], a[20:23], v[160:163]
    v_exp_f32 v221, v221
    v_exp_f32 v222, v222
    v_mfma_f32_16x16x32_bf16 v[160:163], v[96:99], a[24:27], v[160:163]
    s_barrier
    v_exp_f32 v223, v223
    v_cvt_pk_bf16_f32 v2, v176, v180
    v_mfma_f32_16x16x32_bf16 v[160:163], v[100:103], a[28:31], v[160:163]
    ds_read_b128 v[40:43], v36 offset:16384
    v_cvt_pk_bf16_f32 v3, v184, v188
    v_mfma_f32_16x16x32_bf16 v[164:167], v[72:75], a[32:35], v[228:231]
    buffer_store_dwordx2 v[2:3], v23, s[40:43], s73 offen sc1
    v_rcp_f32 v104, v104
    v_mfma_f32_16x16x32_bf16 v[164:167], v[76:79], a[36:39], v[164:167]
    ds_read_b128 v[44:47], v36 offset:17408
    v_rcp_f32 v105, v105
    v_mfma_f32_16x16x32_bf16 v[164:167], v[80:83], a[40:43], v[164:167]
    ds_read_b128 v[48:51], v36 offset:18432
    v_rcp_f32 v106, v106
    v_mfma_f32_16x16x32_bf16 v[164:167], v[84:87], a[44:47], v[164:167]
    ds_read_b128 v[52:55], v36 offset:19456
    v_rcp_f32 v107, v107
    v_cvt_pk_bf16_f32 v4, v177, v181
    v_mfma_f32_16x16x32_bf16 v[164:167], v[88:91], a[48:51], v[164:167]
    ds_read_b128 v[56:59], v36 offset:20480
    v_cvt_pk_bf16_f32 v5, v185, v189
    v_rcp_f32 v108, v108
    v_mfma_f32_16x16x32_bf16 v[164:167], v[92:95], a[52:55], v[164:167]
    buffer_store_dwordx2 v[4:5], v24, s[40:43], s73 offen sc1
    v_mfma_f32_16x16x32_bf16 v[164:167], v[96:99], a[56:59], v[164:167]
    ds_read_b128 v[60:63], v36 offset:21504
    v_rcp_f32 v109, v109
    v_mfma_f32_16x16x32_bf16 v[164:167], v[100:103], a[60:63], v[164:167]
    ds_read_b128 v[64:67], v36 offset:22528
    v_rcp_f32 v110, v110
    v_rcp_f32 v111, v111
    v_mfma_f32_16x16x32_bf16 v[168:171], v[72:75], a[64:67], v[232:235]
    ds_read_b128 v[68:71], v36 offset:23552
    v_cvt_pk_bf16_f32 v120, v104, v105
    v_mfma_f32_16x16x32_bf16 v[168:171], v[76:79], a[68:71], v[168:171]
    v_cvt_pk_bf16_f32 v121, v106, v107
    v_cvt_pk_bf16_f32 v122, v108, v109
    v_cvt_pk_bf16_f32 v123, v110, v111
    v_fma_f32 v112, v248, v208, 1.0
    v_mfma_f32_16x16x32_bf16 v[168:171], v[80:83], a[72:75], v[168:171]
    ds_write_b128 v20, v[120:123] offset:0
    v_mfma_f32_16x16x32_bf16 v[168:171], v[84:87], a[76:79], v[168:171]
    v_fma_f32 v113, v249, v209, 1.0
    v_fma_f32 v114, v250, v210, 1.0
    v_mfma_f32_16x16x32_bf16 v[168:171], v[88:91], a[80:83], v[168:171]
    v_fma_f32 v115, v251, v211, 1.0
    v_fma_f32 v116, v252, v216, 1.0
    v_fma_f32 v117, v253, v217, 1.0
    v_mfma_f32_16x16x32_bf16 v[168:171], v[92:95], a[84:87], v[168:171]
    v_fma_f32 v118, v254, v218, 1.0
    v_fma_f32 v119, v255, v219, 1.0
    v_cvt_pk_bf16_f32 v6, v178, v182
    v_mfma_f32_16x16x32_bf16 v[168:171], v[96:99], a[88:91], v[168:171]
    ds_read_b128 v[248:251], v21 offset:7296
    v_cvt_pk_bf16_f32 v7, v186, v190
    v_rcp_f32 v112, v112
    v_mfma_f32_16x16x32_bf16 v[168:171], v[100:103], a[92:95], v[168:171]
    ds_read_b128 v[252:255], v21 offset:7312
    v_rcp_f32 v113, v113
    v_mfma_f32_16x16x32_bf16 v[172:175], v[72:75], a[96:99], v[236:239]
    buffer_store_dwordx2 v[6:7], v25, s[40:43], s73 offen sc1
    v_rcp_f32 v114, v114
    v_mfma_f32_16x16x32_bf16 v[172:175], v[76:79], a[100:103], v[172:175]
    v_rcp_f32 v115, v115
    v_mfma_f32_16x16x32_bf16 v[172:175], v[80:83], a[104:107], v[172:175]
    v_cvt_pk_bf16_f32 v8, v179, v183
    v_cvt_pk_bf16_f32 v9, v187, v191
    v_rcp_f32 v116, v116
    v_mfma_f32_16x16x32_bf16 v[172:175], v[84:87], a[108:111], v[172:175]
    buffer_store_dwordx2 v[8:9], v26, s[40:43], s73 offen sc1
    v_mfma_f32_16x16x32_bf16 v[172:175], v[88:91], a[112:115], v[172:175]
    v_rcp_f32 v117, v117
    v_rcp_f32 v118, v118
    v_mfma_f32_16x16x32_bf16 v[172:175], v[92:95], a[116:119], v[172:175]
    v_rcp_f32 v119, v119
    v_cvt_pk_bf16_f32 v124, v112, v113
    v_cvt_pk_bf16_f32 v125, v114, v115
    v_mfma_f32_16x16x32_bf16 v[172:175], v[96:99], a[120:123], v[172:175]
    v_cvt_pk_bf16_f32 v126, v116, v117
    v_cvt_pk_bf16_f32 v127, v118, v119
    v_mfma_f32_16x16x32_bf16 v[172:175], v[100:103], a[124:127], v[172:175]
    s_waitcnt lgkmcnt(2)
    ds_write_b128 v20, v[124:127] offset:1024
    v_mfma_f32_16x16x32_bf16 v[176:179], v[40:43], a[0:3], v[224:227]
    v_fma_f32 v104, v240, v192, 1.0
    v_fma_f32 v105, v241, v193, 1.0
    v_fma_f32 v106, v242, v194, 1.0
    v_mfma_f32_16x16x32_bf16 v[176:179], v[44:47], a[4:7], v[176:179]
    s_add_u32 s73, s71, 2048
    v_fma_f32 v107, v243, v195, 1.0
    v_fma_f32 v108, v244, v200, 1.0
    v_fma_f32 v109, v245, v201, 1.0
    v_mfma_f32_16x16x32_bf16 v[176:179], v[48:51], a[8:11], v[176:179]
    v_fma_f32 v110, v246, v202, 1.0
    v_fma_f32 v111, v247, v203, 1.0
    v_cvt_pk_bf16_f32 v2, v160, v164
    v_mfma_f32_16x16x32_bf16 v[176:179], v[52:55], a[12:15], v[176:179]
    ds_read_b128 v[240:243], v21 offset:0
    v_cvt_pk_bf16_f32 v3, v168, v172
    v_mfma_f32_16x16x32_bf16 v[176:179], v[56:59], a[16:19], v[176:179]
    ds_read_b128 v[244:247], v21 offset:16
    v_rcp_f32 v104, v104
    v_mfma_f32_16x16x32_bf16 v[176:179], v[60:63], a[20:23], v[176:179]
    buffer_store_dwordx2 v[2:3], v23, s[40:43], s73 offen sc1
    v_rcp_f32 v105, v105
    v_mfma_f32_16x16x32_bf16 v[176:179], v[64:67], a[24:27], v[176:179]
    s_waitcnt lgkmcnt(2)
    s_barrier
    v_rcp_f32 v106, v106
    v_mfma_f32_16x16x32_bf16 v[176:179], v[68:71], a[28:31], v[176:179]
    ds_read_b128 v[72:75], v36 offset:0
    v_rcp_f32 v107, v107
    v_mfma_f32_16x16x32_bf16 v[180:183], v[40:43], a[32:35], v[228:231]
    ds_read_b128 v[76:79], v36 offset:1024
    v_cvt_pk_bf16_f32 v4, v161, v165
    v_cvt_pk_bf16_f32 v5, v169, v173
    v_mfma_f32_16x16x32_bf16 v[180:183], v[44:47], a[36:39], v[180:183]
    buffer_store_dwordx2 v[4:5], v24, s[40:43], s73 offen sc1
    v_mfma_f32_16x16x32_bf16 v[180:183], v[48:51], a[40:43], v[180:183]
    ds_read_b128 v[80:83], v36 offset:2048
    v_rcp_f32 v108, v108
    v_mfma_f32_16x16x32_bf16 v[180:183], v[52:55], a[44:47], v[180:183]
    ds_read_b128 v[84:87], v36 offset:3072
    v_rcp_f32 v109, v109
    v_mfma_f32_16x16x32_bf16 v[180:183], v[56:59], a[48:51], v[180:183]
    ds_read_b128 v[88:91], v36 offset:4096
    v_rcp_f32 v110, v110
    v_mfma_f32_16x16x32_bf16 v[180:183], v[60:63], a[52:55], v[180:183]
    ds_read_b128 v[92:95], v36 offset:5120
    v_rcp_f32 v111, v111
    v_mfma_f32_16x16x32_bf16 v[180:183], v[64:67], a[56:59], v[180:183]
    ds_read_b128 v[96:99], v36 offset:6144
    v_cvt_pk_bf16_f32 v120, v104, v105
    v_cvt_pk_bf16_f32 v121, v106, v107
    v_mfma_f32_16x16x32_bf16 v[180:183], v[68:71], a[60:63], v[180:183]
    ds_read_b128 v[100:103], v36 offset:7168
    v_cvt_pk_bf16_f32 v122, v108, v109
    v_cvt_pk_bf16_f32 v123, v110, v111
    v_mfma_f32_16x16x32_bf16 v[184:187], v[40:43], a[64:67], v[232:235]
    ds_write_b128 v20, v[120:123] offset:8192
    v_mfma_f32_16x16x32_bf16 v[184:187], v[44:47], a[68:71], v[184:187]
    v_fma_f32 v112, v248, v208, 1.0
    v_fma_f32 v113, v249, v209, 1.0
    v_mfma_f32_16x16x32_bf16 v[184:187], v[48:51], a[72:75], v[184:187]
    v_fma_f32 v114, v250, v210, 1.0
    v_fma_f32 v115, v251, v211, 1.0
    v_fma_f32 v116, v252, v216, 1.0
    v_mfma_f32_16x16x32_bf16 v[184:187], v[52:55], a[76:79], v[184:187]
    v_fma_f32 v117, v253, v217, 1.0
    v_fma_f32 v118, v254, v218, 1.0
    v_mfma_f32_16x16x32_bf16 v[184:187], v[56:59], a[80:83], v[184:187]
    v_fma_f32 v119, v255, v219, 1.0
    v_cvt_pk_bf16_f32 v6, v162, v166
    v_cvt_pk_bf16_f32 v7, v170, v174
    v_mfma_f32_16x16x32_bf16 v[184:187], v[60:63], a[84:87], v[184:187]
    ds_read_b128 v[248:251], v21 offset:128
    v_rcp_f32 v112, v112
    v_mfma_f32_16x16x32_bf16 v[184:187], v[64:67], a[88:91], v[184:187]
    ds_read_b128 v[252:255], v21 offset:144
    v_rcp_f32 v113, v113
    v_mfma_f32_16x16x32_bf16 v[184:187], v[68:71], a[92:95], v[184:187]
    buffer_store_dwordx2 v[6:7], v25, s[40:43], s73 offen sc1
    v_rcp_f32 v114, v114
    v_mfma_f32_16x16x32_bf16 v[188:191], v[40:43], a[96:99], v[236:239]
    v_rcp_f32 v115, v115
    v_mfma_f32_16x16x32_bf16 v[188:191], v[44:47], a[100:103], v[188:191]
    v_cvt_pk_bf16_f32 v8, v163, v167
    v_cvt_pk_bf16_f32 v9, v171, v175
    v_mfma_f32_16x16x32_bf16 v[188:191], v[48:51], a[104:107], v[188:191]
    buffer_store_dwordx2 v[8:9], v26, s[40:43], s73 offen sc1
    v_rcp_f32 v116, v116
    v_mfma_f32_16x16x32_bf16 v[188:191], v[52:55], a[108:111], v[188:191]
    v_rcp_f32 v117, v117
    v_mfma_f32_16x16x32_bf16 v[188:191], v[56:59], a[112:115], v[188:191]
    v_rcp_f32 v118, v118
    v_rcp_f32 v119, v119
    v_mfma_f32_16x16x32_bf16 v[188:191], v[60:63], a[116:119], v[188:191]
    v_cvt_pk_bf16_f32 v124, v112, v113
    v_cvt_pk_bf16_f32 v125, v114, v115
    v_mfma_f32_16x16x32_bf16 v[188:191], v[64:67], a[120:123], v[188:191]
    v_cvt_pk_bf16_f32 v126, v116, v117
    v_cvt_pk_bf16_f32 v127, v118, v119
    v_mfma_f32_16x16x32_bf16 v[188:191], v[68:71], a[124:127], v[188:191]
    s_waitcnt lgkmcnt(1)
    ds_write_b128 v20, v[124:127] offset:9216
    v_mfma_f32_16x16x32_bf16 v[160:163], v[72:75], a[0:3], v[224:227]
    v_fma_f32 v104, v240, v196, 1.0
    v_fma_f32 v105, v241, v197, 1.0
    v_fma_f32 v106, v242, v198, 1.0
    v_mfma_f32_16x16x32_bf16 v[160:163], v[76:79], a[4:7], v[160:163]
    s_add_u32 s73, s71, 2560
    v_fma_f32 v107, v243, v199, 1.0
    v_fma_f32 v108, v244, v204, 1.0
    v_fma_f32 v109, v245, v205, 1.0
    v_mfma_f32_16x16x32_bf16 v[160:163], v[80:83], a[8:11], v[160:163]
    v_fma_f32 v110, v246, v206, 1.0
    v_fma_f32 v111, v247, v207, 1.0
    v_cvt_pk_bf16_f32 v2, v176, v180
    v_mfma_f32_16x16x32_bf16 v[160:163], v[84:87], a[12:15], v[160:163]
    ds_read_b128 v[240:243], v21 offset:1024
    v_cvt_pk_bf16_f32 v3, v184, v188
    v_mfma_f32_16x16x32_bf16 v[160:163], v[88:91], a[16:19], v[160:163]
    ds_read_b128 v[244:247], v21 offset:1040
    v_rcp_f32 v104, v104
    v_mfma_f32_16x16x32_bf16 v[160:163], v[92:95], a[20:23], v[160:163]
    buffer_store_dwordx2 v[2:3], v23, s[40:43], s73 offen sc1
    v_rcp_f32 v105, v105
    v_mfma_f32_16x16x32_bf16 v[160:163], v[96:99], a[24:27], v[160:163]
    s_waitcnt lgkmcnt(2)
    s_barrier
    v_rcp_f32 v106, v106
    v_mfma_f32_16x16x32_bf16 v[160:163], v[100:103], a[28:31], v[160:163]
    ds_read_b128 v[40:43], v36 offset:8192
    v_rcp_f32 v107, v107
    v_mfma_f32_16x16x32_bf16 v[164:167], v[72:75], a[32:35], v[228:231]
    ds_read_b128 v[44:47], v36 offset:9216
    v_cvt_pk_bf16_f32 v4, v177, v181
    v_cvt_pk_bf16_f32 v5, v185, v189
    v_mfma_f32_16x16x32_bf16 v[164:167], v[76:79], a[36:39], v[164:167]
    buffer_store_dwordx2 v[4:5], v24, s[40:43], s73 offen sc1
    v_mfma_f32_16x16x32_bf16 v[164:167], v[80:83], a[40:43], v[164:167]
    ds_read_b128 v[48:51], v36 offset:10240
    v_rcp_f32 v108, v108
    v_mfma_f32_16x16x32_bf16 v[164:167], v[84:87], a[44:47], v[164:167]
    ds_read_b128 v[52:55], v36 offset:11264
    v_rcp_f32 v109, v109
    v_mfma_f32_16x16x32_bf16 v[164:167], v[88:91], a[48:51], v[164:167]
    ds_read_b128 v[56:59], v36 offset:12288
    v_rcp_f32 v110, v110
    v_mfma_f32_16x16x32_bf16 v[164:167], v[92:95], a[52:55], v[164:167]
    ds_read_b128 v[60:63], v36 offset:13312
    v_rcp_f32 v111, v111
    v_mfma_f32_16x16x32_bf16 v[164:167], v[96:99], a[56:59], v[164:167]
    ds_read_b128 v[64:67], v36 offset:14336
    v_cvt_pk_bf16_f32 v120, v104, v105
    v_cvt_pk_bf16_f32 v121, v106, v107
    v_mfma_f32_16x16x32_bf16 v[164:167], v[100:103], a[60:63], v[164:167]
    ds_read_b128 v[68:71], v36 offset:15360
    v_cvt_pk_bf16_f32 v122, v108, v109
    v_cvt_pk_bf16_f32 v123, v110, v111
    v_mfma_f32_16x16x32_bf16 v[168:171], v[72:75], a[64:67], v[232:235]
    ds_write_b128 v20, v[120:123] offset:16384
    v_mfma_f32_16x16x32_bf16 v[168:171], v[76:79], a[68:71], v[168:171]
    v_fma_f32 v112, v248, v212, 1.0
    v_fma_f32 v113, v249, v213, 1.0
    v_mfma_f32_16x16x32_bf16 v[168:171], v[80:83], a[72:75], v[168:171]
    v_fma_f32 v114, v250, v214, 1.0
    v_fma_f32 v115, v251, v215, 1.0
    v_fma_f32 v116, v252, v220, 1.0
    v_mfma_f32_16x16x32_bf16 v[168:171], v[84:87], a[76:79], v[168:171]
    v_fma_f32 v117, v253, v221, 1.0
    v_fma_f32 v118, v254, v222, 1.0
    v_mfma_f32_16x16x32_bf16 v[168:171], v[88:91], a[80:83], v[168:171]
    v_fma_f32 v119, v255, v223, 1.0
    v_cvt_pk_bf16_f32 v6, v178, v182
    v_cvt_pk_bf16_f32 v7, v186, v190
    v_mfma_f32_16x16x32_bf16 v[168:171], v[92:95], a[84:87], v[168:171]
    ds_read_b128 v[248:251], v21 offset:1152
    v_rcp_f32 v112, v112
    v_mfma_f32_16x16x32_bf16 v[168:171], v[96:99], a[88:91], v[168:171]
    ds_read_b128 v[252:255], v21 offset:1168
    v_rcp_f32 v113, v113
    v_mfma_f32_16x16x32_bf16 v[168:171], v[100:103], a[92:95], v[168:171]
    buffer_store_dwordx2 v[6:7], v25, s[40:43], s73 offen sc1
    v_rcp_f32 v114, v114
    v_mfma_f32_16x16x32_bf16 v[172:175], v[72:75], a[96:99], v[236:239]
    v_rcp_f32 v115, v115
    v_mfma_f32_16x16x32_bf16 v[172:175], v[76:79], a[100:103], v[172:175]
    v_cvt_pk_bf16_f32 v8, v179, v183
    v_cvt_pk_bf16_f32 v9, v187, v191
    v_mfma_f32_16x16x32_bf16 v[172:175], v[80:83], a[104:107], v[172:175]
    buffer_store_dwordx2 v[8:9], v26, s[40:43], s73 offen sc1
    v_rcp_f32 v116, v116
    v_mfma_f32_16x16x32_bf16 v[172:175], v[84:87], a[108:111], v[172:175]
    v_rcp_f32 v117, v117
    v_mfma_f32_16x16x32_bf16 v[172:175], v[88:91], a[112:115], v[172:175]
    v_rcp_f32 v118, v118
    v_rcp_f32 v119, v119
    v_mfma_f32_16x16x32_bf16 v[172:175], v[92:95], a[116:119], v[172:175]
    v_cvt_pk_bf16_f32 v124, v112, v113
    v_cvt_pk_bf16_f32 v125, v114, v115
    v_mfma_f32_16x16x32_bf16 v[172:175], v[96:99], a[120:123], v[172:175]
    v_cvt_pk_bf16_f32 v126, v116, v117
    v_cvt_pk_bf16_f32 v127, v118, v119
    v_mfma_f32_16x16x32_bf16 v[172:175], v[100:103], a[124:127], v[172:175]
    s_waitcnt lgkmcnt(1)
    ds_write_b128 v20, v[124:127] offset:17408
    v_mfma_f32_16x16x32_bf16 v[176:179], v[40:43], a[0:3], v[224:227]
    v_fma_f32 v104, v240, v196, 1.0
    v_fma_f32 v105, v241, v197, 1.0
    v_fma_f32 v106, v242, v198, 1.0
    v_mfma_f32_16x16x32_bf16 v[176:179], v[44:47], a[4:7], v[176:179]
    s_add_u32 s73, s71, 3072
    v_fma_f32 v107, v243, v199, 1.0
    v_fma_f32 v108, v244, v204, 1.0
    v_fma_f32 v109, v245, v205, 1.0
    v_mfma_f32_16x16x32_bf16 v[176:179], v[48:51], a[8:11], v[176:179]
L_rw5:
    v_mov_b32 v18, L_rw5-L_pc+2048
    v_fma_f32 v110, v246, v206, 1.0
    v_fma_f32 v111, v247, v207, 1.0
    v_mfma_f32_16x16x32_bf16 v[176:179], v[52:55], a[12:15], v[176:179]
    ds_read_b128 v[240:243], v21 offset:2048
    v_cvt_pk_bf16_f32 v2, v160, v164
    v_cvt_pk_bf16_f32 v3, v168, v172
    v_mfma_f32_16x16x32_bf16 v[176:179], v[56:59], a[16:19], v[176:179]
    ds_read_b128 v[244:247], v21 offset:2064
    v_rcp_f32 v104, v104
    v_mfma_f32_16x16x32_bf16 v[176:179], v[60:63], a[20:23], v[176:179]
    buffer_store_dwordx2 v[2:3], v23, s[40:43], s73 offen sc1
    v_mfma_f32_16x16x32_bf16 v[176:179], v[64:67], a[24:27], v[176:179]
    s_waitcnt lgkmcnt(2)
    s_barrier
    global_load_dword v19, v18, s[78:79]
    v_rcp_f32 v105, v105
    v_mfma_f32_16x16x32_bf16 v[176:179], v[68:71], a[28:31], v[176:179]
    ds_read_b128 v[72:75], v36 offset:16384
    v_rcp_f32 v106, v106
    v_mfma_f32_16x16x32_bf16 v[180:183], v[40:43], a[32:35], v[228:231]
    ds_read_b128 v[76:79], v36 offset:17408
    v_rcp_f32 v107, v107
    v_mfma_f32_16x16x32_bf16 v[180:183], v[44:47], a[36:39], v[180:183]
    ds_read_b128 v[80:83], v36 offset:18432
    v_cvt_pk_bf16_f32 v4, v161, v165
    v_cvt_pk_bf16_f32 v5, v169, v173
    v_mfma_f32_16x16x32_bf16 v[180:183], v[48:51], a[40:43], v[180:183]
    buffer_store_dwordx2 v[4:5], v24, s[40:43], s73 offen sc1
    v_rcp_f32 v108, v108
    v_mfma_f32_16x16x32_bf16 v[180:183], v[52:55], a[44:47], v[180:183]
    ds_read_b128 v[84:87], v36 offset:19456
    v_rcp_f32 v109, v109
    v_mfma_f32_16x16x32_bf16 v[180:183], v[56:59], a[48:51], v[180:183]
    ds_read_b128 v[88:91], v36 offset:20480
    v_rcp_f32 v110, v110
    v_mfma_f32_16x16x32_bf16 v[180:183], v[60:63], a[52:55], v[180:183]
    ds_read_b128 v[92:95], v36 offset:21504
    v_rcp_f32 v111, v111
    v_mfma_f32_16x16x32_bf16 v[180:183], v[64:67], a[56:59], v[180:183]
    ds_read_b128 v[96:99], v36 offset:22528
    v_cvt_pk_bf16_f32 v120, v104, v105
    v_mfma_f32_16x16x32_bf16 v[180:183], v[68:71], a[60:63], v[180:183]
    ds_read_b128 v[100:103], v36 offset:23552
    v_cvt_pk_bf16_f32 v121, v106, v107
    v_cvt_pk_bf16_f32 v122, v108, v109
    v_mfma_f32_16x16x32_bf16 v[184:187], v[40:43], a[64:67], v[232:235]
    v_cvt_pk_bf16_f32 v123, v110, v111
    v_fma_f32 v112, v248, v212, 1.0
    v_fma_f32 v113, v249, v213, 1.0
    v_mfma_f32_16x16x32_bf16 v[184:187], v[44:47], a[68:71], v[184:187]
    ds_write_b128 v20, v[120:123] offset:0
    v_mfma_f32_16x16x32_bf16 v[184:187], v[48:51], a[72:75], v[184:187]
    v_fma_f32 v114, v250, v214, 1.0
    v_fma_f32 v115, v251, v215, 1.0
    v_mfma_f32_16x16x32_bf16 v[184:187], v[52:55], a[76:79], v[184:187]
    v_fma_f32 v116, v252, v220, 1.0
    v_fma_f32 v117, v253, v221, 1.0
    v_fma_f32 v118, v254, v222, 1.0
    v_mfma_f32_16x16x32_bf16 v[184:187], v[56:59], a[80:83], v[184:187]
    v_fma_f32 v119, v255, v223, 1.0
    v_cvt_pk_bf16_f32 v6, v162, v166
    v_mfma_f32_16x16x32_bf16 v[184:187], v[60:63], a[84:87], v[184:187]
    ds_read_b128 v[248:251], v21 offset:2176
    v_cvt_pk_bf16_f32 v7, v170, v174
    v_rcp_f32 v112, v112
    v_mfma_f32_16x16x32_bf16 v[184:187], v[64:67], a[88:91], v[184:187]
    ds_read_b128 v[252:255], v21 offset:2192
    v_rcp_f32 v113, v113
    v_mfma_f32_16x16x32_bf16 v[184:187], v[68:71], a[92:95], v[184:187]
    buffer_store_dwordx2 v[6:7], v25, s[40:43], s73 offen sc1
    v_mfma_f32_16x16x32_bf16 v[188:191], v[40:43], a[96:99], v[236:239]
    v_rcp_f32 v114, v114
    v_rcp_f32 v115, v115
    v_mfma_f32_16x16x32_bf16 v[188:191], v[44:47], a[100:103], v[188:191]
    v_cvt_pk_bf16_f32 v8, v163, v167
    v_cvt_pk_bf16_f32 v9, v171, v175
    v_mfma_f32_16x16x32_bf16 v[188:191], v[48:51], a[104:107], v[188:191]
    buffer_store_dwordx2 v[8:9], v26, s[40:43], s73 offen sc1
    v_rcp_f32 v116, v116
    v_mfma_f32_16x16x32_bf16 v[188:191], v[52:55], a[108:111], v[188:191]
    v_rcp_f32 v117, v117
    v_mfma_f32_16x16x32_bf16 v[188:191], v[56:59], a[112:115], v[188:191]
    v_rcp_f32 v118, v118
    v_mfma_f32_16x16x32_bf16 v[188:191], v[60:63], a[116:119], v[188:191]
    v_rcp_f32 v119, v119
    v_cvt_pk_bf16_f32 v124, v112, v113
    v_cvt_pk_bf16_f32 v125, v114, v115
    v_mfma_f32_16x16x32_bf16 v[188:191], v[64:67], a[120:123], v[188:191]
    v_cvt_pk_bf16_f32 v126, v116, v117
    v_cvt_pk_bf16_f32 v127, v118, v119
    v_mfma_f32_16x16x32_bf16 v[188:191], v[68:71], a[124:127], v[188:191]
    s_waitcnt lgkmcnt(1)
    ds_write_b128 v20, v[124:127] offset:1024
    v_mfma_f32_16x16x32_bf16 v[160:163], v[72:75], a[0:3], v[224:227]
    v_fma_f32 v104, v240, v196, 1.0
    v_fma_f32 v105, v241, v197, 1.0
    v_fma_f32 v106, v242, v198, 1.0
    v_mfma_f32_16x16x32_bf16 v[160:163], v[76:79], a[4:7], v[160:163]
    s_add_u32 s73, s71, 3584
    v_fma_f32 v107, v243, v199, 1.0
    v_fma_f32 v108, v244, v204, 1.0
    v_fma_f32 v109, v245, v205, 1.0
    v_mfma_f32_16x16x32_bf16 v[160:163], v[80:83], a[8:11], v[160:163]
    v_fma_f32 v110, v246, v206, 1.0
    v_fma_f32 v111, v247, v207, 1.0
    v_cvt_pk_bf16_f32 v2, v176, v180
    v_mfma_f32_16x16x32_bf16 v[160:163], v[84:87], a[12:15], v[160:163]
    ds_read_b128 v[240:243], v21 offset:3072
    v_cvt_pk_bf16_f32 v3, v184, v188
    v_mfma_f32_16x16x32_bf16 v[160:163], v[88:91], a[16:19], v[160:163]
    ds_read_b128 v[244:247], v21 offset:3088
    v_rcp_f32 v104, v104
    v_mfma_f32_16x16x32_bf16 v[160:163], v[92:95], a[20:23], v[160:163]
    buffer_store_dwordx2 v[2:3], v23, s[40:43], s73 offen sc1
    v_rcp_f32 v105, v105
    v_mfma_f32_16x16x32_bf16 v[160:163], v[96:99], a[24:27], v[160:163]
    s_waitcnt lgkmcnt(2)
    s_barrier
    v_rcp_f32 v106, v106
    v_mfma_f32_16x16x32_bf16 v[160:163], v[100:103], a[28:31], v[160:163]
    ds_read_b128 v[40:43], v36 offset:0
    v_rcp_f32 v107, v107
    v_mfma_f32_16x16x32_bf16 v[164:167], v[72:75], a[32:35], v[228:231]
    ds_read_b128 v[44:47], v36 offset:1024
    v_cvt_pk_bf16_f32 v4, v177, v181
    v_cvt_pk_bf16_f32 v5, v185, v189
    v_mfma_f32_16x16x32_bf16 v[164:167], v[76:79], a[36:39], v[164:167]
    buffer_store_dwordx2 v[4:5], v24, s[40:43], s73 offen sc1
    v_mfma_f32_16x16x32_bf16 v[164:167], v[80:83], a[40:43], v[164:167]
    ds_read_b128 v[48:51], v36 offset:2048
    v_rcp_f32 v108, v108
    v_mfma_f32_16x16x32_bf16 v[164:167], v[84:87], a[44:47], v[164:167]
    ds_read_b128 v[52:55], v36 offset:3072
    v_rcp_f32 v109, v109
    v_mfma_f32_16x16x32_bf16 v[164:167], v[88:91], a[48:51], v[164:167]
    ds_read_b128 v[56:59], v36 offset:4096
    v_rcp_f32 v110, v110
    v_mfma_f32_16x16x32_bf16 v[164:167], v[92:95], a[52:55], v[164:167]
    ds_read_b128 v[60:63], v36 offset:5120
    v_rcp_f32 v111, v111
    v_mfma_f32_16x16x32_bf16 v[164:167], v[96:99], a[56:59], v[164:167]
    ds_read_b128 v[64:67], v36 offset:6144
    v_cvt_pk_bf16_f32 v120, v104, v105
    v_cvt_pk_bf16_f32 v121, v106, v107
    v_mfma_f32_16x16x32_bf16 v[164:167], v[100:103], a[60:63], v[164:167]
    ds_read_b128 v[68:71], v36 offset:7168
    v_cvt_pk_bf16_f32 v122, v108, v109
    v_cvt_pk_bf16_f32 v123, v110, v111
    v_mfma_f32_16x16x32_bf16 v[168:171], v[72:75], a[64:67], v[232:235]
    ds_write_b128 v20, v[120:123] offset:8192
    v_mfma_f32_16x16x32_bf16 v[168:171], v[76:79], a[68:71], v[168:171]
    v_fma_f32 v112, v248, v212, 1.0
    v_fma_f32 v113, v249, v213, 1.0
    v_mfma_f32_16x16x32_bf16 v[168:171], v[80:83], a[72:75], v[168:171]
    v_fma_f32 v114, v250, v214, 1.0
    v_fma_f32 v115, v251, v215, 1.0
    v_fma_f32 v116, v252, v220, 1.0
    v_mfma_f32_16x16x32_bf16 v[168:171], v[84:87], a[76:79], v[168:171]
    v_fma_f32 v117, v253, v221, 1.0
    v_fma_f32 v118, v254, v222, 1.0
    v_mfma_f32_16x16x32_bf16 v[168:171], v[88:91], a[80:83], v[168:171]
    v_fma_f32 v119, v255, v223, 1.0
    v_cvt_pk_bf16_f32 v6, v178, v182
    v_cvt_pk_bf16_f32 v7, v186, v190
    v_mfma_f32_16x16x32_bf16 v[168:171], v[92:95], a[84:87], v[168:171]
    ds_read_b128 v[248:251], v21 offset:3200
    v_rcp_f32 v112, v112
    v_mfma_f32_16x16x32_bf16 v[168:171], v[96:99], a[88:91], v[168:171]
    ds_read_b128 v[252:255], v21 offset:3216
    v_rcp_f32 v113, v113
    v_mfma_f32_16x16x32_bf16 v[168:171], v[100:103], a[92:95], v[168:171]
    buffer_store_dwordx2 v[6:7], v25, s[40:43], s73 offen sc1
    v_rcp_f32 v114, v114
    v_mfma_f32_16x16x32_bf16 v[172:175], v[72:75], a[96:99], v[236:239]
    v_rcp_f32 v115, v115
    v_mfma_f32_16x16x32_bf16 v[172:175], v[76:79], a[100:103], v[172:175]
    v_cvt_pk_bf16_f32 v8, v179, v183
    v_cvt_pk_bf16_f32 v9, v187, v191
    v_mfma_f32_16x16x32_bf16 v[172:175], v[80:83], a[104:107], v[172:175]
    buffer_store_dwordx2 v[8:9], v26, s[40:43], s73 offen sc1
    v_rcp_f32 v116, v116
    v_mfma_f32_16x16x32_bf16 v[172:175], v[84:87], a[108:111], v[172:175]
    v_rcp_f32 v117, v117
    v_mfma_f32_16x16x32_bf16 v[172:175], v[88:91], a[112:115], v[172:175]
    v_rcp_f32 v118, v118
    v_rcp_f32 v119, v119
    v_mfma_f32_16x16x32_bf16 v[172:175], v[92:95], a[116:119], v[172:175]
    v_cvt_pk_bf16_f32 v124, v112, v113
    v_cvt_pk_bf16_f32 v125, v114, v115
    v_mfma_f32_16x16x32_bf16 v[172:175], v[96:99], a[120:123], v[172:175]
    v_cvt_pk_bf16_f32 v126, v116, v117
    v_cvt_pk_bf16_f32 v127, v118, v119
    v_mfma_f32_16x16x32_bf16 v[172:175], v[100:103], a[124:127], v[172:175]
    s_waitcnt lgkmcnt(1)
    ds_write_b128 v20, v[124:127] offset:9216
    v_mfma_f32_16x16x32_bf16 v[176:179], v[40:43], a[0:3], v[224:227]
    v_fma_f32 v104, v240, v196, 1.0
    v_fma_f32 v105, v241, v197, 1.0
    v_fma_f32 v106, v242, v198, 1.0
    v_mfma_f32_16x16x32_bf16 v[176:179], v[44:47], a[4:7], v[176:179]
    s_add_u32 s73, s71, 0
    v_fma_f32 v107, v243, v199, 1.0
    v_fma_f32 v108, v244, v204, 1.0
    v_fma_f32 v109, v245, v205, 1.0
    v_mfma_f32_16x16x32_bf16 v[176:179], v[48:51], a[8:11], v[176:179]
    v_fma_f32 v110, v246, v206, 1.0
    v_fma_f32 v111, v247, v207, 1.0
    v_cvt_pk_bf16_f32 v2, v160, v164
    v_mfma_f32_16x16x32_bf16 v[176:179], v[52:55], a[12:15], v[176:179]
    ds_read_b128 v[240:243], v21 offset:4096
    v_cvt_pk_bf16_f32 v3, v168, v172
    v_mfma_f32_16x16x32_bf16 v[176:179], v[56:59], a[16:19], v[176:179]
    ds_read_b128 v[244:247], v21 offset:4112
    v_rcp_f32 v104, v104
    v_mfma_f32_16x16x32_bf16 v[176:179], v[60:63], a[20:23], v[176:179]
    buffer_store_dwordx2 v[2:3], v27, s[40:43], s73 offen sc1
    v_rcp_f32 v105, v105
    v_mfma_f32_16x16x32_bf16 v[176:179], v[64:67], a[24:27], v[176:179]
    s_waitcnt lgkmcnt(2)
    s_barrier
    v_rcp_f32 v106, v106
    v_mfma_f32_16x16x32_bf16 v[176:179], v[68:71], a[28:31], v[176:179]
    ds_read_b128 v[72:75], v36 offset:8192
    v_rcp_f32 v107, v107
    v_mfma_f32_16x16x32_bf16 v[180:183], v[40:43], a[32:35], v[228:231]
    ds_read_b128 v[76:79], v36 offset:9216
    v_cvt_pk_bf16_f32 v4, v161, v165
    v_cvt_pk_bf16_f32 v5, v169, v173
    v_mfma_f32_16x16x32_bf16 v[180:183], v[44:47], a[36:39], v[180:183]
    buffer_store_dwordx2 v[4:5], v30, s[40:43], s73 offen sc1
    v_mfma_f32_16x16x32_bf16 v[180:183], v[48:51], a[40:43], v[180:183]
    ds_read_b128 v[80:83], v36 offset:10240
    v_rcp_f32 v108, v108
    v_mfma_f32_16x16x32_bf16 v[180:183], v[52:55], a[44:47], v[180:183]
    ds_read_b128 v[84:87], v36 offset:11264
    v_rcp_f32 v109, v109
    v_mfma_f32_16x16x32_bf16 v[180:183], v[56:59], a[48:51], v[180:183]
    ds_read_b128 v[88:91], v36 offset:12288
    v_rcp_f32 v110, v110
    v_mfma_f32_16x16x32_bf16 v[180:183], v[60:63], a[52:55], v[180:183]
    ds_read_b128 v[92:95], v36 offset:13312
    v_rcp_f32 v111, v111
    v_mfma_f32_16x16x32_bf16 v[180:183], v[64:67], a[56:59], v[180:183]
    ds_read_b128 v[96:99], v36 offset:14336
    v_cvt_pk_bf16_f32 v120, v104, v105
    v_cvt_pk_bf16_f32 v121, v106, v107
    v_mfma_f32_16x16x32_bf16 v[180:183], v[68:71], a[60:63], v[180:183]
    ds_read_b128 v[100:103], v36 offset:15360
    v_cvt_pk_bf16_f32 v122, v108, v109
    v_cvt_pk_bf16_f32 v123, v110, v111
    v_mfma_f32_16x16x32_bf16 v[184:187], v[40:43], a[64:67], v[232:235]
    ds_write_b128 v20, v[120:123] offset:16384
    v_mfma_f32_16x16x32_bf16 v[184:187], v[44:47], a[68:71], v[184:187]
    v_fma_f32 v112, v248, v212, 1.0
    v_fma_f32 v113, v249, v213, 1.0
    v_mfma_f32_16x16x32_bf16 v[184:187], v[48:51], a[72:75], v[184:187]
    v_fma_f32 v114, v250, v214, 1.0
    v_fma_f32 v115, v251, v215, 1.0
    v_fma_f32 v116, v252, v220, 1.0
    v_mfma_f32_16x16x32_bf16 v[184:187], v[52:55], a[76:79], v[184:187]
    v_fma_f32 v117, v253, v221, 1.0
    v_fma_f32 v118, v254, v222, 1.0
    v_mfma_f32_16x16x32_bf16 v[184:187], v[56:59], a[80:83], v[184:187]
    v_fma_f32 v119, v255, v223, 1.0
    v_cvt_pk_bf16_f32 v6, v162, v166
    v_cvt_pk_bf16_f32 v7, v170, v174
    v_mfma_f32_16x16x32_bf16 v[184:187], v[60:63], a[84:87], v[184:187]
    ds_read_b128 v[248:251], v21 offset:4224
    v_rcp_f32 v112, v112
    v_mfma_f32_16x16x32_bf16 v[184:187], v[64:67], a[88:91], v[184:187]
    ds_read_b128 v[252:255], v21 offset:4240
    v_rcp_f32 v113, v113
    v_mfma_f32_16x16x32_bf16 v[184:187], v[68:71], a[92:95], v[184:187]
    buffer_store_dwordx2 v[6:7], v31, s[40:43], s73 offen sc1
    v_rcp_f32 v114, v114
    v_mfma_f32_16x16x32_bf16 v[188:191], v[40:43], a[96:99], v[236:239]
    v_rcp_f32 v115, v115
    v_mfma_f32_16x16x32_bf16 v[188:191], v[44:47], a[100:103], v[188:191]
    v_cvt_pk_bf16_f32 v8, v163, v167
    v_cvt_pk_bf16_f32 v9, v171, v175
    v_mfma_f32_16x16x32_bf16 v[188:191], v[48:51], a[104:107], v[188:191]
    buffer_store_dwordx2 v[8:9], v11, s[40:43], s73 offen sc1
    v_rcp_f32 v116, v116
    v_mfma_f32_16x16x32_bf16 v[188:191], v[52:55], a[108:111], v[188:191]
    v_rcp_f32 v117, v117
    v_mfma_f32_16x16x32_bf16 v[188:191], v[56:59], a[112:115], v[188:191]
    v_rcp_f32 v118, v118
    v_rcp_f32 v119, v119
    v_mfma_f32_16x16x32_bf16 v[188:191], v[60:63], a[116:119], v[188:191]
    v_cvt_pk_bf16_f32 v124, v112, v113
    v_cvt_pk_bf16_f32 v125, v114, v115
    v_mfma_f32_16x16x32_bf16 v[188:191], v[64:67], a[120:123], v[188:191]
    v_cvt_pk_bf16_f32 v126, v116, v117
    v_cvt_pk_bf16_f32 v127, v118, v119
    v_mfma_f32_16x16x32_bf16 v[188:191], v[68:71], a[124:127], v[188:191]
    s_waitcnt lgkmcnt(1)
    ds_write_b128 v20, v[124:127] offset:17408
    v_mfma_f32_16x16x32_bf16 v[160:163], v[72:75], a[0:3], v[224:227]
    v_fma_f32 v104, v240, v196, 1.0
    v_fma_f32 v105, v241, v197, 1.0
    v_fma_f32 v106, v242, v198, 1.0
    v_mfma_f32_16x16x32_bf16 v[160:163], v[76:79], a[4:7], v[160:163]
    s_add_u32 s73, s71, 512
    v_fma_f32 v107, v243, v199, 1.0
    v_fma_f32 v108, v244, v204, 1.0
    v_fma_f32 v109, v245, v205, 1.0
    v_mfma_f32_16x16x32_bf16 v[160:163], v[80:83], a[8:11], v[160:163]
    v_fma_f32 v110, v246, v206, 1.0
    v_fma_f32 v111, v247, v207, 1.0
    v_cvt_pk_bf16_f32 v2, v176, v180
    v_mfma_f32_16x16x32_bf16 v[160:163], v[84:87], a[12:15], v[160:163]
    ds_read_b128 v[240:243], v21 offset:5120
    v_cvt_pk_bf16_f32 v3, v184, v188
    v_mfma_f32_16x16x32_bf16 v[160:163], v[88:91], a[16:19], v[160:163]
    ds_read_b128 v[244:247], v21 offset:5136
    v_rcp_f32 v104, v104
    v_mfma_f32_16x16x32_bf16 v[160:163], v[92:95], a[20:23], v[160:163]
    buffer_store_dwordx2 v[2:3], v27, s[40:43], s73 offen sc1
    v_rcp_f32 v105, v105
    v_mfma_f32_16x16x32_bf16 v[160:163], v[96:99], a[24:27], v[160:163]
    s_waitcnt lgkmcnt(2)
    s_barrier
    v_rcp_f32 v106, v106
    v_mfma_f32_16x16x32_bf16 v[160:163], v[100:103], a[28:31], v[160:163]
    ds_read_b128 v[40:43], v36 offset:16384
    v_rcp_f32 v107, v107
    v_mfma_f32_16x16x32_bf16 v[164:167], v[72:75], a[32:35], v[228:231]
    ds_read_b128 v[44:47], v36 offset:17408
    v_cvt_pk_bf16_f32 v4, v177, v181
    v_cvt_pk_bf16_f32 v5, v185, v189
    v_mfma_f32_16x16x32_bf16 v[164:167], v[76:79], a[36:39], v[164:167]
    buffer_store_dwordx2 v[4:5], v30, s[40:43], s73 offen sc1
    v_mfma_f32_16x16x32_bf16 v[164:167], v[80:83], a[40:43], v[164:167]
    ds_read_b128 v[48:51], v36 offset:18432
    v_rcp_f32 v108, v108
    v_mfma_f32_16x16x32_bf16 v[164:167], v[84:87], a[44:47], v[164:167]
    ds_read_b128 v[52:55], v36 offset:19456
    v_rcp_f32 v109, v109
    v_mfma_f32_16x16x32_bf16 v[164:167], v[88:91], a[48:51], v[164:167]
    ds_read_b128 v[56:59], v36 offset:20480
    v_rcp_f32 v110, v110
    v_mfma_f32_16x16x32_bf16 v[164:167], v[92:95], a[52:55], v[164:167]
    ds_read_b128 v[60:63], v36 offset:21504
    v_rcp_f32 v111, v111
    v_mfma_f32_16x16x32_bf16 v[164:167], v[96:99], a[56:59], v[164:167]
    ds_read_b128 v[64:67], v36 offset:22528
    v_cvt_pk_bf16_f32 v120, v104, v105
    v_cvt_pk_bf16_f32 v121, v106, v107
    v_mfma_f32_16x16x32_bf16 v[164:167], v[100:103], a[60:63], v[164:167]
    ds_read_b128 v[68:71], v36 offset:23552
    v_cvt_pk_bf16_f32 v122, v108, v109
    v_cvt_pk_bf16_f32 v123, v110, v111
    v_mfma_f32_16x16x32_bf16 v[168:171], v[72:75], a[64:67], v[232:235]
    ds_write_b128 v20, v[120:123] offset:0
    v_mfma_f32_16x16x32_bf16 v[168:171], v[76:79], a[68:71], v[168:171]
    v_fma_f32 v112, v248, v212, 1.0
    v_fma_f32 v113, v249, v213, 1.0
    v_mfma_f32_16x16x32_bf16 v[168:171], v[80:83], a[72:75], v[168:171]
    v_fma_f32 v114, v250, v214, 1.0
    v_fma_f32 v115, v251, v215, 1.0
    v_fma_f32 v116, v252, v220, 1.0
    v_mfma_f32_16x16x32_bf16 v[168:171], v[84:87], a[76:79], v[168:171]
    v_fma_f32 v117, v253, v221, 1.0
    v_fma_f32 v118, v254, v222, 1.0
    v_mfma_f32_16x16x32_bf16 v[168:171], v[88:91], a[80:83], v[168:171]
    v_fma_f32 v119, v255, v223, 1.0
    v_cvt_pk_bf16_f32 v6, v178, v182
    v_cvt_pk_bf16_f32 v7, v186, v190
    v_mfma_f32_16x16x32_bf16 v[168:171], v[92:95], a[84:87], v[168:171]
    ds_read_b128 v[248:251], v21 offset:5248
    v_rcp_f32 v112, v112
    v_mfma_f32_16x16x32_bf16 v[168:171], v[96:99], a[88:91], v[168:171]
    ds_read_b128 v[252:255], v21 offset:5264
    v_rcp_f32 v113, v113
    v_mfma_f32_16x16x32_bf16 v[168:171], v[100:103], a[92:95], v[168:171]
    buffer_store_dwordx2 v[6:7], v31, s[40:43], s73 offen sc1
    v_rcp_f32 v114, v114
    v_mfma_f32_16x16x32_bf16 v[172:175], v[72:75], a[96:99], v[236:239]
    v_rcp_f32 v115, v115
    v_mfma_f32_16x16x32_bf16 v[172:175], v[76:79], a[100:103], v[172:175]
    v_cvt_pk_bf16_f32 v8, v179, v183
    v_cvt_pk_bf16_f32 v9, v187, v191
    v_mfma_f32_16x16x32_bf16 v[172:175], v[80:83], a[104:107], v[172:175]
    buffer_store_dwordx2 v[8:9], v11, s[40:43], s73 offen sc1
    v_rcp_f32 v116, v116
    v_mfma_f32_16x16x32_bf16 v[172:175], v[84:87], a[108:111], v[172:175]
    v_rcp_f32 v117, v117
    v_mfma_f32_16x16x32_bf16 v[172:175], v[88:91], a[112:115], v[172:175]
    v_rcp_f32 v118, v118
    v_rcp_f32 v119, v119
    v_mfma_f32_16x16x32_bf16 v[172:175], v[92:95], a[116:119], v[172:175]
    v_cvt_pk_bf16_f32 v124, v112, v113
    v_cvt_pk_bf16_f32 v125, v114, v115
    v_mfma_f32_16x16x32_bf16 v[172:175], v[96:99], a[120:123], v[172:175]
    v_cvt_pk_bf16_f32 v126, v116, v117
    v_cvt_pk_bf16_f32 v127, v118, v119
    v_mfma_f32_16x16x32_bf16 v[172:175], v[100:103], a[124:127], v[172:175]
    s_waitcnt lgkmcnt(1)
    ds_write_b128 v20, v[124:127] offset:1024
    v_mfma_f32_16x16x32_bf16 v[176:179], v[40:43], a[0:3], v[224:227]
    v_fma_f32 v104, v240, v196, 1.0
    v_fma_f32 v105, v241, v197, 1.0
    v_fma_f32 v106, v242, v198, 1.0
    v_mfma_f32_16x16x32_bf16 v[176:179], v[44:47], a[4:7], v[176:179]
    s_add_u32 s73, s71, 1024
    v_fma_f32 v107, v243, v199, 1.0
    v_fma_f32 v108, v244, v204, 1.0
    v_fma_f32 v109, v245, v205, 1.0
    v_mfma_f32_16x16x32_bf16 v[176:179], v[48:51], a[8:11], v[176:179]
    v_fma_f32 v110, v246, v206, 1.0
    v_fma_f32 v111, v247, v207, 1.0
    v_cvt_pk_bf16_f32 v2, v160, v164
    v_mfma_f32_16x16x32_bf16 v[176:179], v[52:55], a[12:15], v[176:179]
    ds_read_b128 v[240:243], v21 offset:6144
    v_cvt_pk_bf16_f32 v3, v168, v172
    v_mfma_f32_16x16x32_bf16 v[176:179], v[56:59], a[16:19], v[176:179]
    ds_read_b128 v[244:247], v21 offset:6160
    v_rcp_f32 v104, v104
    v_mfma_f32_16x16x32_bf16 v[176:179], v[60:63], a[20:23], v[176:179]
    buffer_store_dwordx2 v[2:3], v27, s[40:43], s73 offen sc1
    v_rcp_f32 v105, v105
    v_mfma_f32_16x16x32_bf16 v[176:179], v[64:67], a[24:27], v[176:179]
    s_waitcnt lgkmcnt(2)
    s_barrier
    v_rcp_f32 v106, v106
    v_mfma_f32_16x16x32_bf16 v[176:179], v[68:71], a[28:31], v[176:179]
    ds_read_b128 v[72:75], v36 offset:0
    v_rcp_f32 v107, v107
    v_mfma_f32_16x16x32_bf16 v[180:183], v[40:43], a[32:35], v[228:231]
    ds_read_b128 v[76:79], v36 offset:1024
    v_cvt_pk_bf16_f32 v4, v161, v165
    v_cvt_pk_bf16_f32 v5, v169, v173
    v_mfma_f32_16x16x32_bf16 v[180:183], v[44:47], a[36:39], v[180:183]
    buffer_store_dwordx2 v[4:5], v30, s[40:43], s73 offen sc1
    v_mfma_f32_16x16x32_bf16 v[180:183], v[48:51], a[40:43], v[180:183]
    ds_read_b128 v[80:83], v36 offset:2048
    v_rcp_f32 v108, v108
    v_mfma_f32_16x16x32_bf16 v[180:183], v[52:55], a[44:47], v[180:183]
    ds_read_b128 v[84:87], v36 offset:3072
    v_rcp_f32 v109, v109
    v_mfma_f32_16x16x32_bf16 v[180:183], v[56:59], a[48:51], v[180:183]
    ds_read_b128 v[88:91], v36 offset:4096
    v_rcp_f32 v110, v110
    v_mfma_f32_16x16x32_bf16 v[180:183], v[60:63], a[52:55], v[180:183]
    ds_read_b128 v[92:95], v36 offset:5120
    v_rcp_f32 v111, v111
    v_mfma_f32_16x16x32_bf16 v[180:183], v[64:67], a[56:59], v[180:183]
    ds_read_b128 v[96:99], v36 offset:6144
    v_cvt_pk_bf16_f32 v120, v104, v105
    v_cvt_pk_bf16_f32 v121, v106, v107
    v_mfma_f32_16x16x32_bf16 v[180:183], v[68:71], a[60:63], v[180:183]
    ds_read_b128 v[100:103], v36 offset:7168
    v_cvt_pk_bf16_f32 v122, v108, v109
    v_cvt_pk_bf16_f32 v123, v110, v111
    v_mfma_f32_16x16x32_bf16 v[184:187], v[40:43], a[64:67], v[232:235]
    ds_write_b128 v20, v[120:123] offset:8192
    v_mfma_f32_16x16x32_bf16 v[184:187], v[44:47], a[68:71], v[184:187]
    v_fma_f32 v112, v248, v212, 1.0
    v_fma_f32 v113, v249, v213, 1.0
    v_mfma_f32_16x16x32_bf16 v[184:187], v[48:51], a[72:75], v[184:187]
    v_fma_f32 v114, v250, v214, 1.0
    v_fma_f32 v115, v251, v215, 1.0
    v_fma_f32 v116, v252, v220, 1.0
    v_mfma_f32_16x16x32_bf16 v[184:187], v[52:55], a[76:79], v[184:187]
    v_fma_f32 v117, v253, v221, 1.0
    v_fma_f32 v118, v254, v222, 1.0
    v_mfma_f32_16x16x32_bf16 v[184:187], v[56:59], a[80:83], v[184:187]
    v_fma_f32 v119, v255, v223, 1.0
    v_cvt_pk_bf16_f32 v6, v162, v166
    v_cvt_pk_bf16_f32 v7, v170, v174
    v_mfma_f32_16x16x32_bf16 v[184:187], v[60:63], a[84:87], v[184:187]
    ds_read_b128 v[248:251], v21 offset:6272
    v_rcp_f32 v112, v112
    v_mfma_f32_16x16x32_bf16 v[184:187], v[64:67], a[88:91], v[184:187]
    ds_read_b128 v[252:255], v21 offset:6288
    v_rcp_f32 v113, v113
    v_mfma_f32_16x16x32_bf16 v[184:187], v[68:71], a[92:95], v[184:187]
    buffer_store_dwordx2 v[6:7], v31, s[40:43], s73 offen sc1
    v_rcp_f32 v114, v114
    v_mfma_f32_16x16x32_bf16 v[188:191], v[40:43], a[96:99], v[236:239]
    v_rcp_f32 v115, v115
    v_mfma_f32_16x16x32_bf16 v[188:191], v[44:47], a[100:103], v[188:191]
    v_cvt_pk_bf16_f32 v8, v163, v167
    v_cvt_pk_bf16_f32 v9, v171, v175
    v_mfma_f32_16x16x32_bf16 v[188:191], v[48:51], a[104:107], v[188:191]
    buffer_store_dwordx2 v[8:9], v11, s[40:43], s73 offen sc1
    v_rcp_f32 v116, v116
    v_mfma_f32_16x16x32_bf16 v[188:191], v[52:55], a[108:111], v[188:191]
    v_rcp_f32 v117, v117
    v_mfma_f32_16x16x32_bf16 v[188:191], v[56:59], a[112:115], v[188:191]
    v_rcp_f32 v118, v118
    v_rcp_f32 v119, v119
    v_mfma_f32_16x16x32_bf16 v[188:191], v[60:63], a[116:119], v[188:191]
    v_cvt_pk_bf16_f32 v124, v112, v113
    v_cvt_pk_bf16_f32 v125, v114, v115
    v_mfma_f32_16x16x32_bf16 v[188:191], v[64:67], a[120:123], v[188:191]
    v_cvt_pk_bf16_f32 v126, v116, v117
    v_cvt_pk_bf16_f32 v127, v118, v119
    v_mfma_f32_16x16x32_bf16 v[188:191], v[68:71], a[124:127], v[188:191]
    s_waitcnt lgkmcnt(1)
    ds_write_b128 v20, v[124:127] offset:9216
    v_mfma_f32_16x16x32_bf16 v[160:163], v[72:75], a[0:3], v[224:227]
    v_fma_f32 v104, v240, v196, 1.0
    v_fma_f32 v105, v241, v197, 1.0
    v_fma_f32 v106, v242, v198, 1.0
    v_mfma_f32_16x16x32_bf16 v[160:163], v[76:79], a[4:7], v[160:163]
    s_add_u32 s73, s71, 1536
    v_fma_f32 v107, v243, v199, 1.0
    v_fma_f32 v108, v244, v204, 1.0
    v_fma_f32 v109, v245, v205, 1.0
    v_mfma_f32_16x16x32_bf16 v[160:163], v[80:83], a[8:11], v[160:163]
    v_fma_f32 v110, v246, v206, 1.0
    v_fma_f32 v111, v247, v207, 1.0
    v_cvt_pk_bf16_f32 v2, v176, v180
    v_mfma_f32_16x16x32_bf16 v[160:163], v[84:87], a[12:15], v[160:163]
    ds_read_b128 v[240:243], v21 offset:7168
    v_cvt_pk_bf16_f32 v3, v184, v188
    v_mfma_f32_16x16x32_bf16 v[160:163], v[88:91], a[16:19], v[160:163]
    ds_read_b128 v[244:247], v21 offset:7184
    v_rcp_f32 v104, v104
    v_mfma_f32_16x16x32_bf16 v[160:163], v[92:95], a[20:23], v[160:163]
    buffer_store_dwordx2 v[2:3], v27, s[40:43], s73 offen sc1
    v_rcp_f32 v105, v105
    v_mfma_f32_16x16x32_bf16 v[160:163], v[96:99], a[24:27], v[160:163]
    s_waitcnt lgkmcnt(2)
    s_barrier
    v_rcp_f32 v106, v106
    v_mfma_f32_16x16x32_bf16 v[160:163], v[100:103], a[28:31], v[160:163]
    ds_read_b128 v[40:43], v36 offset:8192
    v_rcp_f32 v107, v107
    v_mfma_f32_16x16x32_bf16 v[164:167], v[72:75], a[32:35], v[228:231]
    ds_read_b128 v[44:47], v36 offset:9216
    v_cvt_pk_bf16_f32 v4, v177, v181
    v_cvt_pk_bf16_f32 v5, v185, v189
    v_mfma_f32_16x16x32_bf16 v[164:167], v[76:79], a[36:39], v[164:167]
    buffer_store_dwordx2 v[4:5], v30, s[40:43], s73 offen sc1
    v_mfma_f32_16x16x32_bf16 v[164:167], v[80:83], a[40:43], v[164:167]
    ds_read_b128 v[48:51], v36 offset:10240
    v_rcp_f32 v108, v108
    v_mfma_f32_16x16x32_bf16 v[164:167], v[84:87], a[44:47], v[164:167]
    ds_read_b128 v[52:55], v36 offset:11264
    v_rcp_f32 v109, v109
    v_mfma_f32_16x16x32_bf16 v[164:167], v[88:91], a[48:51], v[164:167]
    ds_read_b128 v[56:59], v36 offset:12288
    v_rcp_f32 v110, v110
    v_mfma_f32_16x16x32_bf16 v[164:167], v[92:95], a[52:55], v[164:167]
    ds_read_b128 v[60:63], v36 offset:13312
    v_rcp_f32 v111, v111
    v_mfma_f32_16x16x32_bf16 v[164:167], v[96:99], a[56:59], v[164:167]
    ds_read_b128 v[64:67], v36 offset:14336
    v_cvt_pk_bf16_f32 v120, v104, v105
    v_cvt_pk_bf16_f32 v121, v106, v107
    v_mfma_f32_16x16x32_bf16 v[164:167], v[100:103], a[60:63], v[164:167]
    ds_read_b128 v[68:71], v36 offset:15360
    v_cvt_pk_bf16_f32 v122, v108, v109
    v_cvt_pk_bf16_f32 v123, v110, v111
    v_mfma_f32_16x16x32_bf16 v[168:171], v[72:75], a[64:67], v[232:235]
    ds_write_b128 v20, v[120:123] offset:16384
    v_mfma_f32_16x16x32_bf16 v[168:171], v[76:79], a[68:71], v[168:171]
    v_fma_f32 v112, v248, v212, 1.0
    v_fma_f32 v113, v249, v213, 1.0
    v_mfma_f32_16x16x32_bf16 v[168:171], v[80:83], a[72:75], v[168:171]
    v_fma_f32 v114, v250, v214, 1.0
    v_fma_f32 v115, v251, v215, 1.0
    v_fma_f32 v116, v252, v220, 1.0
    v_mfma_f32_16x16x32_bf16 v[168:171], v[84:87], a[76:79], v[168:171]
    v_fma_f32 v117, v253, v221, 1.0
    v_fma_f32 v118, v254, v222, 1.0
    v_mfma_f32_16x16x32_bf16 v[168:171], v[88:91], a[80:83], v[168:171]
    v_fma_f32 v119, v255, v223, 1.0
    v_cvt_pk_bf16_f32 v6, v178, v182
    v_cvt_pk_bf16_f32 v7, v186, v190
    v_mfma_f32_16x16x32_bf16 v[168:171], v[92:95], a[84:87], v[168:171]
    ds_read_b128 v[248:251], v21 offset:7296
    v_rcp_f32 v112, v112
    v_mfma_f32_16x16x32_bf16 v[168:171], v[96:99], a[88:91], v[168:171]
    ds_read_b128 v[252:255], v21 offset:7312
    v_rcp_f32 v113, v113
    v_mfma_f32_16x16x32_bf16 v[168:171], v[100:103], a[92:95], v[168:171]
    buffer_store_dwordx2 v[6:7], v31, s[40:43], s73 offen sc1
    v_rcp_f32 v114, v114
    v_mfma_f32_16x16x32_bf16 v[172:175], v[72:75], a[96:99], v[236:239]
    v_rcp_f32 v115, v115
    v_mfma_f32_16x16x32_bf16 v[172:175], v[76:79], a[100:103], v[172:175]
    v_cvt_pk_bf16_f32 v8, v179, v183
    v_cvt_pk_bf16_f32 v9, v187, v191
    v_mfma_f32_16x16x32_bf16 v[172:175], v[80:83], a[104:107], v[172:175]
    buffer_store_dwordx2 v[8:9], v11, s[40:43], s73 offen sc1
    v_rcp_f32 v116, v116
    v_mfma_f32_16x16x32_bf16 v[172:175], v[84:87], a[108:111], v[172:175]
    v_rcp_f32 v117, v117
    v_mfma_f32_16x16x32_bf16 v[172:175], v[88:91], a[112:115], v[172:175]
    v_rcp_f32 v118, v118
    v_rcp_f32 v119, v119
    v_mfma_f32_16x16x32_bf16 v[172:175], v[92:95], a[116:119], v[172:175]
    v_cvt_pk_bf16_f32 v124, v112, v113
    v_cvt_pk_bf16_f32 v125, v114, v115
    v_mfma_f32_16x16x32_bf16 v[172:175], v[96:99], a[120:123], v[172:175]
    v_cvt_pk_bf16_f32 v126, v116, v117
    v_cvt_pk_bf16_f32 v127, v118, v119
    v_mfma_f32_16x16x32_bf16 v[172:175], v[100:103], a[124:127], v[172:175]
    s_waitcnt lgkmcnt(1)
    ds_write_b128 v20, v[124:127] offset:17408
    v_mfma_f32_16x16x32_bf16 v[176:179], v[40:43], a[0:3], v[224:227]
    v_fma_f32 v104, v240, v196, 1.0
    v_fma_f32 v105, v241, v197, 1.0
    v_fma_f32 v106, v242, v198, 1.0
    v_mfma_f32_16x16x32_bf16 v[176:179], v[44:47], a[4:7], v[176:179]
    s_add_u32 s73, s71, 2048
    v_fma_f32 v107, v243, v199, 1.0
    v_fma_f32 v108, v244, v204, 1.0
    v_mfma_f32_16x16x32_bf16 v[176:179], v[48:51], a[8:11], v[176:179]
    v_fma_f32 v109, v245, v205, 1.0
    v_fma_f32 v110, v246, v206, 1.0
    v_fma_f32 v111, v247, v207, 1.0
    v_mfma_f32_16x16x32_bf16 v[176:179], v[52:55], a[12:15], v[176:179]
    v_cvt_pk_bf16_f32 v2, v160, v164
    v_cvt_pk_bf16_f32 v3, v168, v172
    v_rcp_f32 v104, v104
    v_mfma_f32_16x16x32_bf16 v[176:179], v[56:59], a[16:19], v[176:179]
    buffer_store_dwordx2 v[2:3], v27, s[40:43], s73 offen sc1
    v_mfma_f32_16x16x32_bf16 v[176:179], v[60:63], a[20:23], v[176:179]
    v_rcp_f32 v105, v105
    v_mfma_f32_16x16x32_bf16 v[176:179], v[64:67], a[24:27], v[176:179]
    s_waitcnt lgkmcnt(0)
    s_barrier
    v_rcp_f32 v106, v106
    v_rcp_f32 v107, v107
    v_mfma_f32_16x16x32_bf16 v[176:179], v[68:71], a[28:31], v[176:179]
    ds_read_b128 v[72:75], v36 offset:16384
    v_cvt_pk_bf16_f32 v4, v161, v165
    v_mfma_f32_16x16x32_bf16 v[180:183], v[40:43], a[32:35], v[228:231]
    ds_read_b128 v[76:79], v36 offset:17408
    v_cvt_pk_bf16_f32 v5, v169, v173
    v_mfma_f32_16x16x32_bf16 v[180:183], v[44:47], a[36:39], v[180:183]
    buffer_store_dwordx2 v[4:5], v30, s[40:43], s73 offen sc1
    v_rcp_f32 v108, v108
    v_mfma_f32_16x16x32_bf16 v[180:183], v[48:51], a[40:43], v[180:183]
    ds_read_b128 v[80:83], v36 offset:18432
    v_rcp_f32 v109, v109
    v_mfma_f32_16x16x32_bf16 v[180:183], v[52:55], a[44:47], v[180:183]
    ds_read_b128 v[84:87], v36 offset:19456
    v_rcp_f32 v110, v110
    v_mfma_f32_16x16x32_bf16 v[180:183], v[56:59], a[48:51], v[180:183]
    ds_read_b128 v[88:91], v36 offset:20480
    v_rcp_f32 v111, v111
    v_mfma_f32_16x16x32_bf16 v[180:183], v[60:63], a[52:55], v[180:183]
    ds_read_b128 v[92:95], v36 offset:21504
    v_cvt_pk_bf16_f32 v120, v104, v105
    v_mfma_f32_16x16x32_bf16 v[180:183], v[64:67], a[56:59], v[180:183]
    ds_read_b128 v[96:99], v36 offset:22528
    v_cvt_pk_bf16_f32 v121, v106, v107
    v_mfma_f32_16x16x32_bf16 v[180:183], v[68:71], a[60:63], v[180:183]
    ds_read_b128 v[100:103], v36 offset:23552
    v_cvt_pk_bf16_f32 v122, v108, v109
    v_cvt_pk_bf16_f32 v123, v110, v111
    v_mfma_f32_16x16x32_bf16 v[184:187], v[40:43], a[64:67], v[232:235]
    ds_write_b128 v20, v[120:123] offset:0
    v_mfma_f32_16x16x32_bf16 v[184:187], v[44:47], a[68:71], v[184:187]
    v_fma_f32 v112, v248, v212, 1.0
    v_fma_f32 v113, v249, v213, 1.0
    v_mfma_f32_16x16x32_bf16 v[184:187], v[48:51], a[72:75], v[184:187]
    v_fma_f32 v114, v250, v214, 1.0
    v_fma_f32 v115, v251, v215, 1.0
    v_mfma_f32_16x16x32_bf16 v[184:187], v[52:55], a[76:79], v[184:187]
    v_fma_f32 v116, v252, v220, 1.0
    v_fma_f32 v117, v253, v221, 1.0
    v_fma_f32 v118, v254, v222, 1.0
    v_mfma_f32_16x16x32_bf16 v[184:187], v[56:59], a[80:83], v[184:187]
    v_fma_f32 v119, v255, v223, 1.0
    v_cvt_pk_bf16_f32 v6, v162, v166
    v_mfma_f32_16x16x32_bf16 v[184:187], v[60:63], a[84:87], v[184:187]
    v_cvt_pk_bf16_f32 v7, v170, v174
    v_rcp_f32 v112, v112
    v_mfma_f32_16x16x32_bf16 v[184:187], v[64:67], a[88:91], v[184:187]
    buffer_store_dwordx2 v[6:7], v31, s[40:43], s73 offen sc1
    v_rcp_f32 v113, v113
    v_mfma_f32_16x16x32_bf16 v[184:187], v[68:71], a[92:95], v[184:187]
    v_rcp_f32 v114, v114
    v_mfma_f32_16x16x32_bf16 v[188:191], v[40:43], a[96:99], v[236:239]
    v_rcp_f32 v115, v115
    v_mfma_f32_16x16x32_bf16 v[188:191], v[44:47], a[100:103], v[188:191]
    v_cvt_pk_bf16_f32 v8, v163, v167
    v_cvt_pk_bf16_f32 v9, v171, v175
    v_rcp_f32 v116, v116
    v_mfma_f32_16x16x32_bf16 v[188:191], v[48:51], a[104:107], v[188:191]
    buffer_store_dwordx2 v[8:9], v11, s[40:43], s73 offen sc1
    v_mfma_f32_16x16x32_bf16 v[188:191], v[52:55], a[108:111], v[188:191]
    v_rcp_f32 v117, v117
    v_mfma_f32_16x16x32_bf16 v[188:191], v[56:59], a[112:115], v[188:191]
    v_rcp_f32 v118, v118
    v_rcp_f32 v119, v119
    v_mfma_f32_16x16x32_bf16 v[188:191], v[60:63], a[116:119], v[188:191]
    v_cvt_pk_bf16_f32 v124, v112, v113
    v_cvt_pk_bf16_f32 v125, v114, v115
    v_mfma_f32_16x16x32_bf16 v[188:191], v[64:67], a[120:123], v[188:191]
    v_cvt_pk_bf16_f32 v126, v116, v117
    v_cvt_pk_bf16_f32 v127, v118, v119
    v_mfma_f32_16x16x32_bf16 v[188:191], v[68:71], a[124:127], v[188:191]
    s_waitcnt lgkmcnt(0)
    ds_write_b128 v20, v[124:127] offset:1024
    v_mfma_f32_16x16x32_bf16 v[160:163], v[72:75], a[0:3], v[224:227]
    v_mfma_f32_16x16x32_bf16 v[160:163], v[76:79], a[4:7], v[160:163]
    s_add_u32 s73, s71, 2560
    v_mfma_f32_16x16x32_bf16 v[160:163], v[80:83], a[8:11], v[160:163]
    v_mfma_f32_16x16x32_bf16 v[160:163], v[84:87], a[12:15], v[160:163]
    v_mfma_f32_16x16x32_bf16 v[160:163], v[88:91], a[16:19], v[160:163]
    v_cvt_pk_bf16_f32 v2, v176, v180
    v_cvt_pk_bf16_f32 v3, v184, v188
    v_cvt_pk_bf16_f32 v4, v177, v181
    v_cvt_pk_bf16_f32 v5, v185, v189
    v_mfma_f32_16x16x32_bf16 v[160:163], v[92:95], a[20:23], v[160:163]
    buffer_store_dwordx2 v[2:3], v27, s[40:43], s73 offen sc1
    v_mfma_f32_16x16x32_bf16 v[160:163], v[96:99], a[24:27], v[160:163]
    s_waitcnt lgkmcnt(0)
    s_barrier
    buffer_store_dwordx2 v[4:5], v30, s[40:43], s73 offen sc1
    v_mfma_f32_16x16x32_bf16 v[160:163], v[100:103], a[28:31], v[160:163]
    ds_read_b128 v[40:43], v36 offset:0
    v_cvt_pk_bf16_f32 v6, v178, v182
    v_mfma_f32_16x16x32_bf16 v[164:167], v[72:75], a[32:35], v[228:231]
    ds_read_b128 v[44:47], v36 offset:1024
    v_cvt_pk_bf16_f32 v7, v186, v190
    v_mfma_f32_16x16x32_bf16 v[164:167], v[76:79], a[36:39], v[164:167]
    buffer_store_dwordx2 v[6:7], v31, s[40:43], s73 offen sc1
    v_mfma_f32_16x16x32_bf16 v[164:167], v[80:83], a[40:43], v[164:167]
    ds_read_b128 v[48:51], v36 offset:2048
    v_cvt_pk_bf16_f32 v8, v179, v183
    v_mfma_f32_16x16x32_bf16 v[164:167], v[84:87], a[44:47], v[164:167]
    ds_read_b128 v[52:55], v36 offset:3072
    v_cvt_pk_bf16_f32 v9, v187, v191
    v_mfma_f32_16x16x32_bf16 v[164:167], v[88:91], a[48:51], v[164:167]
    buffer_store_dwordx2 v[8:9], v11, s[40:43], s73 offen sc1
    v_mfma_f32_16x16x32_bf16 v[164:167], v[92:95], a[52:55], v[164:167]
    ds_read_b128 v[56:59], v36 offset:4096
    v_mfma_f32_16x16x32_bf16 v[164:167], v[96:99], a[56:59], v[164:167]
    ds_read_b128 v[60:63], v36 offset:5120
    v_mfma_f32_16x16x32_bf16 v[164:167], v[100:103], a[60:63], v[164:167]
    ds_read_b128 v[64:67], v36 offset:6144
    v_mfma_f32_16x16x32_bf16 v[168:171], v[72:75], a[64:67], v[232:235]
    ds_read_b128 v[68:71], v36 offset:7168
    v_mfma_f32_16x16x32_bf16 v[168:171], v[76:79], a[68:71], v[168:171]
    v_mfma_f32_16x16x32_bf16 v[168:171], v[80:83], a[72:75], v[168:171]
    v_mfma_f32_16x16x32_bf16 v[168:171], v[84:87], a[76:79], v[168:171]
    v_mfma_f32_16x16x32_bf16 v[168:171], v[88:91], a[80:83], v[168:171]
    v_mfma_f32_16x16x32_bf16 v[168:171], v[92:95], a[84:87], v[168:171]
    v_mfma_f32_16x16x32_bf16 v[168:171], v[96:99], a[88:91], v[168:171]
    v_mfma_f32_16x16x32_bf16 v[168:171], v[100:103], a[92:95], v[168:171]
    v_mfma_f32_16x16x32_bf16 v[172:175], v[72:75], a[96:99], v[236:239]
    v_mfma_f32_16x16x32_bf16 v[172:175], v[76:79], a[100:103], v[172:175]
    v_mfma_f32_16x16x32_bf16 v[172:175], v[80:83], a[104:107], v[172:175]
    v_mfma_f32_16x16x32_bf16 v[172:175], v[84:87], a[108:111], v[172:175]
    v_mfma_f32_16x16x32_bf16 v[172:175], v[88:91], a[112:115], v[172:175]
    v_mfma_f32_16x16x32_bf16 v[172:175], v[92:95], a[116:119], v[172:175]
    v_mfma_f32_16x16x32_bf16 v[172:175], v[96:99], a[120:123], v[172:175]
    v_mfma_f32_16x16x32_bf16 v[172:175], v[100:103], a[124:127], v[172:175]
    s_waitcnt lgkmcnt(0)
    v_mfma_f32_16x16x32_bf16 v[176:179], v[40:43], a[0:3], v[224:227]
    v_mfma_f32_16x16x32_bf16 v[176:179], v[44:47], a[4:7], v[176:179]
    s_add_u32 s73, s71, 3072
    v_mfma_f32_16x16x32_bf16 v[176:179], v[48:51], a[8:11], v[176:179]
    v_mfma_f32_16x16x32_bf16 v[176:179], v[52:55], a[12:15], v[176:179]
    v_mfma_f32_16x16x32_bf16 v[176:179], v[56:59], a[16:19], v[176:179]
    v_cvt_pk_bf16_f32 v2, v160, v164
    v_cvt_pk_bf16_f32 v3, v168, v172
    v_cvt_pk_bf16_f32 v4, v161, v165
    v_mfma_f32_16x16x32_bf16 v[176:179], v[60:63], a[20:23], v[176:179]
    buffer_store_dwordx2 v[2:3], v27, s[40:43], s73 offen sc1
    v_mfma_f32_16x16x32_bf16 v[176:179], v[64:67], a[24:27], v[176:179]
    v_cvt_pk_bf16_f32 v5, v169, v173
    v_cvt_pk_bf16_f32 v6, v162, v166
    v_mfma_f32_16x16x32_bf16 v[176:179], v[68:71], a[28:31], v[176:179]
    buffer_store_dwordx2 v[4:5], v30, s[40:43], s73 offen sc1
    v_mfma_f32_16x16x32_bf16 v[180:183], v[40:43], a[32:35], v[228:231]
    v_cvt_pk_bf16_f32 v7, v170, v174
    v_cvt_pk_bf16_f32 v8, v163, v167
    v_mfma_f32_16x16x32_bf16 v[180:183], v[44:47], a[36:39], v[180:183]
    buffer_store_dwordx2 v[6:7], v31, s[40:43], s73 offen sc1
    v_mfma_f32_16x16x32_bf16 v[180:183], v[48:51], a[40:43], v[180:183]
    v_cvt_pk_bf16_f32 v9, v171, v175
    v_mfma_f32_16x16x32_bf16 v[180:183], v[52:55], a[44:47], v[180:183]
    buffer_store_dwordx2 v[8:9], v11, s[40:43], s73 offen sc1
    v_mfma_f32_16x16x32_bf16 v[180:183], v[56:59], a[48:51], v[180:183]
    v_mfma_f32_16x16x32_bf16 v[180:183], v[60:63], a[52:55], v[180:183]
    v_mfma_f32_16x16x32_bf16 v[180:183], v[64:67], a[56:59], v[180:183]
    v_mfma_f32_16x16x32_bf16 v[180:183], v[68:71], a[60:63], v[180:183]
    v_mfma_f32_16x16x32_bf16 v[184:187], v[40:43], a[64:67], v[232:235]
    v_mfma_f32_16x16x32_bf16 v[184:187], v[44:47], a[68:71], v[184:187]
    v_mfma_f32_16x16x32_bf16 v[184:187], v[48:51], a[72:75], v[184:187]
    v_mfma_f32_16x16x32_bf16 v[184:187], v[52:55], a[76:79], v[184:187]
    v_mfma_f32_16x16x32_bf16 v[184:187], v[56:59], a[80:83], v[184:187]
    v_mfma_f32_16x16x32_bf16 v[184:187], v[60:63], a[84:87], v[184:187]
    v_mfma_f32_16x16x32_bf16 v[184:187], v[64:67], a[88:91], v[184:187]
    v_mfma_f32_16x16x32_bf16 v[184:187], v[68:71], a[92:95], v[184:187]
    v_mfma_f32_16x16x32_bf16 v[188:191], v[40:43], a[96:99], v[236:239]
    v_mfma_f32_16x16x32_bf16 v[188:191], v[44:47], a[100:103], v[188:191]
    v_mfma_f32_16x16x32_bf16 v[188:191], v[48:51], a[104:107], v[188:191]
    v_mfma_f32_16x16x32_bf16 v[188:191], v[52:55], a[108:111], v[188:191]
    v_mfma_f32_16x16x32_bf16 v[188:191], v[56:59], a[112:115], v[188:191]
    v_mfma_f32_16x16x32_bf16 v[188:191], v[60:63], a[116:119], v[188:191]
    v_mfma_f32_16x16x32_bf16 v[188:191], v[64:67], a[120:123], v[188:191]
    v_mfma_f32_16x16x32_bf16 v[188:191], v[68:71], a[124:127], v[188:191]
    s_nop 7
    s_add_u32 s73, s71, 3584
    v_cvt_pk_bf16_f32 v2, v176, v180
    v_cvt_pk_bf16_f32 v3, v184, v188
    buffer_store_dwordx2 v[2:3], v27, s[40:43], s73 offen sc1
    v_cvt_pk_bf16_f32 v4, v177, v181
    v_cvt_pk_bf16_f32 v5, v185, v189
    buffer_store_dwordx2 v[4:5], v30, s[40:43], s73 offen sc1
    v_cvt_pk_bf16_f32 v6, v178, v182
    v_cvt_pk_bf16_f32 v7, v186, v190
    buffer_store_dwordx2 v[6:7], v31, s[40:43], s73 offen sc1
    v_cvt_pk_bf16_f32 v8, v179, v183
    v_cvt_pk_bf16_f32 v9, v187, v191
    buffer_store_dwordx2 v[8:9], v11, s[40:43], s73 offen sc1
L_fin:
L_end:
    s_endpgm
L_non:
    s_mov_b32 s69, 0x200000
L_non_l:
    buffer_load_dword v38, off, s[44:47], 0 sc1
    s_sub_u32 s69, s69, 1
    s_cbranch_scc1 L_non_b
    s_waitcnt vmcnt(0)
    v_readfirstlane_b32 s3, v38
    s_nop 0
    s_cmp_eq_u32 s3, 0
    s_cbranch_scc1 L_non_l
    s_branch L_non_b
L_cw1:
    s_mov_b32 s69, 0x200000
L_cw1_l:
    buffer_load_dword v150, v149, s[36:39], 0 offen sc1
    s_sub_u32 s69, s69, 1
    s_cbranch_scc1 L_cw1_b
    s_waitcnt vmcnt(0)
    v_cmp_ne_u32 vcc, s3, v150
    s_nop 0
    s_cbranch_vccnz L_cw1_l
    s_branch L_cw1_b
L_cwo:
    s_mov_b32 s69, 0x200000
L_cwo_l:
    buffer_load_dword v152, v151, s[36:39], 0 offen sc1
    s_sub_u32 s69, s69, 1
    s_cbranch_scc1 L_cwo_b
    s_waitcnt vmcnt(0)
    v_cmp_ne_u32 vcc, s3, v152
    s_nop 0
    s_cbranch_vccnz L_cwo_l
    s_branch L_cwo_b
L_cw2:
    s_mov_b32 s69, 0x200000
L_cw2_l:
    buffer_load_dword v150, v149, s[36:39], 0 offen sc1
    s_sub_u32 s69, s69, 1
    s_cbranch_scc1 L_cw2_b
    s_waitcnt vmcnt(0)
    v_cmp_ne_u32 vcc, s3, v150
    s_nop 0
    s_cbranch_vccnz L_cw2_l
    s_branch L_cw2_b
L_cwf:
    s_mov_b32 s69, 0x200000
L_cwf_l:
    buffer_load_dword v152, v151, s[36:39], 0 offen sc1
    s_sub_u32 s69, s69, 1
    s_cbranch_scc1 L_cwf_b
    s_waitcnt vmcnt(0)
    v_cmp_ne_u32 vcc, s3, v152
    s_nop 0
    s_cbranch_vccnz L_cwf_l
    s_branch L_cwf_b
L_ch:
    s_mov_b32 s69, 0x200000
L_ch_l:
    buffer_load_dword v29, v11, s[36:39], 0 offen sc1
    s_sub_u32 s69, s69, 1
    s_cbranch_scc1 L_ch_b
    s_waitcnt vmcnt(0)
    v_cmp_ne_u32 vcc, s3, v29
    s_nop 0
    s_cbranch_vccnz L_ch_l
    s_branch L_ch_b
L_cg:
    s_mov_b32 s69, 0x200000
L_cg_l:
    buffer_load_dword v16, v17, s[36:39], 0 offen sc1
    s_sub_u32 s69, s69, 1
    s_cbranch_scc1 L_cg_b
    s_waitcnt vmcnt(0)
    v_and_b32 v18, -2, v16
    v_cmp_ne_u32 vcc, s3, v18
    s_nop 0
    s_cbranch_vccnz L_cg_l
    s_branch L_cg_b
L_cfa:
    s_mov_b32 s69, 0x200000
L_cfa_l:
    s_add_u32 s62, s70, 0
    buffer_load_dwordx4 v[76:79], v36, s[36:39], s62 offen offset:0 sc1
    buffer_load_dwordx4 v[80:83], v36, s[36:39], s62 offen offset:1024 sc1
    buffer_load_dwordx4 v[84:87], v36, s[36:39], s62 offen offset:2048 sc1
    buffer_load_dwordx4 v[88:91], v36, s[36:39], s62 offen offset:3072 sc1
    s_add_u32 s62, s70, 4096
    buffer_load_dwordx4 v[92:95], v36, s[36:39], s62 offen offset:0 sc1
    buffer_load_dwordx4 v[96:99], v36, s[36:39], s62 offen offset:1024 sc1
    buffer_load_dwordx4 v[100:103], v36, s[36:39], s62 offen offset:2048 sc1
    buffer_load_dwordx4 v[132:135], v36, s[36:39], s62 offen offset:3072 sc1
    s_sub_u32 s69, s69, 1
    s_cbranch_scc1 L_cfa_x
    s_waitcnt vmcnt(0)
    v_max3_u32 v1, v76, v77, v78
    v_max3_u32 v1, v79, v80, v1
    v_max3_u32 v1, v81, v82, v1
    v_max3_u32 v1, v83, v84, v1
    v_max3_u32 v1, v85, v86, v1
    v_max3_u32 v1, v87, v88, v1
    v_max3_u32 v1, v89, v90, v1
    v_max3_u32 v1, v91, v92, v1
    v_max3_u32 v1, v93, v94, v1
    v_max3_u32 v1, v95, v96, v1
    v_max3_u32 v1, v97, v98, v1
    v_max3_u32 v1, v99, v100, v1
    v_max3_u32 v1, v101, v102, v1
    v_max3_u32 v1, v103, v132, v1
    v_max3_u32 v1, v133, v134, v1
    v_max_u32 v1, v135, v1
    v_cmp_eq_u32 vcc, -1, v1
    s_nop 0
    s_cbranch_vccnz L_cfa_l
L_cfa_x:
    s_waitcnt vmcnt(0)
    s_branch L_cfa_b
L_cfbf:
    s_mov_b32 s69, 0x200000
L_cfbf_l:
    s_add_u32 s62, s70, 8192
    buffer_load_dwordx4 v[128:131], v36, s[36:39], s62 offen offset:0 sc1
    buffer_load_dwordx4 v[132:135], v36, s[36:39], s62 offen offset:1024 sc1
    buffer_load_dwordx4 v[136:139], v36, s[36:39], s62 offen offset:2048 sc1
    buffer_load_dwordx4 v[140:143], v36, s[36:39], s62 offen offset:3072 sc1
    s_add_u32 s62, s70, 12288
    buffer_load_dwordx4 v[144:147], v36, s[36:39], s62 offen offset:0 sc1
    buffer_load_dwordx4 v[148:151], v36, s[36:39], s62 offen offset:1024 sc1
    buffer_load_dwordx4 v[152:155], v36, s[36:39], s62 offen offset:2048 sc1
    buffer_load_dwordx4 v[156:159], v36, s[36:39], s62 offen offset:3072 sc1
    s_sub_u32 s69, s69, 1
    s_cbranch_scc1 L_cfbf_x
    s_waitcnt vmcnt(0)
    v_max3_u32 v1, v128, v129, v130
    v_max3_u32 v1, v131, v132, v1
    v_max3_u32 v1, v133, v134, v1
    v_max3_u32 v1, v135, v136, v1
    v_max3_u32 v1, v137, v138, v1
    v_max3_u32 v1, v139, v140, v1
    v_max3_u32 v1, v141, v142, v1
    v_max3_u32 v1, v143, v144, v1
    v_max3_u32 v1, v145, v146, v1
    v_max3_u32 v1, v147, v148, v1
    v_max3_u32 v1, v149, v150, v1
    v_max3_u32 v1, v151, v152, v1
    v_max3_u32 v1, v153, v154, v1
    v_max3_u32 v1, v155, v156, v1
    v_max3_u32 v1, v157, v158, v1
    v_max_u32 v1, v159, v1
    v_cmp_eq_u32 vcc, -1, v1
    s_nop 0
    s_cbranch_vccnz L_cfbf_l
L_cfbf_x:
    s_waitcnt vmcnt(0)
    s_branch L_cfbf_b
L_cfbs:
    s_mov_b32 s69, 0x200000
L_cfbs_l:
    s_add_u32 s62, s70, 8192
    buffer_load_dwordx4 v[128:131], v36, s[36:39], s62 offen offset:0 sc1
    buffer_load_dwordx4 v[132:135], v36, s[36:39], s62 offen offset:1024 sc1
    buffer_load_dwordx4 v[136:139], v36, s[36:39], s62 offen offset:2048 sc1
    buffer_load_dwordx4 v[140:143], v36, s[36:39], s62 offen offset:3072 sc1
    s_add_u32 s62, s70, 12288
    buffer_load_dwordx4 v[144:147], v36, s[36:39], s62 offen offset:0 sc1
    buffer_load_dwordx4 v[148:151], v36, s[36:39], s62 offen offset:1024 sc1
    buffer_load_dwordx4 v[152:155], v36, s[36:39], s62 offen offset:2048 sc1
    buffer_load_dwordx4 v[156:159], v36, s[36:39], s62 offen offset:3072 sc1
    s_sub_u32 s69, s69, 1
    s_cbranch_scc1 L_cfbs_x
    s_waitcnt vmcnt(0)
    v_max3_u32 v1, v128, v129, v130
    v_max3_u32 v1, v131, v132, v1
    v_max3_u32 v1, v133, v134, v1
    v_max3_u32 v1, v135, v136, v1
    v_max3_u32 v1, v137, v138, v1
    v_max3_u32 v1, v139, v140, v1
    v_max3_u32 v1, v141, v142, v1
    v_max3_u32 v1, v143, v144, v1
    v_max3_u32 v1, v145, v146, v1
    v_max3_u32 v1, v147, v148, v1
    v_max3_u32 v1, v149, v150, v1
    v_max3_u32 v1, v151, v152, v1
    v_max3_u32 v1, v153, v154, v1
    v_max3_u32 v1, v155, v156, v1
    v_max3_u32 v1, v157, v158, v1
    v_max_u32 v1, v159, v1
    v_cmp_eq_u32 vcc, -1, v1
    s_nop 0
    s_cbranch_vccnz L_cfbs_l
L_cfbs_x:
    s_waitcnt vmcnt(0)
    s_branch L_cfbs_b
L_slow:
    v_mfma_f32_16x16x32_bf16 v[192:195], a[128:131], v[76:79], 0
    ds_read_b128 v[240:243], v21 offset:0
    v_mfma_f32_16x16x32_bf16 v[192:195], a[132:135], v[80:83], v[192:195]
    ds_read_b128 v[244:247], v21 offset:16
    v_mfma_f32_16x16x32_bf16 v[192:195], a[136:139], v[84:87], v[192:195]
    ds_read_b128 v[248:251], v21 offset:128
    v_mfma_f32_16x16x32_bf16 v[192:195], a[140:143], v[88:91], v[192:195]
    ds_read_b128 v[252:255], v21 offset:144
    v_mfma_f32_16x16x32_bf16 v[192:195], a[144:147], v[92:95], v[192:195]
    v_mfma_f32_16x16x32_bf16 v[192:195], a[148:151], v[96:99], v[192:195]
    v_mfma_f32_16x16x32_bf16 v[192:195], a[152:155], v[100:103], v[192:195]
    v_mfma_f32_16x16x32_bf16 v[192:195], a[156:159], v[132:135], v[192:195]
    v_mov_b32 v224, v34
    v_mov_b32 v225, v34
    v_mfma_f32_16x16x32_bf16 v[200:203], a[160:163], v[76:79], 0
    v_mov_b32 v226, v34
    v_mov_b32 v227, v34
    v_mfma_f32_16x16x32_bf16 v[200:203], a[164:167], v[80:83], v[200:203]
    v_mov_b32 v228, v35
    v_mov_b32 v229, v35
    v_mfma_f32_16x16x32_bf16 v[200:203], a[168:171], v[84:87], v[200:203]
    v_mov_b32 v230, v35
    v_mov_b32 v231, v35
    v_mfma_f32_16x16x32_bf16 v[200:203], a[172:175], v[88:91], v[200:203]
    v_mul_f32 v192, s72, v192
    v_mul_f32 v193, s72, v193
    v_mfma_f32_16x16x32_bf16 v[200:203], a[176:179], v[92:95], v[200:203]
    v_mul_f32 v194, s72, v194
    v_mul_f32 v195, s72, v195
    v_mfma_f32_16x16x32_bf16 v[200:203], a[180:183], v[96:99], v[200:203]
    v_mov_b32 v232, v32
    v_mov_b32 v233, v32
    v_mfma_f32_16x16x32_bf16 v[200:203], a[184:187], v[100:103], v[200:203]
    v_mov_b32 v234, v32
    v_mfma_f32_16x16x32_bf16 v[200:203], a[188:191], v[132:135], v[200:203]
    v_mov_b32 v235, v32
    v_mfma_f32_16x16x32_bf16 v[208:211], a[192:195], v[76:79], 0
    v_mfma_f32_16x16x32_bf16 v[208:211], a[196:199], v[80:83], v[208:211]
    v_mfma_f32_16x16x32_bf16 v[208:211], a[200:203], v[84:87], v[208:211]
    v_mfma_f32_16x16x32_bf16 v[208:211], a[204:207], v[88:91], v[208:211]
    s_nop 2
    v_mul_f32 v200, s72, v200
    v_mul_f32 v201, s72, v201
    v_mfma_f32_16x16x32_bf16 v[208:211], a[208:211], v[92:95], v[208:211]
    v_mul_f32 v202, s72, v202
    v_mul_f32 v203, s72, v203
    v_mfma_f32_16x16x32_bf16 v[208:211], a[212:215], v[96:99], v[208:211]
    v_mov_b32 v236, v33
    v_mov_b32 v237, v33
    v_mfma_f32_16x16x32_bf16 v[208:211], a[216:219], v[100:103], v[208:211]
    v_mov_b32 v238, v33
    v_mfma_f32_16x16x32_bf16 v[208:211], a[220:223], v[132:135], v[208:211]
    v_mov_b32 v239, v33
    v_mfma_f32_16x16x32_bf16 v[216:219], a[224:227], v[76:79], 0
    v_mfma_f32_16x16x32_bf16 v[216:219], a[228:231], v[80:83], v[216:219]
    v_mfma_f32_16x16x32_bf16 v[216:219], a[232:235], v[84:87], v[216:219]
    v_mfma_f32_16x16x32_bf16 v[216:219], a[236:239], v[88:91], v[216:219]
    s_nop 2
    v_mul_f32 v208, s72, v208
    v_mul_f32 v209, s72, v209
    v_mfma_f32_16x16x32_bf16 v[216:219], a[240:243], v[92:95], v[216:219]
    v_mul_f32 v210, s72, v210
    v_mul_f32 v211, s72, v211
    v_mfma_f32_16x16x32_bf16 v[216:219], a[244:247], v[96:99], v[216:219]
    s_waitcnt lgkmcnt(0)
    v_add_f32 v104, v240, v192
    v_add_f32 v105, v241, v193
    v_mfma_f32_16x16x32_bf16 v[216:219], a[248:251], v[100:103], v[216:219]
    v_add_f32 v106, v242, v194
    v_add_f32 v107, v243, v195
    v_mfma_f32_16x16x32_bf16 v[216:219], a[252:255], v[132:135], v[216:219]
    v_add_f32 v108, v244, v200
    v_add_f32 v109, v245, v201
    v_add_f32 v110, v246, v202
    v_add_f32 v111, v247, v203
    s_nop 3
    v_mul_f32 v216, s72, v216
    v_mul_f32 v217, s72, v217
    v_mul_f32 v218, s72, v218
    v_mul_f32 v219, s72, v219
    v_exp_f32 v104, v104
    v_exp_f32 v105, v105
    v_exp_f32 v106, v106
    v_exp_f32 v107, v107
    v_exp_f32 v108, v108
    v_exp_f32 v109, v109
    v_exp_f32 v110, v110
    v_exp_f32 v111, v111
    v_add_f32 v104, 1.0, v104
    v_add_f32 v105, 1.0, v105
    v_add_f32 v106, 1.0, v106
    v_add_f32 v107, 1.0, v107
    v_add_f32 v108, 1.0, v108
    v_add_f32 v109, 1.0, v109
    v_add_f32 v110, 1.0, v110
    v_add_f32 v111, 1.0, v111
    v_rcp_f32 v104, v104
    v_rcp_f32 v105, v105
    v_rcp_f32 v106, v106
    v_rcp_f32 v107, v107
    v_rcp_f32 v108, v108
    v_rcp_f32 v109, v109
    v_rcp_f32 v110, v110
    v_rcp_f32 v111, v111
    v_cvt_pk_bf16_f32 v120, v104, v105
    v_cvt_pk_bf16_f32 v121, v106, v107
    v_cvt_pk_bf16_f32 v122, v108, v109
    v_cvt_pk_bf16_f32 v123, v110, v111
    ds_write_b128 v20, v[120:123] offset:0
    v_add_f32 v112, v248, v208
    v_add_f32 v113, v249, v209
    v_add_f32 v114, v250, v210
    v_add_f32 v115, v251, v211
    v_add_f32 v116, v252, v216
    v_add_f32 v117, v253, v217
    v_add_f32 v118, v254, v218
    v_add_f32 v119, v255, v219
    v_exp_f32 v112, v112
    v_exp_f32 v113, v113
    v_exp_f32 v114, v114
    v_exp_f32 v115, v115
    v_exp_f32 v116, v116
    v_exp_f32 v117, v117
    v_exp_f32 v118, v118
    v_exp_f32 v119, v119
    v_add_f32 v112, 1.0, v112
    v_add_f32 v113, 1.0, v113
    v_add_f32 v114, 1.0, v114
    v_add_f32 v115, 1.0, v115
    v_add_f32 v116, 1.0, v116
    v_add_f32 v117, 1.0, v117
    v_add_f32 v118, 1.0, v118
    v_add_f32 v119, 1.0, v119
    v_rcp_f32 v112, v112
    v_rcp_f32 v113, v113
    v_rcp_f32 v114, v114
    v_rcp_f32 v115, v115
    v_rcp_f32 v116, v116
    v_rcp_f32 v117, v117
    v_rcp_f32 v118, v118
    v_rcp_f32 v119, v119
    v_cvt_pk_bf16_f32 v124, v112, v113
    v_cvt_pk_bf16_f32 v125, v114, v115
    v_cvt_pk_bf16_f32 v126, v116, v117
    v_cvt_pk_bf16_f32 v127, v118, v119
    ds_write_b128 v20, v[124:127] offset:1024
    ds_read_b128 v[240:243], v21 offset:1024
    ds_read_b128 v[244:247], v21 offset:1040
    ds_read_b128 v[248:251], v21 offset:1152
    ds_read_b128 v[252:255], v21 offset:1168
    s_waitcnt lgkmcnt(4)
    s_barrier
    ds_read_b128 v[72:75], v36 offset:0
    ds_read_b128 v[76:79], v36 offset:1024
    ds_read_b128 v[80:83], v36 offset:2048
    ds_read_b128 v[84:87], v36 offset:3072
    ds_read_b128 v[88:91], v36 offset:4096
    ds_read_b128 v[92:95], v36 offset:5120
    ds_read_b128 v[96:99], v36 offset:6144
    ds_read_b128 v[100:103], v36 offset:7168
    s_waitcnt lgkmcnt(11)
    v_add_f32 v104, v240, v192
    v_add_f32 v105, v241, v193
    v_add_f32 v106, v242, v194
    v_add_f32 v107, v243, v195
    s_waitcnt lgkmcnt(10)
    v_add_f32 v108, v244, v200
    v_add_f32 v109, v245, v201
    v_add_f32 v110, v246, v202
    v_add_f32 v111, v247, v203
    v_exp_f32 v104, v104
    v_exp_f32 v105, v105
    v_exp_f32 v106, v106
    v_exp_f32 v107, v107
    v_exp_f32 v108, v108
    v_exp_f32 v109, v109
    v_exp_f32 v110, v110
    v_exp_f32 v111, v111
    v_add_f32 v104, 1.0, v104
    v_add_f32 v105, 1.0, v105
    v_add_f32 v106, 1.0, v106
    v_add_f32 v107, 1.0, v107
    v_add_f32 v108, 1.0, v108
    v_add_f32 v109, 1.0, v109
    v_add_f32 v110, 1.0, v110
    v_add_f32 v111, 1.0, v111
    v_rcp_f32 v104, v104
    v_rcp_f32 v105, v105
    v_rcp_f32 v106, v106
    v_rcp_f32 v107, v107
    v_rcp_f32 v108, v108
    v_rcp_f32 v109, v109
    v_rcp_f32 v110, v110
    v_rcp_f32 v111, v111
    v_cvt_pk_bf16_f32 v120, v104, v105
    v_cvt_pk_bf16_f32 v121, v106, v107
    v_cvt_pk_bf16_f32 v122, v108, v109
    v_cvt_pk_bf16_f32 v123, v110, v111
    ds_write_b128 v20, v[120:123] offset:8192
    s_waitcnt lgkmcnt(10)
    v_add_f32 v112, v248, v208
    v_add_f32 v113, v249, v209
    v_add_f32 v114, v250, v210
    v_add_f32 v115, v251, v211
    s_waitcnt lgkmcnt(9)
    v_add_f32 v116, v252, v216
    v_add_f32 v117, v253, v217
    v_add_f32 v118, v254, v218
    v_add_f32 v119, v255, v219
    v_exp_f32 v112, v112
    v_exp_f32 v113, v113
    v_exp_f32 v114, v114
    v_exp_f32 v115, v115
    v_exp_f32 v116, v116
    v_exp_f32 v117, v117
    v_exp_f32 v118, v118
    v_exp_f32 v119, v119
    v_add_f32 v112, 1.0, v112
    v_add_f32 v113, 1.0, v113
    v_add_f32 v114, 1.0, v114
    v_add_f32 v115, 1.0, v115
    v_add_f32 v116, 1.0, v116
    v_add_f32 v117, 1.0, v117
    v_add_f32 v118, 1.0, v118
    v_add_f32 v119, 1.0, v119
    v_rcp_f32 v112, v112
    v_rcp_f32 v113, v113
    v_rcp_f32 v114, v114
    v_rcp_f32 v115, v115
    v_rcp_f32 v116, v116
    v_rcp_f32 v117, v117
    v_rcp_f32 v118, v118
    v_rcp_f32 v119, v119
    v_cvt_pk_bf16_f32 v124, v112, v113
    v_cvt_pk_bf16_f32 v125, v114, v115
    v_cvt_pk_bf16_f32 v126, v116, v117
    v_cvt_pk_bf16_f32 v127, v118, v119
    ds_write_b128 v20, v[124:127] offset:9216
    ds_read_b128 v[240:243], v21 offset:2048
    ds_read_b128 v[244:247], v21 offset:2064
    ds_read_b128 v[248:251], v21 offset:2176
    ds_read_b128 v[252:255], v21 offset:2192
    s_waitcnt lgkmcnt(13)
    v_mfma_f32_16x16x32_bf16 v[160:163], v[72:75], a[0:3], v[224:227]
    s_waitcnt lgkmcnt(3)
    v_add_f32 v104, v240, v192
    v_add_f32 v105, v241, v193
    v_add_f32 v106, v242, v194
    v_add_f32 v107, v243, v195
    v_mfma_f32_16x16x32_bf16 v[160:163], v[76:79], a[4:7], v[160:163]
    s_waitcnt lgkmcnt(2)
    v_add_f32 v108, v244, v200
    v_add_f32 v109, v245, v201
    v_add_f32 v110, v246, v202
    v_add_f32 v111, v247, v203
    v_mfma_f32_16x16x32_bf16 v[160:163], v[80:83], a[8:11], v[160:163]
    ds_read_b128 v[240:243], v21 offset:3072
    v_exp_f32 v104, v104
    v_exp_f32 v105, v105
    v_mfma_f32_16x16x32_bf16 v[160:163], v[84:87], a[12:15], v[160:163]
    s_add_u32 s62, s70, 8192
    buffer_load_dwordx4 v[128:131], v36, s[36:39], s62 offen offset:0 sc1
    v_exp_f32 v106, v106
    v_mfma_f32_16x16x32_bf16 v[160:163], v[88:91], a[16:19], v[160:163]
    ds_read_b128 v[244:247], v21 offset:3088
    v_exp_f32 v107, v107
    v_exp_f32 v108, v108
    v_mfma_f32_16x16x32_bf16 v[160:163], v[92:95], a[20:23], v[160:163]
    v_exp_f32 v109, v109
    v_exp_f32 v110, v110
    v_mfma_f32_16x16x32_bf16 v[160:163], v[96:99], a[24:27], v[160:163]
    s_barrier
    buffer_load_dwordx4 v[132:135], v36, s[36:39], s62 offen offset:1024 sc1
    v_exp_f32 v111, v111
    v_add_f32 v104, 1.0, v104
    v_mfma_f32_16x16x32_bf16 v[160:163], v[100:103], a[28:31], v[160:163]
    ds_read_b128 v[40:43], v36 offset:8192
    v_add_f32 v105, 1.0, v105
    v_add_f32 v106, 1.0, v106
    v_add_f32 v107, 1.0, v107
    v_mfma_f32_16x16x32_bf16 v[164:167], v[72:75], a[32:35], v[228:231]
    ds_read_b128 v[44:47], v36 offset:9216
    v_add_f32 v108, 1.0, v108
    v_add_f32 v109, 1.0, v109
    v_add_f32 v110, 1.0, v110
    v_mfma_f32_16x16x32_bf16 v[164:167], v[76:79], a[36:39], v[164:167]
    buffer_load_dwordx4 v[136:139], v36, s[36:39], s62 offen offset:2048 sc1
    v_add_f32 v111, 1.0, v111
    v_rcp_f32 v104, v104
    v_mfma_f32_16x16x32_bf16 v[164:167], v[80:83], a[40:43], v[164:167]
    ds_read_b128 v[48:51], v36 offset:10240
    v_rcp_f32 v105, v105
    v_rcp_f32 v106, v106
    v_mfma_f32_16x16x32_bf16 v[164:167], v[84:87], a[44:47], v[164:167]
    ds_read_b128 v[52:55], v36 offset:11264
    v_rcp_f32 v107, v107
    v_mfma_f32_16x16x32_bf16 v[164:167], v[88:91], a[48:51], v[164:167]
    buffer_load_dwordx4 v[140:143], v36, s[36:39], s62 offen offset:3072 sc1
    v_rcp_f32 v108, v108
    v_rcp_f32 v109, v109
    v_mfma_f32_16x16x32_bf16 v[164:167], v[92:95], a[52:55], v[164:167]
    ds_read_b128 v[56:59], v36 offset:12288
    v_rcp_f32 v110, v110
    v_mfma_f32_16x16x32_bf16 v[164:167], v[96:99], a[56:59], v[164:167]
    ds_read_b128 v[60:63], v36 offset:13312
    v_rcp_f32 v111, v111
    v_cvt_pk_bf16_f32 v120, v104, v105
    v_cvt_pk_bf16_f32 v121, v106, v107
    v_mfma_f32_16x16x32_bf16 v[164:167], v[100:103], a[60:63], v[164:167]
    s_waitcnt lgkmcnt(6)
    s_add_u32 s62, s70, 12288
    buffer_load_dwordx4 v[144:147], v36, s[36:39], s62 offen offset:0 sc1
    v_cvt_pk_bf16_f32 v122, v108, v109
    v_cvt_pk_bf16_f32 v123, v110, v111
    v_add_f32 v112, v248, v208
    v_mfma_f32_16x16x32_bf16 v[168:171], v[72:75], a[64:67], v[232:235]
    ds_write_b128 v20, v[120:123] offset:16384
    v_mfma_f32_16x16x32_bf16 v[168:171], v[76:79], a[68:71], v[168:171]
    ds_read_b128 v[64:67], v36 offset:14336
    v_add_f32 v113, v249, v209
    v_add_f32 v114, v250, v210
    v_add_f32 v115, v251, v211
    v_mfma_f32_16x16x32_bf16 v[168:171], v[80:83], a[72:75], v[168:171]
    buffer_load_dwordx4 v[148:151], v36, s[36:39], s62 offen offset:1024 sc1
    v_add_f32 v116, v252, v216
    v_add_f32 v117, v253, v217
    v_add_f32 v118, v254, v218
    v_mfma_f32_16x16x32_bf16 v[168:171], v[84:87], a[76:79], v[168:171]
    ds_read_b128 v[68:71], v36 offset:15360
    v_add_f32 v119, v255, v219
    v_exp_f32 v112, v112
    v_mfma_f32_16x16x32_bf16 v[168:171], v[88:91], a[80:83], v[168:171]
    ds_read_b128 v[248:251], v21 offset:3200
    v_exp_f32 v113, v113
    v_exp_f32 v114, v114
    v_mfma_f32_16x16x32_bf16 v[168:171], v[92:95], a[84:87], v[168:171]
    buffer_load_dwordx4 v[152:155], v36, s[36:39], s62 offen offset:2048 sc1
    v_exp_f32 v115, v115
    v_mfma_f32_16x16x32_bf16 v[168:171], v[96:99], a[88:91], v[168:171]
    ds_read_b128 v[252:255], v21 offset:3216
    v_exp_f32 v116, v116
    v_exp_f32 v117, v117
    v_mfma_f32_16x16x32_bf16 v[168:171], v[100:103], a[92:95], v[168:171]
    v_exp_f32 v118, v118
    v_exp_f32 v119, v119
    v_mfma_f32_16x16x32_bf16 v[172:175], v[72:75], a[96:99], v[236:239]
    buffer_load_dwordx4 v[156:159], v36, s[36:39], s62 offen offset:3072 sc1
    v_add_f32 v112, 1.0, v112
    v_add_f32 v113, 1.0, v113
    v_add_f32 v114, 1.0, v114
    v_mfma_f32_16x16x32_bf16 v[172:175], v[76:79], a[100:103], v[172:175]
    v_add_f32 v115, 1.0, v115
    v_add_f32 v116, 1.0, v116
    v_add_f32 v117, 1.0, v117
    v_add_f32 v118, 1.0, v118
    v_mfma_f32_16x16x32_bf16 v[172:175], v[80:83], a[104:107], v[172:175]
    v_add_f32 v119, 1.0, v119
    v_rcp_f32 v112, v112
    v_rcp_f32 v113, v113
    v_mfma_f32_16x16x32_bf16 v[172:175], v[84:87], a[108:111], v[172:175]
    v_rcp_f32 v114, v114
    v_rcp_f32 v115, v115
    v_mfma_f32_16x16x32_bf16 v[172:175], v[88:91], a[112:115], v[172:175]
    v_rcp_f32 v116, v116
    v_rcp_f32 v117, v117
    v_mfma_f32_16x16x32_bf16 v[172:175], v[92:95], a[116:119], v[172:175]
    v_rcp_f32 v118, v118
    v_rcp_f32 v119, v119
    v_mfma_f32_16x16x32_bf16 v[172:175], v[96:99], a[120:123], v[172:175]
    v_cvt_pk_bf16_f32 v124, v112, v113
    v_cvt_pk_bf16_f32 v125, v114, v115
    v_cvt_pk_bf16_f32 v126, v116, v117
    v_cvt_pk_bf16_f32 v127, v118, v119
    v_mfma_f32_16x16x32_bf16 v[172:175], v[100:103], a[124:127], v[172:175]
    s_waitcnt lgkmcnt(1)
    ds_write_b128 v20, v[124:127] offset:17408
    v_mfma_f32_16x16x32_bf16 v[176:179], v[40:43], a[0:3], v[224:227]
    v_add_f32 v104, v240, v192
    v_add_f32 v105, v241, v193
    v_add_f32 v106, v242, v194
    v_add_f32 v107, v243, v195
    v_mfma_f32_16x16x32_bf16 v[176:179], v[44:47], a[4:7], v[176:179]
    s_add_u32 s73, s71, 0
    v_add_f32 v108, v244, v200
    v_add_f32 v109, v245, v201
    v_add_f32 v110, v246, v202
    v_add_f32 v111, v247, v203
    v_cvt_pk_bf16_f32 v2, v160, v164
    v_mfma_f32_16x16x32_bf16 v[176:179], v[48:51], a[8:11], v[176:179]
    ds_read_b128 v[240:243], v21 offset:4096
    v_cvt_pk_bf16_f32 v3, v168, v172
    v_exp_f32 v104, v104
    v_mfma_f32_16x16x32_bf16 v[176:179], v[52:55], a[12:15], v[176:179]
    ds_read_b128 v[244:247], v21 offset:4112
    v_exp_f32 v105, v105
    v_exp_f32 v106, v106
    v_mfma_f32_16x16x32_bf16 v[176:179], v[56:59], a[16:19], v[176:179]
    buffer_store_dwordx2 v[2:3], v23, s[40:43], s73 offen sc1
    v_exp_f32 v107, v107
    v_mfma_f32_16x16x32_bf16 v[176:179], v[60:63], a[20:23], v[176:179]
    v_exp_f32 v108, v108
    v_exp_f32 v109, v109
    v_mfma_f32_16x16x32_bf16 v[176:179], v[64:67], a[24:27], v[176:179]
    s_waitcnt lgkmcnt(2)
    s_barrier
    v_exp_f32 v110, v110
    v_exp_f32 v111, v111
    v_add_f32 v104, 1.0, v104
    v_mfma_f32_16x16x32_bf16 v[176:179], v[68:71], a[28:31], v[176:179]
    ds_read_b128 v[72:75], v36 offset:16384
    v_add_f32 v105, 1.0, v105
    v_add_f32 v106, 1.0, v106
    v_add_f32 v107, 1.0, v107
    v_mfma_f32_16x16x32_bf16 v[180:183], v[40:43], a[32:35], v[228:231]
    ds_read_b128 v[76:79], v36 offset:17408
    v_add_f32 v108, 1.0, v108
    v_add_f32 v109, 1.0, v109
    v_add_f32 v110, 1.0, v110
    v_mfma_f32_16x16x32_bf16 v[180:183], v[44:47], a[36:39], v[180:183]
    ds_read_b128 v[80:83], v36 offset:18432
    v_add_f32 v111, 1.0, v111
    v_rcp_f32 v104, v104
    v_mfma_f32_16x16x32_bf16 v[180:183], v[48:51], a[40:43], v[180:183]
    ds_read_b128 v[84:87], v36 offset:19456
    v_rcp_f32 v105, v105
    v_rcp_f32 v106, v106
    v_mfma_f32_16x16x32_bf16 v[180:183], v[52:55], a[44:47], v[180:183]
    ds_read_b128 v[88:91], v36 offset:20480
    v_rcp_f32 v107, v107
    v_cvt_pk_bf16_f32 v4, v161, v165
    v_cvt_pk_bf16_f32 v5, v169, v173
    v_mfma_f32_16x16x32_bf16 v[180:183], v[56:59], a[48:51], v[180:183]
    buffer_store_dwordx2 v[4:5], v24, s[40:43], s73 offen sc1
    v_rcp_f32 v108, v108
    v_mfma_f32_16x16x32_bf16 v[180:183], v[60:63], a[52:55], v[180:183]
    ds_read_b128 v[92:95], v36 offset:21504
    v_rcp_f32 v109, v109
    v_rcp_f32 v110, v110
    v_mfma_f32_16x16x32_bf16 v[180:183], v[64:67], a[56:59], v[180:183]
    ds_read_b128 v[96:99], v36 offset:22528
    v_rcp_f32 v111, v111
    v_cvt_pk_bf16_f32 v120, v104, v105
    v_mfma_f32_16x16x32_bf16 v[180:183], v[68:71], a[60:63], v[180:183]
    ds_read_b128 v[100:103], v36 offset:23552
    v_cvt_pk_bf16_f32 v121, v106, v107
    v_cvt_pk_bf16_f32 v122, v108, v109
    v_cvt_pk_bf16_f32 v123, v110, v111
    v_mfma_f32_16x16x32_bf16 v[184:187], v[40:43], a[64:67], v[232:235]
    ds_write_b128 v20, v[120:123] offset:0
    v_mfma_f32_16x16x32_bf16 v[184:187], v[44:47], a[68:71], v[184:187]
    v_add_f32 v112, v248, v208
    v_add_f32 v113, v249, v209
    v_add_f32 v114, v250, v210
    v_add_f32 v115, v251, v211
    v_add_f32 v116, v252, v216
    v_mfma_f32_16x16x32_bf16 v[184:187], v[48:51], a[72:75], v[184:187]
    v_add_f32 v117, v253, v217
    v_add_f32 v118, v254, v218
    v_add_f32 v119, v255, v219
    v_cvt_pk_bf16_f32 v6, v162, v166
    v_mfma_f32_16x16x32_bf16 v[184:187], v[52:55], a[76:79], v[184:187]
    ds_read_b128 v[248:251], v21 offset:4224
    v_cvt_pk_bf16_f32 v7, v170, v174
    v_exp_f32 v112, v112
    v_mfma_f32_16x16x32_bf16 v[184:187], v[56:59], a[80:83], v[184:187]
    ds_read_b128 v[252:255], v21 offset:4240
    v_exp_f32 v113, v113
    v_exp_f32 v114, v114
    v_mfma_f32_16x16x32_bf16 v[184:187], v[60:63], a[84:87], v[184:187]
    buffer_store_dwordx2 v[6:7], v25, s[40:43], s73 offen sc1
    v_exp_f32 v115, v115
    v_mfma_f32_16x16x32_bf16 v[184:187], v[64:67], a[88:91], v[184:187]
    v_exp_f32 v116, v116
    v_exp_f32 v117, v117
    v_mfma_f32_16x16x32_bf16 v[184:187], v[68:71], a[92:95], v[184:187]
    v_exp_f32 v118, v118
    v_exp_f32 v119, v119
    v_add_f32 v112, 1.0, v112
    v_mfma_f32_16x16x32_bf16 v[188:191], v[40:43], a[96:99], v[236:239]
    v_add_f32 v113, 1.0, v113
    v_add_f32 v114, 1.0, v114
    v_add_f32 v115, 1.0, v115
    v_add_f32 v116, 1.0, v116
    v_mfma_f32_16x16x32_bf16 v[188:191], v[44:47], a[100:103], v[188:191]
    v_add_f32 v117, 1.0, v117
    v_add_f32 v118, 1.0, v118
    v_add_f32 v119, 1.0, v119
    v_rcp_f32 v112, v112
    v_mfma_f32_16x16x32_bf16 v[188:191], v[48:51], a[104:107], v[188:191]
    v_rcp_f32 v113, v113
    v_rcp_f32 v114, v114
    v_mfma_f32_16x16x32_bf16 v[188:191], v[52:55], a[108:111], v[188:191]
    v_rcp_f32 v115, v115
    v_cvt_pk_bf16_f32 v8, v163, v167
    v_cvt_pk_bf16_f32 v9, v171, v175
    v_mfma_f32_16x16x32_bf16 v[188:191], v[56:59], a[112:115], v[188:191]
    buffer_store_dwordx2 v[8:9], v26, s[40:43], s73 offen sc1
    v_rcp_f32 v116, v116
    v_rcp_f32 v117, v117
    v_mfma_f32_16x16x32_bf16 v[188:191], v[60:63], a[116:119], v[188:191]
    v_rcp_f32 v118, v118
    v_rcp_f32 v119, v119
    v_mfma_f32_16x16x32_bf16 v[188:191], v[64:67], a[120:123], v[188:191]
    v_cvt_pk_bf16_f32 v124, v112, v113
    v_cvt_pk_bf16_f32 v125, v114, v115
    v_cvt_pk_bf16_f32 v126, v116, v117
    v_mfma_f32_16x16x32_bf16 v[188:191], v[68:71], a[124:127], v[188:191]
    s_waitcnt lgkmcnt(0)
    v_cvt_pk_bf16_f32 v127, v118, v119
    ds_write_b128 v20, v[124:127] offset:1024
    v_mfma_f32_16x16x32_bf16 v[160:163], v[72:75], a[0:3], v[224:227]
    v_add_f32 v104, v240, v192
    v_add_f32 v105, v241, v193
    v_add_f32 v106, v242, v194
    v_add_f32 v107, v243, v195
    v_add_f32 v108, v244, v200
    v_mfma_f32_16x16x32_bf16 v[160:163], v[76:79], a[4:7], v[160:163]
    s_add_u32 s73, s71, 512
    v_add_f32 v109, v245, v201
    v_add_f32 v110, v246, v202
    v_add_f32 v111, v247, v203
    v_cvt_pk_bf16_f32 v2, v176, v180
    v_cvt_pk_bf16_f32 v3, v184, v188
    v_mfma_f32_16x16x32_bf16 v[160:163], v[80:83], a[8:11], v[160:163]
    ds_read_b128 v[240:243], v21 offset:5120
    v_exp_f32 v104, v104
    v_exp_f32 v105, v105
    v_mfma_f32_16x16x32_bf16 v[160:163], v[84:87], a[12:15], v[160:163]
    ds_read_b128 v[244:247], v21 offset:5136
    v_exp_f32 v106, v106
    v_exp_f32 v107, v107
    v_mfma_f32_16x16x32_bf16 v[160:163], v[88:91], a[16:19], v[160:163]
    buffer_store_dwordx2 v[2:3], v23, s[40:43], s73 offen sc1
    v_exp_f32 v108, v108
    v_mfma_f32_16x16x32_bf16 v[160:163], v[92:95], a[20:23], v[160:163]
    v_exp_f32 v109, v109
    v_exp_f32 v110, v110
    v_exp_f32 v111, v111
    v_mfma_f32_16x16x32_bf16 v[160:163], v[96:99], a[24:27], v[160:163]
    s_waitcnt lgkmcnt(2)
    s_barrier
    v_add_f32 v104, 1.0, v104
    v_add_f32 v105, 1.0, v105
    v_add_f32 v106, 1.0, v106
    v_add_f32 v107, 1.0, v107
    v_add_f32 v108, 1.0, v108
    v_mfma_f32_16x16x32_bf16 v[160:163], v[100:103], a[28:31], v[160:163]
    ds_read_b128 v[40:43], v36 offset:0
    v_add_f32 v109, 1.0, v109
    v_add_f32 v110, 1.0, v110
    v_add_f32 v111, 1.0, v111
    v_mfma_f32_16x16x32_bf16 v[164:167], v[72:75], a[32:35], v[228:231]
    ds_read_b128 v[44:47], v36 offset:1024
    v_rcp_f32 v104, v104
    v_rcp_f32 v105, v105
    v_mfma_f32_16x16x32_bf16 v[164:167], v[76:79], a[36:39], v[164:167]
    ds_read_b128 v[48:51], v36 offset:2048
    v_rcp_f32 v106, v106
    v_rcp_f32 v107, v107
    v_cvt_pk_bf16_f32 v4, v177, v181
    v_mfma_f32_16x16x32_bf16 v[164:167], v[80:83], a[40:43], v[164:167]
    ds_read_b128 v[52:55], v36 offset:3072
    v_cvt_pk_bf16_f32 v5, v185, v189
    v_rcp_f32 v108, v108
    v_mfma_f32_16x16x32_bf16 v[164:167], v[84:87], a[44:47], v[164:167]
    buffer_store_dwordx2 v[4:5], v24, s[40:43], s73 offen sc1
    v_rcp_f32 v109, v109
    v_rcp_f32 v110, v110
    v_mfma_f32_16x16x32_bf16 v[164:167], v[88:91], a[48:51], v[164:167]
    ds_read_b128 v[56:59], v36 offset:4096
    v_rcp_f32 v111, v111
    v_cvt_pk_bf16_f32 v120, v104, v105
    v_cvt_pk_bf16_f32 v121, v106, v107
    v_mfma_f32_16x16x32_bf16 v[164:167], v[92:95], a[52:55], v[164:167]
    ds_read_b128 v[60:63], v36 offset:5120
    v_cvt_pk_bf16_f32 v122, v108, v109
    v_cvt_pk_bf16_f32 v123, v110, v111
    v_add_f32 v112, v248, v208
    v_add_f32 v113, v249, v209
    v_mfma_f32_16x16x32_bf16 v[164:167], v[96:99], a[56:59], v[164:167]
    ds_write_b128 v20, v[120:123] offset:8192
    v_add_f32 v114, v250, v210
    v_mfma_f32_16x16x32_bf16 v[164:167], v[100:103], a[60:63], v[164:167]
    ds_read_b128 v[64:67], v36 offset:6144
    v_add_f32 v115, v251, v211
    v_add_f32 v116, v252, v216
    v_add_f32 v117, v253, v217
    v_mfma_f32_16x16x32_bf16 v[168:171], v[72:75], a[64:67], v[232:235]
    ds_read_b128 v[68:71], v36 offset:7168
    v_add_f32 v118, v254, v218
    v_add_f32 v119, v255, v219
    v_cvt_pk_bf16_f32 v6, v178, v182
    v_cvt_pk_bf16_f32 v7, v186, v190
    v_mfma_f32_16x16x32_bf16 v[168:171], v[76:79], a[68:71], v[168:171]
    ds_read_b128 v[248:251], v21 offset:5248
    v_exp_f32 v112, v112
    v_exp_f32 v113, v113
    v_mfma_f32_16x16x32_bf16 v[168:171], v[80:83], a[72:75], v[168:171]
    ds_read_b128 v[252:255], v21 offset:5264
    v_exp_f32 v114, v114
    v_exp_f32 v115, v115
    v_mfma_f32_16x16x32_bf16 v[168:171], v[84:87], a[76:79], v[168:171]
    buffer_store_dwordx2 v[6:7], v25, s[40:43], s73 offen sc1
    v_exp_f32 v116, v116
    v_exp_f32 v117, v117
    v_mfma_f32_16x16x32_bf16 v[168:171], v[88:91], a[80:83], v[168:171]
    v_exp_f32 v118, v118
    v_exp_f32 v119, v119
    v_mfma_f32_16x16x32_bf16 v[168:171], v[92:95], a[84:87], v[168:171]
    v_add_f32 v112, 1.0, v112
    v_add_f32 v113, 1.0, v113
    v_add_f32 v114, 1.0, v114
    v_add_f32 v115, 1.0, v115
    v_add_f32 v116, 1.0, v116
    v_mfma_f32_16x16x32_bf16 v[168:171], v[96:99], a[88:91], v[168:171]
    v_add_f32 v117, 1.0, v117
    v_add_f32 v118, 1.0, v118
    v_add_f32 v119, 1.0, v119
    v_rcp_f32 v112, v112
    v_mfma_f32_16x16x32_bf16 v[168:171], v[100:103], a[92:95], v[168:171]
    v_rcp_f32 v113, v113
    v_rcp_f32 v114, v114
    v_rcp_f32 v115, v115
    v_mfma_f32_16x16x32_bf16 v[172:175], v[72:75], a[96:99], v[236:239]
    v_cvt_pk_bf16_f32 v8, v179, v183
    v_cvt_pk_bf16_f32 v9, v187, v191
    v_rcp_f32 v116, v116
    v_mfma_f32_16x16x32_bf16 v[172:175], v[76:79], a[100:103], v[172:175]
    buffer_store_dwordx2 v[8:9], v26, s[40:43], s73 offen sc1
    v_rcp_f32 v117, v117
    v_rcp_f32 v118, v118
    v_mfma_f32_16x16x32_bf16 v[172:175], v[80:83], a[104:107], v[172:175]
    v_rcp_f32 v119, v119
    v_cvt_pk_bf16_f32 v124, v112, v113
    v_cvt_pk_bf16_f32 v125, v114, v115
    v_mfma_f32_16x16x32_bf16 v[172:175], v[84:87], a[108:111], v[172:175]
    s_waitcnt vmcnt(8)
    v_cvt_pk_bf16_f32 v126, v116, v117
    v_cvt_pk_bf16_f32 v127, v118, v119
    v_max3_u32 v1, v128, v129, v130
    v_max3_u32 v1, v131, v132, v1
    v_max3_u32 v1, v133, v134, v1
    v_mfma_f32_16x16x32_bf16 v[172:175], v[88:91], a[112:115], v[172:175]
    ds_write_b128 v20, v[124:127] offset:9216
    v_max3_u32 v1, v135, v136, v1
    v_mfma_f32_16x16x32_bf16 v[172:175], v[92:95], a[116:119], v[172:175]
    v_max3_u32 v1, v137, v138, v1
    v_max3_u32 v1, v139, v140, v1
    v_max3_u32 v1, v141, v142, v1
    v_max3_u32 v1, v143, v144, v1
    v_max3_u32 v1, v145, v146, v1
    v_mfma_f32_16x16x32_bf16 v[172:175], v[96:99], a[120:123], v[172:175]
    v_max3_u32 v1, v147, v148, v1
    v_max3_u32 v1, v149, v150, v1
    v_max3_u32 v1, v151, v152, v1
    v_max3_u32 v1, v153, v154, v1
    v_max3_u32 v1, v155, v156, v1
    v_mfma_f32_16x16x32_bf16 v[172:175], v[100:103], a[124:127], v[172:175]
    v_max3_u32 v1, v157, v158, v1
    v_max_u32 v1, v159, v1
    v_cmp_eq_u32 vcc, -1, v1
    s_nop 0
    s_cbranch_vccnz L_cfbs
L_cfbs_b:
    s_waitcnt lgkmcnt(1)
    v_mfma_f32_16x16x32_bf16 v[176:179], v[40:43], a[0:3], v[224:227]
    v_add_f32 v104, v240, v192
    v_add_f32 v105, v241, v193
    v_mfma_f32_16x16x32_bf16 v[176:179], v[44:47], a[4:7], v[176:179]
    s_add_u32 s73, s71, 1024
    v_add_f32 v106, v242, v194
    v_add_f32 v107, v243, v195
    v_add_f32 v108, v244, v200
    v_mfma_f32_16x16x32_bf16 v[176:179], v[48:51], a[8:11], v[176:179]
L_rw6:
    v_mov_b32 v18, L_rw6-L_pc+2048
    v_add_f32 v109, v245, v201
    v_mfma_f32_16x16x32_bf16 v[176:179], v[52:55], a[12:15], v[176:179]
    v_add_f32 v110, v246, v202
    v_add_f32 v111, v247, v203
    v_cvt_pk_bf16_f32 v2, v160, v164
    v_mfma_f32_16x16x32_bf16 v[176:179], v[56:59], a[16:19], v[176:179]
    ds_read_b128 v[240:243], v21 offset:6144
    v_cvt_pk_bf16_f32 v3, v168, v172
    v_mfma_f32_16x16x32_bf16 v[176:179], v[60:63], a[20:23], v[176:179]
    ds_read_b128 v[244:247], v21 offset:6160
    v_exp_f32 v104, v104
    v_mfma_f32_16x16x32_bf16 v[176:179], v[64:67], a[24:27], v[176:179]
    s_waitcnt lgkmcnt(2)
    s_barrier
    buffer_store_dwordx2 v[2:3], v23, s[40:43], s73 offen sc1
    v_mfma_f32_16x16x32_bf16 v[176:179], v[68:71], a[28:31], v[176:179]
    ds_read_b128 v[72:75], v36 offset:8192
    v_exp_f32 v105, v105
    v_mfma_f32_16x16x32_bf16 v[180:183], v[40:43], a[32:35], v[228:231]
    ds_read_b128 v[76:79], v36 offset:9216
    v_exp_f32 v106, v106
    v_mfma_f32_16x16x32_bf16 v[180:183], v[44:47], a[36:39], v[180:183]
    ds_read_b128 v[80:83], v36 offset:10240
    v_exp_f32 v107, v107
    v_mfma_f32_16x16x32_bf16 v[180:183], v[48:51], a[40:43], v[180:183]
    ds_read_b128 v[84:87], v36 offset:11264
    v_exp_f32 v108, v108
    v_mfma_f32_16x16x32_bf16 v[180:183], v[52:55], a[44:47], v[180:183]
    ds_read_b128 v[88:91], v36 offset:12288
    v_exp_f32 v109, v109
    v_mfma_f32_16x16x32_bf16 v[180:183], v[56:59], a[48:51], v[180:183]
    ds_read_b128 v[92:95], v36 offset:13312
    v_exp_f32 v110, v110
    v_mfma_f32_16x16x32_bf16 v[180:183], v[60:63], a[52:55], v[180:183]
    ds_read_b128 v[96:99], v36 offset:14336
    v_exp_f32 v111, v111
    v_mfma_f32_16x16x32_bf16 v[180:183], v[64:67], a[56:59], v[180:183]
    ds_read_b128 v[100:103], v36 offset:15360
    v_add_f32 v104, 1.0, v104
    v_mfma_f32_16x16x32_bf16 v[180:183], v[68:71], a[60:63], v[180:183]
    global_load_dword v19, v18, s[78:79]
    v_add_f32 v105, 1.0, v105
    v_mfma_f32_16x16x32_bf16 v[184:187], v[40:43], a[64:67], v[232:235]
    v_add_f32 v106, 1.0, v106
    v_add_f32 v107, 1.0, v107
    v_mfma_f32_16x16x32_bf16 v[184:187], v[44:47], a[68:71], v[184:187]
    v_add_f32 v108, 1.0, v108
    v_add_f32 v109, 1.0, v109
    v_mfma_f32_16x16x32_bf16 v[184:187], v[48:51], a[72:75], v[184:187]
    v_add_f32 v110, 1.0, v110
    v_add_f32 v111, 1.0, v111
    v_mfma_f32_16x16x32_bf16 v[184:187], v[52:55], a[76:79], v[184:187]
    v_rcp_f32 v104, v104
    v_mfma_f32_16x16x32_bf16 v[184:187], v[56:59], a[80:83], v[184:187]
    v_rcp_f32 v105, v105
    v_mfma_f32_16x16x32_bf16 v[184:187], v[60:63], a[84:87], v[184:187]
    v_rcp_f32 v106, v106
    v_mfma_f32_16x16x32_bf16 v[184:187], v[64:67], a[88:91], v[184:187]
    v_rcp_f32 v107, v107
    v_mfma_f32_16x16x32_bf16 v[184:187], v[68:71], a[92:95], v[184:187]
    v_cvt_pk_bf16_f32 v4, v161, v165
    v_cvt_pk_bf16_f32 v5, v169, v173
    v_mfma_f32_16x16x32_bf16 v[188:191], v[40:43], a[96:99], v[236:239]
    buffer_store_dwordx2 v[4:5], v24, s[40:43], s73 offen sc1
    v_mfma_f32_16x16x32_bf16 v[188:191], v[44:47], a[100:103], v[188:191]
    v_rcp_f32 v108, v108
    v_mfma_f32_16x16x32_bf16 v[188:191], v[48:51], a[104:107], v[188:191]
    v_rcp_f32 v109, v109
    v_mfma_f32_16x16x32_bf16 v[188:191], v[52:55], a[108:111], v[188:191]
    v_rcp_f32 v110, v110
    v_mfma_f32_16x16x32_bf16 v[188:191], v[56:59], a[112:115], v[188:191]
    v_rcp_f32 v111, v111
    v_cvt_pk_bf16_f32 v120, v104, v105
    v_mfma_f32_16x16x32_bf16 v[188:191], v[60:63], a[116:119], v[188:191]
    v_cvt_pk_bf16_f32 v121, v106, v107
    v_cvt_pk_bf16_f32 v122, v108, v109
    v_mfma_f32_16x16x32_bf16 v[188:191], v[64:67], a[120:123], v[188:191]
    v_cvt_pk_bf16_f32 v123, v110, v111
    v_add_f32 v112, v248, v208
    v_add_f32 v113, v249, v209
    v_mfma_f32_16x16x32_bf16 v[188:191], v[68:71], a[124:127], v[188:191]
    ds_write_b128 v20, v[120:123] offset:16384
    v_mfma_f32_16x16x32_bf16 v[196:199], a[128:131], v[128:131], 0
    v_add_f32 v114, v250, v210
    v_add_f32 v115, v251, v211
    v_mfma_f32_16x16x32_bf16 v[196:199], a[132:135], v[132:135], v[196:199]
    v_add_f32 v116, v252, v216
    v_add_f32 v117, v253, v217
    v_mfma_f32_16x16x32_bf16 v[196:199], a[136:139], v[136:139], v[196:199]
    v_add_f32 v118, v254, v218
    v_add_f32 v119, v255, v219
    v_mfma_f32_16x16x32_bf16 v[196:199], a[140:143], v[140:143], v[196:199]
    ds_read_b128 v[248:251], v21 offset:6272
    v_cvt_pk_bf16_f32 v6, v162, v166
    v_mfma_f32_16x16x32_bf16 v[196:199], a[144:147], v[144:147], v[196:199]
    ds_read_b128 v[252:255], v21 offset:6288
    v_cvt_pk_bf16_f32 v7, v170, v174
    v_mfma_f32_16x16x32_bf16 v[196:199], a[148:151], v[148:151], v[196:199]
    buffer_store_dwordx2 v[6:7], v25, s[40:43], s73 offen sc1
    v_mfma_f32_16x16x32_bf16 v[196:199], a[152:155], v[152:155], v[196:199]
    v_exp_f32 v112, v112
    v_exp_f32 v113, v113
    v_mfma_f32_16x16x32_bf16 v[196:199], a[156:159], v[156:159], v[196:199]
    v_exp_f32 v114, v114
    v_mfma_f32_16x16x32_bf16 v[204:207], a[160:163], v[128:131], 0
    v_exp_f32 v115, v115
    v_mfma_f32_16x16x32_bf16 v[204:207], a[164:167], v[132:135], v[204:207]
    v_exp_f32 v116, v116
    v_mfma_f32_16x16x32_bf16 v[204:207], a[168:171], v[136:139], v[204:207]
    v_exp_f32 v117, v117
    v_mfma_f32_16x16x32_bf16 v[204:207], a[172:175], v[140:143], v[204:207]
    v_exp_f32 v118, v118
    v_exp_f32 v119, v119
    v_mfma_f32_16x16x32_bf16 v[204:207], a[176:179], v[144:147], v[204:207]
    v_add_f32 v112, 1.0, v112
    v_add_f32 v113, 1.0, v113
    v_mfma_f32_16x16x32_bf16 v[204:207], a[180:183], v[148:151], v[204:207]
    v_add_f32 v114, 1.0, v114
    v_add_f32 v115, 1.0, v115
    v_mfma_f32_16x16x32_bf16 v[204:207], a[184:187], v[152:155], v[204:207]
    v_add_f32 v116, 1.0, v116
    v_add_f32 v117, 1.0, v117
    v_add_f32 v118, 1.0, v118
    v_mfma_f32_16x16x32_bf16 v[204:207], a[188:191], v[156:159], v[204:207]
    v_add_f32 v119, 1.0, v119
    v_rcp_f32 v112, v112
    v_mfma_f32_16x16x32_bf16 v[212:215], a[192:195], v[128:131], 0
    v_rcp_f32 v113, v113
    v_mfma_f32_16x16x32_bf16 v[212:215], a[196:199], v[132:135], v[212:215]
    v_rcp_f32 v114, v114
    v_mfma_f32_16x16x32_bf16 v[212:215], a[200:203], v[136:139], v[212:215]
    v_rcp_f32 v115, v115
    v_mfma_f32_16x16x32_bf16 v[212:215], a[204:207], v[140:143], v[212:215]
    v_cvt_pk_bf16_f32 v8, v163, v167
    v_cvt_pk_bf16_f32 v9, v171, v175
    v_mfma_f32_16x16x32_bf16 v[212:215], a[208:211], v[144:147], v[212:215]
    buffer_store_dwordx2 v[8:9], v26, s[40:43], s73 offen sc1
    v_rcp_f32 v116, v116
    v_mfma_f32_16x16x32_bf16 v[212:215], a[212:215], v[148:151], v[212:215]
    v_rcp_f32 v117, v117
    v_mfma_f32_16x16x32_bf16 v[212:215], a[216:219], v[152:155], v[212:215]
    v_rcp_f32 v118, v118
    v_mfma_f32_16x16x32_bf16 v[212:215], a[220:223], v[156:159], v[212:215]
    v_rcp_f32 v119, v119
    v_mfma_f32_16x16x32_bf16 v[220:223], a[224:227], v[128:131], 0
    v_cvt_pk_bf16_f32 v124, v112, v113
    v_cvt_pk_bf16_f32 v125, v114, v115
    v_cvt_pk_bf16_f32 v126, v116, v117
    v_mfma_f32_16x16x32_bf16 v[220:223], a[228:231], v[132:135], v[220:223]
    v_cvt_pk_bf16_f32 v127, v118, v119
    v_mul_f32 v196, s72, v196
    v_mfma_f32_16x16x32_bf16 v[220:223], a[232:235], v[136:139], v[220:223]
    ds_write_b128 v20, v[124:127] offset:17408
    v_mfma_f32_16x16x32_bf16 v[220:223], a[236:239], v[140:143], v[220:223]
    v_mul_f32 v197, s72, v197
    v_mul_f32 v198, s72, v198
    v_mfma_f32_16x16x32_bf16 v[220:223], a[240:243], v[144:147], v[220:223]
    v_mul_f32 v199, s72, v199
    v_mul_f32 v204, s72, v204
    v_mfma_f32_16x16x32_bf16 v[220:223], a[244:247], v[148:151], v[220:223]
    v_mul_f32 v205, s72, v205
    v_mul_f32 v206, s72, v206
    v_mfma_f32_16x16x32_bf16 v[220:223], a[248:251], v[152:155], v[220:223]
    v_mul_f32 v207, s72, v207
    v_mul_f32 v212, s72, v212
    v_mfma_f32_16x16x32_bf16 v[220:223], a[252:255], v[156:159], v[220:223]
    s_waitcnt lgkmcnt(1)
    v_mul_f32 v213, s72, v213
    v_mul_f32 v214, s72, v214
    v_mul_f32 v215, s72, v215
    v_mfma_f32_16x16x32_bf16 v[160:163], v[72:75], a[0:3], v[224:227]
    v_add_f32 v104, v240, v192
    v_add_f32 v105, v241, v193
    v_add_f32 v106, v242, v194
    v_add_f32 v107, v243, v195
    v_add_f32 v108, v244, v200
    v_mfma_f32_16x16x32_bf16 v[160:163], v[76:79], a[4:7], v[160:163]
    s_add_u32 s73, s71, 1536
    v_add_f32 v109, v245, v201
    v_add_f32 v110, v246, v202
    v_add_f32 v111, v247, v203
    v_mul_f32 v220, s72, v220
    v_mfma_f32_16x16x32_bf16 v[160:163], v[80:83], a[8:11], v[160:163]
    ds_read_b128 v[240:243], v21 offset:7168
    v_mul_f32 v221, s72, v221
    v_mul_f32 v222, s72, v222
    v_mul_f32 v223, s72, v223
    v_mfma_f32_16x16x32_bf16 v[160:163], v[84:87], a[12:15], v[160:163]
    ds_read_b128 v[244:247], v21 offset:7184
    v_cvt_pk_bf16_f32 v2, v176, v180
    v_cvt_pk_bf16_f32 v3, v184, v188
    v_exp_f32 v104, v104
    v_mfma_f32_16x16x32_bf16 v[160:163], v[88:91], a[16:19], v[160:163]
    buffer_store_dwordx2 v[2:3], v23, s[40:43], s73 offen sc1
    v_exp_f32 v105, v105
    v_mfma_f32_16x16x32_bf16 v[160:163], v[92:95], a[20:23], v[160:163]
    v_exp_f32 v106, v106
    v_exp_f32 v107, v107
    v_exp_f32 v108, v108
    v_mfma_f32_16x16x32_bf16 v[160:163], v[96:99], a[24:27], v[160:163]
    s_waitcnt lgkmcnt(2)
    s_barrier
    v_exp_f32 v109, v109
    v_exp_f32 v110, v110
    v_mfma_f32_16x16x32_bf16 v[160:163], v[100:103], a[28:31], v[160:163]
    ds_read_b128 v[40:43], v36 offset:16384
    v_exp_f32 v111, v111
    v_add_f32 v104, 1.0, v104
    v_mfma_f32_16x16x32_bf16 v[164:167], v[72:75], a[32:35], v[228:231]
    ds_read_b128 v[44:47], v36 offset:17408
    v_add_f32 v105, 1.0, v105
    v_add_f32 v106, 1.0, v106
    v_add_f32 v107, 1.0, v107
    v_mfma_f32_16x16x32_bf16 v[164:167], v[76:79], a[36:39], v[164:167]
    ds_read_b128 v[48:51], v36 offset:18432
    v_add_f32 v108, 1.0, v108
    v_add_f32 v109, 1.0, v109
    v_add_f32 v110, 1.0, v110
    v_add_f32 v111, 1.0, v111
    v_mfma_f32_16x16x32_bf16 v[164:167], v[80:83], a[40:43], v[164:167]
    ds_read_b128 v[52:55], v36 offset:19456
    v_rcp_f32 v104, v104
    v_rcp_f32 v105, v105
    v_mfma_f32_16x16x32_bf16 v[164:167], v[84:87], a[44:47], v[164:167]
    ds_read_b128 v[56:59], v36 offset:20480
    v_rcp_f32 v106, v106
    v_mfma_f32_16x16x32_bf16 v[164:167], v[88:91], a[48:51], v[164:167]
    ds_read_b128 v[60:63], v36 offset:21504
    v_rcp_f32 v107, v107
    v_cvt_pk_bf16_f32 v4, v177, v181
    v_cvt_pk_bf16_f32 v5, v185, v189
    v_mfma_f32_16x16x32_bf16 v[164:167], v[92:95], a[52:55], v[164:167]
    buffer_store_dwordx2 v[4:5], v24, s[40:43], s73 offen sc1
    v_rcp_f32 v108, v108
    v_rcp_f32 v109, v109
    v_mfma_f32_16x16x32_bf16 v[164:167], v[96:99], a[56:59], v[164:167]
    ds_read_b128 v[64:67], v36 offset:22528
    v_rcp_f32 v110, v110
    v_mfma_f32_16x16x32_bf16 v[164:167], v[100:103], a[60:63], v[164:167]
    ds_read_b128 v[68:71], v36 offset:23552
    v_rcp_f32 v111, v111
    v_cvt_pk_bf16_f32 v120, v104, v105
    v_cvt_pk_bf16_f32 v121, v106, v107
    v_mfma_f32_16x16x32_bf16 v[168:171], v[72:75], a[64:67], v[232:235]
    v_cvt_pk_bf16_f32 v122, v108, v109
    v_cvt_pk_bf16_f32 v123, v110, v111
    v_add_f32 v112, v248, v208
    v_add_f32 v113, v249, v209
    v_add_f32 v114, v250, v210
    v_mfma_f32_16x16x32_bf16 v[168:171], v[76:79], a[68:71], v[168:171]
    ds_write_b128 v20, v[120:123] offset:0
    v_mfma_f32_16x16x32_bf16 v[168:171], v[80:83], a[72:75], v[168:171]
    v_add_f32 v115, v251, v211
    v_add_f32 v116, v252, v216
    v_add_f32 v117, v253, v217
    v_add_f32 v118, v254, v218
    v_mfma_f32_16x16x32_bf16 v[168:171], v[84:87], a[76:79], v[168:171]
    v_add_f32 v119, v255, v219
    v_cvt_pk_bf16_f32 v6, v178, v182
    v_cvt_pk_bf16_f32 v7, v186, v190
    v_exp_f32 v112, v112
    v_mfma_f32_16x16x32_bf16 v[168:171], v[88:91], a[80:83], v[168:171]
    ds_read_b128 v[248:251], v21 offset:7296
    v_exp_f32 v113, v113
    v_exp_f32 v114, v114
    v_mfma_f32_16x16x32_bf16 v[168:171], v[92:95], a[84:87], v[168:171]
    ds_read_b128 v[252:255], v21 offset:7312
    v_exp_f32 v115, v115
    v_mfma_f32_16x16x32_bf16 v[168:171], v[96:99], a[88:91], v[168:171]
    buffer_store_dwordx2 v[6:7], v25, s[40:43], s73 offen sc1
    v_exp_f32 v116, v116
    v_exp_f32 v117, v117
    v_mfma_f32_16x16x32_bf16 v[168:171], v[100:103], a[92:95], v[168:171]
    v_exp_f32 v118, v118
    v_exp_f32 v119, v119
    v_mfma_f32_16x16x32_bf16 v[172:175], v[72:75], a[96:99], v[236:239]
    v_add_f32 v112, 1.0, v112
    v_add_f32 v113, 1.0, v113
    v_add_f32 v114, 1.0, v114
    v_add_f32 v115, 1.0, v115
    v_add_f32 v116, 1.0, v116
    v_mfma_f32_16x16x32_bf16 v[172:175], v[76:79], a[100:103], v[172:175]
    v_add_f32 v117, 1.0, v117
    v_add_f32 v118, 1.0, v118
    v_add_f32 v119, 1.0, v119
    v_mfma_f32_16x16x32_bf16 v[172:175], v[80:83], a[104:107], v[172:175]
    v_rcp_f32 v112, v112
    v_rcp_f32 v113, v113
    v_rcp_f32 v114, v114
    v_mfma_f32_16x16x32_bf16 v[172:175], v[84:87], a[108:111], v[172:175]
    v_rcp_f32 v115, v115
    v_cvt_pk_bf16_f32 v8, v179, v183
    v_cvt_pk_bf16_f32 v9, v187, v191
    v_mfma_f32_16x16x32_bf16 v[172:175], v[88:91], a[112:115], v[172:175]
    buffer_store_dwordx2 v[8:9], v26, s[40:43], s73 offen sc1
    v_rcp_f32 v116, v116
    v_mfma_f32_16x16x32_bf16 v[172:175], v[92:95], a[116:119], v[172:175]
    v_rcp_f32 v117, v117
    v_rcp_f32 v118, v118
    v_rcp_f32 v119, v119
    v_mfma_f32_16x16x32_bf16 v[172:175], v[96:99], a[120:123], v[172:175]
    v_cvt_pk_bf16_f32 v124, v112, v113
    v_cvt_pk_bf16_f32 v125, v114, v115
    v_cvt_pk_bf16_f32 v126, v116, v117
    v_mfma_f32_16x16x32_bf16 v[172:175], v[100:103], a[124:127], v[172:175]
    s_waitcnt lgkmcnt(0)
    v_cvt_pk_bf16_f32 v127, v118, v119
    ds_write_b128 v20, v[124:127] offset:1024
    v_mfma_f32_16x16x32_bf16 v[176:179], v[40:43], a[0:3], v[224:227]
    v_add_f32 v104, v240, v192
    v_add_f32 v105, v241, v193
    v_add_f32 v106, v242, v194
    v_add_f32 v107, v243, v195
    v_mfma_f32_16x16x32_bf16 v[176:179], v[44:47], a[4:7], v[176:179]
    s_add_u32 s73, s71, 2048
    v_add_f32 v108, v244, v200
    v_add_f32 v109, v245, v201
    v_add_f32 v110, v246, v202
    v_add_f32 v111, v247, v203
    v_cvt_pk_bf16_f32 v2, v160, v164
    v_mfma_f32_16x16x32_bf16 v[176:179], v[48:51], a[8:11], v[176:179]
    ds_read_b128 v[240:243], v21 offset:0
    v_cvt_pk_bf16_f32 v3, v168, v172
    v_exp_f32 v104, v104
    v_mfma_f32_16x16x32_bf16 v[176:179], v[52:55], a[12:15], v[176:179]
    ds_read_b128 v[244:247], v21 offset:16
    v_exp_f32 v105, v105
    v_exp_f32 v106, v106
    v_mfma_f32_16x16x32_bf16 v[176:179], v[56:59], a[16:19], v[176:179]
    buffer_store_dwordx2 v[2:3], v23, s[40:43], s73 offen sc1
    v_exp_f32 v107, v107
    v_mfma_f32_16x16x32_bf16 v[176:179], v[60:63], a[20:23], v[176:179]
    v_exp_f32 v108, v108
    v_exp_f32 v109, v109
    v_mfma_f32_16x16x32_bf16 v[176:179], v[64:67], a[24:27], v[176:179]
    s_waitcnt lgkmcnt(2)
    s_barrier
    v_exp_f32 v110, v110
    v_exp_f32 v111, v111
    v_add_f32 v104, 1.0, v104
    v_mfma_f32_16x16x32_bf16 v[176:179], v[68:71], a[28:31], v[176:179]
    ds_read_b128 v[72:75], v36 offset:0
    v_add_f32 v105, 1.0, v105
    v_add_f32 v106, 1.0, v106
    v_add_f32 v107, 1.0, v107
    v_mfma_f32_16x16x32_bf16 v[180:183], v[40:43], a[32:35], v[228:231]
    ds_read_b128 v[76:79], v36 offset:1024
    v_add_f32 v108, 1.0, v108
    v_add_f32 v109, 1.0, v109
    v_add_f32 v110, 1.0, v110
    v_mfma_f32_16x16x32_bf16 v[180:183], v[44:47], a[36:39], v[180:183]
    ds_read_b128 v[80:83], v36 offset:2048
    v_add_f32 v111, 1.0, v111
    v_rcp_f32 v104, v104
    v_mfma_f32_16x16x32_bf16 v[180:183], v[48:51], a[40:43], v[180:183]
    ds_read_b128 v[84:87], v36 offset:3072
    v_rcp_f32 v105, v105
    v_rcp_f32 v106, v106
    v_mfma_f32_16x16x32_bf16 v[180:183], v[52:55], a[44:47], v[180:183]
    ds_read_b128 v[88:91], v36 offset:4096
    v_rcp_f32 v107, v107
    v_cvt_pk_bf16_f32 v4, v161, v165
    v_cvt_pk_bf16_f32 v5, v169, v173
    v_mfma_f32_16x16x32_bf16 v[180:183], v[56:59], a[48:51], v[180:183]
    buffer_store_dwordx2 v[4:5], v24, s[40:43], s73 offen sc1
    v_rcp_f32 v108, v108
    v_mfma_f32_16x16x32_bf16 v[180:183], v[60:63], a[52:55], v[180:183]
    ds_read_b128 v[92:95], v36 offset:5120
    v_rcp_f32 v109, v109
    v_rcp_f32 v110, v110
    v_mfma_f32_16x16x32_bf16 v[180:183], v[64:67], a[56:59], v[180:183]
    ds_read_b128 v[96:99], v36 offset:6144
    v_rcp_f32 v111, v111
    v_cvt_pk_bf16_f32 v120, v104, v105
    v_mfma_f32_16x16x32_bf16 v[180:183], v[68:71], a[60:63], v[180:183]
    ds_read_b128 v[100:103], v36 offset:7168
    v_cvt_pk_bf16_f32 v121, v106, v107
    v_cvt_pk_bf16_f32 v122, v108, v109
    v_cvt_pk_bf16_f32 v123, v110, v111
    v_mfma_f32_16x16x32_bf16 v[184:187], v[40:43], a[64:67], v[232:235]
    ds_write_b128 v20, v[120:123] offset:8192
    v_mfma_f32_16x16x32_bf16 v[184:187], v[44:47], a[68:71], v[184:187]
    v_add_f32 v112, v248, v208
    v_add_f32 v113, v249, v209
    v_add_f32 v114, v250, v210
    v_add_f32 v115, v251, v211
    v_add_f32 v116, v252, v216
    v_mfma_f32_16x16x32_bf16 v[184:187], v[48:51], a[72:75], v[184:187]
    v_add_f32 v117, v253, v217
    v_add_f32 v118, v254, v218
    v_add_f32 v119, v255, v219
    v_cvt_pk_bf16_f32 v6, v162, v166
    v_mfma_f32_16x16x32_bf16 v[184:187], v[52:55], a[76:79], v[184:187]
    ds_read_b128 v[248:251], v21 offset:128
    v_cvt_pk_bf16_f32 v7, v170, v174
    v_exp_f32 v112, v112
    v_mfma_f32_16x16x32_bf16 v[184:187], v[56:59], a[80:83], v[184:187]
    ds_read_b128 v[252:255], v21 offset:144
    v_exp_f32 v113, v113
    v_exp_f32 v114, v114
    v_mfma_f32_16x16x32_bf16 v[184:187], v[60:63], a[84:87], v[184:187]
    buffer_store_dwordx2 v[6:7], v25, s[40:43], s73 offen sc1
    v_exp_f32 v115, v115
    v_mfma_f32_16x16x32_bf16 v[184:187], v[64:67], a[88:91], v[184:187]
    v_exp_f32 v116, v116
    v_exp_f32 v117, v117
    v_mfma_f32_16x16x32_bf16 v[184:187], v[68:71], a[92:95], v[184:187]
    v_exp_f32 v118, v118
    v_exp_f32 v119, v119
    v_add_f32 v112, 1.0, v112
    v_mfma_f32_16x16x32_bf16 v[188:191], v[40:43], a[96:99], v[236:239]
    v_add_f32 v113, 1.0, v113
    v_add_f32 v114, 1.0, v114
    v_add_f32 v115, 1.0, v115
    v_add_f32 v116, 1.0, v116
    v_mfma_f32_16x16x32_bf16 v[188:191], v[44:47], a[100:103], v[188:191]
    v_add_f32 v117, 1.0, v117
    v_add_f32 v118, 1.0, v118
    v_add_f32 v119, 1.0, v119
    v_rcp_f32 v112, v112
    v_mfma_f32_16x16x32_bf16 v[188:191], v[48:51], a[104:107], v[188:191]
    v_rcp_f32 v113, v113
    v_rcp_f32 v114, v114
    v_mfma_f32_16x16x32_bf16 v[188:191], v[52:55], a[108:111], v[188:191]
    v_rcp_f32 v115, v115
    v_cvt_pk_bf16_f32 v8, v163, v167
    v_cvt_pk_bf16_f32 v9, v171, v175
    v_mfma_f32_16x16x32_bf16 v[188:191], v[56:59], a[112:115], v[188:191]
    buffer_store_dwordx2 v[8:9], v26, s[40:43], s73 offen sc1
    v_rcp_f32 v116, v116
    v_rcp_f32 v117, v117
    v_mfma_f32_16x16x32_bf16 v[188:191], v[60:63], a[116:119], v[188:191]
    v_rcp_f32 v118, v118
    v_rcp_f32 v119, v119
    v_mfma_f32_16x16x32_bf16 v[188:191], v[64:67], a[120:123], v[188:191]
    v_cvt_pk_bf16_f32 v124, v112, v113
    v_cvt_pk_bf16_f32 v125, v114, v115
    v_cvt_pk_bf16_f32 v126, v116, v117
    v_mfma_f32_16x16x32_bf16 v[188:191], v[68:71], a[124:127], v[188:191]
    s_waitcnt lgkmcnt(0)
    v_cvt_pk_bf16_f32 v127, v118, v119
    ds_write_b128 v20, v[124:127] offset:9216
    v_mfma_f32_16x16x32_bf16 v[160:163], v[72:75], a[0:3], v[224:227]
    v_add_f32 v104, v240, v196
    v_add_f32 v105, v241, v197
    v_add_f32 v106, v242, v198
    v_add_f32 v107, v243, v199
    v_mfma_f32_16x16x32_bf16 v[160:163], v[76:79], a[4:7], v[160:163]
    s_add_u32 s73, s71, 2560
    v_add_f32 v108, v244, v204
    v_add_f32 v109, v245, v205
    v_add_f32 v110, v246, v206
    v_add_f32 v111, v247, v207
    v_cvt_pk_bf16_f32 v2, v176, v180
    v_mfma_f32_16x16x32_bf16 v[160:163], v[80:83], a[8:11], v[160:163]
    ds_read_b128 v[240:243], v21 offset:1024
    v_cvt_pk_bf16_f32 v3, v184, v188
    v_exp_f32 v104, v104
    v_mfma_f32_16x16x32_bf16 v[160:163], v[84:87], a[12:15], v[160:163]
    ds_read_b128 v[244:247], v21 offset:1040
    v_exp_f32 v105, v105
    v_exp_f32 v106, v106
    v_mfma_f32_16x16x32_bf16 v[160:163], v[88:91], a[16:19], v[160:163]
    buffer_store_dwordx2 v[2:3], v23, s[40:43], s73 offen sc1
    v_exp_f32 v107, v107
    v_mfma_f32_16x16x32_bf16 v[160:163], v[92:95], a[20:23], v[160:163]
    v_exp_f32 v108, v108
    v_exp_f32 v109, v109
    v_mfma_f32_16x16x32_bf16 v[160:163], v[96:99], a[24:27], v[160:163]
    s_waitcnt lgkmcnt(2)
    s_barrier
    v_exp_f32 v110, v110
    v_exp_f32 v111, v111
    v_add_f32 v104, 1.0, v104
    v_mfma_f32_16x16x32_bf16 v[160:163], v[100:103], a[28:31], v[160:163]
    ds_read_b128 v[40:43], v36 offset:8192
    v_add_f32 v105, 1.0, v105
    v_add_f32 v106, 1.0, v106
    v_add_f32 v107, 1.0, v107
    v_mfma_f32_16x16x32_bf16 v[164:167], v[72:75], a[32:35], v[228:231]
    ds_read_b128 v[44:47], v36 offset:9216
    v_add_f32 v108, 1.0, v108
    v_add_f32 v109, 1.0, v109
    v_add_f32 v110, 1.0, v110
    v_mfma_f32_16x16x32_bf16 v[164:167], v[76:79], a[36:39], v[164:167]
    ds_read_b128 v[48:51], v36 offset:10240
    v_add_f32 v111, 1.0, v111
    v_rcp_f32 v104, v104
    v_mfma_f32_16x16x32_bf16 v[164:167], v[80:83], a[40:43], v[164:167]
    ds_read_b128 v[52:55], v36 offset:11264
    v_rcp_f32 v105, v105
    v_rcp_f32 v106, v106
    v_mfma_f32_16x16x32_bf16 v[164:167], v[84:87], a[44:47], v[164:167]
    ds_read_b128 v[56:59], v36 offset:12288
    v_rcp_f32 v107, v107
    v_cvt_pk_bf16_f32 v4, v177, v181
    v_cvt_pk_bf16_f32 v5, v185, v189
    v_mfma_f32_16x16x32_bf16 v[164:167], v[88:91], a[48:51], v[164:167]
    buffer_store_dwordx2 v[4:5], v24, s[40:43], s73 offen sc1
    v_rcp_f32 v108, v108
    v_mfma_f32_16x16x32_bf16 v[164:167], v[92:95], a[52:55], v[164:167]
    ds_read_b128 v[60:63], v36 offset:13312
    v_rcp_f32 v109, v109
    v_rcp_f32 v110, v110
    v_mfma_f32_16x16x32_bf16 v[164:167], v[96:99], a[56:59], v[164:167]
    ds_read_b128 v[64:67], v36 offset:14336
    v_rcp_f32 v111, v111
    v_cvt_pk_bf16_f32 v120, v104, v105
    v_mfma_f32_16x16x32_bf16 v[164:167], v[100:103], a[60:63], v[164:167]
    ds_read_b128 v[68:71], v36 offset:15360
    v_cvt_pk_bf16_f32 v121, v106, v107
    v_cvt_pk_bf16_f32 v122, v108, v109
    v_cvt_pk_bf16_f32 v123, v110, v111
    v_mfma_f32_16x16x32_bf16 v[168:171], v[72:75], a[64:67], v[232:235]
    ds_write_b128 v20, v[120:123] offset:16384
    v_mfma_f32_16x16x32_bf16 v[168:171], v[76:79], a[68:71], v[168:171]
    v_add_f32 v112, v248, v212
    v_add_f32 v113, v249, v213
    v_add_f32 v114, v250, v214
    v_add_f32 v115, v251, v215
    v_add_f32 v116, v252, v220
    v_mfma_f32_16x16x32_bf16 v[168:171], v[80:83], a[72:75], v[168:171]
    v_add_f32 v117, v253, v221
    v_add_f32 v118, v254, v222
    v_add_f32 v119, v255, v223
    v_cvt_pk_bf16_f32 v6, v178, v182
    v_mfma_f32_16x16x32_bf16 v[168:171], v[84:87], a[76:79], v[168:171]
    ds_read_b128 v[248:251], v21 offset:1152
    v_cvt_pk_bf16_f32 v7, v186, v190
    v_exp_f32 v112, v112
    v_mfma_f32_16x16x32_bf16 v[168:171], v[88:91], a[80:83], v[168:171]
    ds_read_b128 v[252:255], v21 offset:1168
    v_exp_f32 v113, v113
    v_exp_f32 v114, v114
    v_mfma_f32_16x16x32_bf16 v[168:171], v[92:95], a[84:87], v[168:171]
    buffer_store_dwordx2 v[6:7], v25, s[40:43], s73 offen sc1
    v_exp_f32 v115, v115
    v_mfma_f32_16x16x32_bf16 v[168:171], v[96:99], a[88:91], v[168:171]
    v_exp_f32 v116, v116
    v_exp_f32 v117, v117
    v_mfma_f32_16x16x32_bf16 v[168:171], v[100:103], a[92:95], v[168:171]
    v_exp_f32 v118, v118
    v_exp_f32 v119, v119
    v_add_f32 v112, 1.0, v112
    v_mfma_f32_16x16x32_bf16 v[172:175], v[72:75], a[96:99], v[236:239]
    v_add_f32 v113, 1.0, v113
    v_add_f32 v114, 1.0, v114
    v_add_f32 v115, 1.0, v115
    v_add_f32 v116, 1.0, v116
    v_mfma_f32_16x16x32_bf16 v[172:175], v[76:79], a[100:103], v[172:175]
    v_add_f32 v117, 1.0, v117
    v_add_f32 v118, 1.0, v118
    v_add_f32 v119, 1.0, v119
    v_rcp_f32 v112, v112
    v_mfma_f32_16x16x32_bf16 v[172:175], v[80:83], a[104:107], v[172:175]
    v_rcp_f32 v113, v113
    v_rcp_f32 v114, v114
    v_mfma_f32_16x16x32_bf16 v[172:175], v[84:87], a[108:111], v[172:175]
    v_rcp_f32 v115, v115
    v_cvt_pk_bf16_f32 v8, v179, v183
    v_cvt_pk_bf16_f32 v9, v187, v191
    v_mfma_f32_16x16x32_bf16 v[172:175], v[88:91], a[112:115], v[172:175]
    buffer_store_dwordx2 v[8:9], v26, s[40:43], s73 offen sc1
    v_rcp_f32 v116, v116
    v_rcp_f32 v117, v117
    v_mfma_f32_16x16x32_bf16 v[172:175], v[92:95], a[116:119], v[172:175]
    v_rcp_f32 v118, v118
    v_rcp_f32 v119, v119
    v_mfma_f32_16x16x32_bf16 v[172:175], v[96:99], a[120:123], v[172:175]
    v_cvt_pk_bf16_f32 v124, v112, v113
    v_cvt_pk_bf16_f32 v125, v114, v115
    v_cvt_pk_bf16_f32 v126, v116, v117
    v_mfma_f32_16x16x32_bf16 v[172:175], v[100:103], a[124:127], v[172:175]
    s_waitcnt lgkmcnt(0)
    v_cvt_pk_bf16_f32 v127, v118, v119
    ds_write_b128 v20, v[124:127] offset:17408
    v_mfma_f32_16x16x32_bf16 v[176:179], v[40:43], a[0:3], v[224:227]
    v_add_f32 v104, v240, v196
    v_add_f32 v105, v241, v197
    v_add_f32 v106, v242, v198
    v_add_f32 v107, v243, v199
    v_mfma_f32_16x16x32_bf16 v[176:179], v[44:47], a[4:7], v[176:179]
    s_add_u32 s73, s71, 3072
    v_add_f32 v108, v244, v204
    v_add_f32 v109, v245, v205
    v_add_f32 v110, v246, v206
    v_add_f32 v111, v247, v207
    v_cvt_pk_bf16_f32 v2, v160, v164
    v_mfma_f32_16x16x32_bf16 v[176:179], v[48:51], a[8:11], v[176:179]
L_rw7:
    ds_read_b128 v[240:243], v21 offset:2048
    v_mov_b32 v18, L_rw7-L_pc+2048
    v_cvt_pk_bf16_f32 v3, v168, v172
    v_exp_f32 v104, v104
    v_mfma_f32_16x16x32_bf16 v[176:179], v[52:55], a[12:15], v[176:179]
    ds_read_b128 v[244:247], v21 offset:2064
    v_exp_f32 v105, v105
    v_mfma_f32_16x16x32_bf16 v[176:179], v[56:59], a[16:19], v[176:179]
    buffer_store_dwordx2 v[2:3], v23, s[40:43], s73 offen sc1
    v_exp_f32 v106, v106
    v_exp_f32 v107, v107
    v_mfma_f32_16x16x32_bf16 v[176:179], v[60:63], a[20:23], v[176:179]
    global_load_dword v19, v18, s[78:79]
    v_exp_f32 v108, v108
    v_mfma_f32_16x16x32_bf16 v[176:179], v[64:67], a[24:27], v[176:179]
    s_waitcnt lgkmcnt(2)
    s_barrier
    v_exp_f32 v109, v109
    v_exp_f32 v110, v110
    v_exp_f32 v111, v111
    v_mfma_f32_16x16x32_bf16 v[176:179], v[68:71], a[28:31], v[176:179]
    ds_read_b128 v[72:75], v36 offset:16384
    v_add_f32 v104, 1.0, v104
    v_add_f32 v105, 1.0, v105
    v_mfma_f32_16x16x32_bf16 v[180:183], v[40:43], a[32:35], v[228:231]
    ds_read_b128 v[76:79], v36 offset:17408
    v_add_f32 v106, 1.0, v106
    v_add_f32 v107, 1.0, v107
    v_add_f32 v108, 1.0, v108
    v_add_f32 v109, 1.0, v109
    v_mfma_f32_16x16x32_bf16 v[180:183], v[44:47], a[36:39], v[180:183]
    ds_read_b128 v[80:83], v36 offset:18432
    v_add_f32 v110, 1.0, v110
    v_add_f32 v111, 1.0, v111
    v_rcp_f32 v104, v104
    v_mfma_f32_16x16x32_bf16 v[180:183], v[48:51], a[40:43], v[180:183]
    ds_read_b128 v[84:87], v36 offset:19456
    v_rcp_f32 v105, v105
    v_mfma_f32_16x16x32_bf16 v[180:183], v[52:55], a[44:47], v[180:183]
    ds_read_b128 v[88:91], v36 offset:20480
    v_rcp_f32 v106, v106
    v_rcp_f32 v107, v107
    v_mfma_f32_16x16x32_bf16 v[180:183], v[56:59], a[48:51], v[180:183]
    ds_read_b128 v[92:95], v36 offset:21504
    v_cvt_pk_bf16_f32 v4, v161, v165
    v_cvt_pk_bf16_f32 v5, v169, v173
    v_rcp_f32 v108, v108
    v_mfma_f32_16x16x32_bf16 v[180:183], v[60:63], a[52:55], v[180:183]
    buffer_store_dwordx2 v[4:5], v24, s[40:43], s73 offen sc1
    v_rcp_f32 v109, v109
    v_mfma_f32_16x16x32_bf16 v[180:183], v[64:67], a[56:59], v[180:183]
    ds_read_b128 v[96:99], v36 offset:22528
    v_rcp_f32 v110, v110
    v_rcp_f32 v111, v111
    v_mfma_f32_16x16x32_bf16 v[180:183], v[68:71], a[60:63], v[180:183]
    ds_read_b128 v[100:103], v36 offset:23552
    v_cvt_pk_bf16_f32 v120, v104, v105
    v_cvt_pk_bf16_f32 v121, v106, v107
    v_cvt_pk_bf16_f32 v122, v108, v109
    v_mfma_f32_16x16x32_bf16 v[184:187], v[40:43], a[64:67], v[232:235]
    v_cvt_pk_bf16_f32 v123, v110, v111
    v_add_f32 v112, v248, v212
    v_add_f32 v113, v249, v213
    v_add_f32 v114, v250, v214
    v_mfma_f32_16x16x32_bf16 v[184:187], v[44:47], a[68:71], v[184:187]
    ds_write_b128 v20, v[120:123] offset:0
    v_add_f32 v115, v251, v215
    v_mfma_f32_16x16x32_bf16 v[184:187], v[48:51], a[72:75], v[184:187]
    v_add_f32 v116, v252, v220
    v_add_f32 v117, v253, v221
    v_add_f32 v118, v254, v222
    v_add_f32 v119, v255, v223
    v_mfma_f32_16x16x32_bf16 v[184:187], v[52:55], a[76:79], v[184:187]
    ds_read_b128 v[248:251], v21 offset:2176
    v_cvt_pk_bf16_f32 v6, v162, v166
    v_cvt_pk_bf16_f32 v7, v170, v174
    v_exp_f32 v112, v112
    v_mfma_f32_16x16x32_bf16 v[184:187], v[56:59], a[80:83], v[184:187]
    ds_read_b128 v[252:255], v21 offset:2192
    v_exp_f32 v113, v113
    v_exp_f32 v114, v114
    v_mfma_f32_16x16x32_bf16 v[184:187], v[60:63], a[84:87], v[184:187]
    buffer_store_dwordx2 v[6:7], v25, s[40:43], s73 offen sc1
    v_exp_f32 v115, v115
    v_mfma_f32_16x16x32_bf16 v[184:187], v[64:67], a[88:91], v[184:187]
    v_exp_f32 v116, v116
    v_exp_f32 v117, v117
    v_mfma_f32_16x16x32_bf16 v[184:187], v[68:71], a[92:95], v[184:187]
    v_exp_f32 v118, v118
    v_exp_f32 v119, v119
    v_mfma_f32_16x16x32_bf16 v[188:191], v[40:43], a[96:99], v[236:239]
    v_add_f32 v112, 1.0, v112
    v_add_f32 v113, 1.0, v113
    v_add_f32 v114, 1.0, v114
    v_add_f32 v115, 1.0, v115
    v_add_f32 v116, 1.0, v116
    v_mfma_f32_16x16x32_bf16 v[188:191], v[44:47], a[100:103], v[188:191]
    v_add_f32 v117, 1.0, v117
    v_add_f32 v118, 1.0, v118
    v_add_f32 v119, 1.0, v119
    v_rcp_f32 v112, v112
    v_mfma_f32_16x16x32_bf16 v[188:191], v[48:51], a[104:107], v[188:191]
    v_rcp_f32 v113, v113
    v_rcp_f32 v114, v114
    v_mfma_f32_16x16x32_bf16 v[188:191], v[52:55], a[108:111], v[188:191]
    v_rcp_f32 v115, v115
    v_cvt_pk_bf16_f32 v8, v163, v167
    v_cvt_pk_bf16_f32 v9, v171, v175
    v_mfma_f32_16x16x32_bf16 v[188:191], v[56:59], a[112:115], v[188:191]
    buffer_store_dwordx2 v[8:9], v26, s[40:43], s73 offen sc1
    v_rcp_f32 v116, v116
    v_mfma_f32_16x16x32_bf16 v[188:191], v[60:63], a[116:119], v[188:191]
    v_rcp_f32 v117, v117
    v_rcp_f32 v118, v118
    v_rcp_f32 v119, v119
    v_mfma_f32_16x16x32_bf16 v[188:191], v[64:67], a[120:123], v[188:191]
    v_cvt_pk_bf16_f32 v124, v112, v113
    v_cvt_pk_bf16_f32 v125, v114, v115
    v_cvt_pk_bf16_f32 v126, v116, v117
    v_mfma_f32_16x16x32_bf16 v[188:191], v[68:71], a[124:127], v[188:191]
    s_waitcnt lgkmcnt(0)
    v_cvt_pk_bf16_f32 v127, v118, v119
    ds_write_b128 v20, v[124:127] offset:1024
    v_mfma_f32_16x16x32_bf16 v[160:163], v[72:75], a[0:3], v[224:227]
    v_add_f32 v104, v240, v196
    v_add_f32 v105, v241, v197
    v_add_f32 v106, v242, v198
    v_add_f32 v107, v243, v199
    v_mfma_f32_16x16x32_bf16 v[160:163], v[76:79], a[4:7], v[160:163]
    s_add_u32 s73, s71, 3584
    v_add_f32 v108, v244, v204
    v_add_f32 v109, v245, v205
    v_add_f32 v110, v246, v206
    v_add_f32 v111, v247, v207
    v_cvt_pk_bf16_f32 v2, v176, v180
    v_mfma_f32_16x16x32_bf16 v[160:163], v[80:83], a[8:11], v[160:163]
    ds_read_b128 v[240:243], v21 offset:3072
    v_cvt_pk_bf16_f32 v3, v184, v188
    v_exp_f32 v104, v104
    v_mfma_f32_16x16x32_bf16 v[160:163], v[84:87], a[12:15], v[160:163]
    ds_read_b128 v[244:247], v21 offset:3088
    v_exp_f32 v105, v105
    v_exp_f32 v106, v106
    v_mfma_f32_16x16x32_bf16 v[160:163], v[88:91], a[16:19], v[160:163]
    buffer_store_dwordx2 v[2:3], v23, s[40:43], s73 offen sc1
    v_exp_f32 v107, v107
    v_mfma_f32_16x16x32_bf16 v[160:163], v[92:95], a[20:23], v[160:163]
    v_exp_f32 v108, v108
    v_exp_f32 v109, v109
    v_mfma_f32_16x16x32_bf16 v[160:163], v[96:99], a[24:27], v[160:163]
    s_waitcnt lgkmcnt(2)
    s_barrier
    v_exp_f32 v110, v110
    v_exp_f32 v111, v111
    v_add_f32 v104, 1.0, v104
    v_mfma_f32_16x16x32_bf16 v[160:163], v[100:103], a[28:31], v[160:163]
    ds_read_b128 v[40:43], v36 offset:0
    v_add_f32 v105, 1.0, v105
    v_add_f32 v106, 1.0, v106
    v_add_f32 v107, 1.0, v107
    v_mfma_f32_16x16x32_bf16 v[164:167], v[72:75], a[32:35], v[228:231]
    ds_read_b128 v[44:47], v36 offset:1024
    v_add_f32 v108, 1.0, v108
    v_add_f32 v109, 1.0, v109
    v_add_f32 v110, 1.0, v110
    v_mfma_f32_16x16x32_bf16 v[164:167], v[76:79], a[36:39], v[164:167]
    ds_read_b128 v[48:51], v36 offset:2048
    v_add_f32 v111, 1.0, v111
    v_rcp_f32 v104, v104
    v_mfma_f32_16x16x32_bf16 v[164:167], v[80:83], a[40:43], v[164:167]
    ds_read_b128 v[52:55], v36 offset:3072
    v_rcp_f32 v105, v105
    v_rcp_f32 v106, v106
    v_mfma_f32_16x16x32_bf16 v[164:167], v[84:87], a[44:47], v[164:167]
    ds_read_b128 v[56:59], v36 offset:4096
    v_rcp_f32 v107, v107
    v_cvt_pk_bf16_f32 v4, v177, v181
    v_cvt_pk_bf16_f32 v5, v185, v189
    v_mfma_f32_16x16x32_bf16 v[164:167], v[88:91], a[48:51], v[164:167]
    buffer_store_dwordx2 v[4:5], v24, s[40:43], s73 offen sc1
    v_rcp_f32 v108, v108
    v_mfma_f32_16x16x32_bf16 v[164:167], v[92:95], a[52:55], v[164:167]
    ds_read_b128 v[60:63], v36 offset:5120
    v_rcp_f32 v109, v109
    v_rcp_f32 v110, v110
    v_mfma_f32_16x16x32_bf16 v[164:167], v[96:99], a[56:59], v[164:167]
    ds_read_b128 v[64:67], v36 offset:6144
    v_rcp_f32 v111, v111
    v_cvt_pk_bf16_f32 v120, v104, v105
    v_mfma_f32_16x16x32_bf16 v[164:167], v[100:103], a[60:63], v[164:167]
    ds_read_b128 v[68:71], v36 offset:7168
    v_cvt_pk_bf16_f32 v121, v106, v107
    v_cvt_pk_bf16_f32 v122, v108, v109
    v_cvt_pk_bf16_f32 v123, v110, v111
    v_mfma_f32_16x16x32_bf16 v[168:171], v[72:75], a[64:67], v[232:235]
    ds_write_b128 v20, v[120:123] offset:8192
    v_mfma_f32_16x16x32_bf16 v[168:171], v[76:79], a[68:71], v[168:171]
    v_add_f32 v112, v248, v212
    v_add_f32 v113, v249, v213
    v_add_f32 v114, v250, v214
    v_add_f32 v115, v251, v215
    v_add_f32 v116, v252, v220
    v_mfma_f32_16x16x32_bf16 v[168:171], v[80:83], a[72:75], v[168:171]
    v_add_f32 v117, v253, v221
    v_add_f32 v118, v254, v222
    v_add_f32 v119, v255, v223
    v_cvt_pk_bf16_f32 v6, v178, v182
    v_mfma_f32_16x16x32_bf16 v[168:171], v[84:87], a[76:79], v[168:171]
    ds_read_b128 v[248:251], v21 offset:3200
    v_cvt_pk_bf16_f32 v7, v186, v190
    v_exp_f32 v112, v112
    v_mfma_f32_16x16x32_bf16 v[168:171], v[88:91], a[80:83], v[168:171]
    ds_read_b128 v[252:255], v21 offset:3216
    v_exp_f32 v113, v113
    v_exp_f32 v114, v114
    v_mfma_f32_16x16x32_bf16 v[168:171], v[92:95], a[84:87], v[168:171]
    buffer_store_dwordx2 v[6:7], v25, s[40:43], s73 offen sc1
    v_exp_f32 v115, v115
    v_mfma_f32_16x16x32_bf16 v[168:171], v[96:99], a[88:91], v[168:171]
    v_exp_f32 v116, v116
    v_exp_f32 v117, v117
    v_mfma_f32_16x16x32_bf16 v[168:171], v[100:103], a[92:95], v[168:171]
    v_exp_f32 v118, v118
    v_exp_f32 v119, v119
    v_add_f32 v112, 1.0, v112
    v_mfma_f32_16x16x32_bf16 v[172:175], v[72:75], a[96:99], v[236:239]
    v_add_f32 v113, 1.0, v113
    v_add_f32 v114, 1.0, v114
    v_add_f32 v115, 1.0, v115
    v_add_f32 v116, 1.0, v116
    v_mfma_f32_16x16x32_bf16 v[172:175], v[76:79], a[100:103], v[172:175]
    v_add_f32 v117, 1.0, v117
    v_add_f32 v118, 1.0, v118
    v_add_f32 v119, 1.0, v119
    v_rcp_f32 v112, v112
    v_mfma_f32_16x16x32_bf16 v[172:175], v[80:83], a[104:107], v[172:175]
    v_rcp_f32 v113, v113
    v_rcp_f32 v114, v114
    v_mfma_f32_16x16x32_bf16 v[172:175], v[84:87], a[108:111], v[172:175]
    v_rcp_f32 v115, v115
    v_cvt_pk_bf16_f32 v8, v179, v183
    v_cvt_pk_bf16_f32 v9, v187, v191
    v_mfma_f32_16x16x32_bf16 v[172:175], v[88:91], a[112:115], v[172:175]
    buffer_store_dwordx2 v[8:9], v26, s[40:43], s73 offen sc1
    v_rcp_f32 v116, v116
    v_rcp_f32 v117, v117
    v_mfma_f32_16x16x32_bf16 v[172:175], v[92:95], a[116:119], v[172:175]
    v_rcp_f32 v118, v118
    v_rcp_f32 v119, v119
    v_mfma_f32_16x16x32_bf16 v[172:175], v[96:99], a[120:123], v[172:175]
    v_cvt_pk_bf16_f32 v124, v112, v113
    v_cvt_pk_bf16_f32 v125, v114, v115
    v_cvt_pk_bf16_f32 v126, v116, v117
    v_mfma_f32_16x16x32_bf16 v[172:175], v[100:103], a[124:127], v[172:175]
    s_waitcnt lgkmcnt(0)
    v_cvt_pk_bf16_f32 v127, v118, v119
    ds_write_b128 v20, v[124:127] offset:9216
    v_mfma_f32_16x16x32_bf16 v[176:179], v[40:43], a[0:3], v[224:227]
    v_add_f32 v104, v240, v196
    v_add_f32 v105, v241, v197
    v_add_f32 v106, v242, v198
    v_add_f32 v107, v243, v199
    v_mfma_f32_16x16x32_bf16 v[176:179], v[44:47], a[4:7], v[176:179]
    s_add_u32 s73, s71, 0
    v_add_f32 v108, v244, v204
    v_add_f32 v109, v245, v205
    v_add_f32 v110, v246, v206
    v_add_f32 v111, v247, v207
    v_cvt_pk_bf16_f32 v2, v160, v164
    v_mfma_f32_16x16x32_bf16 v[176:179], v[48:51], a[8:11], v[176:179]
    ds_read_b128 v[240:243], v21 offset:4096
    v_cvt_pk_bf16_f32 v3, v168, v172
    v_exp_f32 v104, v104
    v_mfma_f32_16x16x32_bf16 v[176:179], v[52:55], a[12:15], v[176:179]
    ds_read_b128 v[244:247], v21 offset:4112
    v_exp_f32 v105, v105
    v_exp_f32 v106, v106
    v_mfma_f32_16x16x32_bf16 v[176:179], v[56:59], a[16:19], v[176:179]
    buffer_store_dwordx2 v[2:3], v27, s[40:43], s73 offen sc1
    v_exp_f32 v107, v107
    v_mfma_f32_16x16x32_bf16 v[176:179], v[60:63], a[20:23], v[176:179]
    v_exp_f32 v108, v108
    v_exp_f32 v109, v109
    v_mfma_f32_16x16x32_bf16 v[176:179], v[64:67], a[24:27], v[176:179]
    s_waitcnt lgkmcnt(2)
    s_barrier
    v_exp_f32 v110, v110
    v_exp_f32 v111, v111
    v_add_f32 v104, 1.0, v104
    v_mfma_f32_16x16x32_bf16 v[176:179], v[68:71], a[28:31], v[176:179]
    ds_read_b128 v[72:75], v36 offset:8192
    v_add_f32 v105, 1.0, v105
    v_add_f32 v106, 1.0, v106
    v_add_f32 v107, 1.0, v107
    v_mfma_f32_16x16x32_bf16 v[180:183], v[40:43], a[32:35], v[228:231]
    ds_read_b128 v[76:79], v36 offset:9216
    v_add_f32 v108, 1.0, v108
    v_add_f32 v109, 1.0, v109
    v_add_f32 v110, 1.0, v110
    v_mfma_f32_16x16x32_bf16 v[180:183], v[44:47], a[36:39], v[180:183]
    ds_read_b128 v[80:83], v36 offset:10240
    v_add_f32 v111, 1.0, v111
    v_rcp_f32 v104, v104
    v_mfma_f32_16x16x32_bf16 v[180:183], v[48:51], a[40:43], v[180:183]
    ds_read_b128 v[84:87], v36 offset:11264
    v_rcp_f32 v105, v105
    v_rcp_f32 v106, v106
    v_mfma_f32_16x16x32_bf16 v[180:183], v[52:55], a[44:47], v[180:183]
    ds_read_b128 v[88:91], v36 offset:12288
    v_rcp_f32 v107, v107
    v_cvt_pk_bf16_f32 v4, v161, v165
    v_cvt_pk_bf16_f32 v5, v169, v173
    v_mfma_f32_16x16x32_bf16 v[180:183], v[56:59], a[48:51], v[180:183]
    buffer_store_dwordx2 v[4:5], v30, s[40:43], s73 offen sc1
    v_rcp_f32 v108, v108
    v_mfma_f32_16x16x32_bf16 v[180:183], v[60:63], a[52:55], v[180:183]
    ds_read_b128 v[92:95], v36 offset:13312
    v_rcp_f32 v109, v109
    v_rcp_f32 v110, v110
    v_mfma_f32_16x16x32_bf16 v[180:183], v[64:67], a[56:59], v[180:183]
    ds_read_b128 v[96:99], v36 offset:14336
    v_rcp_f32 v111, v111
    v_cvt_pk_bf16_f32 v120, v104, v105
    v_mfma_f32_16x16x32_bf16 v[180:183], v[68:71], a[60:63], v[180:183]
    ds_read_b128 v[100:103], v36 offset:15360
    v_cvt_pk_bf16_f32 v121, v106, v107
    v_cvt_pk_bf16_f32 v122, v108, v109
    v_cvt_pk_bf16_f32 v123, v110, v111
    v_mfma_f32_16x16x32_bf16 v[184:187], v[40:43], a[64:67], v[232:235]
    ds_write_b128 v20, v[120:123] offset:16384
    v_mfma_f32_16x16x32_bf16 v[184:187], v[44:47], a[68:71], v[184:187]
    v_add_f32 v112, v248, v212
    v_add_f32 v113, v249, v213
    v_add_f32 v114, v250, v214
    v_add_f32 v115, v251, v215
    v_add_f32 v116, v252, v220
    v_mfma_f32_16x16x32_bf16 v[184:187], v[48:51], a[72:75], v[184:187]
    v_add_f32 v117, v253, v221
    v_add_f32 v118, v254, v222
    v_add_f32 v119, v255, v223
    v_cvt_pk_bf16_f32 v6, v162, v166
    v_mfma_f32_16x16x32_bf16 v[184:187], v[52:55], a[76:79], v[184:187]
    ds_read_b128 v[248:251], v21 offset:4224
    v_cvt_pk_bf16_f32 v7, v170, v174
    v_exp_f32 v112, v112
    v_mfma_f32_16x16x32_bf16 v[184:187], v[56:59], a[80:83], v[184:187]
    ds_read_b128 v[252:255], v21 offset:4240
    v_exp_f32 v113, v113
    v_exp_f32 v114, v114
    v_mfma_f32_16x16x32_bf16 v[184:187], v[60:63], a[84:87], v[184:187]
    buffer_store_dwordx2 v[6:7], v31, s[40:43], s73 offen sc1
    v_exp_f32 v115, v115
    v_mfma_f32_16x16x32_bf16 v[184:187], v[64:67], a[88:91], v[184:187]
    v_exp_f32 v116, v116
    v_exp_f32 v117, v117
    v_mfma_f32_16x16x32_bf16 v[184:187], v[68:71], a[92:95], v[184:187]
    v_exp_f32 v118, v118
    v_exp_f32 v119, v119
    v_add_f32 v112, 1.0, v112
    v_mfma_f32_16x16x32_bf16 v[188:191], v[40:43], a[96:99], v[236:239]
    v_add_f32 v113, 1.0, v113
    v_add_f32 v114, 1.0, v114
    v_add_f32 v115, 1.0, v115
    v_add_f32 v116, 1.0, v116
    v_mfma_f32_16x16x32_bf16 v[188:191], v[44:47], a[100:103], v[188:191]
    v_add_f32 v117, 1.0, v117
    v_add_f32 v118, 1.0, v118
    v_add_f32 v119, 1.0, v119
    v_rcp_f32 v112, v112
    v_mfma_f32_16x16x32_bf16 v[188:191], v[48:51], a[104:107], v[188:191]
    v_rcp_f32 v113, v113
    v_rcp_f32 v114, v114
    v_mfma_f32_16x16x32_bf16 v[188:191], v[52:55], a[108:111], v[188:191]
    v_rcp_f32 v115, v115
    v_cvt_pk_bf16_f32 v8, v163, v167
    v_cvt_pk_bf16_f32 v9, v171, v175
    v_mfma_f32_16x16x32_bf16 v[188:191], v[56:59], a[112:115], v[188:191]
    buffer_store_dwordx2 v[8:9], v11, s[40:43], s73 offen sc1
    v_rcp_f32 v116, v116
    v_rcp_f32 v117, v117
    v_mfma_f32_16x16x32_bf16 v[188:191], v[60:63], a[116:119], v[188:191]
    v_rcp_f32 v118, v118
    v_rcp_f32 v119, v119
    v_mfma_f32_16x16x32_bf16 v[188:191], v[64:67], a[120:123], v[188:191]
    v_cvt_pk_bf16_f32 v124, v112, v113
    v_cvt_pk_bf16_f32 v125, v114, v115
    v_cvt_pk_bf16_f32 v126, v116, v117
    v_mfma_f32_16x16x32_bf16 v[188:191], v[68:71], a[124:127], v[188:191]
    s_waitcnt lgkmcnt(0)
    v_cvt_pk_bf16_f32 v127, v118, v119
    ds_write_b128 v20, v[124:127] offset:17408
    v_mfma_f32_16x16x32_bf16 v[160:163], v[72:75], a[0:3], v[224:227]
    v_add_f32 v104, v240, v196
    v_add_f32 v105, v241, v197
    v_add_f32 v106, v242, v198
    v_add_f32 v107, v243, v199
    v_mfma_f32_16x16x32_bf16 v[160:163], v[76:79], a[4:7], v[160:163]
    s_add_u32 s73, s71, 512
    v_add_f32 v108, v244, v204
    v_add_f32 v109, v245, v205
    v_add_f32 v110, v246, v206
    v_add_f32 v111, v247, v207
    v_cvt_pk_bf16_f32 v2, v176, v180
    v_mfma_f32_16x16x32_bf16 v[160:163], v[80:83], a[8:11], v[160:163]
    ds_read_b128 v[240:243], v21 offset:5120
    v_cvt_pk_bf16_f32 v3, v184, v188
    v_exp_f32 v104, v104
    v_mfma_f32_16x16x32_bf16 v[160:163], v[84:87], a[12:15], v[160:163]
    ds_read_b128 v[244:247], v21 offset:5136
    v_exp_f32 v105, v105
    v_exp_f32 v106, v106
    v_mfma_f32_16x16x32_bf16 v[160:163], v[88:91], a[16:19], v[160:163]
    buffer_store_dwordx2 v[2:3], v27, s[40:43], s73 offen sc1
    v_exp_f32 v107, v107
    v_mfma_f32_16x16x32_bf16 v[160:163], v[92:95], a[20:23], v[160:163]
    v_exp_f32 v108, v108
    v_exp_f32 v109, v109
    v_mfma_f32_16x16x32_bf16 v[160:163], v[96:99], a[24:27], v[160:163]
    s_waitcnt lgkmcnt(2)
    s_barrier
    v_exp_f32 v110, v110
    v_exp_f32 v111, v111
    v_add_f32 v104, 1.0, v104
    v_mfma_f32_16x16x32_bf16 v[160:163], v[100:103], a[28:31], v[160:163]
    ds_read_b128 v[40:43], v36 offset:16384
    v_add_f32 v105, 1.0, v105
    v_add_f32 v106, 1.0, v106
    v_add_f32 v107, 1.0, v107
    v_mfma_f32_16x16x32_bf16 v[164:167], v[72:75], a[32:35], v[228:231]
    ds_read_b128 v[44:47], v36 offset:17408
    v_add_f32 v108, 1.0, v108
    v_add_f32 v109, 1.0, v109
    v_add_f32 v110, 1.0, v110
    v_mfma_f32_16x16x32_bf16 v[164:167], v[76:79], a[36:39], v[164:167]
    ds_read_b128 v[48:51], v36 offset:18432
    v_add_f32 v111, 1.0, v111
    v_rcp_f32 v104, v104
    v_mfma_f32_16x16x32_bf16 v[164:167], v[80:83], a[40:43], v[164:167]
    ds_read_b128 v[52:55], v36 offset:19456
    v_rcp_f32 v105, v105
    v_rcp_f32 v106, v106
    v_mfma_f32_16x16x32_bf16 v[164:167], v[84:87], a[44:47], v[164:167]
    ds_read_b128 v[56:59], v36 offset:20480
    v_rcp_f32 v107, v107
    v_cvt_pk_bf16_f32 v4, v177, v181
    v_cvt_pk_bf16_f32 v5, v185, v189
    v_mfma_f32_16x16x32_bf16 v[164:167], v[88:91], a[48:51], v[164:167]
    buffer_store_dwordx2 v[4:5], v30, s[40:43], s73 offen sc1
    v_rcp_f32 v108, v108
    v_mfma_f32_16x16x32_bf16 v[164:167], v[92:95], a[52:55], v[164:167]
    ds_read_b128 v[60:63], v36 offset:21504
    v_rcp_f32 v109, v109
    v_rcp_f32 v110, v110
    v_mfma_f32_16x16x32_bf16 v[164:167], v[96:99], a[56:59], v[164:167]
    ds_read_b128 v[64:67], v36 offset:22528
    v_rcp_f32 v111, v111
    v_cvt_pk_bf16_f32 v120, v104, v105
    v_mfma_f32_16x16x32_bf16 v[164:167], v[100:103], a[60:63], v[164:167]
    ds_read_b128 v[68:71], v36 offset:23552
    v_cvt_pk_bf16_f32 v121, v106, v107
    v_cvt_pk_bf16_f32 v122, v108, v109
    v_cvt_pk_bf16_f32 v123, v110, v111
    v_mfma_f32_16x16x32_bf16 v[168:171], v[72:75], a[64:67], v[232:235]
    ds_write_b128 v20, v[120:123] offset:0
    v_mfma_f32_16x16x32_bf16 v[168:171], v[76:79], a[68:71], v[168:171]
    v_add_f32 v112, v248, v212
    v_add_f32 v113, v249, v213
    v_add_f32 v114, v250, v214
    v_add_f32 v115, v251, v215
    v_add_f32 v116, v252, v220
    v_mfma_f32_16x16x32_bf16 v[168:171], v[80:83], a[72:75], v[168:171]
    v_add_f32 v117, v253, v221
    v_add_f32 v118, v254, v222
    v_add_f32 v119, v255, v223
    v_cvt_pk_bf16_f32 v6, v178, v182
    v_mfma_f32_16x16x32_bf16 v[168:171], v[84:87], a[76:79], v[168:171]
    ds_read_b128 v[248:251], v21 offset:5248
    v_cvt_pk_bf16_f32 v7, v186, v190
    v_exp_f32 v112, v112
    v_mfma_f32_16x16x32_bf16 v[168:171], v[88:91], a[80:83], v[168:171]
    ds_read_b128 v[252:255], v21 offset:5264
    v_exp_f32 v113, v113
    v_exp_f32 v114, v114
    v_mfma_f32_16x16x32_bf16 v[168:171], v[92:95], a[84:87], v[168:171]
    buffer_store_dwordx2 v[6:7], v31, s[40:43], s73 offen sc1
    v_exp_f32 v115, v115
    v_mfma_f32_16x16x32_bf16 v[168:171], v[96:99], a[88:91], v[168:171]
    v_exp_f32 v116, v116
    v_exp_f32 v117, v117
    v_mfma_f32_16x16x32_bf16 v[168:171], v[100:103], a[92:95], v[168:171]
    v_exp_f32 v118, v118
    v_exp_f32 v119, v119
    v_add_f32 v112, 1.0, v112
    v_mfma_f32_16x16x32_bf16 v[172:175], v[72:75], a[96:99], v[236:239]
    v_add_f32 v113, 1.0, v113
    v_add_f32 v114, 1.0, v114
    v_add_f32 v115, 1.0, v115
    v_add_f32 v116, 1.0, v116
    v_mfma_f32_16x16x32_bf16 v[172:175], v[76:79], a[100:103], v[172:175]
    v_add_f32 v117, 1.0, v117
    v_add_f32 v118, 1.0, v118
    v_add_f32 v119, 1.0, v119
    v_rcp_f32 v112, v112
    v_mfma_f32_16x16x32_bf16 v[172:175], v[80:83], a[104:107], v[172:175]
    v_rcp_f32 v113, v113
    v_rcp_f32 v114, v114
    v_mfma_f32_16x16x32_bf16 v[172:175], v[84:87], a[108:111], v[172:175]
    v_rcp_f32 v115, v115
    v_cvt_pk_bf16_f32 v8, v179, v183
    v_cvt_pk_bf16_f32 v9, v187, v191
    v_mfma_f32_16x16x32_bf16 v[172:175], v[88:91], a[112:115], v[172:175]
    buffer_store_dwordx2 v[8:9], v11, s[40:43], s73 offen sc1
    v_rcp_f32 v116, v116
    v_rcp_f32 v117, v117
    v_mfma_f32_16x16x32_bf16 v[172:175], v[92:95], a[116:119], v[172:175]
    v_rcp_f32 v118, v118
    v_rcp_f32 v119, v119
    v_mfma_f32_16x16x32_bf16 v[172:175], v[96:99], a[120:123], v[172:175]
    v_cvt_pk_bf16_f32 v124, v112, v113
    v_cvt_pk_bf16_f32 v125, v114, v115
    v_cvt_pk_bf16_f32 v126, v116, v117
    v_mfma_f32_16x16x32_bf16 v[172:175], v[100:103], a[124:127], v[172:175]
    s_waitcnt lgkmcnt(0)
    v_cvt_pk_bf16_f32 v127, v118, v119
    ds_write_b128 v20, v[124:127] offset:1024
    v_mfma_f32_16x16x32_bf16 v[176:179], v[40:43], a[0:3], v[224:227]
    v_add_f32 v104, v240, v196
    v_add_f32 v105, v241, v197
    v_add_f32 v106, v242, v198
    v_add_f32 v107, v243, v199
    v_mfma_f32_16x16x32_bf16 v[176:179], v[44:47], a[4:7], v[176:179]
    s_add_u32 s73, s71, 1024
    v_add_f32 v108, v244, v204
    v_add_f32 v109, v245, v205
    v_add_f32 v110, v246, v206
    v_add_f32 v111, v247, v207
    v_cvt_pk_bf16_f32 v2, v160, v164
    v_mfma_f32_16x16x32_bf16 v[176:179], v[48:51], a[8:11], v[176:179]
    ds_read_b128 v[240:243], v21 offset:6144
    v_cvt_pk_bf16_f32 v3, v168, v172
    v_exp_f32 v104, v104
    v_mfma_f32_16x16x32_bf16 v[176:179], v[52:55], a[12:15], v[176:179]
    ds_read_b128 v[244:247], v21 offset:6160
    v_exp_f32 v105, v105
    v_exp_f32 v106, v106
    v_mfma_f32_16x16x32_bf16 v[176:179], v[56:59], a[16:19], v[176:179]
    buffer_store_dwordx2 v[2:3], v27, s[40:43], s73 offen sc1
    v_exp_f32 v107, v107
    v_mfma_f32_16x16x32_bf16 v[176:179], v[60:63], a[20:23], v[176:179]
    v_exp_f32 v108, v108
    v_exp_f32 v109, v109
    v_mfma_f32_16x16x32_bf16 v[176:179], v[64:67], a[24:27], v[176:179]
    s_waitcnt lgkmcnt(2)
    s_barrier
    v_exp_f32 v110, v110
    v_exp_f32 v111, v111
    v_add_f32 v104, 1.0, v104
    v_mfma_f32_16x16x32_bf16 v[176:179], v[68:71], a[28:31], v[176:179]
    ds_read_b128 v[72:75], v36 offset:0
    v_add_f32 v105, 1.0, v105
    v_add_f32 v106, 1.0, v106
    v_add_f32 v107, 1.0, v107
    v_mfma_f32_16x16x32_bf16 v[180:183], v[40:43], a[32:35], v[228:231]
    ds_read_b128 v[76:79], v36 offset:1024
    v_add_f32 v108, 1.0, v108
    v_add_f32 v109, 1.0, v109
    v_add_f32 v110, 1.0, v110
    v_mfma_f32_16x16x32_bf16 v[180:183], v[44:47], a[36:39], v[180:183]
    ds_read_b128 v[80:83], v36 offset:2048
    v_add_f32 v111, 1.0, v111
    v_rcp_f32 v104, v104
    v_mfma_f32_16x16x32_bf16 v[180:183], v[48:51], a[40:43], v[180:183]
    ds_read_b128 v[84:87], v36 offset:3072
    v_rcp_f32 v105, v105
    v_rcp_f32 v106, v106
    v_mfma_f32_16x16x32_bf16 v[180:183], v[52:55], a[44:47], v[180:183]
    ds_read_b128 v[88:91], v36 offset:4096
    v_rcp_f32 v107, v107
    v_cvt_pk_bf16_f32 v4, v161, v165
    v_cvt_pk_bf16_f32 v5, v169, v173
    v_mfma_f32_16x16x32_bf16 v[180:183], v[56:59], a[48:51], v[180:183]
    buffer_store_dwordx2 v[4:5], v30, s[40:43], s73 offen sc1
    v_rcp_f32 v108, v108
    v_mfma_f32_16x16x32_bf16 v[180:183], v[60:63], a[52:55], v[180:183]
    ds_read_b128 v[92:95], v36 offset:5120
    v_rcp_f32 v109, v109
    v_rcp_f32 v110, v110
    v_mfma_f32_16x16x32_bf16 v[180:183], v[64:67], a[56:59], v[180:183]
    ds_read_b128 v[96:99], v36 offset:6144
    v_rcp_f32 v111, v111
    v_cvt_pk_bf16_f32 v120, v104, v105
    v_mfma_f32_16x16x32_bf16 v[180:183], v[68:71], a[60:63], v[180:183]
    ds_read_b128 v[100:103], v36 offset:7168
    v_cvt_pk_bf16_f32 v121, v106, v107
    v_cvt_pk_bf16_f32 v122, v108, v109
    v_cvt_pk_bf16_f32 v123, v110, v111
    v_mfma_f32_16x16x32_bf16 v[184:187], v[40:43], a[64:67], v[232:235]
    ds_write_b128 v20, v[120:123] offset:8192
    v_mfma_f32_16x16x32_bf16 v[184:187], v[44:47], a[68:71], v[184:187]
    v_add_f32 v112, v248, v212
    v_add_f32 v113, v249, v213
    v_add_f32 v114, v250, v214
    v_add_f32 v115, v251, v215
    v_add_f32 v116, v252, v220
    v_mfma_f32_16x16x32_bf16 v[184:187], v[48:51], a[72:75], v[184:187]
    v_add_f32 v117, v253, v221
    v_add_f32 v118, v254, v222
    v_add_f32 v119, v255, v223
    v_cvt_pk_bf16_f32 v6, v162, v166
    v_mfma_f32_16x16x32_bf16 v[184:187], v[52:55], a[76:79], v[184:187]
    ds_read_b128 v[248:251], v21 offset:6272
    v_cvt_pk_bf16_f32 v7, v170, v174
    v_exp_f32 v112, v112
    v_mfma_f32_16x16x32_bf16 v[184:187], v[56:59], a[80:83], v[184:187]
    ds_read_b128 v[252:255], v21 offset:6288
    v_exp_f32 v113, v113
    v_exp_f32 v114, v114
    v_mfma_f32_16x16x32_bf16 v[184:187], v[60:63], a[84:87], v[184:187]
    buffer_store_dwordx2 v[6:7], v31, s[40:43], s73 offen sc1
    v_exp_f32 v115, v115
    v_mfma_f32_16x16x32_bf16 v[184:187], v[64:67], a[88:91], v[184:187]
    v_exp_f32 v116, v116
    v_exp_f32 v117, v117
    v_mfma_f32_16x16x32_bf16 v[184:187], v[68:71], a[92:95], v[184:187]
    v_exp_f32 v118, v118
    v_exp_f32 v119, v119
    v_add_f32 v112, 1.0, v112
    v_mfma_f32_16x16x32_bf16 v[188:191], v[40:43], a[96:99], v[236:239]
    v_add_f32 v113, 1.0, v113
    v_add_f32 v114, 1.0, v114
    v_add_f32 v115, 1.0, v115
    v_add_f32 v116, 1.0, v116
    v_mfma_f32_16x16x32_bf16 v[188:191], v[44:47], a[100:103], v[188:191]
    v_add_f32 v117, 1.0, v117
    v_add_f32 v118, 1.0, v118
    v_add_f32 v119, 1.0, v119
    v_rcp_f32 v112, v112
    v_mfma_f32_16x16x32_bf16 v[188:191], v[48:51], a[104:107], v[188:191]
    v_rcp_f32 v113, v113
    v_rcp_f32 v114, v114
    v_mfma_f32_16x16x32_bf16 v[188:191], v[52:55], a[108:111], v[188:191]
    v_rcp_f32 v115, v115
    v_cvt_pk_bf16_f32 v8, v163, v167
    v_cvt_pk_bf16_f32 v9, v171, v175
    v_mfma_f32_16x16x32_bf16 v[188:191], v[56:59], a[112:115], v[188:191]
    buffer_store_dwordx2 v[8:9], v11, s[40:43], s73 offen sc1
    v_rcp_f32 v116, v116
    v_rcp_f32 v117, v117
    v_mfma_f32_16x16x32_bf16 v[188:191], v[60:63], a[116:119], v[188:191]
    v_rcp_f32 v118, v118
    v_rcp_f32 v119, v119
    v_mfma_f32_16x16x32_bf16 v[188:191], v[64:67], a[120:123], v[188:191]
    v_cvt_pk_bf16_f32 v124, v112, v113
    v_cvt_pk_bf16_f32 v125, v114, v115
    v_cvt_pk_bf16_f32 v126, v116, v117
    v_mfma_f32_16x16x32_bf16 v[188:191], v[68:71], a[124:127], v[188:191]
    s_waitcnt lgkmcnt(0)
    v_cvt_pk_bf16_f32 v127, v118, v119
    ds_write_b128 v20, v[124:127] offset:9216
    v_mfma_f32_16x16x32_bf16 v[160:163], v[72:75], a[0:3], v[224:227]
    v_add_f32 v104, v240, v196
    v_add_f32 v105, v241, v197
    v_add_f32 v106, v242, v198
    v_add_f32 v107, v243, v199
    v_mfma_f32_16x16x32_bf16 v[160:163], v[76:79], a[4:7], v[160:163]
    s_add_u32 s73, s71, 1536
    v_add_f32 v108, v244, v204
    v_add_f32 v109, v245, v205
    v_add_f32 v110, v246, v206
    v_add_f32 v111, v247, v207
    v_cvt_pk_bf16_f32 v2, v176, v180
    v_mfma_f32_16x16x32_bf16 v[160:163], v[80:83], a[8:11], v[160:163]
    ds_read_b128 v[240:243], v21 offset:7168
    v_cvt_pk_bf16_f32 v3, v184, v188
    v_exp_f32 v104, v104
    v_mfma_f32_16x16x32_bf16 v[160:163], v[84:87], a[12:15], v[160:163]
    ds_read_b128 v[244:247], v21 offset:7184
    v_exp_f32 v105, v105
    v_exp_f32 v106, v106
    v_mfma_f32_16x16x32_bf16 v[160:163], v[88:91], a[16:19], v[160:163]
    buffer_store_dwordx2 v[2:3], v27, s[40:43], s73 offen sc1
    v_exp_f32 v107, v107
    v_mfma_f32_16x16x32_bf16 v[160:163], v[92:95], a[20:23], v[160:163]
    v_exp_f32 v108, v108
    v_exp_f32 v109, v109
    v_mfma_f32_16x16x32_bf16 v[160:163], v[96:99], a[24:27], v[160:163]
    s_waitcnt lgkmcnt(2)
    s_barrier
    v_exp_f32 v110, v110
    v_exp_f32 v111, v111
    v_add_f32 v104, 1.0, v104
    v_mfma_f32_16x16x32_bf16 v[160:163], v[100:103], a[28:31], v[160:163]
    ds_read_b128 v[40:43], v36 offset:8192
    v_add_f32 v105, 1.0, v105
    v_add_f32 v106, 1.0, v106
    v_add_f32 v107, 1.0, v107
    v_mfma_f32_16x16x32_bf16 v[164:167], v[72:75], a[32:35], v[228:231]
    ds_read_b128 v[44:47], v36 offset:9216
    v_add_f32 v108, 1.0, v108
    v_add_f32 v109, 1.0, v109
    v_add_f32 v110, 1.0, v110
    v_mfma_f32_16x16x32_bf16 v[164:167], v[76:79], a[36:39], v[164:167]
    ds_read_b128 v[48:51], v36 offset:10240
    v_add_f32 v111, 1.0, v111
    v_rcp_f32 v104, v104
    v_mfma_f32_16x16x32_bf16 v[164:167], v[80:83], a[40:43], v[164:167]
    ds_read_b128 v[52:55], v36 offset:11264
    v_rcp_f32 v105, v105
    v_rcp_f32 v106, v106
    v_mfma_f32_16x16x32_bf16 v[164:167], v[84:87], a[44:47], v[164:167]
    ds_read_b128 v[56:59], v36 offset:12288
    v_rcp_f32 v107, v107
    v_cvt_pk_bf16_f32 v4, v177, v181
    v_cvt_pk_bf16_f32 v5, v185, v189
    v_mfma_f32_16x16x32_bf16 v[164:167], v[88:91], a[48:51], v[164:167]
    buffer_store_dwordx2 v[4:5], v30, s[40:43], s73 offen sc1
    v_rcp_f32 v108, v108
    v_mfma_f32_16x16x32_bf16 v[164:167], v[92:95], a[52:55], v[164:167]
    ds_read_b128 v[60:63], v36 offset:13312
    v_rcp_f32 v109, v109
    v_rcp_f32 v110, v110
    v_mfma_f32_16x16x32_bf16 v[164:167], v[96:99], a[56:59], v[164:167]
    ds_read_b128 v[64:67], v36 offset:14336
    v_rcp_f32 v111, v111
    v_cvt_pk_bf16_f32 v120, v104, v105
    v_mfma_f32_16x16x32_bf16 v[164:167], v[100:103], a[60:63], v[164:167]
    ds_read_b128 v[68:71], v36 offset:15360
    v_cvt_pk_bf16_f32 v121, v106, v107
    v_cvt_pk_bf16_f32 v122, v108, v109
    v_cvt_pk_bf16_f32 v123, v110, v111
    v_mfma_f32_16x16x32_bf16 v[168:171], v[72:75], a[64:67], v[232:235]
    ds_write_b128 v20, v[120:123] offset:16384
    v_mfma_f32_16x16x32_bf16 v[168:171], v[76:79], a[68:71], v[168:171]
    v_add_f32 v112, v248, v212
    v_add_f32 v113, v249, v213
    v_add_f32 v114, v250, v214
    v_add_f32 v115, v251, v215
    v_add_f32 v116, v252, v220
    v_mfma_f32_16x16x32_bf16 v[168:171], v[80:83], a[72:75], v[168:171]
    v_add_f32 v117, v253, v221
    v_add_f32 v118, v254, v222
    v_add_f32 v119, v255, v223
    v_cvt_pk_bf16_f32 v6, v178, v182
    v_mfma_f32_16x16x32_bf16 v[168:171], v[84:87], a[76:79], v[168:171]
    ds_read_b128 v[248:251], v21 offset:7296
    v_cvt_pk_bf16_f32 v7, v186, v190
    v_exp_f32 v112, v112
    v_mfma_f32_16x16x32_bf16 v[168:171], v[88:91], a[80:83], v[168:171]
    ds_read_b128 v[252:255], v21 offset:7312
    v_exp_f32 v113, v113
    v_exp_f32 v114, v114
    v_mfma_f32_16x16x32_bf16 v[168:171], v[92:95], a[84:87], v[168:171]
    buffer_store_dwordx2 v[6:7], v31, s[40:43], s73 offen sc1
    v_exp_f32 v115, v115
    v_mfma_f32_16x16x32_bf16 v[168:171], v[96:99], a[88:91], v[168:171]
    v_exp_f32 v116, v116
    v_exp_f32 v117, v117
    v_mfma_f32_16x16x32_bf16 v[168:171], v[100:103], a[92:95], v[168:171]
    v_exp_f32 v118, v118
    v_exp_f32 v119, v119
    v_add_f32 v112, 1.0, v112
    v_mfma_f32_16x16x32_bf16 v[172:175], v[72:75], a[96:99], v[236:239]
    v_add_f32 v113, 1.0, v113
    v_add_f32 v114, 1.0, v114
    v_add_f32 v115, 1.0, v115
    v_add_f32 v116, 1.0, v116
    v_mfma_f32_16x16x32_bf16 v[172:175], v[76:79], a[100:103], v[172:175]
    v_add_f32 v117, 1.0, v117
    v_add_f32 v118, 1.0, v118
    v_add_f32 v119, 1.0, v119
    v_rcp_f32 v112, v112
    v_mfma_f32_16x16x32_bf16 v[172:175], v[80:83], a[104:107], v[172:175]
    v_rcp_f32 v113, v113
    v_rcp_f32 v114, v114
    v_mfma_f32_16x16x32_bf16 v[172:175], v[84:87], a[108:111], v[172:175]
    v_rcp_f32 v115, v115
    v_cvt_pk_bf16_f32 v8, v179, v183
    v_cvt_pk_bf16_f32 v9, v187, v191
    v_mfma_f32_16x16x32_bf16 v[172:175], v[88:91], a[112:115], v[172:175]
    buffer_store_dwordx2 v[8:9], v11, s[40:43], s73 offen sc1
    v_rcp_f32 v116, v116
    v_rcp_f32 v117, v117
    v_mfma_f32_16x16x32_bf16 v[172:175], v[92:95], a[116:119], v[172:175]
    v_rcp_f32 v118, v118
    v_rcp_f32 v119, v119
    v_mfma_f32_16x16x32_bf16 v[172:175], v[96:99], a[120:123], v[172:175]
    v_cvt_pk_bf16_f32 v124, v112, v113
    v_cvt_pk_bf16_f32 v125, v114, v115
    v_cvt_pk_bf16_f32 v126, v116, v117
    v_mfma_f32_16x16x32_bf16 v[172:175], v[100:103], a[124:127], v[172:175]
    s_waitcnt lgkmcnt(0)
    v_cvt_pk_bf16_f32 v127, v118, v119
    ds_write_b128 v20, v[124:127] offset:17408
    v_mfma_f32_16x16x32_bf16 v[176:179], v[40:43], a[0:3], v[224:227]
    v_add_f32 v104, v240, v196
    v_add_f32 v105, v241, v197
    v_add_f32 v106, v242, v198
    v_add_f32 v107, v243, v199
    v_mfma_f32_16x16x32_bf16 v[176:179], v[44:47], a[4:7], v[176:179]
    s_add_u32 s73, s71, 2048
    v_add_f32 v108, v244, v204
    v_add_f32 v109, v245, v205
    v_add_f32 v110, v246, v206
    v_add_f32 v111, v247, v207
    v_cvt_pk_bf16_f32 v2, v160, v164
    v_mfma_f32_16x16x32_bf16 v[176:179], v[48:51], a[8:11], v[176:179]
    v_cvt_pk_bf16_f32 v3, v168, v172
    v_exp_f32 v104, v104
    v_mfma_f32_16x16x32_bf16 v[176:179], v[52:55], a[12:15], v[176:179]
    buffer_store_dwordx2 v[2:3], v27, s[40:43], s73 offen sc1
    v_exp_f32 v105, v105
    v_exp_f32 v106, v106
    v_mfma_f32_16x16x32_bf16 v[176:179], v[56:59], a[16:19], v[176:179]
    v_exp_f32 v107, v107
    v_exp_f32 v108, v108
    v_mfma_f32_16x16x32_bf16 v[176:179], v[60:63], a[20:23], v[176:179]
    v_exp_f32 v109, v109
    v_exp_f32 v110, v110
    v_mfma_f32_16x16x32_bf16 v[176:179], v[64:67], a[24:27], v[176:179]
    s_waitcnt lgkmcnt(0)
    s_barrier
    v_exp_f32 v111, v111
    v_add_f32 v104, 1.0, v104
    v_add_f32 v105, 1.0, v105
    v_mfma_f32_16x16x32_bf16 v[176:179], v[68:71], a[28:31], v[176:179]
    ds_read_b128 v[72:75], v36 offset:16384
    v_add_f32 v106, 1.0, v106
    v_add_f32 v107, 1.0, v107
    v_add_f32 v108, 1.0, v108
    v_mfma_f32_16x16x32_bf16 v[180:183], v[40:43], a[32:35], v[228:231]
    ds_read_b128 v[76:79], v36 offset:17408
    v_add_f32 v109, 1.0, v109
    v_add_f32 v110, 1.0, v110
    v_add_f32 v111, 1.0, v111
    v_mfma_f32_16x16x32_bf16 v[180:183], v[44:47], a[36:39], v[180:183]
    ds_read_b128 v[80:83], v36 offset:18432
    v_rcp_f32 v104, v104
    v_rcp_f32 v105, v105
    v_mfma_f32_16x16x32_bf16 v[180:183], v[48:51], a[40:43], v[180:183]
    ds_read_b128 v[84:87], v36 offset:19456
    v_rcp_f32 v106, v106
    v_mfma_f32_16x16x32_bf16 v[180:183], v[52:55], a[44:47], v[180:183]
    ds_read_b128 v[88:91], v36 offset:20480
    v_rcp_f32 v107, v107
    v_cvt_pk_bf16_f32 v4, v161, v165
    v_cvt_pk_bf16_f32 v5, v169, v173
    v_mfma_f32_16x16x32_bf16 v[180:183], v[56:59], a[48:51], v[180:183]
    buffer_store_dwordx2 v[4:5], v30, s[40:43], s73 offen sc1
    v_rcp_f32 v108, v108
    v_mfma_f32_16x16x32_bf16 v[180:183], v[60:63], a[52:55], v[180:183]
    ds_read_b128 v[92:95], v36 offset:21504
    v_rcp_f32 v109, v109
    v_rcp_f32 v110, v110
    v_mfma_f32_16x16x32_bf16 v[180:183], v[64:67], a[56:59], v[180:183]
    ds_read_b128 v[96:99], v36 offset:22528
    v_rcp_f32 v111, v111
    v_cvt_pk_bf16_f32 v120, v104, v105
    v_mfma_f32_16x16x32_bf16 v[180:183], v[68:71], a[60:63], v[180:183]
    ds_read_b128 v[100:103], v36 offset:23552
    v_cvt_pk_bf16_f32 v121, v106, v107
    v_cvt_pk_bf16_f32 v122, v108, v109
    v_cvt_pk_bf16_f32 v123, v110, v111
    v_mfma_f32_16x16x32_bf16 v[184:187], v[40:43], a[64:67], v[232:235]
    ds_write_b128 v20, v[120:123] offset:0
    v_mfma_f32_16x16x32_bf16 v[184:187], v[44:47], a[68:71], v[184:187]
    v_add_f32 v112, v248, v212
    v_add_f32 v113, v249, v213
    v_add_f32 v114, v250, v214
    v_add_f32 v115, v251, v215
    v_mfma_f32_16x16x32_bf16 v[184:187], v[48:51], a[72:75], v[184:187]
    v_add_f32 v116, v252, v220
    v_add_f32 v117, v253, v221
    v_add_f32 v118, v254, v222
    v_add_f32 v119, v255, v223
    v_cvt_pk_bf16_f32 v6, v162, v166
    v_mfma_f32_16x16x32_bf16 v[184:187], v[52:55], a[76:79], v[184:187]
    v_cvt_pk_bf16_f32 v7, v170, v174
    v_exp_f32 v112, v112
    v_mfma_f32_16x16x32_bf16 v[184:187], v[56:59], a[80:83], v[184:187]
    buffer_store_dwordx2 v[6:7], v31, s[40:43], s73 offen sc1
    v_exp_f32 v113, v113
    v_exp_f32 v114, v114
    v_mfma_f32_16x16x32_bf16 v[184:187], v[60:63], a[84:87], v[184:187]
    v_exp_f32 v115, v115
    v_exp_f32 v116, v116
    v_mfma_f32_16x16x32_bf16 v[184:187], v[64:67], a[88:91], v[184:187]
    v_exp_f32 v117, v117
    v_exp_f32 v118, v118
    v_mfma_f32_16x16x32_bf16 v[184:187], v[68:71], a[92:95], v[184:187]
    v_exp_f32 v119, v119
    v_add_f32 v112, 1.0, v112
    v_add_f32 v113, 1.0, v113
    v_mfma_f32_16x16x32_bf16 v[188:191], v[40:43], a[96:99], v[236:239]
    v_add_f32 v114, 1.0, v114
    v_add_f32 v115, 1.0, v115
    v_add_f32 v116, 1.0, v116
    v_add_f32 v117, 1.0, v117
    v_mfma_f32_16x16x32_bf16 v[188:191], v[44:47], a[100:103], v[188:191]
    v_add_f32 v118, 1.0, v118
    v_add_f32 v119, 1.0, v119
    v_rcp_f32 v112, v112
    v_mfma_f32_16x16x32_bf16 v[188:191], v[48:51], a[104:107], v[188:191]
    v_rcp_f32 v113, v113
    v_rcp_f32 v114, v114
    v_mfma_f32_16x16x32_bf16 v[188:191], v[52:55], a[108:111], v[188:191]
    v_rcp_f32 v115, v115
    v_cvt_pk_bf16_f32 v8, v163, v167
    v_cvt_pk_bf16_f32 v9, v171, v175
    v_rcp_f32 v116, v116
    v_mfma_f32_16x16x32_bf16 v[188:191], v[56:59], a[112:115], v[188:191]
    buffer_store_dwordx2 v[8:9], v11, s[40:43], s73 offen sc1
    v_rcp_f32 v117, v117
    v_mfma_f32_16x16x32_bf16 v[188:191], v[60:63], a[116:119], v[188:191]
    v_rcp_f32 v118, v118
    v_rcp_f32 v119, v119
    v_mfma_f32_16x16x32_bf16 v[188:191], v[64:67], a[120:123], v[188:191]
    v_cvt_pk_bf16_f32 v124, v112, v113
    v_cvt_pk_bf16_f32 v125, v114, v115
    v_cvt_pk_bf16_f32 v126, v116, v117
    v_mfma_f32_16x16x32_bf16 v[188:191], v[68:71], a[124:127], v[188:191]
    s_waitcnt lgkmcnt(0)
    v_cvt_pk_bf16_f32 v127, v118, v119
    ds_write_b128 v20, v[124:127] offset:1024
    v_mfma_f32_16x16x32_bf16 v[160:163], v[72:75], a[0:3], v[224:227]
    v_mfma_f32_16x16x32_bf16 v[160:163], v[76:79], a[4:7], v[160:163]
    s_add_u32 s73, s71, 2560
    v_mfma_f32_16x16x32_bf16 v[160:163], v[80:83], a[8:11], v[160:163]
    v_mfma_f32_16x16x32_bf16 v[160:163], v[84:87], a[12:15], v[160:163]
    v_mfma_f32_16x16x32_bf16 v[160:163], v[88:91], a[16:19], v[160:163]
    v_cvt_pk_bf16_f32 v2, v176, v180
    v_cvt_pk_bf16_f32 v3, v184, v188
    v_cvt_pk_bf16_f32 v4, v177, v181
    v_cvt_pk_bf16_f32 v5, v185, v189
    v_mfma_f32_16x16x32_bf16 v[160:163], v[92:95], a[20:23], v[160:163]
    buffer_store_dwordx2 v[2:3], v27, s[40:43], s73 offen sc1
    v_mfma_f32_16x16x32_bf16 v[160:163], v[96:99], a[24:27], v[160:163]
    s_waitcnt lgkmcnt(0)
    s_barrier
    buffer_store_dwordx2 v[4:5], v30, s[40:43], s73 offen sc1
    v_mfma_f32_16x16x32_bf16 v[160:163], v[100:103], a[28:31], v[160:163]
    ds_read_b128 v[40:43], v36 offset:0
    v_cvt_pk_bf16_f32 v6, v178, v182
    v_mfma_f32_16x16x32_bf16 v[164:167], v[72:75], a[32:35], v[228:231]
    ds_read_b128 v[44:47], v36 offset:1024
    v_cvt_pk_bf16_f32 v7, v186, v190
    v_mfma_f32_16x16x32_bf16 v[164:167], v[76:79], a[36:39], v[164:167]
    buffer_store_dwordx2 v[6:7], v31, s[40:43], s73 offen sc1
    v_mfma_f32_16x16x32_bf16 v[164:167], v[80:83], a[40:43], v[164:167]
    ds_read_b128 v[48:51], v36 offset:2048
    v_cvt_pk_bf16_f32 v8, v179, v183
    v_mfma_f32_16x16x32_bf16 v[164:167], v[84:87], a[44:47], v[164:167]
    ds_read_b128 v[52:55], v36 offset:3072
    v_cvt_pk_bf16_f32 v9, v187, v191
    v_mfma_f32_16x16x32_bf16 v[164:167], v[88:91], a[48:51], v[164:167]
    buffer_store_dwordx2 v[8:9], v11, s[40:43], s73 offen sc1
    v_mfma_f32_16x16x32_bf16 v[164:167], v[92:95], a[52:55], v[164:167]
    ds_read_b128 v[56:59], v36 offset:4096
    v_mfma_f32_16x16x32_bf16 v[164:167], v[96:99], a[56:59], v[164:167]
    ds_read_b128 v[60:63], v36 offset:5120
    v_mfma_f32_16x16x32_bf16 v[164:167], v[100:103], a[60:63], v[164:167]
    ds_read_b128 v[64:67], v36 offset:6144
    v_mfma_f32_16x16x32_bf16 v[168:171], v[72:75], a[64:67], v[232:235]
    ds_read_b128 v[68:71], v36 offset:7168
    v_mfma_f32_16x16x32_bf16 v[168:171], v[76:79], a[68:71], v[168:171]
    v_mfma_f32_16x16x32_bf16 v[168:171], v[80:83], a[72:75], v[168:171]
    v_mfma_f32_16x16x32_bf16 v[168:171], v[84:87], a[76:79], v[168:171]
    v_mfma_f32_16x16x32_bf16 v[168:171], v[88:91], a[80:83], v[168:171]
    v_mfma_f32_16x16x32_bf16 v[168:171], v[92:95], a[84:87], v[168:171]
    v_mfma_f32_16x16x32_bf16 v[168:171], v[96:99], a[88:91], v[168:171]
    v_mfma_f32_16x16x32_bf16 v[168:171], v[100:103], a[92:95], v[168:171]
    v_mfma_f32_16x16x32_bf16 v[172:175], v[72:75], a[96:99], v[236:239]
    v_mfma_f32_16x16x32_bf16 v[172:175], v[76:79], a[100:103], v[172:175]
    v_mfma_f32_16x16x32_bf16 v[172:175], v[80:83], a[104:107], v[172:175]
    v_mfma_f32_16x16x32_bf16 v[172:175], v[84:87], a[108:111], v[172:175]
    v_mfma_f32_16x16x32_bf16 v[172:175], v[88:91], a[112:115], v[172:175]
    v_mfma_f32_16x16x32_bf16 v[172:175], v[92:95], a[116:119], v[172:175]
    v_mfma_f32_16x16x32_bf16 v[172:175], v[96:99], a[120:123], v[172:175]
    v_mfma_f32_16x16x32_bf16 v[172:175], v[100:103], a[124:127], v[172:175]
    s_waitcnt lgkmcnt(0)
    v_mfma_f32_16x16x32_bf16 v[176:179], v[40:43], a[0:3], v[224:227]
    v_mfma_f32_16x16x32_bf16 v[176:179], v[44:47], a[4:7], v[176:179]
    s_add_u32 s73, s71, 3072
    v_mfma_f32_16x16x32_bf16 v[176:179], v[48:51], a[8:11], v[176:179]
    v_mfma_f32_16x16x32_bf16 v[176:179], v[52:55], a[12:15], v[176:179]
    v_mfma_f32_16x16x32_bf16 v[176:179], v[56:59], a[16:19], v[176:179]
    v_cvt_pk_bf16_f32 v2, v160, v164
    v_cvt_pk_bf16_f32 v3, v168, v172
    v_cvt_pk_bf16_f32 v4, v161, v165
    v_mfma_f32_16x16x32_bf16 v[176:179], v[60:63], a[20:23], v[176:179]
    buffer_store_dwordx2 v[2:3], v27, s[40:43], s73 offen sc1
    v_mfma_f32_16x16x32_bf16 v[176:179], v[64:67], a[24:27], v[176:179]
    v_cvt_pk_bf16_f32 v5, v169, v173
    v_cvt_pk_bf16_f32 v6, v162, v166
    v_mfma_f32_16x16x32_bf16 v[176:179], v[68:71], a[28:31], v[176:179]
    buffer_store_dwordx2 v[4:5], v30, s[40:43], s73 offen sc1
    v_mfma_f32_16x16x32_bf16 v[180:183], v[40:43], a[32:35], v[228:231]
    v_cvt_pk_bf16_f32 v7, v170, v174
    v_cvt_pk_bf16_f32 v8, v163, v167
    v_mfma_f32_16x16x32_bf16 v[180:183], v[44:47], a[36:39], v[180:183]
    buffer_store_dwordx2 v[6:7], v31, s[40:43], s73 offen sc1
    v_mfma_f32_16x16x32_bf16 v[180:183], v[48:51], a[40:43], v[180:183]
    v_cvt_pk_bf16_f32 v9, v171, v175
    v_mfma_f32_16x16x32_bf16 v[180:183], v[52:55], a[44:47], v[180:183]
    buffer_store_dwordx2 v[8:9], v11, s[40:43], s73 offen sc1
    v_mfma_f32_16x16x32_bf16 v[180:183], v[56:59], a[48:51], v[180:183]
    v_mfma_f32_16x16x32_bf16 v[180:183], v[60:63], a[52:55], v[180:183]
    v_mfma_f32_16x16x32_bf16 v[180:183], v[64:67], a[56:59], v[180:183]
    v_mfma_f32_16x16x32_bf16 v[180:183], v[68:71], a[60:63], v[180:183]
    v_mfma_f32_16x16x32_bf16 v[184:187], v[40:43], a[64:67], v[232:235]
    v_mfma_f32_16x16x32_bf16 v[184:187], v[44:47], a[68:71], v[184:187]
    v_mfma_f32_16x16x32_bf16 v[184:187], v[48:51], a[72:75], v[184:187]
    v_mfma_f32_16x16x32_bf16 v[184:187], v[52:55], a[76:79], v[184:187]
    v_mfma_f32_16x16x32_bf16 v[184:187], v[56:59], a[80:83], v[184:187]
    v_mfma_f32_16x16x32_bf16 v[184:187], v[60:63], a[84:87], v[184:187]
    v_mfma_f32_16x16x32_bf16 v[184:187], v[64:67], a[88:91], v[184:187]
    v_mfma_f32_16x16x32_bf16 v[184:187], v[68:71], a[92:95], v[184:187]
    v_mfma_f32_16x16x32_bf16 v[188:191], v[40:43], a[96:99], v[236:239]
    v_mfma_f32_16x16x32_bf16 v[188:191], v[44:47], a[100:103], v[188:191]
    v_mfma_f32_16x16x32_bf16 v[188:191], v[48:51], a[104:107], v[188:191]
    v_mfma_f32_16x16x32_bf16 v[188:191], v[52:55], a[108:111], v[188:191]
    v_mfma_f32_16x16x32_bf16 v[188:191], v[56:59], a[112:115], v[188:191]
    v_mfma_f32_16x16x32_bf16 v[188:191], v[60:63], a[116:119], v[188:191]
    v_mfma_f32_16x16x32_bf16 v[188:191], v[64:67], a[120:123], v[188:191]
    v_mfma_f32_16x16x32_bf16 v[188:191], v[68:71], a[124:127], v[188:191]
    s_nop 7
    s_add_u32 s73, s71, 3584
    v_cvt_pk_bf16_f32 v2, v176, v180
    v_cvt_pk_bf16_f32 v3, v184, v188
    buffer_store_dwordx2 v[2:3], v27, s[40:43], s73 offen sc1
    v_cvt_pk_bf16_f32 v4, v177, v181
    v_cvt_pk_bf16_f32 v5, v185, v189
    buffer_store_dwordx2 v[4:5], v30, s[40:43], s73 offen sc1
    v_cvt_pk_bf16_f32 v6, v178, v182
    v_cvt_pk_bf16_f32 v7, v186, v190
    buffer_store_dwordx2 v[6:7], v31, s[40:43], s73 offen sc1
    v_cvt_pk_bf16_f32 v8, v179, v183
    v_cvt_pk_bf16_f32 v9, v187, v191
    buffer_store_dwordx2 v[8:9], v11, s[40:43], s73 offen sc1
    s_branch L_fin
    s_endpgm
.fill 5120, 4, 0xbf810000
.section .rodata,"a"
.p2align 6
.amdhsa_kernel standalone__seq2seq_rnn_t_joint__speech_kernel
  .amdhsa_next_free_vgpr 512
  .amdhsa_next_free_sgpr 102
  .amdhsa_accum_offset 256
  .amdhsa_group_segment_fixed_size 0
  .amdhsa_kernarg_size 80
  .amdhsa_user_sgpr_count 2
  .amdhsa_user_sgpr_kernarg_segment_ptr 1
  .amdhsa_system_sgpr_workgroup_id_x 1
  .amdhsa_float_denorm_mode_32 3
.end_amdhsa_kernel
```
